```python
import torch

def _softmax(x, axis=-1):
    return torch.softmax(x, dim=axis)

def _gelu(x):
    return torch.nn.functional.gelu(x, approximate='tanh')

def _silu(x):
    return torch.nn.functional.silu(x)

def _sigmoid(x):
    return torch.sigmoid(x)

def _layernorm(x, axis=-1, eps=1e-05):
    m = x.mean(dim=axis, keepdim=True)
    v = x.var(dim=axis, keepdim=True, unbiased=False)
    return (x - m) / torch.sqrt(v + eps)

def _scatter_add(tgt, idx, src, axis=0):
    return tgt.clone().index_add_(axis, idx, src)

def _segment_sum(src, seg, n):
    out = torch.zeros((n,) + src.shape[1:], dtype=src.dtype)
    return out.index_add_(0, seg, src)

def _pad(x, pw):
    flat = tuple((v for pair in reversed(pw) for v in pair))
    return torch.nn.functional.pad(x, flat)
kernel_name = 'gated_mix__memory_aug_recurrent_mem_tr__ssm_conv_s4__prompt'

def setup_inputs():

    _w = lambda a: (lambda t: t.to(torch.bfloat16) if t.is_floating_point() else t)(torch.as_tensor(a))

    def _A_setup():
        B, S, Dm = (1, 2048, 512)
        H, Dh = (32, 128)
        M, seg = (8, 32)
        seg = min(seg, S)
        S = S // seg * seg
        return {'x': _w((lambda *s: torch.randn(*s, dtype=torch.bfloat16) * 0.05)(B, S, Dm)), 'mem0': _w((lambda *s: torch.randn(*s, dtype=torch.bfloat16) * 0.4)(B, M, Dm)), 'Wq': _w((lambda *s: torch.randn(*s, dtype=torch.bfloat16) * 6.4)(Dm, H, Dh) * Dm ** (-0.5)), 'Wk': _w((lambda *s: torch.randn(*s, dtype=torch.bfloat16) * 6.4)(Dm, H, Dh) * Dm ** (-0.5)), 'Wv': _w((lambda *s: torch.randn(*s, dtype=torch.bfloat16) * 0.4)(Dm, H, Dh) * Dm ** (-0.5)), 'Wo': _w((lambda *s: torch.randn(*s, dtype=torch.bfloat16) * 0.4)(H, Dh, Dm) * (H * Dh) ** (-0.5)), 'seg_len': seg}
    _A_in = _A_setup()

    def _B_setup():
        B, L, D, N = (1, 2048, 512, 128)
        A_re = -(lambda _x: torch.exp(torch.as_tensor(_x)))((lambda *s: torch.randn(*s, dtype=torch.bfloat16) * 6.4)(D, N))
        A_im = torch.pi * (lambda *s: torch.randn(*s, dtype=torch.bfloat16) * 0.05)(D, N)
        B_re = (lambda *s: torch.randn(*s, dtype=torch.bfloat16) * 0.1)(D, N)
        B_im = (lambda *s: torch.randn(*s, dtype=torch.bfloat16) * 0.1)(D, N)
        C_re = (lambda *s: torch.randn(*s, dtype=torch.bfloat16) * 0.1)(D, N)
        C_im = (lambda *s: torch.randn(*s, dtype=torch.bfloat16) * 0.1)(D, N)
        log_dt = (lambda *s: torch.randn(*s, dtype=torch.bfloat16) * 0.05)(D) * 0.5 - 4.0
        Dskip = (lambda *s: torch.randn(*s, dtype=torch.bfloat16) * 0.05)(D)
        return {'u': _w((lambda *s: torch.randn(*s, dtype=torch.bfloat16) * 0.05)(B, L, D)), 'A_re': _w(A_re), 'A_im': _w(A_im), 'B_re': _w(B_re), 'B_im': _w(B_im), 'C_re': _w(C_re), 'C_im': _w(C_im), 'log_dt': _w(log_dt), 'Dskip': _w(Dskip)}
    _B_in = _B_setup()
    return {'A_x': _A_in['x'], 'A_mem0': _A_in['mem0'], 'A_Wq': _A_in['Wq'], 'A_Wk': _A_in['Wk'], 'A_Wv': _A_in['Wv'], 'A_Wo': _A_in['Wo'], 'A_seg_len': _A_in['seg_len'], 'B_u': _B_in['u'], 'B_A_re': _B_in['A_re'], 'B_A_im': _B_in['A_im'], 'B_B_re': _B_in['B_re'], 'B_B_im': _B_in['B_im'], 'B_C_re': _B_in['C_re'], 'B_C_im': _B_in['C_im'], 'B_log_dt': _B_in['log_dt'], 'B_Dskip': _B_in['Dskip'], 'gate_w': _w((lambda *s: torch.randn(*s, dtype=torch.bfloat16) * 0.05)(512) * 16.0)}

def reference(A_x, A_mem0, A_Wq, A_Wk, A_Wv, A_Wo, A_seg_len, B_u, B_A_re, B_A_im, B_B_re, B_B_im, B_C_re, B_C_im, B_log_dt, B_Dskip, gate_w):

    def _A_ref(x, mem0, Wq, Wk, Wv, Wo, seg_len):
        B, S, Dm = x.shape
        H, Dh = (Wq.shape[1], Wq.shape[2])
        M = mem0.shape[1]
        scale = Dh ** (-0.5)
        n_seg = S // seg_len
        L = M + seg_len
        idx = torch.arange(L)
        mask = (idx[:, None] < M) | (idx[:, None] >= idx[None, :])
        mem = mem0
        outs = []
        for s in range(n_seg):
            xs = x[:, s * seg_len:(s + 1) * seg_len, :].clone()
            h = torch.concatenate([mem, xs], axis=1)
            q = torch.einsum('btd,dhe->bhte', h, Wq)
            k = torch.einsum('btd,dhe->bhte', h, Wk)
            v = torch.einsum('btd,dhe->bhte', h, Wv)
            scores = torch.einsum('bhqe,bhke->bhqk', q, k) * scale
            scores = torch.where(mask[None, None], scores, -1000000000.0)
            p = _softmax(scores, axis=-1)
            o = torch.einsum('bhqk,bhke->bhqe', p, v)
            o = torch.einsum('bhte,hed->btd', o, Wo)
            mem = o[:, :M, :].clone()
            outs.append(o[:, M:, :])
        return torch.concatenate(outs, axis=1)

    def _B_ref(u, A_re, A_im, B_re, B_im, C_re, C_im, log_dt, Dskip):
        Bsz, L, D = u.shape
        dt = torch.exp(log_dt)[:, None]
        A = A_re + 1j * A_im
        Bc = B_re + 1j * B_im
        Cc = C_re + 1j * C_im
        logdA = dt * A
        dB = dt * Bc
        l = (lambda x, dt: x.to(dt))(torch.arange(L), A_re.dtype)
        P = torch.exp(logdA[:, :, None] * l[None, None, :])
        K = torch.einsum('dn,dnl,dn->dl', Cc, P, dB).real
        L2 = 2 * L
        Kp = _pad(K, ((0, 0), (0, L)))
        up = (lambda x, *d: x.permute(*d))(u, 0, 2, 1)
        up = _pad(up, ((0, 0), (0, 0), (0, L)))
        Kf = (lambda x, axes=(-2, -1): torch.fft.rfft2(x.float(), dim=axes))(Kp[:, None, :], axes=(-2, -1))
        Uf = (lambda x, axes=(-2, -1): torch.fft.rfft2(x.float(), dim=axes))(up[:, :, None, :], axes=(-2, -1))
        Yf = Uf * Kf[None, :, :, :]
        y = (lambda x, s, axes=(-2, -1): torch.fft.irfft2(x, s=s, dim=axes).to(torch.bfloat16))(Yf, (1, L2), axes=(-2, -1))[:, :, 0, :L]
        y = (lambda x, *d: x.permute(*d))(y, 0, 2, 1) + u * Dskip[None, None, :]
        return y
    x = A_x
    g = _sigmoid((x * gate_w).sum(-1, keepdims=True))
    a = _A_ref(x, A_mem0, A_Wq, A_Wk, A_Wv, A_Wo, A_seg_len)
    b = _B_ref(x, B_A_re, B_A_im, B_B_re, B_B_im, B_C_re, B_C_im, B_log_dt, B_Dskip)
    return g * a + (1 - g) * b
```

```asm
; @launch kernel=main_kernel grid=(256,1,1) block=(256,1,1) lds=163840
.amdgcn_target "amdgcn-amd-amdhsa--gfx950"
.text
.globl main_kernel
.p2align 8
.type main_kernel,@function
main_kernel:
    s_cmp_ge_u32 s2, 256
    s_cbranch_scc1 main_kernel_exit
    s_load_dwordx2 s[16:17], s[0:1], 144
    s_getreg_b32 s15, hwreg(HW_REG_XCC_ID)
    s_and_b32 s15, s15, 15
    v_lshrrev_b32 v1, 6, v0
    s_nop 0
    v_readfirstlane_b32 s13, v1
    v_and_b32 v7, 63, v0
    s_waitcnt lgkmcnt(0)
    s_mov_b32 s44, s16
    s_and_b32 s45, s17, 0xffff
    s_mov_b32 s46, 0x100
    s_mov_b32 s47, 0x00020000
    s_mov_b32 s92, 0
    s_cmp_lg_u32 s13, 0
    s_cbranch_scc1 main_kernel_role_wait
    s_mov_b64 exec, 1
    s_lshl_b32 s18, s15, 2
    v_mov_b32 v2, s18
    v_mov_b32 v3, 1
    buffer_atomic_add v3, v2, s[44:47], 0 offen sc0
    s_waitcnt vmcnt(0)
    v_readfirstlane_b32 s18, v3
    s_mov_b32 s12, 99
    s_cmp_gt_u32 s18, 31
    s_cbranch_scc1 main_kernel_role_pub
    s_cmp_lg_u32 s18, 31
    s_cbranch_scc1 main_kernel_role_poll
    s_add_u32 s19, s15, 1
    v_mov_b32 v4, s19
    v_mov_b32 v5, 0
    v_mov_b32 v2, 64
    buffer_atomic_cmpswap v[4:5], v2, s[44:47], 0 offen
    s_waitcnt vmcnt(0)
main_kernel_role_poll:
    s_mov_b32 s43, 24
    v_mov_b32 v2, 64
main_kernel_role_poll_loop:
    buffer_load_dword v4, v2, s[44:47], 0 offen sc1
    s_waitcnt vmcnt(0)
    v_readfirstlane_b32 s19, v4
    s_nop 0
    s_cmp_lg_u32 s19, 0
    s_cbranch_scc1 main_kernel_role_got
    s_sub_u32 s43, s43, 1
    s_cbranch_scc0 main_kernel_role_poll_loop
    v_mov_b32 v4, 0xff
    v_mov_b32 v5, 0
    buffer_atomic_cmpswap v[4:5], v2, s[44:47], 0 offen sc0
    s_waitcnt vmcnt(0)
    v_readfirstlane_b32 s19, v4
main_kernel_role_got:
    s_nop 0
    s_sub_u32 s19, s19, 1
    s_cmp_lg_u32 s19, s15
    s_cbranch_scc1 main_kernel_role_pub
    s_mov_b32 s12, s18
main_kernel_role_pub:
    v_mov_b32 v2, 30720
    v_mov_b32 v3, s12
    ds_write_b32 v2, v3
    s_waitcnt lgkmcnt(0)
    s_mov_b64 exec, -1
main_kernel_role_wait:
    s_barrier
    v_mov_b32 v2, 30720
    ds_read_b32 v3, v2
    s_waitcnt lgkmcnt(0)
    v_readfirstlane_b32 s12, v3
    s_barrier
main_kernel_role_end:
    s_mov_b32 s101, 0
    s_cmp_gt_u32 s12, 31
    s_cbranch_scc1 main_kernel_worker
main_kernel_chain:
    s_load_dwordx16 s[52:67], s[0:1], 0
    s_load_dwordx2 s[50:51], s[0:1], 152
    s_waitcnt lgkmcnt(0)
    s_mov_b32 s4, s50
    s_and_b32 s5, s51, 0xffff
    s_mov_b32 s6, 0x10000000
    s_mov_b32 s7, 0x00020000
    v_and_b32 v1, 15, v7
    v_lshrrev_b32 v2, 4, v7
    v_lshlrev_b32 v116, 4, v7
    v_and_b32 v3, 2, v1
    v_cmp_eq_u32 vcc, 0, v3
    v_mov_b32 v3, 0xeeee
    v_mov_b32 v4, 0x4444
    v_cndmask_b32 v104, v3, v4, vcc
    v_mov_b32 v106, 0x3f803f80
    v_mov_b32 v107, 0x3f803f80
    v_mov_b32 v108, 0x3f803f80
    v_mov_b32 v109, 0x3f803f80
    v_cmp_gt_u32 vcc, 32, v7
    v_mov_b32 v3, 0xff800000
    v_mov_b32 v4, 0
    v_cndmask_b32 v126, v3, v4, vcc
    s_lshl_b32 s15, s13, 15
    s_add_u32 s15, s15, 32768
    v_add_u32 v117, s15, v116
    s_lshl_b32 s15, s13, 10
    s_add_u32 s15, s15, 24576
    v_lshlrev_b32 v3, 5, v1
    v_lshl_add_u32 v3, v2, 3, v3
    v_add_u32 v118, s15, v3
    v_lshrrev_b32 v5, 2, v1
    v_and_b32 v6, 3, v1
    v_lshl_add_u32 v3, v2, 2, v5
    v_lshlrev_b32 v3, 5, v3
    v_lshl_add_u32 v3, v6, 3, v3
    v_add_u32 v119, 24576, v3
    v_lshl_add_u32 v3, v2, 3, v5
    v_lshlrev_b32 v3, 5, v3
    v_lshl_add_u32 v3, v6, 3, v3
    v_add_u32 v121, 28672, v3
    v_and_b32 v3, 1, v1
    v_lshl_add_u32 v3, v5, 1, v3
    v_lshlrev_b32 v3, 5, v3
    v_bfe_u32 v4, v1, 1, 1
    v_lshl_add_u32 v3, v4, 2, v3
    v_lshl_add_u32 v3, v2, 3, v3
    s_lshl_b32 s15, s13, 9
    s_add_u32 s15, s15, 28672
    v_add_u32 v120, s15, v3
    v_lshrrev_b32 v3, 5, v7
    v_lshlrev_b32 v3, 13, v3
    v_and_b32 v4, 1, v2
    v_lshl_add_u32 v3, v4, 7, v3
    v_lshl_add_u32 v3, v1, 3, v3
    s_lshl_b32 s15, s13, 14
    s_lshl_b32 s16, s12, 8
    s_add_u32 s15, s15, s16
    v_add_u32 v122, s15, v3
    v_lshrrev_b32 v3, 2, v7
    v_lshlrev_b32 v3, 8, v3
    v_lshl_add_u32 v3, v6, 4, v3
    s_lshl_b32 s15, s12, 13
    s_lshl_b32 s16, s13, 6
    s_add_u32 s15, s15, s16
    v_add_u32 v123, s15, v3
    s_lshl_b32 s15, s13, 11
    v_add_u32 v124, s15, v116
    v_lshlrev_b32 v3, 8, v2
    v_and_b32 v4, 1, v7
    v_lshl_add_u32 v3, v4, 5, v3
    v_bfe_u32 v4, v7, 1, 1
    v_lshl_add_u32 v3, v4, 2, v3
    s_lshr_b32 s15, s12, 1
    s_lshl_b32 s15, s15, 9
    s_and_b32 s16, s12, 1
    s_lshl_b32 s16, s16, 7
    s_add_u32 s15, s15, s16
    s_lshr_b32 s16, s13, 1
    s_lshl_b32 s16, s16, 6
    s_add_u32 s15, s15, s16
    s_and_b32 s16, s13, 1
    s_lshl_b32 s16, s16, 3
    s_add_u32 s15, s15, s16
    v_add_u32 v125, s15, v3
    v_mov_b32 v110, 0x3f803f80
    v_mov_b32 v111, 0
    v_and_b32 v3, 1, v1
    v_lshlrev_b32 v3, 2, v3
    v_lshl_add_u32 v3, v5, 1, v3
    v_bfe_u32 v4, v1, 1, 1
    v_add_u32 v3, v3, v4
    v_cmp_gt_u32 vcc, 8, v1
    v_mov_b32 v4, 99
    s_nop 0
    v_cndmask_b32 v3, v4, v3, vcc
    v_mov_b32 v8, 0x3f80
    v_mov_b32 v9, 0x3f800000
    v_mov_b32 v10, 0
    v_cmp_eq_u32 vcc, 0, v3
    s_nop 1
    v_cndmask_b32 v4, v10, v8, vcc
    v_cmp_eq_u32 vcc, 1, v3
    s_nop 1
    v_cndmask_b32 v112, v4, v9, vcc
    v_cmp_eq_u32 vcc, 2, v3
    s_nop 1
    v_cndmask_b32 v4, v10, v8, vcc
    v_cmp_eq_u32 vcc, 3, v3
    s_nop 1
    v_cndmask_b32 v113, v4, v9, vcc
    v_cmp_eq_u32 vcc, 4, v3
    s_nop 1
    v_cndmask_b32 v4, v10, v8, vcc
    v_cmp_eq_u32 vcc, 5, v3
    s_nop 1
    v_cndmask_b32 v114, v4, v9, vcc
    v_cmp_eq_u32 vcc, 6, v3
    s_nop 1
    v_cndmask_b32 v4, v10, v8, vcc
    v_cmp_eq_u32 vcc, 7, v3
    s_nop 1
    v_cndmask_b32 v115, v4, v9, vcc
    s_mov_b32 s73, 0
    s_cmp_eq_u32 s12, 0
    s_cselect_b32 s72, -1, 1
    s_lshl_b32 s15, s12, 7
    s_add_u32 s15, s15, 0x4304000
    s_cmp_eq_u32 s12, 0
    s_cselect_b32 s74, 0x4300000, s15
    s_mov_b32 s20, 0x4000000
    s_mov_b32 s21, 0x4010000
    s_mov_b32 s22, 0x4020000
    s_mov_b32 s23, 0x4030000
    s_mov_b32 s28, 0x4000000
    s_mov_b32 s29, 0x4001000
    s_mov_b32 s32, 0x4080000
    s_mov_b32 s24, 0x4040000
    s_mov_b32 s25, 0x4050000
    s_mov_b32 s26, 0x4060000
    s_mov_b32 s27, 0x4070000
    s_mov_b32 s30, 0x4040000
    s_mov_b32 s31, 0x4041000
    s_mov_b32 s33, 0x4082000
    s_mov_b32 s38, 0x00003f80
    s_mov_b32 s39, 0x3f800000
    s_mov_b32 s40, 0x000f000f
    s_mov_b32 s41, 0
    s_mov_b32 s42, 0x3e0293ee
    s_mov_b32 s48, 0
    s_mov_b32 s49, -1
    v_mov_b64 v[8:9], -1
    v_mov_b64 v[10:11], -1
    buffer_store_dwordx4 v[8:11], v123, s[4:7], s28 offen sc1
    buffer_store_dwordx4 v[8:11], v123, s[4:7], s29 offen sc1
    buffer_store_dwordx4 v[8:11], v123, s[4:7], s30 offen sc1
    buffer_store_dwordx4 v[8:11], v123, s[4:7], s31 offen sc1
    s_mov_b64 exec, s[40:41]
    buffer_store_dword v8, v125, s[4:7], s32 offen sc1
    buffer_store_dword v8, v125, s[4:7], s32 offen offset:16 sc1
    buffer_store_dword v8, v125, s[4:7], s33 offen sc1
    buffer_store_dword v8, v125, s[4:7], s33 offen offset:16 sc1
    s_mov_b64 exec, 7
    s_lshl_b32 s15, s12, 7
    s_add_u32 s15, s15, 0x4300000
    v_mov_b32 v9, s15
    s_lshl_b32 s15, s12, 8
    s_add_u32 s15, s15, 0x4300f80
    v_lshlrev_b32 v10, 7, v7
    v_add_u32 v10, s15, v10
    v_cmp_eq_u32 vcc, 0, v7
    s_nop 1
    v_cndmask_b32 v9, v10, v9, vcc
    v_mov_b32 v8, 0
    buffer_store_dword v8, v9, s[4:7], 0 offen sc1
    s_mov_b64 exec, 1
    v_mov_b32 v10, 88
    v_mov_b32 v11, s92
    buffer_atomic_add v11, v10, s[44:47], 0 offen
    s_mov_b64 exec, -1
    s_nop 1
    v_and_b32 v60, 15, v0
    v_lshrrev_b32 v61, 4, v0
    v_lshlrev_b32 v62, 4, v60
    v_lshl_add_u32 v63, v61, 13, v62
    s_lshl_b32 s15, s12, 8
    v_add_u32 v63, s15, v63
    v_lshl_add_u32 v64, v61, 10, v62
    s_lshl_b32 s15, s12, 17
    v_add_u32 v64, s15, v64
    v_lshl_add_u32 v65, v61, 8, v62
    v_add_u32 v65, 0, v65
    v_lshl_add_u32 v3, v2, 3, v5
    v_lshlrev_b32 v3, 8, v3
    v_lshl_add_u32 v3, v6, 3, v3
    s_lshl_b32 s15, s13, 6
    s_add_u32 s15, s15, 0
    v_add_u32 v66, s15, v3
    s_lshl_b32 s15, s13, 5
    s_add_u32 s15, s15, 0
    v_add_u32 v67, s15, v3
    s_mov_b32 s76, s56
    s_and_b32 s77, s57, 0xffff
    s_mov_b32 s78, 0x400000
    s_mov_b32 s79, 0x00020000
    s_mov_b32 s80, s58
    s_and_b32 s81, s59, 0xffff
    s_mov_b32 s82, 0x400000
    s_mov_b32 s83, 0x00020000
    s_mov_b32 s84, s60
    s_and_b32 s85, s61, 0xffff
    s_mov_b32 s86, 0x400000
    s_mov_b32 s87, 0x00020000
    s_mov_b32 s88, s62
    s_and_b32 s89, s63, 0xffff
    s_mov_b32 s90, 0x400000
    s_mov_b32 s91, 0x00020000
    s_mov_b32 s8, s54
    s_and_b32 s9, s55, 0xffff
    s_mov_b32 s10, 0x2000
    s_mov_b32 s11, 0x00020000
    s_mov_b32 s15, 0x0
    buffer_load_dwordx4 v[8:11], v63, s[76:79], s15 offen
    s_mov_b32 s15, 0x20000
    buffer_load_dwordx4 v[12:15], v63, s[76:79], s15 offen
    s_mov_b32 s15, 0x40000
    buffer_load_dwordx4 v[16:19], v63, s[76:79], s15 offen
    s_mov_b32 s15, 0x60000
    buffer_load_dwordx4 v[20:23], v63, s[76:79], s15 offen
    s_mov_b32 s15, 0x80000
    buffer_load_dwordx4 v[24:27], v63, s[76:79], s15 offen
    s_mov_b32 s15, 0xa0000
    buffer_load_dwordx4 v[28:31], v63, s[76:79], s15 offen
    s_mov_b32 s15, 0xc0000
    buffer_load_dwordx4 v[32:35], v63, s[76:79], s15 offen
    s_mov_b32 s15, 0xe0000
    buffer_load_dwordx4 v[36:39], v63, s[76:79], s15 offen
    s_mov_b32 s15, 0x100000
    buffer_load_dwordx4 v[40:43], v63, s[76:79], s15 offen
    s_mov_b32 s15, 0x120000
    buffer_load_dwordx4 v[44:47], v63, s[76:79], s15 offen
    s_mov_b32 s15, 0x140000
    buffer_load_dwordx4 v[48:51], v63, s[76:79], s15 offen
    s_mov_b32 s15, 0x160000
    buffer_load_dwordx4 v[52:55], v63, s[76:79], s15 offen
    s_mov_b32 s15, 0x180000
    buffer_load_dwordx4 v[88:91], v63, s[76:79], s15 offen
    s_mov_b32 s15, 0x1a0000
    buffer_load_dwordx4 v[92:95], v63, s[76:79], s15 offen
    s_mov_b32 s15, 0x1c0000
    buffer_load_dwordx4 v[96:99], v63, s[76:79], s15 offen
    s_mov_b32 s15, 0x1e0000
    buffer_load_dwordx4 v[100:103], v63, s[76:79], s15 offen
    s_mov_b32 s15, 0x200000
    buffer_load_dwordx4 v[128:131], v63, s[76:79], s15 offen
    s_mov_b32 s15, 0x220000
    buffer_load_dwordx4 v[132:135], v63, s[76:79], s15 offen
    s_mov_b32 s15, 0x240000
    buffer_load_dwordx4 v[136:139], v63, s[76:79], s15 offen
    s_mov_b32 s15, 0x260000
    buffer_load_dwordx4 v[140:143], v63, s[76:79], s15 offen
    s_mov_b32 s15, 0x280000
    buffer_load_dwordx4 v[144:147], v63, s[76:79], s15 offen
    s_mov_b32 s15, 0x2a0000
    buffer_load_dwordx4 v[148:151], v63, s[76:79], s15 offen
    s_mov_b32 s15, 0x2c0000
    buffer_load_dwordx4 v[152:155], v63, s[76:79], s15 offen
    s_mov_b32 s15, 0x2e0000
    buffer_load_dwordx4 v[156:159], v63, s[76:79], s15 offen
    s_mov_b32 s15, 0x300000
    buffer_load_dwordx4 v[160:163], v63, s[76:79], s15 offen
    s_mov_b32 s15, 0x320000
    buffer_load_dwordx4 v[164:167], v63, s[76:79], s15 offen
    s_mov_b32 s15, 0x340000
    buffer_load_dwordx4 v[168:171], v63, s[76:79], s15 offen
    s_mov_b32 s15, 0x360000
    buffer_load_dwordx4 v[172:175], v63, s[76:79], s15 offen
    s_mov_b32 s15, 0x380000
    buffer_load_dwordx4 v[176:179], v63, s[76:79], s15 offen
    s_mov_b32 s15, 0x3a0000
    buffer_load_dwordx4 v[180:183], v63, s[76:79], s15 offen
    s_mov_b32 s15, 0x3c0000
    buffer_load_dwordx4 v[184:187], v63, s[76:79], s15 offen
    s_mov_b32 s15, 0x3e0000
    buffer_load_dwordx4 v[188:191], v63, s[76:79], s15 offen
    s_mov_b32 s15, 0x0
    buffer_load_dwordx4 v[192:195], v63, s[80:83], s15 offen
    s_mov_b32 s15, 0x20000
    buffer_load_dwordx4 v[196:199], v63, s[80:83], s15 offen
    s_mov_b32 s15, 0x40000
    buffer_load_dwordx4 v[200:203], v63, s[80:83], s15 offen
    s_mov_b32 s15, 0x60000
    buffer_load_dwordx4 v[204:207], v63, s[80:83], s15 offen
    s_waitcnt vmcnt(32)
    ds_write_b128 v65, v[8:11] offset:0
    ds_write_b128 v65, v[12:15] offset:4096
    ds_write_b128 v65, v[16:19] offset:8192
    ds_write_b128 v65, v[20:23] offset:12288
    s_waitcnt lgkmcnt(0)
    s_barrier
    ds_read_b64_tr_b16 a[0:1], v66 offset:0
    ds_read_b64_tr_b16 a[2:3], v66 offset:1024
    ds_read_b64_tr_b16 a[4:5], v66 offset:8192
    ds_read_b64_tr_b16 a[6:7], v66 offset:9216
    ds_read_b64_tr_b16 a[64:65], v66 offset:32
    ds_read_b64_tr_b16 a[66:67], v66 offset:1056
    ds_read_b64_tr_b16 a[68:69], v66 offset:8224
    ds_read_b64_tr_b16 a[70:71], v66 offset:9248
    s_mov_b32 s15, 0x80000
    buffer_load_dwordx4 v[8:11], v63, s[80:83], s15 offen
    s_mov_b32 s15, 0xa0000
    buffer_load_dwordx4 v[12:15], v63, s[80:83], s15 offen
    s_mov_b32 s15, 0xc0000
    buffer_load_dwordx4 v[16:19], v63, s[80:83], s15 offen
    s_mov_b32 s15, 0xe0000
    buffer_load_dwordx4 v[20:23], v63, s[80:83], s15 offen
    s_waitcnt vmcnt(32)
    ds_write_b128 v65, v[24:27] offset:16384
    ds_write_b128 v65, v[28:31] offset:20480
    ds_write_b128 v65, v[32:35] offset:24576
    ds_write_b128 v65, v[36:39] offset:28672
    s_waitcnt lgkmcnt(0)
    s_barrier
    s_cmp_lg_u32 s13, 0
    s_cbranch_scc1 main_kernel_noini
    s_mov_b64 exec, 1
    v_mov_b32 v84, 80
    v_mov_b32 v85, 1
    buffer_atomic_add v85, v84, s[44:47], 0 offen
    s_mov_b64 exec, -1
main_kernel_noini:
    ds_read_b64_tr_b16 a[8:9], v66 offset:16384
    ds_read_b64_tr_b16 a[10:11], v66 offset:17408
    ds_read_b64_tr_b16 a[12:13], v66 offset:24576
    ds_read_b64_tr_b16 a[14:15], v66 offset:25600
    ds_read_b64_tr_b16 a[72:73], v66 offset:16416
    ds_read_b64_tr_b16 a[74:75], v66 offset:17440
    ds_read_b64_tr_b16 a[76:77], v66 offset:24608
    ds_read_b64_tr_b16 a[78:79], v66 offset:25632
    s_mov_b32 s15, 0x100000
    buffer_load_dwordx4 v[24:27], v63, s[80:83], s15 offen
    s_mov_b32 s15, 0x120000
    buffer_load_dwordx4 v[28:31], v63, s[80:83], s15 offen
    s_mov_b32 s15, 0x140000
    buffer_load_dwordx4 v[32:35], v63, s[80:83], s15 offen
    s_mov_b32 s15, 0x160000
    buffer_load_dwordx4 v[36:39], v63, s[80:83], s15 offen
    s_waitcnt vmcnt(32)
    ds_write_b128 v65, v[40:43] offset:0
    ds_write_b128 v65, v[44:47] offset:4096
    ds_write_b128 v65, v[48:51] offset:8192
    ds_write_b128 v65, v[52:55] offset:12288
    s_waitcnt lgkmcnt(0)
    s_barrier
    ds_read_b64_tr_b16 a[16:17], v66 offset:0
    ds_read_b64_tr_b16 a[18:19], v66 offset:1024
    ds_read_b64_tr_b16 a[20:21], v66 offset:8192
    ds_read_b64_tr_b16 a[22:23], v66 offset:9216
    ds_read_b64_tr_b16 a[80:81], v66 offset:32
    ds_read_b64_tr_b16 a[82:83], v66 offset:1056
    ds_read_b64_tr_b16 a[84:85], v66 offset:8224
    ds_read_b64_tr_b16 a[86:87], v66 offset:9248
    s_mov_b32 s15, 0x180000
    buffer_load_dwordx4 v[40:43], v63, s[80:83], s15 offen
    s_mov_b32 s15, 0x1a0000
    buffer_load_dwordx4 v[44:47], v63, s[80:83], s15 offen
    s_mov_b32 s15, 0x1c0000
    buffer_load_dwordx4 v[48:51], v63, s[80:83], s15 offen
    s_mov_b32 s15, 0x1e0000
    buffer_load_dwordx4 v[52:55], v63, s[80:83], s15 offen
    s_waitcnt vmcnt(32)
    ds_write_b128 v65, v[88:91] offset:16384
    ds_write_b128 v65, v[92:95] offset:20480
    ds_write_b128 v65, v[96:99] offset:24576
    ds_write_b128 v65, v[100:103] offset:28672
    s_waitcnt lgkmcnt(0)
    s_barrier
    ds_read_b64_tr_b16 a[24:25], v66 offset:16384
    ds_read_b64_tr_b16 a[26:27], v66 offset:17408
    ds_read_b64_tr_b16 a[28:29], v66 offset:24576
    ds_read_b64_tr_b16 a[30:31], v66 offset:25600
    ds_read_b64_tr_b16 a[88:89], v66 offset:16416
    ds_read_b64_tr_b16 a[90:91], v66 offset:17440
    ds_read_b64_tr_b16 a[92:93], v66 offset:24608
    ds_read_b64_tr_b16 a[94:95], v66 offset:25632
    s_mov_b32 s15, 0x200000
    buffer_load_dwordx4 v[88:91], v63, s[80:83], s15 offen
    s_mov_b32 s15, 0x220000
    buffer_load_dwordx4 v[92:95], v63, s[80:83], s15 offen
    s_mov_b32 s15, 0x240000
    buffer_load_dwordx4 v[96:99], v63, s[80:83], s15 offen
    s_mov_b32 s15, 0x260000
    buffer_load_dwordx4 v[100:103], v63, s[80:83], s15 offen
    s_waitcnt vmcnt(32)
    ds_write_b128 v65, v[128:131] offset:0
    ds_write_b128 v65, v[132:135] offset:4096
    ds_write_b128 v65, v[136:139] offset:8192
    ds_write_b128 v65, v[140:143] offset:12288
    s_waitcnt lgkmcnt(0)
    s_barrier
    ds_read_b64_tr_b16 a[32:33], v66 offset:0
    ds_read_b64_tr_b16 a[34:35], v66 offset:1024
    ds_read_b64_tr_b16 a[36:37], v66 offset:8192
    ds_read_b64_tr_b16 a[38:39], v66 offset:9216
    ds_read_b64_tr_b16 a[96:97], v66 offset:32
    ds_read_b64_tr_b16 a[98:99], v66 offset:1056
    ds_read_b64_tr_b16 a[100:101], v66 offset:8224
    ds_read_b64_tr_b16 a[102:103], v66 offset:9248
    s_mov_b32 s15, 0x280000
    buffer_load_dwordx4 v[128:131], v63, s[80:83], s15 offen
    s_mov_b32 s15, 0x2a0000
    buffer_load_dwordx4 v[132:135], v63, s[80:83], s15 offen
    s_mov_b32 s15, 0x2c0000
    buffer_load_dwordx4 v[136:139], v63, s[80:83], s15 offen
    s_mov_b32 s15, 0x2e0000
    buffer_load_dwordx4 v[140:143], v63, s[80:83], s15 offen
    s_waitcnt vmcnt(32)
    ds_write_b128 v65, v[144:147] offset:16384
    ds_write_b128 v65, v[148:151] offset:20480
    ds_write_b128 v65, v[152:155] offset:24576
    ds_write_b128 v65, v[156:159] offset:28672
    s_waitcnt lgkmcnt(0)
    s_barrier
    ds_read_b64_tr_b16 a[40:41], v66 offset:16384
    ds_read_b64_tr_b16 a[42:43], v66 offset:17408
    ds_read_b64_tr_b16 a[44:45], v66 offset:24576
    ds_read_b64_tr_b16 a[46:47], v66 offset:25600
    ds_read_b64_tr_b16 a[104:105], v66 offset:16416
    ds_read_b64_tr_b16 a[106:107], v66 offset:17440
    ds_read_b64_tr_b16 a[108:109], v66 offset:24608
    ds_read_b64_tr_b16 a[110:111], v66 offset:25632
    s_mov_b32 s15, 0x300000
    buffer_load_dwordx4 v[144:147], v63, s[80:83], s15 offen
    s_mov_b32 s15, 0x320000
    buffer_load_dwordx4 v[148:151], v63, s[80:83], s15 offen
    s_mov_b32 s15, 0x340000
    buffer_load_dwordx4 v[152:155], v63, s[80:83], s15 offen
    s_mov_b32 s15, 0x360000
    buffer_load_dwordx4 v[156:159], v63, s[80:83], s15 offen
    s_waitcnt vmcnt(32)
    ds_write_b128 v65, v[160:163] offset:0
    ds_write_b128 v65, v[164:167] offset:4096
    ds_write_b128 v65, v[168:171] offset:8192
    ds_write_b128 v65, v[172:175] offset:12288
    s_waitcnt lgkmcnt(0)
    s_barrier
    ds_read_b64_tr_b16 a[48:49], v66 offset:0
    ds_read_b64_tr_b16 a[50:51], v66 offset:1024
    ds_read_b64_tr_b16 a[52:53], v66 offset:8192
    ds_read_b64_tr_b16 a[54:55], v66 offset:9216
    ds_read_b64_tr_b16 a[112:113], v66 offset:32
    ds_read_b64_tr_b16 a[114:115], v66 offset:1056
    ds_read_b64_tr_b16 a[116:117], v66 offset:8224
    ds_read_b64_tr_b16 a[118:119], v66 offset:9248
    s_mov_b32 s15, 0x380000
    buffer_load_dwordx4 v[160:163], v63, s[80:83], s15 offen
    s_mov_b32 s15, 0x3a0000
    buffer_load_dwordx4 v[164:167], v63, s[80:83], s15 offen
    s_mov_b32 s15, 0x3c0000
    buffer_load_dwordx4 v[168:171], v63, s[80:83], s15 offen
    s_mov_b32 s15, 0x3e0000
    buffer_load_dwordx4 v[172:175], v63, s[80:83], s15 offen
    s_waitcnt vmcnt(32)
    ds_write_b128 v65, v[176:179] offset:16384
    ds_write_b128 v65, v[180:183] offset:20480
    ds_write_b128 v65, v[184:187] offset:24576
    ds_write_b128 v65, v[188:191] offset:28672
    s_waitcnt lgkmcnt(0)
    s_barrier
    ds_read_b64_tr_b16 a[56:57], v66 offset:16384
    ds_read_b64_tr_b16 a[58:59], v66 offset:17408
    ds_read_b64_tr_b16 a[60:61], v66 offset:24576
    ds_read_b64_tr_b16 a[62:63], v66 offset:25600
    ds_read_b64_tr_b16 a[120:121], v66 offset:16416
    ds_read_b64_tr_b16 a[122:123], v66 offset:17440
    ds_read_b64_tr_b16 a[124:125], v66 offset:24608
    ds_read_b64_tr_b16 a[126:127], v66 offset:25632
    s_mov_b32 s15, 0x0
    buffer_load_dwordx4 v[208:211], v63, s[84:87], s15 offen
    s_mov_b32 s15, 0x20000
    buffer_load_dwordx4 v[212:215], v63, s[84:87], s15 offen
    s_mov_b32 s15, 0x40000
    buffer_load_dwordx4 v[216:219], v63, s[84:87], s15 offen
    s_mov_b32 s15, 0x60000
    buffer_load_dwordx4 v[220:223], v63, s[84:87], s15 offen
    s_waitcnt vmcnt(32)
    ds_write_b128 v65, v[192:195] offset:0
    ds_write_b128 v65, v[196:199] offset:4096
    ds_write_b128 v65, v[200:203] offset:8192
    ds_write_b128 v65, v[204:207] offset:12288
    s_waitcnt lgkmcnt(0)
    s_barrier
    ds_read_b64_tr_b16 a[128:129], v66 offset:0
    ds_read_b64_tr_b16 a[130:131], v66 offset:1024
    ds_read_b64_tr_b16 a[132:133], v66 offset:8192
    ds_read_b64_tr_b16 a[134:135], v66 offset:9216
    ds_read_b64_tr_b16 v[68:69], v66 offset:32
    ds_read_b64_tr_b16 v[70:71], v66 offset:1056
    ds_read_b64_tr_b16 v[72:73], v66 offset:8224
    ds_read_b64_tr_b16 v[74:75], v66 offset:9248
    s_waitcnt lgkmcnt(0)
    ds_write_b128 v117, v[68:71] offset:0
    ds_write_b128 v117, v[72:75] offset:1024
    s_mov_b32 s15, 0x80000
    buffer_load_dwordx4 v[192:195], v63, s[84:87], s15 offen
    s_mov_b32 s15, 0xa0000
    buffer_load_dwordx4 v[196:199], v63, s[84:87], s15 offen
    s_mov_b32 s15, 0xc0000
    buffer_load_dwordx4 v[200:203], v63, s[84:87], s15 offen
    s_mov_b32 s15, 0xe0000
    buffer_load_dwordx4 v[204:207], v63, s[84:87], s15 offen
    s_waitcnt vmcnt(32)
    ds_write_b128 v65, v[8:11] offset:16384
    ds_write_b128 v65, v[12:15] offset:20480
    ds_write_b128 v65, v[16:19] offset:24576
    ds_write_b128 v65, v[20:23] offset:28672
    s_waitcnt lgkmcnt(0)
    s_barrier
    ds_read_b64_tr_b16 a[136:137], v66 offset:16384
    ds_read_b64_tr_b16 a[138:139], v66 offset:17408
    ds_read_b64_tr_b16 a[140:141], v66 offset:24576
    ds_read_b64_tr_b16 a[142:143], v66 offset:25600
    ds_read_b64_tr_b16 v[68:69], v66 offset:16416
    ds_read_b64_tr_b16 v[70:71], v66 offset:17440
    ds_read_b64_tr_b16 v[72:73], v66 offset:24608
    ds_read_b64_tr_b16 v[74:75], v66 offset:25632
    s_waitcnt lgkmcnt(0)
    ds_write_b128 v117, v[68:71] offset:2048
    ds_write_b128 v117, v[72:75] offset:3072
    s_mov_b32 s15, 0x100000
    buffer_load_dwordx4 v[8:11], v63, s[84:87], s15 offen
    s_mov_b32 s15, 0x120000
    buffer_load_dwordx4 v[12:15], v63, s[84:87], s15 offen
    s_mov_b32 s15, 0x140000
    buffer_load_dwordx4 v[16:19], v63, s[84:87], s15 offen
    s_mov_b32 s15, 0x160000
    buffer_load_dwordx4 v[20:23], v63, s[84:87], s15 offen
    s_waitcnt vmcnt(32)
    ds_write_b128 v65, v[24:27] offset:0
    ds_write_b128 v65, v[28:31] offset:4096
    ds_write_b128 v65, v[32:35] offset:8192
    ds_write_b128 v65, v[36:39] offset:12288
    s_waitcnt lgkmcnt(0)
    s_barrier
    ds_read_b64_tr_b16 a[144:145], v66 offset:0
    ds_read_b64_tr_b16 a[146:147], v66 offset:1024
    ds_read_b64_tr_b16 a[148:149], v66 offset:8192
    ds_read_b64_tr_b16 a[150:151], v66 offset:9216
    ds_read_b64_tr_b16 v[68:69], v66 offset:32
    ds_read_b64_tr_b16 v[70:71], v66 offset:1056
    ds_read_b64_tr_b16 v[72:73], v66 offset:8224
    ds_read_b64_tr_b16 v[74:75], v66 offset:9248
    s_waitcnt lgkmcnt(0)
    ds_write_b128 v117, v[68:71] offset:4096
    ds_write_b128 v117, v[72:75] offset:5120
    s_mov_b32 s15, 0x180000
    buffer_load_dwordx4 v[24:27], v63, s[84:87], s15 offen
    s_mov_b32 s15, 0x1a0000
    buffer_load_dwordx4 v[28:31], v63, s[84:87], s15 offen
    s_mov_b32 s15, 0x1c0000
    buffer_load_dwordx4 v[32:35], v63, s[84:87], s15 offen
    s_mov_b32 s15, 0x1e0000
    buffer_load_dwordx4 v[36:39], v63, s[84:87], s15 offen
    s_waitcnt vmcnt(32)
    ds_write_b128 v65, v[40:43] offset:16384
    ds_write_b128 v65, v[44:47] offset:20480
    ds_write_b128 v65, v[48:51] offset:24576
    ds_write_b128 v65, v[52:55] offset:28672
    s_waitcnt lgkmcnt(0)
    s_barrier
    ds_read_b64_tr_b16 a[152:153], v66 offset:16384
    ds_read_b64_tr_b16 a[154:155], v66 offset:17408
    ds_read_b64_tr_b16 a[156:157], v66 offset:24576
    ds_read_b64_tr_b16 a[158:159], v66 offset:25600
    ds_read_b64_tr_b16 v[68:69], v66 offset:16416
    ds_read_b64_tr_b16 v[70:71], v66 offset:17440
    ds_read_b64_tr_b16 v[72:73], v66 offset:24608
    ds_read_b64_tr_b16 v[74:75], v66 offset:25632
    s_waitcnt lgkmcnt(0)
    ds_write_b128 v117, v[68:71] offset:6144
    ds_write_b128 v117, v[72:75] offset:7168
    s_mov_b32 s15, 0x200000
    buffer_load_dwordx4 v[40:43], v63, s[84:87], s15 offen
    s_mov_b32 s15, 0x220000
    buffer_load_dwordx4 v[44:47], v63, s[84:87], s15 offen
    s_mov_b32 s15, 0x240000
    buffer_load_dwordx4 v[48:51], v63, s[84:87], s15 offen
    s_mov_b32 s15, 0x260000
    buffer_load_dwordx4 v[52:55], v63, s[84:87], s15 offen
    s_waitcnt vmcnt(32)
    ds_write_b128 v65, v[88:91] offset:0
    ds_write_b128 v65, v[92:95] offset:4096
    ds_write_b128 v65, v[96:99] offset:8192
    ds_write_b128 v65, v[100:103] offset:12288
    s_waitcnt lgkmcnt(0)
    s_barrier
    ds_read_b64_tr_b16 a[160:161], v66 offset:0
    ds_read_b64_tr_b16 a[162:163], v66 offset:1024
    ds_read_b64_tr_b16 a[164:165], v66 offset:8192
    ds_read_b64_tr_b16 a[166:167], v66 offset:9216
    ds_read_b64_tr_b16 v[68:69], v66 offset:32
    ds_read_b64_tr_b16 v[70:71], v66 offset:1056
    ds_read_b64_tr_b16 v[72:73], v66 offset:8224
    ds_read_b64_tr_b16 v[74:75], v66 offset:9248
    s_waitcnt lgkmcnt(0)
    ds_write_b128 v117, v[68:71] offset:8192
    ds_write_b128 v117, v[72:75] offset:9216
    s_mov_b32 s15, 0x280000
    buffer_load_dwordx4 v[88:91], v63, s[84:87], s15 offen
    s_mov_b32 s15, 0x2a0000
    buffer_load_dwordx4 v[92:95], v63, s[84:87], s15 offen
    s_mov_b32 s15, 0x2c0000
    buffer_load_dwordx4 v[96:99], v63, s[84:87], s15 offen
    s_mov_b32 s15, 0x2e0000
    buffer_load_dwordx4 v[100:103], v63, s[84:87], s15 offen
    s_waitcnt vmcnt(32)
    ds_write_b128 v65, v[128:131] offset:16384
    ds_write_b128 v65, v[132:135] offset:20480
    ds_write_b128 v65, v[136:139] offset:24576
    ds_write_b128 v65, v[140:143] offset:28672
    s_waitcnt lgkmcnt(0)
    s_barrier
    ds_read_b64_tr_b16 a[168:169], v66 offset:16384
    ds_read_b64_tr_b16 a[170:171], v66 offset:17408
    ds_read_b64_tr_b16 a[172:173], v66 offset:24576
    ds_read_b64_tr_b16 a[174:175], v66 offset:25600
    ds_read_b64_tr_b16 v[68:69], v66 offset:16416
    ds_read_b64_tr_b16 v[70:71], v66 offset:17440
    ds_read_b64_tr_b16 v[72:73], v66 offset:24608
    ds_read_b64_tr_b16 v[74:75], v66 offset:25632
    s_waitcnt lgkmcnt(0)
    ds_write_b128 v117, v[68:71] offset:10240
    ds_write_b128 v117, v[72:75] offset:11264
    s_mov_b32 s15, 0x300000
    buffer_load_dwordx4 v[224:227], v63, s[84:87], s15 offen
    s_mov_b32 s15, 0x320000
    buffer_load_dwordx4 v[228:231], v63, s[84:87], s15 offen
    s_mov_b32 s15, 0x340000
    buffer_load_dwordx4 v[232:235], v63, s[84:87], s15 offen
    s_mov_b32 s15, 0x360000
    buffer_load_dwordx4 v[236:239], v63, s[84:87], s15 offen
    s_waitcnt vmcnt(32)
    ds_write_b128 v65, v[144:147] offset:0
    ds_write_b128 v65, v[148:151] offset:4096
    ds_write_b128 v65, v[152:155] offset:8192
    ds_write_b128 v65, v[156:159] offset:12288
    s_waitcnt lgkmcnt(0)
    s_barrier
    ds_read_b64_tr_b16 a[176:177], v66 offset:0
    ds_read_b64_tr_b16 a[178:179], v66 offset:1024
    ds_read_b64_tr_b16 a[180:181], v66 offset:8192
    ds_read_b64_tr_b16 a[182:183], v66 offset:9216
    ds_read_b64_tr_b16 v[68:69], v66 offset:32
    ds_read_b64_tr_b16 v[70:71], v66 offset:1056
    ds_read_b64_tr_b16 v[72:73], v66 offset:8224
    ds_read_b64_tr_b16 v[74:75], v66 offset:9248
    s_waitcnt lgkmcnt(0)
    ds_write_b128 v117, v[68:71] offset:12288
    ds_write_b128 v117, v[72:75] offset:13312
    s_mov_b32 s15, 0x380000
    buffer_load_dwordx4 v[240:243], v63, s[84:87], s15 offen
    s_mov_b32 s15, 0x3a0000
    buffer_load_dwordx4 v[244:247], v63, s[84:87], s15 offen
    s_mov_b32 s15, 0x3c0000
    buffer_load_dwordx4 v[248:251], v63, s[84:87], s15 offen
    s_mov_b32 s15, 0x3e0000
    buffer_load_dwordx4 v[252:255], v63, s[84:87], s15 offen
    s_waitcnt vmcnt(32)
    ds_write_b128 v65, v[160:163] offset:16384
    ds_write_b128 v65, v[164:167] offset:20480
    ds_write_b128 v65, v[168:171] offset:24576
    ds_write_b128 v65, v[172:175] offset:28672
    s_waitcnt lgkmcnt(0)
    s_barrier
    ds_read_b64_tr_b16 a[184:185], v66 offset:16384
    ds_read_b64_tr_b16 a[186:187], v66 offset:17408
    ds_read_b64_tr_b16 a[188:189], v66 offset:24576
    ds_read_b64_tr_b16 a[190:191], v66 offset:25600
    ds_read_b64_tr_b16 v[68:69], v66 offset:16416
    ds_read_b64_tr_b16 v[70:71], v66 offset:17440
    ds_read_b64_tr_b16 v[72:73], v66 offset:24608
    ds_read_b64_tr_b16 v[74:75], v66 offset:25632
    s_waitcnt lgkmcnt(0)
    ds_write_b128 v117, v[68:71] offset:14336
    ds_write_b128 v117, v[72:75] offset:15360
    s_waitcnt vmcnt(28)
    ds_write_b128 v65, v[208:211] offset:0
    ds_write_b128 v65, v[212:215] offset:4096
    ds_write_b128 v65, v[216:219] offset:8192
    ds_write_b128 v65, v[220:223] offset:12288
    s_waitcnt lgkmcnt(0)
    s_barrier
    ds_read_b64_tr_b16 a[192:193], v66 offset:0
    ds_read_b64_tr_b16 a[194:195], v66 offset:1024
    ds_read_b64_tr_b16 a[196:197], v66 offset:8192
    ds_read_b64_tr_b16 a[198:199], v66 offset:9216
    ds_read_b64_tr_b16 v[128:129], v66 offset:32
    ds_read_b64_tr_b16 v[130:131], v66 offset:1056
    ds_read_b64_tr_b16 v[132:133], v66 offset:8224
    ds_read_b64_tr_b16 v[134:135], v66 offset:9248
    s_waitcnt vmcnt(24)
    ds_write_b128 v65, v[192:195] offset:16384
    ds_write_b128 v65, v[196:199] offset:20480
    ds_write_b128 v65, v[200:203] offset:24576
    ds_write_b128 v65, v[204:207] offset:28672
    s_waitcnt lgkmcnt(0)
    s_barrier
    ds_read_b64_tr_b16 a[200:201], v66 offset:16384
    ds_read_b64_tr_b16 a[202:203], v66 offset:17408
    ds_read_b64_tr_b16 a[204:205], v66 offset:24576
    ds_read_b64_tr_b16 a[206:207], v66 offset:25600
    ds_read_b64_tr_b16 v[136:137], v66 offset:16416
    ds_read_b64_tr_b16 v[138:139], v66 offset:17440
    ds_read_b64_tr_b16 v[140:141], v66 offset:24608
    ds_read_b64_tr_b16 v[142:143], v66 offset:25632
    s_waitcnt vmcnt(20)
    ds_write_b128 v65, v[8:11] offset:0
    ds_write_b128 v65, v[12:15] offset:4096
    ds_write_b128 v65, v[16:19] offset:8192
    ds_write_b128 v65, v[20:23] offset:12288
    s_waitcnt lgkmcnt(0)
    s_barrier
    ds_read_b64_tr_b16 a[208:209], v66 offset:0
    ds_read_b64_tr_b16 a[210:211], v66 offset:1024
    ds_read_b64_tr_b16 a[212:213], v66 offset:8192
    ds_read_b64_tr_b16 a[214:215], v66 offset:9216
    ds_read_b64_tr_b16 v[144:145], v66 offset:32
    ds_read_b64_tr_b16 v[146:147], v66 offset:1056
    ds_read_b64_tr_b16 v[148:149], v66 offset:8224
    ds_read_b64_tr_b16 v[150:151], v66 offset:9248
    s_mov_b32 s15, 0x0
    buffer_load_dwordx4 v[8:11], v64, s[88:91], s15 offen
    s_mov_b32 s15, 0x4000
    buffer_load_dwordx4 v[12:15], v64, s[88:91], s15 offen
    s_mov_b32 s15, 0x8000
    buffer_load_dwordx4 v[16:19], v64, s[88:91], s15 offen
    s_mov_b32 s15, 0xc000
    buffer_load_dwordx4 v[20:23], v64, s[88:91], s15 offen
    s_waitcnt vmcnt(20)
    ds_write_b128 v65, v[24:27] offset:16384
    ds_write_b128 v65, v[28:31] offset:20480
    ds_write_b128 v65, v[32:35] offset:24576
    ds_write_b128 v65, v[36:39] offset:28672
    s_waitcnt lgkmcnt(0)
    s_barrier
    ds_read_b64_tr_b16 a[216:217], v66 offset:16384
    ds_read_b64_tr_b16 a[218:219], v66 offset:17408
    ds_read_b64_tr_b16 a[220:221], v66 offset:24576
    ds_read_b64_tr_b16 a[222:223], v66 offset:25600
    ds_read_b64_tr_b16 v[152:153], v66 offset:16416
    ds_read_b64_tr_b16 v[154:155], v66 offset:17440
    ds_read_b64_tr_b16 v[156:157], v66 offset:24608
    ds_read_b64_tr_b16 v[158:159], v66 offset:25632
    s_mov_b32 s15, 0x100
    buffer_load_dwordx4 v[24:27], v64, s[88:91], s15 offen
    s_mov_b32 s15, 0x4100
    buffer_load_dwordx4 v[28:31], v64, s[88:91], s15 offen
    s_mov_b32 s15, 0x8100
    buffer_load_dwordx4 v[32:35], v64, s[88:91], s15 offen
    s_mov_b32 s15, 0xc100
    buffer_load_dwordx4 v[36:39], v64, s[88:91], s15 offen
    s_waitcnt vmcnt(20)
    ds_write_b128 v65, v[40:43] offset:0
    ds_write_b128 v65, v[44:47] offset:4096
    ds_write_b128 v65, v[48:51] offset:8192
    ds_write_b128 v65, v[52:55] offset:12288
    s_waitcnt lgkmcnt(0)
    s_barrier
    ds_read_b64_tr_b16 a[224:225], v66 offset:0
    ds_read_b64_tr_b16 a[226:227], v66 offset:1024
    ds_read_b64_tr_b16 a[228:229], v66 offset:8192
    ds_read_b64_tr_b16 a[230:231], v66 offset:9216
    ds_read_b64_tr_b16 v[160:161], v66 offset:32
    ds_read_b64_tr_b16 v[162:163], v66 offset:1056
    ds_read_b64_tr_b16 v[164:165], v66 offset:8224
    ds_read_b64_tr_b16 v[166:167], v66 offset:9248
    s_mov_b32 s15, 0x200
    buffer_load_dwordx4 v[40:43], v64, s[88:91], s15 offen
    s_mov_b32 s15, 0x4200
    buffer_load_dwordx4 v[44:47], v64, s[88:91], s15 offen
    s_mov_b32 s15, 0x8200
    buffer_load_dwordx4 v[48:51], v64, s[88:91], s15 offen
    s_mov_b32 s15, 0xc200
    buffer_load_dwordx4 v[52:55], v64, s[88:91], s15 offen
    s_waitcnt vmcnt(20)
    ds_write_b128 v65, v[88:91] offset:16384
    ds_write_b128 v65, v[92:95] offset:20480
    ds_write_b128 v65, v[96:99] offset:24576
    ds_write_b128 v65, v[100:103] offset:28672
    s_waitcnt lgkmcnt(0)
    s_barrier
    ds_read_b64_tr_b16 a[232:233], v66 offset:16384
    ds_read_b64_tr_b16 a[234:235], v66 offset:17408
    ds_read_b64_tr_b16 a[236:237], v66 offset:24576
    ds_read_b64_tr_b16 a[238:239], v66 offset:25600
    ds_read_b64_tr_b16 v[168:169], v66 offset:16416
    ds_read_b64_tr_b16 v[170:171], v66 offset:17440
    ds_read_b64_tr_b16 v[172:173], v66 offset:24608
    ds_read_b64_tr_b16 v[174:175], v66 offset:25632
    s_mov_b32 s15, 0x300
    buffer_load_dwordx4 v[88:91], v64, s[88:91], s15 offen
    s_mov_b32 s15, 0x4300
    buffer_load_dwordx4 v[92:95], v64, s[88:91], s15 offen
    s_mov_b32 s15, 0x8300
    buffer_load_dwordx4 v[96:99], v64, s[88:91], s15 offen
    s_mov_b32 s15, 0xc300
    buffer_load_dwordx4 v[100:103], v64, s[88:91], s15 offen
    s_waitcnt vmcnt(20)
    ds_write_b128 v65, v[224:227] offset:0
    ds_write_b128 v65, v[228:231] offset:4096
    ds_write_b128 v65, v[232:235] offset:8192
    ds_write_b128 v65, v[236:239] offset:12288
    s_waitcnt lgkmcnt(0)
    s_barrier
    ds_read_b64_tr_b16 a[240:241], v66 offset:0
    ds_read_b64_tr_b16 a[242:243], v66 offset:1024
    ds_read_b64_tr_b16 a[244:245], v66 offset:8192
    ds_read_b64_tr_b16 a[246:247], v66 offset:9216
    ds_read_b64_tr_b16 v[176:177], v66 offset:32
    ds_read_b64_tr_b16 v[178:179], v66 offset:1056
    ds_read_b64_tr_b16 v[180:181], v66 offset:8224
    ds_read_b64_tr_b16 v[182:183], v66 offset:9248
    s_waitcnt vmcnt(16)
    ds_write_b128 v65, v[240:243] offset:16384
    ds_write_b128 v65, v[244:247] offset:20480
    ds_write_b128 v65, v[248:251] offset:24576
    ds_write_b128 v65, v[252:255] offset:28672
    s_waitcnt lgkmcnt(0)
    s_barrier
    ds_read_b64_tr_b16 a[248:249], v66 offset:16384
    ds_read_b64_tr_b16 a[250:251], v66 offset:17408
    ds_read_b64_tr_b16 a[252:253], v66 offset:24576
    ds_read_b64_tr_b16 a[254:255], v66 offset:25600
    ds_read_b64_tr_b16 v[184:185], v66 offset:16416
    ds_read_b64_tr_b16 v[186:187], v66 offset:17440
    ds_read_b64_tr_b16 v[188:189], v66 offset:24608
    ds_read_b64_tr_b16 v[190:191], v66 offset:25632
    s_waitcnt vmcnt(12)
    ds_write_b128 v65, v[8:11] offset:0
    ds_write_b128 v65, v[12:15] offset:4096
    ds_write_b128 v65, v[16:19] offset:8192
    ds_write_b128 v65, v[20:23] offset:12288
    s_waitcnt lgkmcnt(0)
    s_barrier
    ds_read_b64_tr_b16 v[192:193], v66 offset:0
    ds_read_b64_tr_b16 v[194:195], v66 offset:1024
    ds_read_b64_tr_b16 v[196:197], v66 offset:8192
    ds_read_b64_tr_b16 v[198:199], v66 offset:9216
    ds_read_b64_tr_b16 v[208:209], v66 offset:32
    ds_read_b64_tr_b16 v[210:211], v66 offset:1056
    ds_read_b64_tr_b16 v[212:213], v66 offset:8224
    ds_read_b64_tr_b16 v[214:215], v66 offset:9248
    s_mov_b32 s15, 0x10000
    buffer_load_dwordx4 v[8:11], v64, s[88:91], s15 offen
    s_mov_b32 s15, 0x14000
    buffer_load_dwordx4 v[12:15], v64, s[88:91], s15 offen
    s_mov_b32 s15, 0x18000
    buffer_load_dwordx4 v[16:19], v64, s[88:91], s15 offen
    s_mov_b32 s15, 0x1c000
    buffer_load_dwordx4 v[20:23], v64, s[88:91], s15 offen
    s_waitcnt vmcnt(12)
    ds_write_b128 v65, v[24:27] offset:16384
    ds_write_b128 v65, v[28:31] offset:20480
    ds_write_b128 v65, v[32:35] offset:24576
    ds_write_b128 v65, v[36:39] offset:28672
    s_waitcnt lgkmcnt(0)
    s_barrier
    ds_read_b64_tr_b16 v[224:225], v66 offset:16384
    ds_read_b64_tr_b16 v[226:227], v66 offset:17408
    ds_read_b64_tr_b16 v[228:229], v66 offset:24576
    ds_read_b64_tr_b16 v[230:231], v66 offset:25600
    ds_read_b64_tr_b16 v[240:241], v66 offset:16416
    ds_read_b64_tr_b16 v[242:243], v66 offset:17440
    ds_read_b64_tr_b16 v[244:245], v66 offset:24608
    ds_read_b64_tr_b16 v[246:247], v66 offset:25632
    s_mov_b32 s15, 0x10100
    buffer_load_dwordx4 v[24:27], v64, s[88:91], s15 offen
    s_mov_b32 s15, 0x14100
    buffer_load_dwordx4 v[28:31], v64, s[88:91], s15 offen
    s_mov_b32 s15, 0x18100
    buffer_load_dwordx4 v[32:35], v64, s[88:91], s15 offen
    s_mov_b32 s15, 0x1c100
    buffer_load_dwordx4 v[36:39], v64, s[88:91], s15 offen
    s_waitcnt vmcnt(12)
    ds_write_b128 v65, v[40:43] offset:0
    ds_write_b128 v65, v[44:47] offset:4096
    ds_write_b128 v65, v[48:51] offset:8192
    ds_write_b128 v65, v[52:55] offset:12288
    s_waitcnt lgkmcnt(0)
    s_barrier
    ds_read_b64_tr_b16 v[68:69], v66 offset:0
    ds_read_b64_tr_b16 v[70:71], v66 offset:1024
    ds_read_b64_tr_b16 v[72:73], v66 offset:8192
    ds_read_b64_tr_b16 v[74:75], v66 offset:9216
    ds_read_b64_tr_b16 v[76:77], v66 offset:32
    ds_read_b64_tr_b16 v[78:79], v66 offset:1056
    ds_read_b64_tr_b16 v[80:81], v66 offset:8224
    ds_read_b64_tr_b16 v[82:83], v66 offset:9248
    s_waitcnt lgkmcnt(0)
    ds_write_b128 v117, v[68:71] offset:16384
    ds_write_b128 v117, v[72:75] offset:17408
    ds_write_b128 v117, v[76:79] offset:20480
    ds_write_b128 v117, v[80:83] offset:21504
    s_mov_b32 s15, 0x10200
    buffer_load_dwordx4 v[40:43], v64, s[88:91], s15 offen
    s_mov_b32 s15, 0x14200
    buffer_load_dwordx4 v[44:47], v64, s[88:91], s15 offen
    s_mov_b32 s15, 0x18200
    buffer_load_dwordx4 v[48:51], v64, s[88:91], s15 offen
    s_mov_b32 s15, 0x1c200
    buffer_load_dwordx4 v[52:55], v64, s[88:91], s15 offen
    s_waitcnt vmcnt(12)
    ds_write_b128 v65, v[88:91] offset:16384
    ds_write_b128 v65, v[92:95] offset:20480
    ds_write_b128 v65, v[96:99] offset:24576
    ds_write_b128 v65, v[100:103] offset:28672
    s_waitcnt lgkmcnt(0)
    s_barrier
    ds_read_b64_tr_b16 v[68:69], v66 offset:16384
    ds_read_b64_tr_b16 v[70:71], v66 offset:17408
    ds_read_b64_tr_b16 v[72:73], v66 offset:24576
    ds_read_b64_tr_b16 v[74:75], v66 offset:25600
    ds_read_b64_tr_b16 v[76:77], v66 offset:16416
    ds_read_b64_tr_b16 v[78:79], v66 offset:17440
    ds_read_b64_tr_b16 v[80:81], v66 offset:24608
    ds_read_b64_tr_b16 v[82:83], v66 offset:25632
    s_waitcnt lgkmcnt(0)
    ds_write_b128 v117, v[68:71] offset:24576
    ds_write_b128 v117, v[72:75] offset:25600
    ds_write_b128 v117, v[76:79] offset:28672
    ds_write_b128 v117, v[80:83] offset:29696
    s_mov_b32 s15, 0x10300
    buffer_load_dwordx4 v[88:91], v64, s[88:91], s15 offen
    s_mov_b32 s15, 0x14300
    buffer_load_dwordx4 v[92:95], v64, s[88:91], s15 offen
    s_mov_b32 s15, 0x18300
    buffer_load_dwordx4 v[96:99], v64, s[88:91], s15 offen
    s_mov_b32 s15, 0x1c300
    buffer_load_dwordx4 v[100:103], v64, s[88:91], s15 offen
    s_waitcnt vmcnt(12)
    ds_write_b128 v65, v[8:11] offset:0
    ds_write_b128 v65, v[12:15] offset:4096
    ds_write_b128 v65, v[16:19] offset:8192
    ds_write_b128 v65, v[20:23] offset:12288
    s_waitcnt lgkmcnt(0)
    s_barrier
    ds_read_b64_tr_b16 v[200:201], v66 offset:0
    ds_read_b64_tr_b16 v[202:203], v66 offset:1024
    ds_read_b64_tr_b16 v[204:205], v66 offset:8192
    ds_read_b64_tr_b16 v[206:207], v66 offset:9216
    ds_read_b64_tr_b16 v[216:217], v66 offset:32
    ds_read_b64_tr_b16 v[218:219], v66 offset:1056
    ds_read_b64_tr_b16 v[220:221], v66 offset:8224
    ds_read_b64_tr_b16 v[222:223], v66 offset:9248
    s_waitcnt vmcnt(8)
    ds_write_b128 v65, v[24:27] offset:16384
    ds_write_b128 v65, v[28:31] offset:20480
    ds_write_b128 v65, v[32:35] offset:24576
    ds_write_b128 v65, v[36:39] offset:28672
    s_waitcnt lgkmcnt(0)
    s_barrier
    ds_read_b64_tr_b16 v[232:233], v66 offset:16384
    ds_read_b64_tr_b16 v[234:235], v66 offset:17408
    ds_read_b64_tr_b16 v[236:237], v66 offset:24576
    ds_read_b64_tr_b16 v[238:239], v66 offset:25600
    ds_read_b64_tr_b16 v[248:249], v66 offset:16416
    ds_read_b64_tr_b16 v[250:251], v66 offset:17440
    ds_read_b64_tr_b16 v[252:253], v66 offset:24608
    ds_read_b64_tr_b16 v[254:255], v66 offset:25632
    s_waitcnt vmcnt(4)
    ds_write_b128 v65, v[40:43] offset:0
    ds_write_b128 v65, v[44:47] offset:4096
    ds_write_b128 v65, v[48:51] offset:8192
    ds_write_b128 v65, v[52:55] offset:12288
    s_waitcnt lgkmcnt(0)
    s_barrier
    ds_read_b64_tr_b16 v[68:69], v66 offset:0
    ds_read_b64_tr_b16 v[70:71], v66 offset:1024
    ds_read_b64_tr_b16 v[72:73], v66 offset:8192
    ds_read_b64_tr_b16 v[74:75], v66 offset:9216
    ds_read_b64_tr_b16 v[76:77], v66 offset:32
    ds_read_b64_tr_b16 v[78:79], v66 offset:1056
    ds_read_b64_tr_b16 v[80:81], v66 offset:8224
    ds_read_b64_tr_b16 v[82:83], v66 offset:9248
    s_waitcnt lgkmcnt(0)
    ds_write_b128 v117, v[68:71] offset:18432
    ds_write_b128 v117, v[72:75] offset:19456
    ds_write_b128 v117, v[76:79] offset:22528
    ds_write_b128 v117, v[80:83] offset:23552
    s_waitcnt vmcnt(0)
    ds_write_b128 v65, v[88:91] offset:16384
    ds_write_b128 v65, v[92:95] offset:20480
    ds_write_b128 v65, v[96:99] offset:24576
    ds_write_b128 v65, v[100:103] offset:28672
    s_waitcnt lgkmcnt(0)
    s_barrier
    ds_read_b64_tr_b16 v[68:69], v66 offset:16384
    ds_read_b64_tr_b16 v[70:71], v66 offset:17408
    ds_read_b64_tr_b16 v[72:73], v66 offset:24576
    ds_read_b64_tr_b16 v[74:75], v66 offset:25600
    ds_read_b64_tr_b16 v[76:77], v66 offset:16416
    ds_read_b64_tr_b16 v[78:79], v66 offset:17440
    ds_read_b64_tr_b16 v[80:81], v66 offset:24608
    ds_read_b64_tr_b16 v[82:83], v66 offset:25632
    s_waitcnt lgkmcnt(0)
    ds_write_b128 v117, v[68:71] offset:26624
    ds_write_b128 v117, v[72:75] offset:27648
    ds_write_b128 v117, v[76:79] offset:30720
    ds_write_b128 v117, v[80:83] offset:31744
    s_waitcnt lgkmcnt(0)
    s_barrier
    v_mov_b32 v3, -1
    ds_write_b32 v111, v3 offset:30736
    ds_write_b32 v111, v3 offset:30740
    ds_write_b32 v111, v3 offset:30744
    ds_write_b32 v111, v3 offset:30748
    s_waitcnt lgkmcnt(0)
    s_barrier
    s_lshl_b32 s34, s12, 13
    s_add_u32 s35, s34, 0x1000000
    s_lshl_b32 s36, s12, 12
    s_lshl_b32 s15, s13, 10
    s_add_u32 s37, s36, s15
    s_add_u32 s37, s37, 0x3800000
    s_add_u32 s36, s36, 0x3000000
    s_lshl_b32 s15, s13, 11
    s_add_u32 s67, s15, 0
    s_add_u32 s68, s15, 8192
    s_mov_b32 s66, 0x4100000
    s_mov_b32 s14, 0
    s_mov_b32 s43, 0x200000
    v_lshrrev_b32 v127, 2, v116
main_kernel_w0:
    buffer_load_dword v126, v127, s[44:47], 0 offen sc1
    s_waitcnt vmcnt(0)
    v_readlane_b32 s18, v126, 20
    v_readlane_b32 s19, v126, 24
    s_lshl_b32 s18, s18, 1
    s_min_u32 s18, s18, s19
    s_cmp_ge_u32 s18, 64
    s_cbranch_scc1 main_kernel_w0ok
    s_sleep 4
    s_sub_u32 s43, s43, 1
    s_cbranch_scc0 main_kernel_w0
main_kernel_w0ok:
    v_readlane_b32 s93, v126, 22
    v_mov_b32 v126, 0
    s_mov_b32 s75, 2
    s_mov_b32 s69, 100
    s_mov_b32 m0, s67
    s_add_u32 s17, s34, 0x40000
    buffer_load_dwordx4 v124, s[4:7], s34 offen sc1 lds
    buffer_load_dwordx4 v124, s[4:7], s34 offen offset:1024 sc1 lds
    buffer_load_dwordx4 v[88:91], v124, s[4:7], s35 offen sc1
    buffer_load_dwordx4 v[92:95], v124, s[4:7], s35 offen offset:1024 sc1
    s_mov_b32 s34, s17
    s_add_u32 s35, s35, 0x40000
    v_and_b32 v3, 1, v1
    v_lshl_add_u32 v3, v5, 1, v3
    v_lshlrev_b32 v3, 10, v3
    v_lshl_add_u32 v3, v2, 5, v3
    v_bfe_u32 v4, v1, 1, 1
    v_lshl_add_u32 v3, v4, 2, v3
    s_lshl_b32 s15, s13, 8
    v_add_u32 v3, s15, v3
    buffer_load_dword v96, v3, s[8:11], 0 offen offset:0
    buffer_load_dword v97, v3, s[8:11], 0 offen offset:8
    buffer_load_dword v98, v3, s[8:11], 0 offen offset:16
    buffer_load_dword v99, v3, s[8:11], 0 offen offset:24
    buffer_load_dword v100, v3, s[8:11], 0 offen offset:128
    buffer_load_dword v101, v3, s[8:11], 0 offen offset:136
    buffer_load_dword v102, v3, s[8:11], 0 offen offset:144
    buffer_load_dword v103, v3, s[8:11], 0 offen offset:152
    v_mov_b32 v32, 0
    v_mov_b32 v33, 0
    v_mov_b32 v34, 0
    v_mov_b32 v35, 0
    v_mov_b32 v36, 0
    v_mov_b32 v37, 0
    v_mov_b32 v38, 0
    v_mov_b32 v39, 0
    v_mov_b32 v40, 0
    v_mov_b32 v41, 0
    v_mov_b32 v42, 0
    v_mov_b32 v43, 0
    v_mov_b32 v44, 0
    v_mov_b32 v45, 0
    v_mov_b32 v46, 0
    v_mov_b32 v47, 0
    v_mov_b32 v48, 0
    v_mov_b32 v49, 0
    v_mov_b32 v50, 0
    v_mov_b32 v51, 0
    v_mov_b32 v52, 0
    v_mov_b32 v53, 0
    v_mov_b32 v54, 0
    v_mov_b32 v55, 0
    s_waitcnt vmcnt(0)
    s_cmp_lg_u32 s93, 0
    s_cbranch_scc1 main_kernel_slowmode
    s_cmp_eq_u32 s13, 1
    s_cbranch_scc1 main_kernel_wl1
    s_cmp_eq_u32 s13, 2
    s_cbranch_scc1 main_kernel_wl2
    s_cmp_eq_u32 s13, 3
    s_cbranch_scc1 main_kernel_wl3
main_kernel_wl0:
    ds_read_b128 v[56:59], v117 offset:0
    ds_read_b128 v[60:63], v117 offset:1024
    ds_read_b128 v[64:67], v117 offset:2048
    ds_read_b128 v[68:71], v117 offset:3072
    ds_read_b128 v[72:75], v117 offset:4096
    ds_read_b128 v[76:79], v117 offset:5120
    ds_read_b128 v[80:83], v117 offset:6144
    ds_read_b128 v[84:87], v117 offset:7168
    s_cmp_eq_u32 s14, 0
    s_cbranch_scc1 main_kernel_m0_0
    s_mov_b32 s43, 0x100000
    buffer_load_dwordx4 v[0:3], v124, s[4:7], s32 offen sc1
    buffer_load_dwordx4 v[4:7], v124, s[4:7], s32 offen offset:1024 sc1
main_kernel_p2_0_0:
    s_waitcnt vmcnt(0)
main_kernel_p2_0_0c:
    v_max3_u32 v105, v0, v1, v2
    v_max3_u32 v127, v3, v4, v5
    v_max3_u32 v105, v6, v7, v105
    v_max_u32 v105, v105, v127
    v_cmp_eq_u32 vcc, -1, v105
    s_cbranch_vccz main_kernel_p2_0_0done
    s_mov_b64 exec, vcc
    buffer_load_dwordx4 v[0:3], v124, s[4:7], s32 offen sc1
    buffer_load_dwordx4 v[4:7], v124, s[4:7], s32 offen offset:1024 sc1
    s_sub_u32 s43, s43, 1
    s_cbranch_scc0 main_kernel_p2_0_0
main_kernel_p2_0_0done:
    s_mov_b64 exec, -1
main_kernel_m0done_0:
    ds_write_b128 v124, v[0:3] offset:16384
    ds_write_b128 v124, v[4:7] offset:17408
    v_smfmac_f32_16x16x64_bf16 v[32:35], v[0:3], a[0:7], v104
    v_smfmac_f32_16x16x64_bf16 v[40:43], v[0:3], a[128:135], v104
    v_smfmac_f32_16x16x64_bf16 v[36:39], v[0:3], a[64:71], v104
    s_waitcnt lgkmcnt(8)
    v_smfmac_f32_16x16x64_bf16 v[44:47], v[0:3], v[56:63], v104
    v_smfmac_f32_16x16x64_bf16 v[48:51], v[0:3], a[192:199], v104
    v_smfmac_f32_16x16x64_bf16 v[52:55], v[0:3], v[128:135], v104
    s_waitcnt lgkmcnt(0)
    s_barrier
    ds_read_b128 v[8:11], v116 offset:18432
    ds_read_b128 v[12:15], v116 offset:19456
    v_smfmac_f32_16x16x64_bf16 v[32:35], v[4:7], a[8:15], v104
    ds_read_b128 v[16:19], v116 offset:20480
    v_smfmac_f32_16x16x64_bf16 v[40:43], v[4:7], a[136:143], v104
    ds_read_b128 v[20:23], v116 offset:21504
    v_smfmac_f32_16x16x64_bf16 v[36:39], v[4:7], a[72:79], v104
    ds_read_b128 v[24:27], v116 offset:22528
    v_smfmac_f32_16x16x64_bf16 v[44:47], v[4:7], v[64:71], v104
    ds_read_b128 v[28:31], v116 offset:23552
    v_smfmac_f32_16x16x64_bf16 v[48:51], v[4:7], a[200:207], v104
    v_smfmac_f32_16x16x64_bf16 v[52:55], v[4:7], v[136:143], v104
    s_waitcnt lgkmcnt(5)
    v_smfmac_f32_16x16x64_bf16 v[32:35], v[8:11], a[16:23], v104
    ds_read_b128 v[56:59], v117 offset:8192
    ds_read_b128 v[60:63], v117 offset:9216
    v_smfmac_f32_16x16x64_bf16 v[40:43], v[8:11], a[144:151], v104
    ds_read_b128 v[64:67], v117 offset:10240
    ds_read_b128 v[68:71], v117 offset:11264
    s_waitcnt lgkmcnt(8)
    v_smfmac_f32_16x16x64_bf16 v[32:35], v[12:15], a[24:31], v104
    s_mov_b32 m0, s68
    s_add_u32 s17, s34, 0x40000
    v_smfmac_f32_16x16x64_bf16 v[40:43], v[12:15], a[152:159], v104
    buffer_load_dwordx4 v124, s[4:7], s34 offen sc1 lds
    s_waitcnt lgkmcnt(7)
    v_smfmac_f32_16x16x64_bf16 v[32:35], v[16:19], a[32:39], v104
    v_smfmac_f32_16x16x64_bf16 v[40:43], v[16:19], a[160:167], v104
    buffer_load_dwordx4 v124, s[4:7], s34 offen offset:1024 sc1 lds
    s_waitcnt lgkmcnt(6)
    v_smfmac_f32_16x16x64_bf16 v[32:35], v[20:23], a[40:47], v104
    v_smfmac_f32_16x16x64_bf16 v[40:43], v[20:23], a[168:175], v104
    buffer_load_dwordx4 v[96:99], v124, s[4:7], s35 offen sc1
    s_waitcnt lgkmcnt(5)
    v_smfmac_f32_16x16x64_bf16 v[32:35], v[24:27], a[48:55], v104
    v_smfmac_f32_16x16x64_bf16 v[40:43], v[24:27], a[176:183], v104
    buffer_load_dwordx4 v[100:103], v124, s[4:7], s35 offen offset:1024 sc1
    s_mov_b32 s34, s17
    s_waitcnt lgkmcnt(4)
    v_smfmac_f32_16x16x64_bf16 v[32:35], v[28:31], a[56:63], v104
    s_add_u32 s35, s35, 0x40000
    v_smfmac_f32_16x16x64_bf16 v[40:43], v[28:31], a[184:191], v104
    v_smfmac_f32_16x16x64_bf16 v[36:39], v[8:11], a[80:87], v104
    v_lshlrev_b32 v127, 3, v116
    v_mov_b32 v105, s14
    v_smfmac_f32_16x16x64_bf16 v[44:47], v[8:11], v[72:79], v104
    ds_read_b128 v[72:75], v117 offset:12288
    ds_read_b128 v[76:79], v117 offset:13312
    v_smfmac_f32_16x16x64_bf16 v[36:39], v[12:15], a[88:95], v104
    s_mov_b64 exec, s[72:73]
    buffer_store_dword v105, v127, s[4:7], s74 offen sc1
    s_mov_b64 exec, -1
    v_smfmac_f32_16x16x64_bf16 v[44:47], v[12:15], v[80:87], v104
    ds_read_b128 v[80:83], v117 offset:14336
    ds_read_b128 v[84:87], v117 offset:15360
    v_smfmac_f32_16x16x64_bf16 v[36:39], v[16:19], a[96:103], v104
    v_add_f32 v40, v40, v42
    v_add_f32 v41, v41, v43
    s_waitcnt lgkmcnt(6)
    v_smfmac_f32_16x16x64_bf16 v[44:47], v[16:19], v[56:63], v104
    v_smfmac_f32_16x16x64_bf16 v[36:39], v[20:23], a[104:111], v104
    v_add_f32 v32, v32, v34
    v_add_f32 v33, v33, v35
    s_waitcnt lgkmcnt(4)
    v_smfmac_f32_16x16x64_bf16 v[44:47], v[20:23], v[64:71], v104
    v_smfmac_f32_16x16x64_bf16 v[36:39], v[24:27], a[112:119], v104
    v_cvt_pk_bf16_f32 v40, v40, v41
    v_cvt_pk_bf16_f32 v41, v32, v33
    s_waitcnt lgkmcnt(2)
    v_smfmac_f32_16x16x64_bf16 v[44:47], v[24:27], v[72:79], v104
    v_smfmac_f32_16x16x64_bf16 v[36:39], v[28:31], a[120:127], v104
    ds_write_b64 v118, v[40:41] offset:0
    s_waitcnt lgkmcnt(1)
    v_smfmac_f32_16x16x64_bf16 v[44:47], v[28:31], v[80:87], v104
    ds_read_b128 v[0:3], v116 offset:0
    ds_read_b128 v[4:7], v116 offset:1024
    v_smfmac_f32_16x16x64_bf16 v[48:51], v[8:11], a[208:215], v104
    v_smfmac_f32_16x16x64_bf16 v[52:55], v[8:11], v[144:151], v104
    ds_read_b128 v[8:11], v116 offset:2048
    s_nop 2
    v_add_f32 v44, v44, v46
    v_add_f32 v45, v45, v47
    v_add_f32 v36, v36, v38
    v_add_f32 v37, v37, v39
    v_cvt_pk_bf16_f32 v44, v44, v45
    v_cvt_pk_bf16_f32 v45, v36, v37
    ds_write_b64 v118, v[44:45] offset:512
    v_smfmac_f32_16x16x64_bf16 v[48:51], v[12:15], a[216:223], v104
    v_smfmac_f32_16x16x64_bf16 v[52:55], v[12:15], v[152:159], v104
    ds_read_b128 v[12:15], v116 offset:3072
    s_waitcnt lgkmcnt(1)
    s_barrier
    ds_read_b64_tr_b16 v[32:33], v119 offset:0
    ds_read_b64_tr_b16 v[34:35], v119 offset:512
    ds_read_b64_tr_b16 v[36:37], v119 offset:1024
    ds_read_b64_tr_b16 v[38:39], v119 offset:1536
    v_smfmac_f32_16x16x64_bf16 v[48:51], v[16:19], a[224:231], v104
    ds_read_b64_tr_b16 v[40:41], v119 offset:2048
    ds_read_b64_tr_b16 v[42:43], v119 offset:2560
    v_smfmac_f32_16x16x64_bf16 v[52:55], v[16:19], v[160:167], v104
    ds_read_b64_tr_b16 v[44:45], v119 offset:3072
    ds_read_b64_tr_b16 v[46:47], v119 offset:3584
    ds_read_b128 v[16:19], v116 offset:4096
    v_smfmac_f32_16x16x64_bf16 v[48:51], v[20:23], a[232:239], v104
    v_smfmac_f32_16x16x64_bf16 v[52:55], v[20:23], v[168:175], v104
    ds_read_b128 v[20:23], v116 offset:5120
    v_smfmac_f32_16x16x64_bf16 v[48:51], v[24:27], a[240:247], v104
    v_smfmac_f32_16x16x64_bf16 v[52:55], v[24:27], v[176:183], v104
    ds_read_b128 v[24:27], v116 offset:6144
    v_smfmac_f32_16x16x64_bf16 v[48:51], v[28:31], a[248:255], v104
    v_smfmac_f32_16x16x64_bf16 v[52:55], v[28:31], v[184:191], v104
    ds_read_b128 v[28:31], v116 offset:7168
    s_waitcnt lgkmcnt(4)
    v_mfma_f32_16x16x32_bf16 v[56:59], v[32:35], v[32:35], 0
    v_mfma_f32_16x16x32_bf16 v[60:63], v[0:3], v[32:35], 0
    buffer_store_dwordx4 v[32:35], v116, s[4:7], s36 offen offset:0 sc1
    s_add_u32 s36, s36, 0x20000
    v_mfma_f32_16x16x32_bf16 v[56:59], v[36:39], v[36:39], v[56:59]
    v_mfma_f32_16x16x32_bf16 v[60:63], v[4:7], v[36:39], v[60:63]
    v_mfma_f32_16x16x32_bf16 v[56:59], v[40:43], v[40:43], v[56:59]
    v_mfma_f32_16x16x32_bf16 v[60:63], v[8:11], v[40:43], v[60:63]
    v_cvt_pk_bf16_f32 v48, v48, v49
    v_cvt_pk_bf16_f32 v49, v50, v51
    v_cvt_pk_bf16_f32 v50, v52, v53
    v_cvt_pk_bf16_f32 v51, v54, v55
    v_mfma_f32_16x16x32_bf16 v[56:59], v[44:47], v[44:47], v[56:59]
    v_mfma_f32_16x16x32_bf16 v[60:63], v[12:15], v[44:47], v[60:63]
    buffer_store_dwordx4 v[48:51], v116, s[4:7], s37 offen sc1
    s_add_u32 s37, s37, 0x20000
    s_waitcnt lgkmcnt(3)
    v_mfma_f32_16x16x32_bf16 v[64:67], v[16:19], v[32:35], 0
    s_waitcnt lgkmcnt(2)
    v_mfma_f32_16x16x32_bf16 v[64:67], v[20:23], v[36:39], v[64:67]
    s_cmp_eq_u32 s14, 63
    s_cbranch_scc1 main_kernel_done
    s_waitcnt lgkmcnt(1)
    v_mfma_f32_16x16x32_bf16 v[64:67], v[24:27], v[40:43], v[64:67]
    s_waitcnt lgkmcnt(0)
    v_mfma_f32_16x16x32_bf16 v[64:67], v[28:31], v[44:47], v[64:67]
    v_mov_b64 v[16:17], 0
    v_mov_b64 v[18:19], 0
    v_mov_b64 v[20:21], 0
    v_mov_b64 v[22:23], 0
    v_max3_f32 v105, v60, v61, v62
    v_max3_f32 v127, v63, v56, v57
    s_nop 1
    v_max3_f32 v127, v64, v65, v127
    v_max3_f32 v105, v66, v67, v105
    v_max_f32 v105, v105, v127
    v_mov_b32 v127, v105
    v_mov_b64 v[0:1], 0
    v_mov_b64 v[2:3], 0
    v_permlane32_swap_b32 v105, v127
    v_max_f32 v105, v105, v127
    v_mov_b32 v127, v105
    v_mov_b64 v[4:5], 0
    v_mov_b64 v[6:7], 0
    v_permlane16_swap_b32 v105, v127
    v_max_f32 v105, v105, v127
    v_mul_f32 v105, s42, v105
    v_fma_f32 v56, v56, s42, -v105
    v_fma_f32 v57, v57, s42, -v105
    v_exp_f32 v56, v56
    v_exp_f32 v57, v57
    v_fma_f32 v60, v60, s42, -v105
    v_fma_f32 v61, v61, s42, -v105
    v_fma_f32 v62, v62, s42, -v105
    v_fma_f32 v63, v63, s42, -v105
    v_fma_f32 v64, v64, s42, -v105
    v_fma_f32 v65, v65, s42, -v105
    v_fma_f32 v66, v66, s42, -v105
    v_fma_f32 v67, v67, s42, -v105
    v_cvt_pk_bf16_f32 v58, v56, v57
    v_cvt_pk_bf16_f32 v59, v56, v57
    v_exp_f32 v60, v60
    v_exp_f32 v61, v61
    v_mfma_f32_16x16x16_bf16 v[72:75], v[58:59], v[110:111], 0
    v_exp_f32 v62, v62
    v_exp_f32 v63, v63
    v_mfma_f32_16x16x16_bf16 v[76:79], v[58:59], v[48:49], 0
    v_exp_f32 v64, v64
    v_exp_f32 v65, v65
    v_mfma_f32_16x16x16_bf16 v[80:83], v[58:59], v[50:51], 0
    v_exp_f32 v66, v66
    v_exp_f32 v67, v67
    v_cvt_pk_bf16_f32 v84, v60, v61
    v_cvt_pk_bf16_f32 v85, v62, v63
    v_cvt_pk_bf16_f32 v86, v64, v65
    v_cvt_pk_bf16_f32 v87, v66, v67
    v_mov_b64 v[24:25], 0
    v_mov_b64 v[26:27], 0
    v_mfma_f32_16x16x32_bf16 v[72:75], v[84:87], v[106:109], v[72:75]
    v_mov_b64 v[28:29], 0
    v_mov_b64 v[30:31], 0
    v_mfma_f32_16x16x32_bf16 v[76:79], v[84:87], v[88:91], v[76:79]
    v_mfma_f32_16x16x32_bf16 v[80:83], v[84:87], v[92:95], v[80:83]
    ds_read_b128 v[56:59], v117 offset:16384
    ds_read_b128 v[60:63], v117 offset:17408
    ds_read_b128 v[64:67], v117 offset:20480
    ds_read_b128 v[68:71], v117 offset:21504
    v_rcp_f32 v74, v74
    v_rcp_f32 v75, v75
    s_nop 0
    v_mul_f32 v78, v78, v74
    v_mul_f32 v79, v79, v75
    v_cvt_pk_bf16_f32 v76, v78, v79
    ds_write_b32 v120, v76 offset:0
    v_mul_f32 v82, v82, v74
    v_mul_f32 v83, v83, v75
    v_cvt_pk_bf16_f32 v80, v82, v83
    ds_write_b32 v120, v80 offset:256
    s_waitcnt lgkmcnt(0)
    s_barrier
    ds_read_b64_tr_b16 v[80:81], v121 offset:0
    ds_read_b64_tr_b16 v[82:83], v121 offset:128
    ds_read_b64_tr_b16 v[84:85], v121 offset:1024
    ds_read_b64_tr_b16 v[86:87], v121 offset:1152
    v_mov_b64 v[8:9], 0
    v_mov_b64 v[10:11], 0
    v_mov_b64 v[12:13], 0
    v_mov_b64 v[14:15], 0
    s_waitcnt lgkmcnt(2)
    s_bfe_i32 s71, s14, 0x10001
    v_smfmac_f32_16x16x64_bf16 v[0:3], v[80:83], v[192:199], v104
    v_smfmac_f32_16x16x64_bf16 v[4:7], v[80:83], v[208:215], v104
    ds_read_b128 v[72:75], v117 offset:18432
    ds_read_b128 v[76:79], v117 offset:19456
    s_waitcnt lgkmcnt(2)
    v_smfmac_f32_16x16x64_bf16 v[0:3], v[84:87], v[200:207], v104
    ds_read_b128 v[32:35], v117 offset:22528
    ds_read_b128 v[36:39], v117 offset:23552
    v_smfmac_f32_16x16x64_bf16 v[4:7], v[84:87], v[216:223], v104
    ds_read_b128 v[40:43], v117 offset:24576
    ds_read_b128 v[44:47], v117 offset:25600
    v_smfmac_f32_16x16x64_bf16 v[8:11], v[80:83], v[224:231], v104
    ds_read_b128 v[48:51], v117 offset:28672
    ds_read_b128 v[52:55], v117 offset:29696
    v_smfmac_f32_16x16x64_bf16 v[12:15], v[80:83], v[240:247], v104
    v_smfmac_f32_16x16x64_bf16 v[8:11], v[84:87], v[232:239], v104
    v_add_f32 v0, v0, v2
    v_add_f32 v1, v1, v3
    v_add_f32 v4, v4, v6
    v_add_f32 v5, v5, v7
    v_smfmac_f32_16x16x64_bf16 v[12:15], v[84:87], v[248:255], v104
    v_cvt_pk_bf16_f32 v0, v0, v1
    v_cvt_pk_bf16_f32 v1, v4, v5
    v_bfi_b32 v0, 1, s71, v0
    buffer_store_dwordx2 v[0:1], v122, s[4:7], s20 offen
    v_smfmac_f32_16x16x64_bf16 v[16:19], v[80:83], v[56:63], v104
    ds_read_b128 v[56:59], v117 offset:26624
    ds_read_b128 v[60:63], v117 offset:27648
    v_smfmac_f32_16x16x64_bf16 v[20:23], v[80:83], v[64:71], v104
    ds_read_b128 v[64:67], v117 offset:30720
    ds_read_b128 v[68:71], v117 offset:31744
    s_waitcnt lgkmcnt(10)
    v_smfmac_f32_16x16x64_bf16 v[16:19], v[84:87], v[72:79], v104
    v_add_f32 v8, v8, v10
    v_add_f32 v9, v9, v11
    v_add_f32 v12, v12, v14
    v_add_f32 v13, v13, v15
    s_waitcnt lgkmcnt(8)
    v_smfmac_f32_16x16x64_bf16 v[20:23], v[84:87], v[32:39], v104
    v_cvt_pk_bf16_f32 v8, v8, v9
    v_cvt_pk_bf16_f32 v9, v12, v13
    v_bfi_b32 v8, 1, s71, v8
    buffer_store_dwordx2 v[8:9], v122, s[4:7], s21 offen
    s_waitcnt lgkmcnt(6)
    v_smfmac_f32_16x16x64_bf16 v[24:27], v[80:83], v[40:47], v104
    s_waitcnt lgkmcnt(4)
    v_smfmac_f32_16x16x64_bf16 v[28:31], v[80:83], v[48:55], v104
    s_waitcnt lgkmcnt(2)
    v_smfmac_f32_16x16x64_bf16 v[24:27], v[84:87], v[56:63], v104
    v_add_f32 v16, v16, v18
    v_add_f32 v17, v17, v19
    v_add_f32 v20, v20, v22
    v_add_f32 v21, v21, v23
    s_waitcnt lgkmcnt(0)
    v_smfmac_f32_16x16x64_bf16 v[28:31], v[84:87], v[64:71], v104
    v_cvt_pk_bf16_f32 v16, v16, v17
    v_cvt_pk_bf16_f32 v17, v20, v21
    v_bfi_b32 v16, 1, s71, v16
    buffer_store_dwordx2 v[16:17], v122, s[4:7], s22 offen
    v_mov_b64 v[32:33], 0
    v_mov_b64 v[34:35], 0
    v_mov_b64 v[36:37], 0
    v_mov_b64 v[38:39], 0
    v_add_f32 v24, v24, v26
    v_add_f32 v25, v25, v27
    v_add_f32 v28, v28, v30
    v_add_f32 v29, v29, v31
    v_cvt_pk_bf16_f32 v24, v24, v25
    v_cvt_pk_bf16_f32 v25, v28, v29
    v_bfi_b32 v24, 1, s71, v24
    buffer_store_dwordx2 v[24:25], v122, s[4:7], s23 offen
    v_mov_b64 v[40:41], 0
    v_mov_b64 v[42:43], 0
    v_mov_b64 v[44:45], 0
    v_mov_b64 v[46:47], 0
    v_mov_b64 v[48:49], 0
    v_mov_b64 v[50:51], 0
    v_mov_b64 v[52:53], 0
    v_mov_b64 v[54:55], 0
    s_mov_b32 s43, 0x100000
    buffer_load_dwordx4 v[56:59], v123, s[4:7], s28 offen sc1
    buffer_load_dwordx4 v[60:63], v123, s[4:7], s29 offen sc1
main_kernel_p1_0_0:
    s_waitcnt vmcnt(0)
main_kernel_p1_0_0c:
    v_bitop3_b32 v105, v56, v58, s71 bitop3:0x7e
    v_bitop3_b32 v127, v60, v62, s71 bitop3:0x7e
    v_or_b32 v105, v105, v127
    v_and_b32 v105, 1, v105
    v_cmp_ne_u32 vcc, 0, v105
    s_cbranch_vccz main_kernel_p1_0_0done
    s_mov_b64 exec, vcc
    buffer_load_dwordx4 v[56:59], v123, s[4:7], s28 offen sc1
    buffer_load_dwordx4 v[60:63], v123, s[4:7], s29 offen sc1
    s_sub_u32 s43, s43, 1
    s_cbranch_scc0 main_kernel_p1_0_0
main_kernel_p1_0_0done:
    s_mov_b64 exec, -1
    v_mfma_f32_16x16x32_bf16 v[64:67], v[112:115], v[56:59], 0
    v_mfma_f32_16x16x32_bf16 v[64:67], v[112:115], v[60:63], v[64:67]
    v_mov_b64 v[72:73], -1
    v_mov_b64 v[74:75], -1
    s_add_u32 s14, s14, 1
    s_nop 4
    v_add_f32_dpp v68, v64, v64 row_ror:4 row_mask:0xf bank_mask:0xf
    v_add_f32_dpp v69, v65, v65 row_ror:4 row_mask:0xf bank_mask:0xf
    v_add_f32_dpp v70, v66, v66 row_ror:4 row_mask:0xf bank_mask:0xf
    v_add_f32_dpp v71, v67, v67 row_ror:4 row_mask:0xf bank_mask:0xf
    v_add_f32_dpp v64, v68, v68 row_ror:8 row_mask:0xf bank_mask:0xf
    v_add_f32_dpp v65, v69, v69 row_ror:8 row_mask:0xf bank_mask:0xf
    v_add_f32_dpp v66, v70, v70 row_ror:8 row_mask:0xf bank_mask:0xf
    v_add_f32_dpp v67, v71, v71 row_ror:8 row_mask:0xf bank_mask:0xf
    s_mov_b64 exec, s[40:41]
    v_cvt_pk_bf16_f32 v64, v64, v65
    v_cvt_pk_bf16_f32 v65, v66, v67
    buffer_store_dword v64, v125, s[4:7], s33 offen
    buffer_store_dword v65, v125, s[4:7], s33 offen offset:16
    buffer_store_dword v72, v125, s[4:7], s32 offen
    buffer_store_dword v72, v125, s[4:7], s32 offen offset:16
    s_mov_b64 exec, -1
    s_add_u32 s15, s14, 1
    s_cmp_lg_u32 s15, s75
    s_cbranch_scc1 main_kernel_nokv0_0
    v_readfirstlane_b32 s18, v126
    s_nop 0
    s_cmp_ge_u32 s18, 64
    s_cbranch_scc1 main_kernel_kvok0_0
    s_mov_b32 s43, 0x200000
    v_mov_b32 v127, s69
main_kernel_wkvn0:
    buffer_load_dword v126, v127, s[44:47], 0 offen sc1
    s_waitcnt vmcnt(0)
    v_readfirstlane_b32 s18, v126
    s_nop 0
    s_cmp_ge_u32 s18, 64
    s_cbranch_scc1 main_kernel_wkvn0_ok
    s_sleep 2
    s_sub_u32 s43, s43, 1
    s_cbranch_scc0 main_kernel_wkvn0
main_kernel_wkvn0_ok:
main_kernel_kvok0_0:
    s_min_u32 s15, s75, 8
    s_add_u32 s75, s75, s15
    s_add_u32 s69, s69, 4
    s_cmp_ge_u32 s75, 64
    s_cselect_b32 s75, 0x7fff, s75
main_kernel_nokv0_0:
    ds_read_b128 v[56:59], v117 offset:0
    ds_read_b128 v[60:63], v117 offset:1024
    ds_read_b128 v[64:67], v117 offset:2048
    ds_read_b128 v[68:71], v117 offset:3072
    ds_read_b128 v[72:75], v117 offset:4096
    ds_read_b128 v[76:79], v117 offset:5120
    ds_read_b128 v[80:83], v117 offset:6144
    ds_read_b128 v[84:87], v117 offset:7168
    s_mov_b32 s43, 0x100000
    buffer_load_dwordx4 v[0:3], v124, s[4:7], s33 offen sc1
    buffer_load_dwordx4 v[4:7], v124, s[4:7], s33 offen offset:1024 sc1
main_kernel_p2_1_0:
    s_waitcnt vmcnt(0)
main_kernel_p2_1_0c:
    v_max3_u32 v105, v0, v1, v2
    v_max3_u32 v127, v3, v4, v5
    v_max3_u32 v105, v6, v7, v105
    v_max_u32 v105, v105, v127
    v_cmp_eq_u32 vcc, -1, v105
    s_cbranch_vccz main_kernel_p2_1_0done
    s_mov_b64 exec, vcc
    buffer_load_dwordx4 v[0:3], v124, s[4:7], s33 offen sc1
    buffer_load_dwordx4 v[4:7], v124, s[4:7], s33 offen offset:1024 sc1
    s_sub_u32 s43, s43, 1
    s_cbranch_scc0 main_kernel_p2_1_0
main_kernel_p2_1_0done:
    s_mov_b64 exec, -1
    ds_write_b128 v124, v[0:3] offset:16384
    ds_write_b128 v124, v[4:7] offset:17408
    v_smfmac_f32_16x16x64_bf16 v[32:35], v[0:3], a[0:7], v104
    v_smfmac_f32_16x16x64_bf16 v[40:43], v[0:3], a[128:135], v104
    v_smfmac_f32_16x16x64_bf16 v[36:39], v[0:3], a[64:71], v104
    s_waitcnt lgkmcnt(8)
    v_smfmac_f32_16x16x64_bf16 v[44:47], v[0:3], v[56:63], v104
    v_smfmac_f32_16x16x64_bf16 v[48:51], v[0:3], a[192:199], v104
    v_smfmac_f32_16x16x64_bf16 v[52:55], v[0:3], v[128:135], v104
    s_waitcnt lgkmcnt(0)
    s_barrier
    ds_read_b128 v[8:11], v116 offset:18432
    ds_read_b128 v[12:15], v116 offset:19456
    v_smfmac_f32_16x16x64_bf16 v[32:35], v[4:7], a[8:15], v104
    ds_read_b128 v[16:19], v116 offset:20480
    v_smfmac_f32_16x16x64_bf16 v[40:43], v[4:7], a[136:143], v104
    ds_read_b128 v[20:23], v116 offset:21504
    v_smfmac_f32_16x16x64_bf16 v[36:39], v[4:7], a[72:79], v104
    ds_read_b128 v[24:27], v116 offset:22528
    v_smfmac_f32_16x16x64_bf16 v[44:47], v[4:7], v[64:71], v104
    ds_read_b128 v[28:31], v116 offset:23552
    v_smfmac_f32_16x16x64_bf16 v[48:51], v[4:7], a[200:207], v104
    v_smfmac_f32_16x16x64_bf16 v[52:55], v[4:7], v[136:143], v104
    s_waitcnt lgkmcnt(5)
    v_smfmac_f32_16x16x64_bf16 v[32:35], v[8:11], a[16:23], v104
    ds_read_b128 v[56:59], v117 offset:8192
    ds_read_b128 v[60:63], v117 offset:9216
    v_smfmac_f32_16x16x64_bf16 v[40:43], v[8:11], a[144:151], v104
    ds_read_b128 v[64:67], v117 offset:10240
    ds_read_b128 v[68:71], v117 offset:11264
    s_waitcnt lgkmcnt(8)
    v_smfmac_f32_16x16x64_bf16 v[32:35], v[12:15], a[24:31], v104
    s_mov_b32 m0, s67
    s_add_u32 s17, s34, 0x40000
    v_smfmac_f32_16x16x64_bf16 v[40:43], v[12:15], a[152:159], v104
    buffer_load_dwordx4 v124, s[4:7], s34 offen sc1 lds
    s_waitcnt lgkmcnt(7)
    v_smfmac_f32_16x16x64_bf16 v[32:35], v[16:19], a[32:39], v104
    v_smfmac_f32_16x16x64_bf16 v[40:43], v[16:19], a[160:167], v104
    buffer_load_dwordx4 v124, s[4:7], s34 offen offset:1024 sc1 lds
    s_waitcnt lgkmcnt(6)
    v_smfmac_f32_16x16x64_bf16 v[32:35], v[20:23], a[40:47], v104
    v_smfmac_f32_16x16x64_bf16 v[40:43], v[20:23], a[168:175], v104
    buffer_load_dwordx4 v[88:91], v124, s[4:7], s35 offen sc1
    s_waitcnt lgkmcnt(5)
    v_smfmac_f32_16x16x64_bf16 v[32:35], v[24:27], a[48:55], v104
    v_smfmac_f32_16x16x64_bf16 v[40:43], v[24:27], a[176:183], v104
    buffer_load_dwordx4 v[92:95], v124, s[4:7], s35 offen offset:1024 sc1
    s_mov_b32 s34, s17
    s_waitcnt lgkmcnt(4)
    v_smfmac_f32_16x16x64_bf16 v[32:35], v[28:31], a[56:63], v104
    s_add_u32 s35, s35, 0x40000
    v_smfmac_f32_16x16x64_bf16 v[40:43], v[28:31], a[184:191], v104
    v_smfmac_f32_16x16x64_bf16 v[36:39], v[8:11], a[80:87], v104
    v_lshlrev_b32 v127, 3, v116
    v_mov_b32 v105, s14
    v_smfmac_f32_16x16x64_bf16 v[44:47], v[8:11], v[72:79], v104
    ds_read_b128 v[72:75], v117 offset:12288
    ds_read_b128 v[76:79], v117 offset:13312
    v_smfmac_f32_16x16x64_bf16 v[36:39], v[12:15], a[88:95], v104
    s_mov_b64 exec, s[72:73]
    buffer_store_dword v105, v127, s[4:7], s74 offen sc1
    s_mov_b64 exec, -1
    v_smfmac_f32_16x16x64_bf16 v[44:47], v[12:15], v[80:87], v104
    ds_read_b128 v[80:83], v117 offset:14336
    ds_read_b128 v[84:87], v117 offset:15360
    v_smfmac_f32_16x16x64_bf16 v[36:39], v[16:19], a[96:103], v104
    v_add_f32 v40, v40, v42
    v_add_f32 v41, v41, v43
    s_waitcnt lgkmcnt(6)
    v_smfmac_f32_16x16x64_bf16 v[44:47], v[16:19], v[56:63], v104
    v_smfmac_f32_16x16x64_bf16 v[36:39], v[20:23], a[104:111], v104
    v_add_f32 v32, v32, v34
    v_add_f32 v33, v33, v35
    s_waitcnt lgkmcnt(4)
    v_smfmac_f32_16x16x64_bf16 v[44:47], v[20:23], v[64:71], v104
    v_smfmac_f32_16x16x64_bf16 v[36:39], v[24:27], a[112:119], v104
    v_cvt_pk_bf16_f32 v40, v40, v41
    v_cvt_pk_bf16_f32 v41, v32, v33
    s_waitcnt lgkmcnt(2)
    v_smfmac_f32_16x16x64_bf16 v[44:47], v[24:27], v[72:79], v104
    v_smfmac_f32_16x16x64_bf16 v[36:39], v[28:31], a[120:127], v104
    ds_write_b64 v118, v[40:41] offset:0
    s_waitcnt lgkmcnt(1)
    v_smfmac_f32_16x16x64_bf16 v[44:47], v[28:31], v[80:87], v104
    ds_read_b128 v[0:3], v116 offset:8192
    ds_read_b128 v[4:7], v116 offset:9216
    v_smfmac_f32_16x16x64_bf16 v[48:51], v[8:11], a[208:215], v104
    v_smfmac_f32_16x16x64_bf16 v[52:55], v[8:11], v[144:151], v104
    ds_read_b128 v[8:11], v116 offset:10240
    s_nop 2
    v_add_f32 v44, v44, v46
    v_add_f32 v45, v45, v47
    v_add_f32 v36, v36, v38
    v_add_f32 v37, v37, v39
    v_cvt_pk_bf16_f32 v44, v44, v45
    v_cvt_pk_bf16_f32 v45, v36, v37
    ds_write_b64 v118, v[44:45] offset:512
    v_smfmac_f32_16x16x64_bf16 v[48:51], v[12:15], a[216:223], v104
    v_smfmac_f32_16x16x64_bf16 v[52:55], v[12:15], v[152:159], v104
    ds_read_b128 v[12:15], v116 offset:11264
    s_waitcnt lgkmcnt(1)
    s_barrier
    ds_read_b64_tr_b16 v[32:33], v119 offset:0
    ds_read_b64_tr_b16 v[34:35], v119 offset:512
    ds_read_b64_tr_b16 v[36:37], v119 offset:1024
    ds_read_b64_tr_b16 v[38:39], v119 offset:1536
    v_smfmac_f32_16x16x64_bf16 v[48:51], v[16:19], a[224:231], v104
    ds_read_b64_tr_b16 v[40:41], v119 offset:2048
    ds_read_b64_tr_b16 v[42:43], v119 offset:2560
    v_smfmac_f32_16x16x64_bf16 v[52:55], v[16:19], v[160:167], v104
    ds_read_b64_tr_b16 v[44:45], v119 offset:3072
    ds_read_b64_tr_b16 v[46:47], v119 offset:3584
    ds_read_b128 v[16:19], v116 offset:12288
    v_smfmac_f32_16x16x64_bf16 v[48:51], v[20:23], a[232:239], v104
    v_smfmac_f32_16x16x64_bf16 v[52:55], v[20:23], v[168:175], v104
    ds_read_b128 v[20:23], v116 offset:13312
    v_smfmac_f32_16x16x64_bf16 v[48:51], v[24:27], a[240:247], v104
    v_smfmac_f32_16x16x64_bf16 v[52:55], v[24:27], v[176:183], v104
    ds_read_b128 v[24:27], v116 offset:14336
    v_smfmac_f32_16x16x64_bf16 v[48:51], v[28:31], a[248:255], v104
    v_smfmac_f32_16x16x64_bf16 v[52:55], v[28:31], v[184:191], v104
    ds_read_b128 v[28:31], v116 offset:15360
    s_waitcnt lgkmcnt(4)
    v_mfma_f32_16x16x32_bf16 v[56:59], v[32:35], v[32:35], 0
    v_mfma_f32_16x16x32_bf16 v[60:63], v[0:3], v[32:35], 0
    buffer_store_dwordx4 v[32:35], v116, s[4:7], s36 offen offset:0 sc1
    s_add_u32 s36, s36, 0x20000
    v_mfma_f32_16x16x32_bf16 v[56:59], v[36:39], v[36:39], v[56:59]
    v_mfma_f32_16x16x32_bf16 v[60:63], v[4:7], v[36:39], v[60:63]
    v_mfma_f32_16x16x32_bf16 v[56:59], v[40:43], v[40:43], v[56:59]
    v_mfma_f32_16x16x32_bf16 v[60:63], v[8:11], v[40:43], v[60:63]
    v_cvt_pk_bf16_f32 v48, v48, v49
    v_cvt_pk_bf16_f32 v49, v50, v51
    v_cvt_pk_bf16_f32 v50, v52, v53
    v_cvt_pk_bf16_f32 v51, v54, v55
    v_mfma_f32_16x16x32_bf16 v[56:59], v[44:47], v[44:47], v[56:59]
    v_mfma_f32_16x16x32_bf16 v[60:63], v[12:15], v[44:47], v[60:63]
    buffer_store_dwordx4 v[48:51], v116, s[4:7], s37 offen sc1
    s_add_u32 s37, s37, 0x20000
    s_waitcnt lgkmcnt(3)
    v_mfma_f32_16x16x32_bf16 v[64:67], v[16:19], v[32:35], 0
    s_waitcnt lgkmcnt(2)
    v_mfma_f32_16x16x32_bf16 v[64:67], v[20:23], v[36:39], v[64:67]
    s_cmp_eq_u32 s14, 63
    s_cbranch_scc1 main_kernel_done
    s_waitcnt lgkmcnt(1)
    v_mfma_f32_16x16x32_bf16 v[64:67], v[24:27], v[40:43], v[64:67]
    s_waitcnt lgkmcnt(0)
    v_mfma_f32_16x16x32_bf16 v[64:67], v[28:31], v[44:47], v[64:67]
    v_mov_b64 v[16:17], 0
    v_mov_b64 v[18:19], 0
    v_mov_b64 v[20:21], 0
    v_mov_b64 v[22:23], 0
    v_max3_f32 v105, v60, v61, v62
    v_max3_f32 v127, v63, v56, v57
    s_nop 1
    v_max3_f32 v127, v64, v65, v127
    v_max3_f32 v105, v66, v67, v105
    v_max_f32 v105, v105, v127
    v_mov_b32 v127, v105
    v_mov_b64 v[0:1], 0
    v_mov_b64 v[2:3], 0
    v_permlane32_swap_b32 v105, v127
    v_max_f32 v105, v105, v127
    v_mov_b32 v127, v105
    v_mov_b64 v[4:5], 0
    v_mov_b64 v[6:7], 0
    v_permlane16_swap_b32 v105, v127
    v_max_f32 v105, v105, v127
    v_mul_f32 v105, s42, v105
    v_fma_f32 v56, v56, s42, -v105
    v_fma_f32 v57, v57, s42, -v105
    v_exp_f32 v56, v56
    v_exp_f32 v57, v57
    v_fma_f32 v60, v60, s42, -v105
    v_fma_f32 v61, v61, s42, -v105
    v_fma_f32 v62, v62, s42, -v105
    v_fma_f32 v63, v63, s42, -v105
    v_fma_f32 v64, v64, s42, -v105
    v_fma_f32 v65, v65, s42, -v105
    v_fma_f32 v66, v66, s42, -v105
    v_fma_f32 v67, v67, s42, -v105
    v_cvt_pk_bf16_f32 v58, v56, v57
    v_cvt_pk_bf16_f32 v59, v56, v57
    v_exp_f32 v60, v60
    v_exp_f32 v61, v61
    v_mfma_f32_16x16x16_bf16 v[72:75], v[58:59], v[110:111], 0
    v_exp_f32 v62, v62
    v_exp_f32 v63, v63
    v_mfma_f32_16x16x16_bf16 v[76:79], v[58:59], v[48:49], 0
    v_exp_f32 v64, v64
    v_exp_f32 v65, v65
    v_mfma_f32_16x16x16_bf16 v[80:83], v[58:59], v[50:51], 0
    v_exp_f32 v66, v66
    v_exp_f32 v67, v67
    v_cvt_pk_bf16_f32 v84, v60, v61
    v_cvt_pk_bf16_f32 v85, v62, v63
    v_cvt_pk_bf16_f32 v86, v64, v65
    v_cvt_pk_bf16_f32 v87, v66, v67
    v_mov_b64 v[24:25], 0
    v_mov_b64 v[26:27], 0
    v_mfma_f32_16x16x32_bf16 v[72:75], v[84:87], v[106:109], v[72:75]
    v_mov_b64 v[28:29], 0
    v_mov_b64 v[30:31], 0
    v_mfma_f32_16x16x32_bf16 v[76:79], v[84:87], v[96:99], v[76:79]
    v_mfma_f32_16x16x32_bf16 v[80:83], v[84:87], v[100:103], v[80:83]
    ds_read_b128 v[56:59], v117 offset:16384
    ds_read_b128 v[60:63], v117 offset:17408
    ds_read_b128 v[64:67], v117 offset:20480
    ds_read_b128 v[68:71], v117 offset:21504
    v_rcp_f32 v74, v74
    v_rcp_f32 v75, v75
    s_nop 0
    v_mul_f32 v78, v78, v74
    v_mul_f32 v79, v79, v75
    v_cvt_pk_bf16_f32 v76, v78, v79
    ds_write_b32 v120, v76 offset:0
    v_mul_f32 v82, v82, v74
    v_mul_f32 v83, v83, v75
    v_cvt_pk_bf16_f32 v80, v82, v83
    ds_write_b32 v120, v80 offset:256
    s_waitcnt lgkmcnt(0)
    s_barrier
    ds_read_b64_tr_b16 v[80:81], v121 offset:0
    ds_read_b64_tr_b16 v[82:83], v121 offset:128
    ds_read_b64_tr_b16 v[84:85], v121 offset:1024
    ds_read_b64_tr_b16 v[86:87], v121 offset:1152
    v_mov_b64 v[8:9], 0
    v_mov_b64 v[10:11], 0
    v_mov_b64 v[12:13], 0
    v_mov_b64 v[14:15], 0
    s_waitcnt lgkmcnt(2)
    s_bfe_i32 s71, s14, 0x10001
    v_smfmac_f32_16x16x64_bf16 v[0:3], v[80:83], v[192:199], v104
    v_smfmac_f32_16x16x64_bf16 v[4:7], v[80:83], v[208:215], v104
    ds_read_b128 v[72:75], v117 offset:18432
    ds_read_b128 v[76:79], v117 offset:19456
    s_waitcnt lgkmcnt(2)
    v_smfmac_f32_16x16x64_bf16 v[0:3], v[84:87], v[200:207], v104
    ds_read_b128 v[32:35], v117 offset:22528
    ds_read_b128 v[36:39], v117 offset:23552
    v_smfmac_f32_16x16x64_bf16 v[4:7], v[84:87], v[216:223], v104
    ds_read_b128 v[40:43], v117 offset:24576
    ds_read_b128 v[44:47], v117 offset:25600
    v_smfmac_f32_16x16x64_bf16 v[8:11], v[80:83], v[224:231], v104
    ds_read_b128 v[48:51], v117 offset:28672
    ds_read_b128 v[52:55], v117 offset:29696
    v_smfmac_f32_16x16x64_bf16 v[12:15], v[80:83], v[240:247], v104
    v_smfmac_f32_16x16x64_bf16 v[8:11], v[84:87], v[232:239], v104
    v_add_f32 v0, v0, v2
    v_add_f32 v1, v1, v3
    v_add_f32 v4, v4, v6
    v_add_f32 v5, v5, v7
    v_smfmac_f32_16x16x64_bf16 v[12:15], v[84:87], v[248:255], v104
    v_cvt_pk_bf16_f32 v0, v0, v1
    v_cvt_pk_bf16_f32 v1, v4, v5
    v_bfi_b32 v0, 1, s71, v0
    buffer_store_dwordx2 v[0:1], v122, s[4:7], s24 offen
    v_smfmac_f32_16x16x64_bf16 v[16:19], v[80:83], v[56:63], v104
    ds_read_b128 v[56:59], v117 offset:26624
    ds_read_b128 v[60:63], v117 offset:27648
    v_smfmac_f32_16x16x64_bf16 v[20:23], v[80:83], v[64:71], v104
    ds_read_b128 v[64:67], v117 offset:30720
    ds_read_b128 v[68:71], v117 offset:31744
    s_waitcnt lgkmcnt(10)
    v_smfmac_f32_16x16x64_bf16 v[16:19], v[84:87], v[72:79], v104
    v_add_f32 v8, v8, v10
    v_add_f32 v9, v9, v11
    v_add_f32 v12, v12, v14
    v_add_f32 v13, v13, v15
    s_waitcnt lgkmcnt(8)
    v_smfmac_f32_16x16x64_bf16 v[20:23], v[84:87], v[32:39], v104
    v_cvt_pk_bf16_f32 v8, v8, v9
    v_cvt_pk_bf16_f32 v9, v12, v13
    v_bfi_b32 v8, 1, s71, v8
    buffer_store_dwordx2 v[8:9], v122, s[4:7], s25 offen
    s_waitcnt lgkmcnt(6)
    v_smfmac_f32_16x16x64_bf16 v[24:27], v[80:83], v[40:47], v104
    s_waitcnt lgkmcnt(4)
    v_smfmac_f32_16x16x64_bf16 v[28:31], v[80:83], v[48:55], v104
    s_waitcnt lgkmcnt(2)
    v_smfmac_f32_16x16x64_bf16 v[24:27], v[84:87], v[56:63], v104
    v_add_f32 v16, v16, v18
    v_add_f32 v17, v17, v19
    v_add_f32 v20, v20, v22
    v_add_f32 v21, v21, v23
    s_waitcnt lgkmcnt(0)
    v_smfmac_f32_16x16x64_bf16 v[28:31], v[84:87], v[64:71], v104
    v_cvt_pk_bf16_f32 v16, v16, v17
    v_cvt_pk_bf16_f32 v17, v20, v21
    v_bfi_b32 v16, 1, s71, v16
    buffer_store_dwordx2 v[16:17], v122, s[4:7], s26 offen
    v_mov_b64 v[32:33], 0
    v_mov_b64 v[34:35], 0
    v_mov_b64 v[36:37], 0
    v_mov_b64 v[38:39], 0
    v_add_f32 v24, v24, v26
    v_add_f32 v25, v25, v27
    v_add_f32 v28, v28, v30
    v_add_f32 v29, v29, v31
    v_cvt_pk_bf16_f32 v24, v24, v25
    v_cvt_pk_bf16_f32 v25, v28, v29
    v_bfi_b32 v24, 1, s71, v24
    buffer_store_dwordx2 v[24:25], v122, s[4:7], s27 offen
    v_mov_b64 v[40:41], 0
    v_mov_b64 v[42:43], 0
    v_mov_b64 v[44:45], 0
    v_mov_b64 v[46:47], 0
    v_mov_b64 v[48:49], 0
    v_mov_b64 v[50:51], 0
    v_mov_b64 v[52:53], 0
    v_mov_b64 v[54:55], 0
    s_mov_b32 s43, 0x100000
    buffer_load_dwordx4 v[56:59], v123, s[4:7], s30 offen sc1
    buffer_load_dwordx4 v[60:63], v123, s[4:7], s31 offen sc1
main_kernel_p1_1_0:
    s_waitcnt vmcnt(0)
main_kernel_p1_1_0c:
    v_bitop3_b32 v105, v56, v58, s71 bitop3:0x7e
    v_bitop3_b32 v127, v60, v62, s71 bitop3:0x7e
    v_or_b32 v105, v105, v127
    v_and_b32 v105, 1, v105
    v_cmp_ne_u32 vcc, 0, v105
    s_cbranch_vccz main_kernel_p1_1_0done
    s_mov_b64 exec, vcc
    buffer_load_dwordx4 v[56:59], v123, s[4:7], s30 offen sc1
    buffer_load_dwordx4 v[60:63], v123, s[4:7], s31 offen sc1
    s_sub_u32 s43, s43, 1
    s_cbranch_scc0 main_kernel_p1_1_0
main_kernel_p1_1_0done:
    s_mov_b64 exec, -1
    v_mfma_f32_16x16x32_bf16 v[64:67], v[112:115], v[56:59], 0
    v_mfma_f32_16x16x32_bf16 v[64:67], v[112:115], v[60:63], v[64:67]
    v_mov_b64 v[72:73], -1
    v_mov_b64 v[74:75], -1
    s_add_u32 s14, s14, 1
    s_nop 4
    v_add_f32_dpp v68, v64, v64 row_ror:4 row_mask:0xf bank_mask:0xf
    v_add_f32_dpp v69, v65, v65 row_ror:4 row_mask:0xf bank_mask:0xf
    v_add_f32_dpp v70, v66, v66 row_ror:4 row_mask:0xf bank_mask:0xf
    v_add_f32_dpp v71, v67, v67 row_ror:4 row_mask:0xf bank_mask:0xf
    v_add_f32_dpp v64, v68, v68 row_ror:8 row_mask:0xf bank_mask:0xf
    v_add_f32_dpp v65, v69, v69 row_ror:8 row_mask:0xf bank_mask:0xf
    v_add_f32_dpp v66, v70, v70 row_ror:8 row_mask:0xf bank_mask:0xf
    v_add_f32_dpp v67, v71, v71 row_ror:8 row_mask:0xf bank_mask:0xf
    s_mov_b64 exec, s[40:41]
    v_cvt_pk_bf16_f32 v64, v64, v65
    v_cvt_pk_bf16_f32 v65, v66, v67
    buffer_store_dword v64, v125, s[4:7], s32 offen
    buffer_store_dword v65, v125, s[4:7], s32 offen offset:16
    buffer_store_dword v72, v125, s[4:7], s33 offen
    buffer_store_dword v72, v125, s[4:7], s33 offen offset:16
    s_mov_b64 exec, -1
    s_add_u32 s15, s14, 2
    s_cmp_lg_u32 s15, s75
    s_cbranch_scc1 main_kernel_nokv1_0
    v_mov_b32 v127, s69
    buffer_load_dword v126, v127, s[44:47], 0 offen sc1
main_kernel_nokv1_0:
    s_branch main_kernel_wl0
main_kernel_wl1:
    ds_read_b128 v[56:59], v117 offset:4096
    ds_read_b128 v[60:63], v117 offset:5120
    ds_read_b128 v[64:67], v117 offset:6144
    ds_read_b128 v[68:71], v117 offset:7168
    ds_read_b128 v[72:75], v117 offset:0
    ds_read_b128 v[76:79], v117 offset:1024
    ds_read_b128 v[80:83], v117 offset:2048
    ds_read_b128 v[84:87], v117 offset:3072
    s_cmp_eq_u32 s14, 0
    s_cbranch_scc1 main_kernel_m0_1
    s_mov_b32 s43, 0x100000
    buffer_load_dwordx4 v[8:11], v124, s[4:7], s32 offen sc1
    buffer_load_dwordx4 v[12:15], v124, s[4:7], s32 offen offset:1024 sc1
main_kernel_p2_0_1:
    s_waitcnt vmcnt(0)
main_kernel_p2_0_1c:
    v_max3_u32 v105, v8, v9, v10
    v_max3_u32 v127, v11, v12, v13
    v_max3_u32 v105, v14, v15, v105
    v_max_u32 v105, v105, v127
    v_cmp_eq_u32 vcc, -1, v105
    s_cbranch_vccz main_kernel_p2_0_1done
    s_mov_b64 exec, vcc
    buffer_load_dwordx4 v[8:11], v124, s[4:7], s32 offen sc1
    buffer_load_dwordx4 v[12:15], v124, s[4:7], s32 offen offset:1024 sc1
    s_sub_u32 s43, s43, 1
    s_cbranch_scc0 main_kernel_p2_0_1
main_kernel_p2_0_1done:
    s_mov_b64 exec, -1
main_kernel_m0done_1:
    ds_write_b128 v124, v[8:11] offset:16384
    ds_write_b128 v124, v[12:15] offset:17408
    v_smfmac_f32_16x16x64_bf16 v[32:35], v[8:11], a[16:23], v104
    v_smfmac_f32_16x16x64_bf16 v[40:43], v[8:11], a[144:151], v104
    v_smfmac_f32_16x16x64_bf16 v[36:39], v[8:11], a[80:87], v104
    s_waitcnt lgkmcnt(8)
    v_smfmac_f32_16x16x64_bf16 v[44:47], v[8:11], v[56:63], v104
    v_smfmac_f32_16x16x64_bf16 v[48:51], v[8:11], a[208:215], v104
    v_smfmac_f32_16x16x64_bf16 v[52:55], v[8:11], v[144:151], v104
    s_waitcnt lgkmcnt(0)
    s_barrier
    ds_read_b128 v[0:3], v116 offset:16384
    ds_read_b128 v[4:7], v116 offset:17408
    v_smfmac_f32_16x16x64_bf16 v[32:35], v[12:15], a[24:31], v104
    ds_read_b128 v[16:19], v116 offset:20480
    v_smfmac_f32_16x16x64_bf16 v[40:43], v[12:15], a[152:159], v104
    ds_read_b128 v[20:23], v116 offset:21504
    v_smfmac_f32_16x16x64_bf16 v[36:39], v[12:15], a[88:95], v104
    ds_read_b128 v[24:27], v116 offset:22528
    v_smfmac_f32_16x16x64_bf16 v[44:47], v[12:15], v[64:71], v104
    ds_read_b128 v[28:31], v116 offset:23552
    v_smfmac_f32_16x16x64_bf16 v[48:51], v[12:15], a[216:223], v104
    v_smfmac_f32_16x16x64_bf16 v[52:55], v[12:15], v[152:159], v104
    s_waitcnt lgkmcnt(5)
    v_smfmac_f32_16x16x64_bf16 v[32:35], v[0:3], a[0:7], v104
    ds_read_b128 v[56:59], v117 offset:8192
    ds_read_b128 v[60:63], v117 offset:9216
    v_smfmac_f32_16x16x64_bf16 v[40:43], v[0:3], a[128:135], v104
    ds_read_b128 v[64:67], v117 offset:10240
    ds_read_b128 v[68:71], v117 offset:11264
    s_waitcnt lgkmcnt(8)
    v_smfmac_f32_16x16x64_bf16 v[32:35], v[4:7], a[8:15], v104
    s_mov_b32 m0, s68
    s_add_u32 s17, s34, 0x40000
    v_smfmac_f32_16x16x64_bf16 v[40:43], v[4:7], a[136:143], v104
    buffer_load_dwordx4 v124, s[4:7], s34 offen sc1 lds
    s_waitcnt lgkmcnt(7)
    v_smfmac_f32_16x16x64_bf16 v[32:35], v[16:19], a[32:39], v104
    v_smfmac_f32_16x16x64_bf16 v[40:43], v[16:19], a[160:167], v104
    buffer_load_dwordx4 v124, s[4:7], s34 offen offset:1024 sc1 lds
    s_waitcnt lgkmcnt(6)
    v_smfmac_f32_16x16x64_bf16 v[32:35], v[20:23], a[40:47], v104
    v_smfmac_f32_16x16x64_bf16 v[40:43], v[20:23], a[168:175], v104
    buffer_load_dwordx4 v[96:99], v124, s[4:7], s35 offen sc1
    s_waitcnt lgkmcnt(5)
    v_smfmac_f32_16x16x64_bf16 v[32:35], v[24:27], a[48:55], v104
    v_smfmac_f32_16x16x64_bf16 v[40:43], v[24:27], a[176:183], v104
    buffer_load_dwordx4 v[100:103], v124, s[4:7], s35 offen offset:1024 sc1
    s_mov_b32 s34, s17
    s_waitcnt lgkmcnt(4)
    v_smfmac_f32_16x16x64_bf16 v[32:35], v[28:31], a[56:63], v104
    s_add_u32 s35, s35, 0x40000
    v_smfmac_f32_16x16x64_bf16 v[40:43], v[28:31], a[184:191], v104
    v_smfmac_f32_16x16x64_bf16 v[36:39], v[0:3], a[64:71], v104
    v_smfmac_f32_16x16x64_bf16 v[44:47], v[0:3], v[72:79], v104
    ds_read_b128 v[72:75], v117 offset:12288
    ds_read_b128 v[76:79], v117 offset:13312
    v_smfmac_f32_16x16x64_bf16 v[36:39], v[4:7], a[72:79], v104
    v_smfmac_f32_16x16x64_bf16 v[44:47], v[4:7], v[80:87], v104
    ds_read_b128 v[80:83], v117 offset:14336
    ds_read_b128 v[84:87], v117 offset:15360
    v_smfmac_f32_16x16x64_bf16 v[36:39], v[16:19], a[96:103], v104
    v_add_f32 v40, v40, v42
    v_add_f32 v41, v41, v43
    s_waitcnt lgkmcnt(6)
    v_smfmac_f32_16x16x64_bf16 v[44:47], v[16:19], v[56:63], v104
    v_smfmac_f32_16x16x64_bf16 v[36:39], v[20:23], a[104:111], v104
    v_add_f32 v32, v32, v34
    v_add_f32 v33, v33, v35
    s_waitcnt lgkmcnt(4)
    v_smfmac_f32_16x16x64_bf16 v[44:47], v[20:23], v[64:71], v104
    v_smfmac_f32_16x16x64_bf16 v[36:39], v[24:27], a[112:119], v104
    v_cvt_pk_bf16_f32 v40, v40, v41
    v_cvt_pk_bf16_f32 v41, v32, v33
    s_waitcnt lgkmcnt(2)
    v_smfmac_f32_16x16x64_bf16 v[44:47], v[24:27], v[72:79], v104
    v_smfmac_f32_16x16x64_bf16 v[36:39], v[28:31], a[120:127], v104
    ds_write_b64 v118, v[40:41] offset:0
    s_waitcnt lgkmcnt(1)
    v_smfmac_f32_16x16x64_bf16 v[44:47], v[28:31], v[80:87], v104
    ds_read_b128 v[8:11], v116 offset:2048
    ds_read_b128 v[12:15], v116 offset:3072
    v_smfmac_f32_16x16x64_bf16 v[48:51], v[0:3], a[192:199], v104
    v_smfmac_f32_16x16x64_bf16 v[52:55], v[0:3], v[128:135], v104
    ds_read_b128 v[0:3], v116 offset:0
    s_nop 2
    v_add_f32 v44, v44, v46
    v_add_f32 v45, v45, v47
    v_add_f32 v36, v36, v38
    v_add_f32 v37, v37, v39
    v_cvt_pk_bf16_f32 v44, v44, v45
    v_cvt_pk_bf16_f32 v45, v36, v37
    ds_write_b64 v118, v[44:45] offset:512
    v_smfmac_f32_16x16x64_bf16 v[48:51], v[4:7], a[200:207], v104
    v_smfmac_f32_16x16x64_bf16 v[52:55], v[4:7], v[136:143], v104
    ds_read_b128 v[4:7], v116 offset:1024
    s_waitcnt lgkmcnt(1)
    s_barrier
    ds_read_b64_tr_b16 v[32:33], v119 offset:0
    ds_read_b64_tr_b16 v[34:35], v119 offset:512
    ds_read_b64_tr_b16 v[36:37], v119 offset:1024
    ds_read_b64_tr_b16 v[38:39], v119 offset:1536
    v_smfmac_f32_16x16x64_bf16 v[48:51], v[16:19], a[224:231], v104
    ds_read_b64_tr_b16 v[40:41], v119 offset:2048
    ds_read_b64_tr_b16 v[42:43], v119 offset:2560
    v_smfmac_f32_16x16x64_bf16 v[52:55], v[16:19], v[160:167], v104
    ds_read_b64_tr_b16 v[44:45], v119 offset:3072
    ds_read_b64_tr_b16 v[46:47], v119 offset:3584
    ds_read_b128 v[16:19], v116 offset:4096
    v_smfmac_f32_16x16x64_bf16 v[48:51], v[20:23], a[232:239], v104
    v_smfmac_f32_16x16x64_bf16 v[52:55], v[20:23], v[168:175], v104
    ds_read_b128 v[20:23], v116 offset:5120
    v_smfmac_f32_16x16x64_bf16 v[48:51], v[24:27], a[240:247], v104
    v_smfmac_f32_16x16x64_bf16 v[52:55], v[24:27], v[176:183], v104
    ds_read_b128 v[24:27], v116 offset:6144
    v_smfmac_f32_16x16x64_bf16 v[48:51], v[28:31], a[248:255], v104
    v_smfmac_f32_16x16x64_bf16 v[52:55], v[28:31], v[184:191], v104
    ds_read_b128 v[28:31], v116 offset:7168
    s_waitcnt lgkmcnt(4)
    v_mfma_f32_16x16x32_bf16 v[56:59], v[32:35], v[32:35], 0
    v_mfma_f32_16x16x32_bf16 v[60:63], v[8:11], v[40:43], 0
    buffer_store_dwordx4 v[36:39], v116, s[4:7], s36 offen offset:1024 sc1
    s_add_u32 s36, s36, 0x20000
    v_mfma_f32_16x16x32_bf16 v[56:59], v[36:39], v[36:39], v[56:59]
    v_mfma_f32_16x16x32_bf16 v[60:63], v[12:15], v[44:47], v[60:63]
    v_mfma_f32_16x16x32_bf16 v[56:59], v[40:43], v[40:43], v[56:59]
    v_mfma_f32_16x16x32_bf16 v[60:63], v[0:3], v[32:35], v[60:63]
    v_cvt_pk_bf16_f32 v48, v48, v49
    v_cvt_pk_bf16_f32 v49, v50, v51
    v_cvt_pk_bf16_f32 v50, v52, v53
    v_cvt_pk_bf16_f32 v51, v54, v55
    v_mfma_f32_16x16x32_bf16 v[56:59], v[44:47], v[44:47], v[56:59]
    v_mfma_f32_16x16x32_bf16 v[60:63], v[4:7], v[36:39], v[60:63]
    buffer_store_dwordx4 v[48:51], v116, s[4:7], s37 offen sc1
    s_add_u32 s37, s37, 0x20000
    s_waitcnt lgkmcnt(3)
    v_mfma_f32_16x16x32_bf16 v[64:67], v[16:19], v[32:35], 0
    s_waitcnt lgkmcnt(2)
    v_mfma_f32_16x16x32_bf16 v[64:67], v[20:23], v[36:39], v[64:67]
    s_cmp_eq_u32 s14, 63
    s_cbranch_scc1 main_kernel_done
    s_waitcnt lgkmcnt(1)
    v_mfma_f32_16x16x32_bf16 v[64:67], v[24:27], v[40:43], v[64:67]
    s_waitcnt lgkmcnt(0)
    v_mfma_f32_16x16x32_bf16 v[64:67], v[28:31], v[44:47], v[64:67]
    v_mov_b64 v[16:17], 0
    v_mov_b64 v[18:19], 0
    v_mov_b64 v[20:21], 0
    v_mov_b64 v[22:23], 0
    v_max3_f32 v105, v60, v61, v62
    v_max3_f32 v127, v63, v56, v57
    s_nop 1
    v_max3_f32 v127, v64, v65, v127
    v_max3_f32 v105, v66, v67, v105
    v_max_f32 v105, v105, v127
    v_mov_b32 v127, v105
    v_mov_b64 v[0:1], 0
    v_mov_b64 v[2:3], 0
    v_permlane32_swap_b32 v105, v127
    v_max_f32 v105, v105, v127
    v_mov_b32 v127, v105
    v_mov_b64 v[4:5], 0
    v_mov_b64 v[6:7], 0
    v_permlane16_swap_b32 v105, v127
    v_max_f32 v105, v105, v127
    v_mul_f32 v105, s42, v105
    v_fma_f32 v56, v56, s42, -v105
    v_fma_f32 v57, v57, s42, -v105
    v_exp_f32 v56, v56
    v_exp_f32 v57, v57
    v_fma_f32 v60, v60, s42, -v105
    v_fma_f32 v61, v61, s42, -v105
    v_fma_f32 v62, v62, s42, -v105
    v_fma_f32 v63, v63, s42, -v105
    v_fma_f32 v64, v64, s42, -v105
    v_fma_f32 v65, v65, s42, -v105
    v_fma_f32 v66, v66, s42, -v105
    v_fma_f32 v67, v67, s42, -v105
    v_cvt_pk_bf16_f32 v58, v56, v57
    v_cvt_pk_bf16_f32 v59, v56, v57
    v_exp_f32 v60, v60
    v_exp_f32 v61, v61
    v_mfma_f32_16x16x16_bf16 v[72:75], v[58:59], v[110:111], 0
    v_exp_f32 v62, v62
    v_exp_f32 v63, v63
    v_mfma_f32_16x16x16_bf16 v[76:79], v[58:59], v[48:49], 0
    v_exp_f32 v64, v64
    v_exp_f32 v65, v65
    v_mfma_f32_16x16x16_bf16 v[80:83], v[58:59], v[50:51], 0
    v_exp_f32 v66, v66
    v_exp_f32 v67, v67
    v_cvt_pk_bf16_f32 v84, v60, v61
    v_cvt_pk_bf16_f32 v85, v62, v63
    v_cvt_pk_bf16_f32 v86, v64, v65
    v_cvt_pk_bf16_f32 v87, v66, v67
    v_mov_b64 v[24:25], 0
    v_mov_b64 v[26:27], 0
    v_mfma_f32_16x16x32_bf16 v[72:75], v[84:87], v[106:109], v[72:75]
    v_mov_b64 v[28:29], 0
    v_mov_b64 v[30:31], 0
    v_mfma_f32_16x16x32_bf16 v[76:79], v[84:87], v[88:91], v[76:79]
    v_mfma_f32_16x16x32_bf16 v[80:83], v[84:87], v[92:95], v[80:83]
    ds_read_b128 v[56:59], v117 offset:16384
    ds_read_b128 v[60:63], v117 offset:17408
    ds_read_b128 v[64:67], v117 offset:20480
    ds_read_b128 v[68:71], v117 offset:21504
    v_rcp_f32 v74, v74
    v_rcp_f32 v75, v75
    s_nop 0
    v_mul_f32 v78, v78, v74
    v_mul_f32 v79, v79, v75
    v_cvt_pk_bf16_f32 v76, v78, v79
    ds_write_b32 v120, v76 offset:0
    v_mul_f32 v82, v82, v74
    v_mul_f32 v83, v83, v75
    v_cvt_pk_bf16_f32 v80, v82, v83
    ds_write_b32 v120, v80 offset:256
    s_waitcnt lgkmcnt(0)
    s_barrier
    ds_read_b64_tr_b16 v[80:81], v121 offset:0
    ds_read_b64_tr_b16 v[82:83], v121 offset:128
    ds_read_b64_tr_b16 v[84:85], v121 offset:1024
    ds_read_b64_tr_b16 v[86:87], v121 offset:1152
    v_mov_b64 v[8:9], 0
    v_mov_b64 v[10:11], 0
    v_mov_b64 v[12:13], 0
    v_mov_b64 v[14:15], 0
    s_waitcnt lgkmcnt(2)
    s_bfe_i32 s71, s14, 0x10001
    v_smfmac_f32_16x16x64_bf16 v[0:3], v[80:83], v[192:199], v104
    v_smfmac_f32_16x16x64_bf16 v[4:7], v[80:83], v[208:215], v104
    ds_read_b128 v[72:75], v117 offset:18432
    ds_read_b128 v[76:79], v117 offset:19456
    s_waitcnt lgkmcnt(2)
    v_smfmac_f32_16x16x64_bf16 v[0:3], v[84:87], v[200:207], v104
    ds_read_b128 v[32:35], v117 offset:22528
    ds_read_b128 v[36:39], v117 offset:23552
    v_smfmac_f32_16x16x64_bf16 v[4:7], v[84:87], v[216:223], v104
    ds_read_b128 v[40:43], v117 offset:24576
    ds_read_b128 v[44:47], v117 offset:25600
    v_smfmac_f32_16x16x64_bf16 v[8:11], v[80:83], v[224:231], v104
    ds_read_b128 v[48:51], v117 offset:28672
    ds_read_b128 v[52:55], v117 offset:29696
    v_smfmac_f32_16x16x64_bf16 v[12:15], v[80:83], v[240:247], v104
    v_smfmac_f32_16x16x64_bf16 v[8:11], v[84:87], v[232:239], v104
    v_add_f32 v0, v0, v2
    v_add_f32 v1, v1, v3
    v_add_f32 v4, v4, v6
    v_add_f32 v5, v5, v7
    v_smfmac_f32_16x16x64_bf16 v[12:15], v[84:87], v[248:255], v104
    v_cvt_pk_bf16_f32 v0, v0, v1
    v_cvt_pk_bf16_f32 v1, v4, v5
    v_bfi_b32 v0, 1, s71, v0
    buffer_store_dwordx2 v[0:1], v122, s[4:7], s20 offen
    v_smfmac_f32_16x16x64_bf16 v[16:19], v[80:83], v[56:63], v104
    ds_read_b128 v[56:59], v117 offset:26624
    ds_read_b128 v[60:63], v117 offset:27648
    v_smfmac_f32_16x16x64_bf16 v[20:23], v[80:83], v[64:71], v104
    ds_read_b128 v[64:67], v117 offset:30720
    ds_read_b128 v[68:71], v117 offset:31744
    s_waitcnt lgkmcnt(10)
    v_smfmac_f32_16x16x64_bf16 v[16:19], v[84:87], v[72:79], v104
    v_add_f32 v8, v8, v10
    v_add_f32 v9, v9, v11
    v_add_f32 v12, v12, v14
    v_add_f32 v13, v13, v15
    s_waitcnt lgkmcnt(8)
    v_smfmac_f32_16x16x64_bf16 v[20:23], v[84:87], v[32:39], v104
    v_cvt_pk_bf16_f32 v8, v8, v9
    v_cvt_pk_bf16_f32 v9, v12, v13
    v_bfi_b32 v8, 1, s71, v8
    buffer_store_dwordx2 v[8:9], v122, s[4:7], s21 offen
    s_waitcnt lgkmcnt(6)
    v_smfmac_f32_16x16x64_bf16 v[24:27], v[80:83], v[40:47], v104
    s_waitcnt lgkmcnt(4)
    v_smfmac_f32_16x16x64_bf16 v[28:31], v[80:83], v[48:55], v104
    s_waitcnt lgkmcnt(2)
    v_smfmac_f32_16x16x64_bf16 v[24:27], v[84:87], v[56:63], v104
    v_add_f32 v16, v16, v18
    v_add_f32 v17, v17, v19
    v_add_f32 v20, v20, v22
    v_add_f32 v21, v21, v23
    s_waitcnt lgkmcnt(0)
    v_smfmac_f32_16x16x64_bf16 v[28:31], v[84:87], v[64:71], v104
    v_cvt_pk_bf16_f32 v16, v16, v17
    v_cvt_pk_bf16_f32 v17, v20, v21
    v_bfi_b32 v16, 1, s71, v16
    buffer_store_dwordx2 v[16:17], v122, s[4:7], s22 offen
    v_mov_b64 v[32:33], 0
    v_mov_b64 v[34:35], 0
    v_mov_b64 v[36:37], 0
    v_mov_b64 v[38:39], 0
    v_add_f32 v24, v24, v26
    v_add_f32 v25, v25, v27
    v_add_f32 v28, v28, v30
    v_add_f32 v29, v29, v31
    v_cvt_pk_bf16_f32 v24, v24, v25
    v_cvt_pk_bf16_f32 v25, v28, v29
    v_bfi_b32 v24, 1, s71, v24
    buffer_store_dwordx2 v[24:25], v122, s[4:7], s23 offen
    v_mov_b64 v[40:41], 0
    v_mov_b64 v[42:43], 0
    v_mov_b64 v[44:45], 0
    v_mov_b64 v[46:47], 0
    v_mov_b64 v[48:49], 0
    v_mov_b64 v[50:51], 0
    v_mov_b64 v[52:53], 0
    v_mov_b64 v[54:55], 0
    s_mov_b32 s43, 0x100000
    buffer_load_dwordx4 v[56:59], v123, s[4:7], s28 offen sc1
    buffer_load_dwordx4 v[60:63], v123, s[4:7], s29 offen sc1
main_kernel_p1_0_1:
    s_waitcnt vmcnt(0)
main_kernel_p1_0_1c:
    v_bitop3_b32 v105, v56, v58, s71 bitop3:0x7e
    v_bitop3_b32 v127, v60, v62, s71 bitop3:0x7e
    v_or_b32 v105, v105, v127
    v_and_b32 v105, 1, v105
    v_cmp_ne_u32 vcc, 0, v105
    s_cbranch_vccz main_kernel_p1_0_1done
    s_mov_b64 exec, vcc
    buffer_load_dwordx4 v[56:59], v123, s[4:7], s28 offen sc1
    buffer_load_dwordx4 v[60:63], v123, s[4:7], s29 offen sc1
    s_sub_u32 s43, s43, 1
    s_cbranch_scc0 main_kernel_p1_0_1
main_kernel_p1_0_1done:
    s_mov_b64 exec, -1
    v_mfma_f32_16x16x32_bf16 v[64:67], v[112:115], v[56:59], 0
    v_mfma_f32_16x16x32_bf16 v[64:67], v[112:115], v[60:63], v[64:67]
    v_mov_b64 v[72:73], -1
    v_mov_b64 v[74:75], -1
    s_add_u32 s14, s14, 1
    s_nop 4
    v_add_f32_dpp v68, v64, v64 row_ror:4 row_mask:0xf bank_mask:0xf
    v_add_f32_dpp v69, v65, v65 row_ror:4 row_mask:0xf bank_mask:0xf
    v_add_f32_dpp v70, v66, v66 row_ror:4 row_mask:0xf bank_mask:0xf
    v_add_f32_dpp v71, v67, v67 row_ror:4 row_mask:0xf bank_mask:0xf
    v_add_f32_dpp v64, v68, v68 row_ror:8 row_mask:0xf bank_mask:0xf
    v_add_f32_dpp v65, v69, v69 row_ror:8 row_mask:0xf bank_mask:0xf
    v_add_f32_dpp v66, v70, v70 row_ror:8 row_mask:0xf bank_mask:0xf
    v_add_f32_dpp v67, v71, v71 row_ror:8 row_mask:0xf bank_mask:0xf
    s_mov_b64 exec, s[40:41]
    v_cvt_pk_bf16_f32 v64, v64, v65
    v_cvt_pk_bf16_f32 v65, v66, v67
    buffer_store_dword v64, v125, s[4:7], s33 offen
    buffer_store_dword v65, v125, s[4:7], s33 offen offset:16
    buffer_store_dword v72, v125, s[4:7], s32 offen
    buffer_store_dword v72, v125, s[4:7], s32 offen offset:16
    s_mov_b64 exec, -1
    s_add_u32 s15, s14, 1
    s_cmp_lg_u32 s15, s75
    s_cbranch_scc1 main_kernel_nokv0_1
    v_readfirstlane_b32 s18, v126
    s_nop 0
    s_cmp_ge_u32 s18, 64
    s_cbranch_scc1 main_kernel_kvok0_1
    s_mov_b32 s43, 0x200000
    v_mov_b32 v127, s69
main_kernel_wkvn1:
    buffer_load_dword v126, v127, s[44:47], 0 offen sc1
    s_waitcnt vmcnt(0)
    v_readfirstlane_b32 s18, v126
    s_nop 0
    s_cmp_ge_u32 s18, 64
    s_cbranch_scc1 main_kernel_wkvn1_ok
    s_sleep 2
    s_sub_u32 s43, s43, 1
    s_cbranch_scc0 main_kernel_wkvn1
main_kernel_wkvn1_ok:
main_kernel_kvok0_1:
    s_min_u32 s15, s75, 8
    s_add_u32 s75, s75, s15
    s_add_u32 s69, s69, 4
    s_cmp_ge_u32 s75, 64
    s_cselect_b32 s75, 0x7fff, s75
main_kernel_nokv0_1:
    ds_read_b128 v[56:59], v117 offset:4096
    ds_read_b128 v[60:63], v117 offset:5120
    ds_read_b128 v[64:67], v117 offset:6144
    ds_read_b128 v[68:71], v117 offset:7168
    ds_read_b128 v[72:75], v117 offset:0
    ds_read_b128 v[76:79], v117 offset:1024
    ds_read_b128 v[80:83], v117 offset:2048
    ds_read_b128 v[84:87], v117 offset:3072
    s_mov_b32 s43, 0x100000
    buffer_load_dwordx4 v[8:11], v124, s[4:7], s33 offen sc1
    buffer_load_dwordx4 v[12:15], v124, s[4:7], s33 offen offset:1024 sc1
main_kernel_p2_1_1:
    s_waitcnt vmcnt(0)
main_kernel_p2_1_1c:
    v_max3_u32 v105, v8, v9, v10
    v_max3_u32 v127, v11, v12, v13
    v_max3_u32 v105, v14, v15, v105
    v_max_u32 v105, v105, v127
    v_cmp_eq_u32 vcc, -1, v105
    s_cbranch_vccz main_kernel_p2_1_1done
    s_mov_b64 exec, vcc
    buffer_load_dwordx4 v[8:11], v124, s[4:7], s33 offen sc1
    buffer_load_dwordx4 v[12:15], v124, s[4:7], s33 offen offset:1024 sc1
    s_sub_u32 s43, s43, 1
    s_cbranch_scc0 main_kernel_p2_1_1
main_kernel_p2_1_1done:
    s_mov_b64 exec, -1
    ds_write_b128 v124, v[8:11] offset:16384
    ds_write_b128 v124, v[12:15] offset:17408
    v_smfmac_f32_16x16x64_bf16 v[32:35], v[8:11], a[16:23], v104
    v_smfmac_f32_16x16x64_bf16 v[40:43], v[8:11], a[144:151], v104
    v_smfmac_f32_16x16x64_bf16 v[36:39], v[8:11], a[80:87], v104
    s_waitcnt lgkmcnt(8)
    v_smfmac_f32_16x16x64_bf16 v[44:47], v[8:11], v[56:63], v104
    v_smfmac_f32_16x16x64_bf16 v[48:51], v[8:11], a[208:215], v104
    v_smfmac_f32_16x16x64_bf16 v[52:55], v[8:11], v[144:151], v104
    s_waitcnt lgkmcnt(0)
    s_barrier
    ds_read_b128 v[0:3], v116 offset:16384
    ds_read_b128 v[4:7], v116 offset:17408
    v_smfmac_f32_16x16x64_bf16 v[32:35], v[12:15], a[24:31], v104
    ds_read_b128 v[16:19], v116 offset:20480
    v_smfmac_f32_16x16x64_bf16 v[40:43], v[12:15], a[152:159], v104
    ds_read_b128 v[20:23], v116 offset:21504
    v_smfmac_f32_16x16x64_bf16 v[36:39], v[12:15], a[88:95], v104
    ds_read_b128 v[24:27], v116 offset:22528
    v_smfmac_f32_16x16x64_bf16 v[44:47], v[12:15], v[64:71], v104
    ds_read_b128 v[28:31], v116 offset:23552
    v_smfmac_f32_16x16x64_bf16 v[48:51], v[12:15], a[216:223], v104
    v_smfmac_f32_16x16x64_bf16 v[52:55], v[12:15], v[152:159], v104
    s_waitcnt lgkmcnt(5)
    v_smfmac_f32_16x16x64_bf16 v[32:35], v[0:3], a[0:7], v104
    ds_read_b128 v[56:59], v117 offset:8192
    ds_read_b128 v[60:63], v117 offset:9216
    v_smfmac_f32_16x16x64_bf16 v[40:43], v[0:3], a[128:135], v104
    ds_read_b128 v[64:67], v117 offset:10240
    ds_read_b128 v[68:71], v117 offset:11264
    s_waitcnt lgkmcnt(8)
    v_smfmac_f32_16x16x64_bf16 v[32:35], v[4:7], a[8:15], v104
    s_mov_b32 m0, s67
    s_add_u32 s17, s34, 0x40000
    v_smfmac_f32_16x16x64_bf16 v[40:43], v[4:7], a[136:143], v104
    buffer_load_dwordx4 v124, s[4:7], s34 offen sc1 lds
    s_waitcnt lgkmcnt(7)
    v_smfmac_f32_16x16x64_bf16 v[32:35], v[16:19], a[32:39], v104
    v_smfmac_f32_16x16x64_bf16 v[40:43], v[16:19], a[160:167], v104
    buffer_load_dwordx4 v124, s[4:7], s34 offen offset:1024 sc1 lds
    s_waitcnt lgkmcnt(6)
    v_smfmac_f32_16x16x64_bf16 v[32:35], v[20:23], a[40:47], v104
    v_smfmac_f32_16x16x64_bf16 v[40:43], v[20:23], a[168:175], v104
    buffer_load_dwordx4 v[88:91], v124, s[4:7], s35 offen sc1
    s_waitcnt lgkmcnt(5)
    v_smfmac_f32_16x16x64_bf16 v[32:35], v[24:27], a[48:55], v104
    v_smfmac_f32_16x16x64_bf16 v[40:43], v[24:27], a[176:183], v104
    buffer_load_dwordx4 v[92:95], v124, s[4:7], s35 offen offset:1024 sc1
    s_mov_b32 s34, s17
    s_waitcnt lgkmcnt(4)
    v_smfmac_f32_16x16x64_bf16 v[32:35], v[28:31], a[56:63], v104
    s_add_u32 s35, s35, 0x40000
    v_smfmac_f32_16x16x64_bf16 v[40:43], v[28:31], a[184:191], v104
    v_smfmac_f32_16x16x64_bf16 v[36:39], v[0:3], a[64:71], v104
    v_smfmac_f32_16x16x64_bf16 v[44:47], v[0:3], v[72:79], v104
    ds_read_b128 v[72:75], v117 offset:12288
    ds_read_b128 v[76:79], v117 offset:13312
    v_smfmac_f32_16x16x64_bf16 v[36:39], v[4:7], a[72:79], v104
    v_smfmac_f32_16x16x64_bf16 v[44:47], v[4:7], v[80:87], v104
    ds_read_b128 v[80:83], v117 offset:14336
    ds_read_b128 v[84:87], v117 offset:15360
    v_smfmac_f32_16x16x64_bf16 v[36:39], v[16:19], a[96:103], v104
    v_add_f32 v40, v40, v42
    v_add_f32 v41, v41, v43
    s_waitcnt lgkmcnt(6)
    v_smfmac_f32_16x16x64_bf16 v[44:47], v[16:19], v[56:63], v104
    v_smfmac_f32_16x16x64_bf16 v[36:39], v[20:23], a[104:111], v104
    v_add_f32 v32, v32, v34
    v_add_f32 v33, v33, v35
    s_waitcnt lgkmcnt(4)
    v_smfmac_f32_16x16x64_bf16 v[44:47], v[20:23], v[64:71], v104
    v_smfmac_f32_16x16x64_bf16 v[36:39], v[24:27], a[112:119], v104
    v_cvt_pk_bf16_f32 v40, v40, v41
    v_cvt_pk_bf16_f32 v41, v32, v33
    s_waitcnt lgkmcnt(2)
    v_smfmac_f32_16x16x64_bf16 v[44:47], v[24:27], v[72:79], v104
    v_smfmac_f32_16x16x64_bf16 v[36:39], v[28:31], a[120:127], v104
    ds_write_b64 v118, v[40:41] offset:0
    s_waitcnt lgkmcnt(1)
    v_smfmac_f32_16x16x64_bf16 v[44:47], v[28:31], v[80:87], v104
    ds_read_b128 v[8:11], v116 offset:10240
    ds_read_b128 v[12:15], v116 offset:11264
    v_smfmac_f32_16x16x64_bf16 v[48:51], v[0:3], a[192:199], v104
    v_smfmac_f32_16x16x64_bf16 v[52:55], v[0:3], v[128:135], v104
    ds_read_b128 v[0:3], v116 offset:8192
    s_nop 2
    v_add_f32 v44, v44, v46
    v_add_f32 v45, v45, v47
    v_add_f32 v36, v36, v38
    v_add_f32 v37, v37, v39
    v_cvt_pk_bf16_f32 v44, v44, v45
    v_cvt_pk_bf16_f32 v45, v36, v37
    ds_write_b64 v118, v[44:45] offset:512
    v_smfmac_f32_16x16x64_bf16 v[48:51], v[4:7], a[200:207], v104
    v_smfmac_f32_16x16x64_bf16 v[52:55], v[4:7], v[136:143], v104
    ds_read_b128 v[4:7], v116 offset:9216
    s_waitcnt lgkmcnt(1)
    s_barrier
    ds_read_b64_tr_b16 v[32:33], v119 offset:0
    ds_read_b64_tr_b16 v[34:35], v119 offset:512
    ds_read_b64_tr_b16 v[36:37], v119 offset:1024
    ds_read_b64_tr_b16 v[38:39], v119 offset:1536
    v_smfmac_f32_16x16x64_bf16 v[48:51], v[16:19], a[224:231], v104
    ds_read_b64_tr_b16 v[40:41], v119 offset:2048
    ds_read_b64_tr_b16 v[42:43], v119 offset:2560
    v_smfmac_f32_16x16x64_bf16 v[52:55], v[16:19], v[160:167], v104
    ds_read_b64_tr_b16 v[44:45], v119 offset:3072
    ds_read_b64_tr_b16 v[46:47], v119 offset:3584
    ds_read_b128 v[16:19], v116 offset:12288
    v_smfmac_f32_16x16x64_bf16 v[48:51], v[20:23], a[232:239], v104
    v_smfmac_f32_16x16x64_bf16 v[52:55], v[20:23], v[168:175], v104
    ds_read_b128 v[20:23], v116 offset:13312
    v_smfmac_f32_16x16x64_bf16 v[48:51], v[24:27], a[240:247], v104
    v_smfmac_f32_16x16x64_bf16 v[52:55], v[24:27], v[176:183], v104
    ds_read_b128 v[24:27], v116 offset:14336
    v_smfmac_f32_16x16x64_bf16 v[48:51], v[28:31], a[248:255], v104
    v_smfmac_f32_16x16x64_bf16 v[52:55], v[28:31], v[184:191], v104
    ds_read_b128 v[28:31], v116 offset:15360
    s_waitcnt lgkmcnt(4)
    v_mfma_f32_16x16x32_bf16 v[56:59], v[32:35], v[32:35], 0
    v_mfma_f32_16x16x32_bf16 v[60:63], v[8:11], v[40:43], 0
    buffer_store_dwordx4 v[36:39], v116, s[4:7], s36 offen offset:1024 sc1
    s_add_u32 s36, s36, 0x20000
    v_mfma_f32_16x16x32_bf16 v[56:59], v[36:39], v[36:39], v[56:59]
    v_mfma_f32_16x16x32_bf16 v[60:63], v[12:15], v[44:47], v[60:63]
    v_mfma_f32_16x16x32_bf16 v[56:59], v[40:43], v[40:43], v[56:59]
    v_mfma_f32_16x16x32_bf16 v[60:63], v[0:3], v[32:35], v[60:63]
    v_cvt_pk_bf16_f32 v48, v48, v49
    v_cvt_pk_bf16_f32 v49, v50, v51
    v_cvt_pk_bf16_f32 v50, v52, v53
    v_cvt_pk_bf16_f32 v51, v54, v55
    v_mfma_f32_16x16x32_bf16 v[56:59], v[44:47], v[44:47], v[56:59]
    v_mfma_f32_16x16x32_bf16 v[60:63], v[4:7], v[36:39], v[60:63]
    buffer_store_dwordx4 v[48:51], v116, s[4:7], s37 offen sc1
    s_add_u32 s37, s37, 0x20000
    s_waitcnt lgkmcnt(3)
    v_mfma_f32_16x16x32_bf16 v[64:67], v[16:19], v[32:35], 0
    s_waitcnt lgkmcnt(2)
    v_mfma_f32_16x16x32_bf16 v[64:67], v[20:23], v[36:39], v[64:67]
    s_cmp_eq_u32 s14, 63
    s_cbranch_scc1 main_kernel_done
    s_waitcnt lgkmcnt(1)
    v_mfma_f32_16x16x32_bf16 v[64:67], v[24:27], v[40:43], v[64:67]
    s_waitcnt lgkmcnt(0)
    v_mfma_f32_16x16x32_bf16 v[64:67], v[28:31], v[44:47], v[64:67]
    v_mov_b64 v[16:17], 0
    v_mov_b64 v[18:19], 0
    v_mov_b64 v[20:21], 0
    v_mov_b64 v[22:23], 0
    v_max3_f32 v105, v60, v61, v62
    v_max3_f32 v127, v63, v56, v57
    s_nop 1
    v_max3_f32 v127, v64, v65, v127
    v_max3_f32 v105, v66, v67, v105
    v_max_f32 v105, v105, v127
    v_mov_b32 v127, v105
    v_mov_b64 v[0:1], 0
    v_mov_b64 v[2:3], 0
    v_permlane32_swap_b32 v105, v127
    v_max_f32 v105, v105, v127
    v_mov_b32 v127, v105
    v_mov_b64 v[4:5], 0
    v_mov_b64 v[6:7], 0
    v_permlane16_swap_b32 v105, v127
    v_max_f32 v105, v105, v127
    v_mul_f32 v105, s42, v105
    v_fma_f32 v56, v56, s42, -v105
    v_fma_f32 v57, v57, s42, -v105
    v_exp_f32 v56, v56
    v_exp_f32 v57, v57
    v_fma_f32 v60, v60, s42, -v105
    v_fma_f32 v61, v61, s42, -v105
    v_fma_f32 v62, v62, s42, -v105
    v_fma_f32 v63, v63, s42, -v105
    v_fma_f32 v64, v64, s42, -v105
    v_fma_f32 v65, v65, s42, -v105
    v_fma_f32 v66, v66, s42, -v105
    v_fma_f32 v67, v67, s42, -v105
    v_cvt_pk_bf16_f32 v58, v56, v57
    v_cvt_pk_bf16_f32 v59, v56, v57
    v_exp_f32 v60, v60
    v_exp_f32 v61, v61
    v_mfma_f32_16x16x16_bf16 v[72:75], v[58:59], v[110:111], 0
    v_exp_f32 v62, v62
    v_exp_f32 v63, v63
    v_mfma_f32_16x16x16_bf16 v[76:79], v[58:59], v[48:49], 0
    v_exp_f32 v64, v64
    v_exp_f32 v65, v65
    v_mfma_f32_16x16x16_bf16 v[80:83], v[58:59], v[50:51], 0
    v_exp_f32 v66, v66
    v_exp_f32 v67, v67
    v_cvt_pk_bf16_f32 v84, v60, v61
    v_cvt_pk_bf16_f32 v85, v62, v63
    v_cvt_pk_bf16_f32 v86, v64, v65
    v_cvt_pk_bf16_f32 v87, v66, v67
    v_mov_b64 v[24:25], 0
    v_mov_b64 v[26:27], 0
    v_mfma_f32_16x16x32_bf16 v[72:75], v[84:87], v[106:109], v[72:75]
    v_mov_b64 v[28:29], 0
    v_mov_b64 v[30:31], 0
    v_mfma_f32_16x16x32_bf16 v[76:79], v[84:87], v[96:99], v[76:79]
    v_mfma_f32_16x16x32_bf16 v[80:83], v[84:87], v[100:103], v[80:83]
    ds_read_b128 v[56:59], v117 offset:16384
    ds_read_b128 v[60:63], v117 offset:17408
    ds_read_b128 v[64:67], v117 offset:20480
    ds_read_b128 v[68:71], v117 offset:21504
    v_rcp_f32 v74, v74
    v_rcp_f32 v75, v75
    s_nop 0
    v_mul_f32 v78, v78, v74
    v_mul_f32 v79, v79, v75
    v_cvt_pk_bf16_f32 v76, v78, v79
    ds_write_b32 v120, v76 offset:0
    v_mul_f32 v82, v82, v74
    v_mul_f32 v83, v83, v75
    v_cvt_pk_bf16_f32 v80, v82, v83
    ds_write_b32 v120, v80 offset:256
    s_waitcnt lgkmcnt(0)
    s_barrier
    ds_read_b64_tr_b16 v[80:81], v121 offset:0
    ds_read_b64_tr_b16 v[82:83], v121 offset:128
    ds_read_b64_tr_b16 v[84:85], v121 offset:1024
    ds_read_b64_tr_b16 v[86:87], v121 offset:1152
    v_mov_b64 v[8:9], 0
    v_mov_b64 v[10:11], 0
    v_mov_b64 v[12:13], 0
    v_mov_b64 v[14:15], 0
    s_waitcnt lgkmcnt(2)
    s_bfe_i32 s71, s14, 0x10001
    v_smfmac_f32_16x16x64_bf16 v[0:3], v[80:83], v[192:199], v104
    v_smfmac_f32_16x16x64_bf16 v[4:7], v[80:83], v[208:215], v104
    ds_read_b128 v[72:75], v117 offset:18432
    ds_read_b128 v[76:79], v117 offset:19456
    s_waitcnt lgkmcnt(2)
    v_smfmac_f32_16x16x64_bf16 v[0:3], v[84:87], v[200:207], v104
    ds_read_b128 v[32:35], v117 offset:22528
    ds_read_b128 v[36:39], v117 offset:23552
    v_smfmac_f32_16x16x64_bf16 v[4:7], v[84:87], v[216:223], v104
    ds_read_b128 v[40:43], v117 offset:24576
    ds_read_b128 v[44:47], v117 offset:25600
    v_smfmac_f32_16x16x64_bf16 v[8:11], v[80:83], v[224:231], v104
    ds_read_b128 v[48:51], v117 offset:28672
    ds_read_b128 v[52:55], v117 offset:29696
    v_smfmac_f32_16x16x64_bf16 v[12:15], v[80:83], v[240:247], v104
    v_smfmac_f32_16x16x64_bf16 v[8:11], v[84:87], v[232:239], v104
    v_add_f32 v0, v0, v2
    v_add_f32 v1, v1, v3
    v_add_f32 v4, v4, v6
    v_add_f32 v5, v5, v7
    v_smfmac_f32_16x16x64_bf16 v[12:15], v[84:87], v[248:255], v104
    v_cvt_pk_bf16_f32 v0, v0, v1
    v_cvt_pk_bf16_f32 v1, v4, v5
    v_bfi_b32 v0, 1, s71, v0
    buffer_store_dwordx2 v[0:1], v122, s[4:7], s24 offen
    v_smfmac_f32_16x16x64_bf16 v[16:19], v[80:83], v[56:63], v104
    ds_read_b128 v[56:59], v117 offset:26624
    ds_read_b128 v[60:63], v117 offset:27648
    v_smfmac_f32_16x16x64_bf16 v[20:23], v[80:83], v[64:71], v104
    ds_read_b128 v[64:67], v117 offset:30720
    ds_read_b128 v[68:71], v117 offset:31744
    s_waitcnt lgkmcnt(10)
    v_smfmac_f32_16x16x64_bf16 v[16:19], v[84:87], v[72:79], v104
    v_add_f32 v8, v8, v10
    v_add_f32 v9, v9, v11
    v_add_f32 v12, v12, v14
    v_add_f32 v13, v13, v15
    s_waitcnt lgkmcnt(8)
    v_smfmac_f32_16x16x64_bf16 v[20:23], v[84:87], v[32:39], v104
    v_cvt_pk_bf16_f32 v8, v8, v9
    v_cvt_pk_bf16_f32 v9, v12, v13
    v_bfi_b32 v8, 1, s71, v8
    buffer_store_dwordx2 v[8:9], v122, s[4:7], s25 offen
    s_waitcnt lgkmcnt(6)
    v_smfmac_f32_16x16x64_bf16 v[24:27], v[80:83], v[40:47], v104
    s_waitcnt lgkmcnt(4)
    v_smfmac_f32_16x16x64_bf16 v[28:31], v[80:83], v[48:55], v104
    s_waitcnt lgkmcnt(2)
    v_smfmac_f32_16x16x64_bf16 v[24:27], v[84:87], v[56:63], v104
    v_add_f32 v16, v16, v18
    v_add_f32 v17, v17, v19
    v_add_f32 v20, v20, v22
    v_add_f32 v21, v21, v23
    s_waitcnt lgkmcnt(0)
    v_smfmac_f32_16x16x64_bf16 v[28:31], v[84:87], v[64:71], v104
    v_cvt_pk_bf16_f32 v16, v16, v17
    v_cvt_pk_bf16_f32 v17, v20, v21
    v_bfi_b32 v16, 1, s71, v16
    buffer_store_dwordx2 v[16:17], v122, s[4:7], s26 offen
    v_mov_b64 v[32:33], 0
    v_mov_b64 v[34:35], 0
    v_mov_b64 v[36:37], 0
    v_mov_b64 v[38:39], 0
    v_add_f32 v24, v24, v26
    v_add_f32 v25, v25, v27
    v_add_f32 v28, v28, v30
    v_add_f32 v29, v29, v31
    v_cvt_pk_bf16_f32 v24, v24, v25
    v_cvt_pk_bf16_f32 v25, v28, v29
    v_bfi_b32 v24, 1, s71, v24
    buffer_store_dwordx2 v[24:25], v122, s[4:7], s27 offen
    v_mov_b64 v[40:41], 0
    v_mov_b64 v[42:43], 0
    v_mov_b64 v[44:45], 0
    v_mov_b64 v[46:47], 0
    v_mov_b64 v[48:49], 0
    v_mov_b64 v[50:51], 0
    v_mov_b64 v[52:53], 0
    v_mov_b64 v[54:55], 0
    s_mov_b32 s43, 0x100000
    buffer_load_dwordx4 v[56:59], v123, s[4:7], s30 offen sc1
    buffer_load_dwordx4 v[60:63], v123, s[4:7], s31 offen sc1
main_kernel_p1_1_1:
    s_waitcnt vmcnt(0)
main_kernel_p1_1_1c:
    v_bitop3_b32 v105, v56, v58, s71 bitop3:0x7e
    v_bitop3_b32 v127, v60, v62, s71 bitop3:0x7e
    v_or_b32 v105, v105, v127
    v_and_b32 v105, 1, v105
    v_cmp_ne_u32 vcc, 0, v105
    s_cbranch_vccz main_kernel_p1_1_1done
    s_mov_b64 exec, vcc
    buffer_load_dwordx4 v[56:59], v123, s[4:7], s30 offen sc1
    buffer_load_dwordx4 v[60:63], v123, s[4:7], s31 offen sc1
    s_sub_u32 s43, s43, 1
    s_cbranch_scc0 main_kernel_p1_1_1
main_kernel_p1_1_1done:
    s_mov_b64 exec, -1
    v_mfma_f32_16x16x32_bf16 v[64:67], v[112:115], v[56:59], 0
    v_mfma_f32_16x16x32_bf16 v[64:67], v[112:115], v[60:63], v[64:67]
    v_mov_b64 v[72:73], -1
    v_mov_b64 v[74:75], -1
    s_add_u32 s14, s14, 1
    s_nop 4
    v_add_f32_dpp v68, v64, v64 row_ror:4 row_mask:0xf bank_mask:0xf
    v_add_f32_dpp v69, v65, v65 row_ror:4 row_mask:0xf bank_mask:0xf
    v_add_f32_dpp v70, v66, v66 row_ror:4 row_mask:0xf bank_mask:0xf
    v_add_f32_dpp v71, v67, v67 row_ror:4 row_mask:0xf bank_mask:0xf
    v_add_f32_dpp v64, v68, v68 row_ror:8 row_mask:0xf bank_mask:0xf
    v_add_f32_dpp v65, v69, v69 row_ror:8 row_mask:0xf bank_mask:0xf
    v_add_f32_dpp v66, v70, v70 row_ror:8 row_mask:0xf bank_mask:0xf
    v_add_f32_dpp v67, v71, v71 row_ror:8 row_mask:0xf bank_mask:0xf
    s_mov_b64 exec, s[40:41]
    v_cvt_pk_bf16_f32 v64, v64, v65
    v_cvt_pk_bf16_f32 v65, v66, v67
    buffer_store_dword v64, v125, s[4:7], s32 offen
    buffer_store_dword v65, v125, s[4:7], s32 offen offset:16
    buffer_store_dword v72, v125, s[4:7], s33 offen
    buffer_store_dword v72, v125, s[4:7], s33 offen offset:16
    s_mov_b64 exec, -1
    s_add_u32 s15, s14, 2
    s_cmp_lg_u32 s15, s75
    s_cbranch_scc1 main_kernel_nokv1_1
    v_mov_b32 v127, s69
    buffer_load_dword v126, v127, s[44:47], 0 offen sc1
main_kernel_nokv1_1:
    s_branch main_kernel_wl1
main_kernel_wl2:
    ds_read_b128 v[56:59], v117 offset:8192
    ds_read_b128 v[60:63], v117 offset:9216
    ds_read_b128 v[64:67], v117 offset:10240
    ds_read_b128 v[68:71], v117 offset:11264
    ds_read_b128 v[72:75], v117 offset:0
    ds_read_b128 v[76:79], v117 offset:1024
    ds_read_b128 v[80:83], v117 offset:2048
    ds_read_b128 v[84:87], v117 offset:3072
    s_cmp_eq_u32 s14, 0
    s_cbranch_scc1 main_kernel_m0_2
    s_mov_b32 s43, 0x100000
    buffer_load_dwordx4 v[16:19], v124, s[4:7], s32 offen sc1
    buffer_load_dwordx4 v[20:23], v124, s[4:7], s32 offen offset:1024 sc1
main_kernel_p2_0_2:
    s_waitcnt vmcnt(0)
main_kernel_p2_0_2c:
    v_max3_u32 v105, v16, v17, v18
    v_max3_u32 v127, v19, v20, v21
    v_max3_u32 v105, v22, v23, v105
    v_max_u32 v105, v105, v127
    v_cmp_eq_u32 vcc, -1, v105
    s_cbranch_vccz main_kernel_p2_0_2done
    s_mov_b64 exec, vcc
    buffer_load_dwordx4 v[16:19], v124, s[4:7], s32 offen sc1
    buffer_load_dwordx4 v[20:23], v124, s[4:7], s32 offen offset:1024 sc1
    s_sub_u32 s43, s43, 1
    s_cbranch_scc0 main_kernel_p2_0_2
main_kernel_p2_0_2done:
    s_mov_b64 exec, -1
main_kernel_m0done_2:
    ds_write_b128 v124, v[16:19] offset:16384
    ds_write_b128 v124, v[20:23] offset:17408
    v_smfmac_f32_16x16x64_bf16 v[32:35], v[16:19], a[32:39], v104
    v_smfmac_f32_16x16x64_bf16 v[40:43], v[16:19], a[160:167], v104
    v_smfmac_f32_16x16x64_bf16 v[36:39], v[16:19], a[96:103], v104
    s_waitcnt lgkmcnt(8)
    v_smfmac_f32_16x16x64_bf16 v[44:47], v[16:19], v[56:63], v104
    v_smfmac_f32_16x16x64_bf16 v[48:51], v[16:19], a[224:231], v104
    v_smfmac_f32_16x16x64_bf16 v[52:55], v[16:19], v[160:167], v104
    s_waitcnt lgkmcnt(0)
    s_barrier
    ds_read_b128 v[0:3], v116 offset:16384
    ds_read_b128 v[4:7], v116 offset:17408
    v_smfmac_f32_16x16x64_bf16 v[32:35], v[20:23], a[40:47], v104
    ds_read_b128 v[8:11], v116 offset:18432
    v_smfmac_f32_16x16x64_bf16 v[40:43], v[20:23], a[168:175], v104
    ds_read_b128 v[12:15], v116 offset:19456
    v_smfmac_f32_16x16x64_bf16 v[36:39], v[20:23], a[104:111], v104
    ds_read_b128 v[24:27], v116 offset:22528
    v_smfmac_f32_16x16x64_bf16 v[44:47], v[20:23], v[64:71], v104
    ds_read_b128 v[28:31], v116 offset:23552
    v_smfmac_f32_16x16x64_bf16 v[48:51], v[20:23], a[232:239], v104
    v_smfmac_f32_16x16x64_bf16 v[52:55], v[20:23], v[168:175], v104
    s_waitcnt lgkmcnt(5)
    v_smfmac_f32_16x16x64_bf16 v[32:35], v[0:3], a[0:7], v104
    ds_read_b128 v[56:59], v117 offset:4096
    ds_read_b128 v[60:63], v117 offset:5120
    v_smfmac_f32_16x16x64_bf16 v[40:43], v[0:3], a[128:135], v104
    ds_read_b128 v[64:67], v117 offset:6144
    ds_read_b128 v[68:71], v117 offset:7168
    s_waitcnt lgkmcnt(8)
    v_smfmac_f32_16x16x64_bf16 v[32:35], v[4:7], a[8:15], v104
    s_mov_b32 m0, s68
    s_add_u32 s17, s34, 0x40000
    v_smfmac_f32_16x16x64_bf16 v[40:43], v[4:7], a[136:143], v104
    buffer_load_dwordx4 v124, s[4:7], s34 offen sc1 lds
    s_waitcnt lgkmcnt(7)
    v_smfmac_f32_16x16x64_bf16 v[32:35], v[8:11], a[16:23], v104
    v_smfmac_f32_16x16x64_bf16 v[40:43], v[8:11], a[144:151], v104
    buffer_load_dwordx4 v124, s[4:7], s34 offen offset:1024 sc1 lds
    s_waitcnt lgkmcnt(6)
    v_smfmac_f32_16x16x64_bf16 v[32:35], v[12:15], a[24:31], v104
    v_smfmac_f32_16x16x64_bf16 v[40:43], v[12:15], a[152:159], v104
    buffer_load_dwordx4 v[96:99], v124, s[4:7], s35 offen sc1
    s_waitcnt lgkmcnt(5)
    v_smfmac_f32_16x16x64_bf16 v[32:35], v[24:27], a[48:55], v104
    v_smfmac_f32_16x16x64_bf16 v[40:43], v[24:27], a[176:183], v104
    buffer_load_dwordx4 v[100:103], v124, s[4:7], s35 offen offset:1024 sc1
    s_mov_b32 s34, s17
    s_waitcnt lgkmcnt(4)
    v_smfmac_f32_16x16x64_bf16 v[32:35], v[28:31], a[56:63], v104
    s_add_u32 s35, s35, 0x40000
    v_smfmac_f32_16x16x64_bf16 v[40:43], v[28:31], a[184:191], v104
    v_smfmac_f32_16x16x64_bf16 v[36:39], v[0:3], a[64:71], v104
    v_smfmac_f32_16x16x64_bf16 v[44:47], v[0:3], v[72:79], v104
    ds_read_b128 v[72:75], v117 offset:12288
    ds_read_b128 v[76:79], v117 offset:13312
    v_smfmac_f32_16x16x64_bf16 v[36:39], v[4:7], a[72:79], v104
    v_smfmac_f32_16x16x64_bf16 v[44:47], v[4:7], v[80:87], v104
    ds_read_b128 v[80:83], v117 offset:14336
    ds_read_b128 v[84:87], v117 offset:15360
    v_smfmac_f32_16x16x64_bf16 v[36:39], v[8:11], a[80:87], v104
    v_add_f32 v40, v40, v42
    v_add_f32 v41, v41, v43
    s_waitcnt lgkmcnt(6)
    v_smfmac_f32_16x16x64_bf16 v[44:47], v[8:11], v[56:63], v104
    v_smfmac_f32_16x16x64_bf16 v[36:39], v[12:15], a[88:95], v104
    v_add_f32 v32, v32, v34
    v_add_f32 v33, v33, v35
    s_waitcnt lgkmcnt(4)
    v_smfmac_f32_16x16x64_bf16 v[44:47], v[12:15], v[64:71], v104
    v_smfmac_f32_16x16x64_bf16 v[36:39], v[24:27], a[112:119], v104
    v_cvt_pk_bf16_f32 v40, v40, v41
    v_cvt_pk_bf16_f32 v41, v32, v33
    s_waitcnt lgkmcnt(2)
    v_smfmac_f32_16x16x64_bf16 v[44:47], v[24:27], v[72:79], v104
    v_smfmac_f32_16x16x64_bf16 v[36:39], v[28:31], a[120:127], v104
    ds_write_b64 v118, v[40:41] offset:0
    s_waitcnt lgkmcnt(1)
    v_smfmac_f32_16x16x64_bf16 v[44:47], v[28:31], v[80:87], v104
    ds_read_b128 v[16:19], v116 offset:4096
    ds_read_b128 v[20:23], v116 offset:5120
    v_smfmac_f32_16x16x64_bf16 v[48:51], v[0:3], a[192:199], v104
    v_smfmac_f32_16x16x64_bf16 v[52:55], v[0:3], v[128:135], v104
    ds_read_b128 v[0:3], v116 offset:0
    s_nop 2
    v_add_f32 v44, v44, v46
    v_add_f32 v45, v45, v47
    v_add_f32 v36, v36, v38
    v_add_f32 v37, v37, v39
    v_cvt_pk_bf16_f32 v44, v44, v45
    v_cvt_pk_bf16_f32 v45, v36, v37
    ds_write_b64 v118, v[44:45] offset:512
    v_smfmac_f32_16x16x64_bf16 v[48:51], v[4:7], a[200:207], v104
    v_smfmac_f32_16x16x64_bf16 v[52:55], v[4:7], v[136:143], v104
    ds_read_b128 v[4:7], v116 offset:1024
    s_waitcnt lgkmcnt(1)
    s_barrier
    ds_read_b64_tr_b16 v[32:33], v119 offset:0
    ds_read_b64_tr_b16 v[34:35], v119 offset:512
    ds_read_b64_tr_b16 v[36:37], v119 offset:1024
    ds_read_b64_tr_b16 v[38:39], v119 offset:1536
    v_smfmac_f32_16x16x64_bf16 v[48:51], v[8:11], a[208:215], v104
    ds_read_b64_tr_b16 v[40:41], v119 offset:2048
    ds_read_b64_tr_b16 v[42:43], v119 offset:2560
    v_smfmac_f32_16x16x64_bf16 v[52:55], v[8:11], v[144:151], v104
    ds_read_b64_tr_b16 v[44:45], v119 offset:3072
    ds_read_b64_tr_b16 v[46:47], v119 offset:3584
    ds_read_b128 v[8:11], v116 offset:2048
    v_smfmac_f32_16x16x64_bf16 v[48:51], v[12:15], a[216:223], v104
    v_smfmac_f32_16x16x64_bf16 v[52:55], v[12:15], v[152:159], v104
    ds_read_b128 v[12:15], v116 offset:3072
    v_smfmac_f32_16x16x64_bf16 v[48:51], v[24:27], a[240:247], v104
    v_smfmac_f32_16x16x64_bf16 v[52:55], v[24:27], v[176:183], v104
    ds_read_b128 v[24:27], v116 offset:6144
    v_smfmac_f32_16x16x64_bf16 v[48:51], v[28:31], a[248:255], v104
    v_smfmac_f32_16x16x64_bf16 v[52:55], v[28:31], v[184:191], v104
    ds_read_b128 v[28:31], v116 offset:7168
    s_waitcnt lgkmcnt(4)
    v_mfma_f32_16x16x32_bf16 v[56:59], v[32:35], v[32:35], 0
    v_mfma_f32_16x16x32_bf16 v[64:67], v[16:19], v[32:35], 0
    buffer_store_dwordx4 v[40:43], v116, s[4:7], s36 offen offset:2048 sc1
    s_add_u32 s36, s36, 0x20000
    v_mfma_f32_16x16x32_bf16 v[56:59], v[36:39], v[36:39], v[56:59]
    v_mfma_f32_16x16x32_bf16 v[64:67], v[20:23], v[36:39], v[64:67]
    v_mfma_f32_16x16x32_bf16 v[56:59], v[40:43], v[40:43], v[56:59]
    v_mfma_f32_16x16x32_bf16 v[60:63], v[0:3], v[32:35], 0
    v_cvt_pk_bf16_f32 v48, v48, v49
    v_cvt_pk_bf16_f32 v49, v50, v51
    v_cvt_pk_bf16_f32 v50, v52, v53
    v_cvt_pk_bf16_f32 v51, v54, v55
    v_mfma_f32_16x16x32_bf16 v[56:59], v[44:47], v[44:47], v[56:59]
    v_mfma_f32_16x16x32_bf16 v[60:63], v[4:7], v[36:39], v[60:63]
    buffer_store_dwordx4 v[48:51], v116, s[4:7], s37 offen sc1
    s_add_u32 s37, s37, 0x20000
    s_waitcnt lgkmcnt(3)
    v_mfma_f32_16x16x32_bf16 v[60:63], v[8:11], v[40:43], v[60:63]
    s_waitcnt lgkmcnt(2)
    v_mfma_f32_16x16x32_bf16 v[60:63], v[12:15], v[44:47], v[60:63]
    s_cmp_eq_u32 s14, 63
    s_cbranch_scc1 main_kernel_done
    s_waitcnt lgkmcnt(1)
    v_mfma_f32_16x16x32_bf16 v[64:67], v[24:27], v[40:43], v[64:67]
    s_waitcnt lgkmcnt(0)
    v_mfma_f32_16x16x32_bf16 v[64:67], v[28:31], v[44:47], v[64:67]
    v_mov_b64 v[16:17], 0
    v_mov_b64 v[18:19], 0
    v_mov_b64 v[20:21], 0
    v_mov_b64 v[22:23], 0
    v_max3_f32 v105, v60, v61, v62
    v_max3_f32 v127, v63, v56, v57
    s_nop 1
    v_max3_f32 v127, v64, v65, v127
    v_max3_f32 v105, v66, v67, v105
    v_max_f32 v105, v105, v127
    v_mov_b32 v127, v105
    v_mov_b64 v[0:1], 0
    v_mov_b64 v[2:3], 0
    v_permlane32_swap_b32 v105, v127
    v_max_f32 v105, v105, v127
    v_mov_b32 v127, v105
    v_mov_b64 v[4:5], 0
    v_mov_b64 v[6:7], 0
    v_permlane16_swap_b32 v105, v127
    v_max_f32 v105, v105, v127
    v_mul_f32 v105, s42, v105
    v_fma_f32 v56, v56, s42, -v105
    v_fma_f32 v57, v57, s42, -v105
    v_exp_f32 v56, v56
    v_exp_f32 v57, v57
    v_fma_f32 v60, v60, s42, -v105
    v_fma_f32 v61, v61, s42, -v105
    v_fma_f32 v62, v62, s42, -v105
    v_fma_f32 v63, v63, s42, -v105
    v_fma_f32 v64, v64, s42, -v105
    v_fma_f32 v65, v65, s42, -v105
    v_fma_f32 v66, v66, s42, -v105
    v_fma_f32 v67, v67, s42, -v105
    v_cvt_pk_bf16_f32 v58, v56, v57
    v_cvt_pk_bf16_f32 v59, v56, v57
    v_exp_f32 v60, v60
    v_exp_f32 v61, v61
    v_mfma_f32_16x16x16_bf16 v[72:75], v[58:59], v[110:111], 0
    v_exp_f32 v62, v62
    v_exp_f32 v63, v63
    v_mfma_f32_16x16x16_bf16 v[76:79], v[58:59], v[48:49], 0
    v_exp_f32 v64, v64
    v_exp_f32 v65, v65
    v_mfma_f32_16x16x16_bf16 v[80:83], v[58:59], v[50:51], 0
    v_exp_f32 v66, v66
    v_exp_f32 v67, v67
    v_cvt_pk_bf16_f32 v84, v60, v61
    v_cvt_pk_bf16_f32 v85, v62, v63
    v_cvt_pk_bf16_f32 v86, v64, v65
    v_cvt_pk_bf16_f32 v87, v66, v67
    v_mov_b64 v[24:25], 0
    v_mov_b64 v[26:27], 0
    v_mfma_f32_16x16x32_bf16 v[72:75], v[84:87], v[106:109], v[72:75]
    v_mov_b64 v[28:29], 0
    v_mov_b64 v[30:31], 0
    v_mfma_f32_16x16x32_bf16 v[76:79], v[84:87], v[88:91], v[76:79]
    v_mfma_f32_16x16x32_bf16 v[80:83], v[84:87], v[92:95], v[80:83]
    ds_read_b128 v[56:59], v117 offset:16384
    ds_read_b128 v[60:63], v117 offset:17408
    ds_read_b128 v[64:67], v117 offset:20480
    ds_read_b128 v[68:71], v117 offset:21504
    v_rcp_f32 v74, v74
    v_rcp_f32 v75, v75
    s_nop 0
    v_mul_f32 v78, v78, v74
    v_mul_f32 v79, v79, v75
    v_cvt_pk_bf16_f32 v76, v78, v79
    ds_write_b32 v120, v76 offset:0
    v_mul_f32 v82, v82, v74
    v_mul_f32 v83, v83, v75
    v_cvt_pk_bf16_f32 v80, v82, v83
    ds_write_b32 v120, v80 offset:256
    s_waitcnt lgkmcnt(0)
    s_barrier
    ds_read_b64_tr_b16 v[80:81], v121 offset:0
    ds_read_b64_tr_b16 v[82:83], v121 offset:128
    ds_read_b64_tr_b16 v[84:85], v121 offset:1024
    ds_read_b64_tr_b16 v[86:87], v121 offset:1152
    v_mov_b64 v[8:9], 0
    v_mov_b64 v[10:11], 0
    v_mov_b64 v[12:13], 0
    v_mov_b64 v[14:15], 0
    s_waitcnt lgkmcnt(2)
    s_bfe_i32 s71, s14, 0x10001
    v_smfmac_f32_16x16x64_bf16 v[0:3], v[80:83], v[192:199], v104
    v_smfmac_f32_16x16x64_bf16 v[4:7], v[80:83], v[208:215], v104
    ds_read_b128 v[72:75], v117 offset:18432
    ds_read_b128 v[76:79], v117 offset:19456
    s_waitcnt lgkmcnt(2)
    v_smfmac_f32_16x16x64_bf16 v[0:3], v[84:87], v[200:207], v104
    ds_read_b128 v[32:35], v117 offset:22528
    ds_read_b128 v[36:39], v117 offset:23552
    v_smfmac_f32_16x16x64_bf16 v[4:7], v[84:87], v[216:223], v104
    ds_read_b128 v[40:43], v117 offset:24576
    ds_read_b128 v[44:47], v117 offset:25600
    v_smfmac_f32_16x16x64_bf16 v[8:11], v[80:83], v[224:231], v104
    ds_read_b128 v[48:51], v117 offset:28672
    ds_read_b128 v[52:55], v117 offset:29696
    v_smfmac_f32_16x16x64_bf16 v[12:15], v[80:83], v[240:247], v104
    v_smfmac_f32_16x16x64_bf16 v[8:11], v[84:87], v[232:239], v104
    v_add_f32 v0, v0, v2
    v_add_f32 v1, v1, v3
    v_add_f32 v4, v4, v6
    v_add_f32 v5, v5, v7
    v_smfmac_f32_16x16x64_bf16 v[12:15], v[84:87], v[248:255], v104
    v_cvt_pk_bf16_f32 v0, v0, v1
    v_cvt_pk_bf16_f32 v1, v4, v5
    v_bfi_b32 v0, 1, s71, v0
    buffer_store_dwordx2 v[0:1], v122, s[4:7], s20 offen
    v_smfmac_f32_16x16x64_bf16 v[16:19], v[80:83], v[56:63], v104
    ds_read_b128 v[56:59], v117 offset:26624
    ds_read_b128 v[60:63], v117 offset:27648
    v_smfmac_f32_16x16x64_bf16 v[20:23], v[80:83], v[64:71], v104
    ds_read_b128 v[64:67], v117 offset:30720
    ds_read_b128 v[68:71], v117 offset:31744
    s_waitcnt lgkmcnt(10)
    v_smfmac_f32_16x16x64_bf16 v[16:19], v[84:87], v[72:79], v104
    v_add_f32 v8, v8, v10
    v_add_f32 v9, v9, v11
    v_add_f32 v12, v12, v14
    v_add_f32 v13, v13, v15
    s_waitcnt lgkmcnt(8)
    v_smfmac_f32_16x16x64_bf16 v[20:23], v[84:87], v[32:39], v104
    v_cvt_pk_bf16_f32 v8, v8, v9
    v_cvt_pk_bf16_f32 v9, v12, v13
    v_bfi_b32 v8, 1, s71, v8
    buffer_store_dwordx2 v[8:9], v122, s[4:7], s21 offen
    s_waitcnt lgkmcnt(6)
    v_smfmac_f32_16x16x64_bf16 v[24:27], v[80:83], v[40:47], v104
    s_waitcnt lgkmcnt(4)
    v_smfmac_f32_16x16x64_bf16 v[28:31], v[80:83], v[48:55], v104
    s_waitcnt lgkmcnt(2)
    v_smfmac_f32_16x16x64_bf16 v[24:27], v[84:87], v[56:63], v104
    v_add_f32 v16, v16, v18
    v_add_f32 v17, v17, v19
    v_add_f32 v20, v20, v22
    v_add_f32 v21, v21, v23
    s_waitcnt lgkmcnt(0)
    v_smfmac_f32_16x16x64_bf16 v[28:31], v[84:87], v[64:71], v104
    v_cvt_pk_bf16_f32 v16, v16, v17
    v_cvt_pk_bf16_f32 v17, v20, v21
    v_bfi_b32 v16, 1, s71, v16
    buffer_store_dwordx2 v[16:17], v122, s[4:7], s22 offen
    v_mov_b64 v[32:33], 0
    v_mov_b64 v[34:35], 0
    v_mov_b64 v[36:37], 0
    v_mov_b64 v[38:39], 0
    v_add_f32 v24, v24, v26
    v_add_f32 v25, v25, v27
    v_add_f32 v28, v28, v30
    v_add_f32 v29, v29, v31
    v_cvt_pk_bf16_f32 v24, v24, v25
    v_cvt_pk_bf16_f32 v25, v28, v29
    v_bfi_b32 v24, 1, s71, v24
    buffer_store_dwordx2 v[24:25], v122, s[4:7], s23 offen
    v_mov_b64 v[40:41], 0
    v_mov_b64 v[42:43], 0
    v_mov_b64 v[44:45], 0
    v_mov_b64 v[46:47], 0
    v_mov_b64 v[48:49], 0
    v_mov_b64 v[50:51], 0
    v_mov_b64 v[52:53], 0
    v_mov_b64 v[54:55], 0
    s_mov_b32 s43, 0x100000
    buffer_load_dwordx4 v[56:59], v123, s[4:7], s28 offen sc1
    buffer_load_dwordx4 v[60:63], v123, s[4:7], s29 offen sc1
main_kernel_p1_0_2:
    s_waitcnt vmcnt(0)
main_kernel_p1_0_2c:
    v_bitop3_b32 v105, v56, v58, s71 bitop3:0x7e
    v_bitop3_b32 v127, v60, v62, s71 bitop3:0x7e
    v_or_b32 v105, v105, v127
    v_and_b32 v105, 1, v105
    v_cmp_ne_u32 vcc, 0, v105
    s_cbranch_vccz main_kernel_p1_0_2done
    s_mov_b64 exec, vcc
    buffer_load_dwordx4 v[56:59], v123, s[4:7], s28 offen sc1
    buffer_load_dwordx4 v[60:63], v123, s[4:7], s29 offen sc1
    s_sub_u32 s43, s43, 1
    s_cbranch_scc0 main_kernel_p1_0_2
main_kernel_p1_0_2done:
    s_mov_b64 exec, -1
    v_mfma_f32_16x16x32_bf16 v[64:67], v[112:115], v[56:59], 0
    v_mfma_f32_16x16x32_bf16 v[64:67], v[112:115], v[60:63], v[64:67]
    v_mov_b64 v[72:73], -1
    v_mov_b64 v[74:75], -1
    s_add_u32 s14, s14, 1
    s_nop 4
    v_add_f32_dpp v68, v64, v64 row_ror:4 row_mask:0xf bank_mask:0xf
    v_add_f32_dpp v69, v65, v65 row_ror:4 row_mask:0xf bank_mask:0xf
    v_add_f32_dpp v70, v66, v66 row_ror:4 row_mask:0xf bank_mask:0xf
    v_add_f32_dpp v71, v67, v67 row_ror:4 row_mask:0xf bank_mask:0xf
    v_add_f32_dpp v64, v68, v68 row_ror:8 row_mask:0xf bank_mask:0xf
    v_add_f32_dpp v65, v69, v69 row_ror:8 row_mask:0xf bank_mask:0xf
    v_add_f32_dpp v66, v70, v70 row_ror:8 row_mask:0xf bank_mask:0xf
    v_add_f32_dpp v67, v71, v71 row_ror:8 row_mask:0xf bank_mask:0xf
    s_mov_b64 exec, s[40:41]
    v_cvt_pk_bf16_f32 v64, v64, v65
    v_cvt_pk_bf16_f32 v65, v66, v67
    buffer_store_dword v64, v125, s[4:7], s33 offen
    buffer_store_dword v65, v125, s[4:7], s33 offen offset:16
    buffer_store_dword v72, v125, s[4:7], s32 offen
    buffer_store_dword v72, v125, s[4:7], s32 offen offset:16
    s_mov_b64 exec, -1
    s_add_u32 s15, s14, 1
    s_cmp_lg_u32 s15, s75
    s_cbranch_scc1 main_kernel_nokv0_2
    v_readfirstlane_b32 s18, v126
    s_nop 0
    s_cmp_ge_u32 s18, 64
    s_cbranch_scc1 main_kernel_kvok0_2
    s_mov_b32 s43, 0x200000
    v_mov_b32 v127, s69
main_kernel_wkvn2:
    buffer_load_dword v126, v127, s[44:47], 0 offen sc1
    s_waitcnt vmcnt(0)
    v_readfirstlane_b32 s18, v126
    s_nop 0
    s_cmp_ge_u32 s18, 64
    s_cbranch_scc1 main_kernel_wkvn2_ok
    s_sleep 2
    s_sub_u32 s43, s43, 1
    s_cbranch_scc0 main_kernel_wkvn2
main_kernel_wkvn2_ok:
main_kernel_kvok0_2:
    s_min_u32 s15, s75, 8
    s_add_u32 s75, s75, s15
    s_add_u32 s69, s69, 4
    s_cmp_ge_u32 s75, 64
    s_cselect_b32 s75, 0x7fff, s75
main_kernel_nokv0_2:
    ds_read_b128 v[56:59], v117 offset:8192
    ds_read_b128 v[60:63], v117 offset:9216
    ds_read_b128 v[64:67], v117 offset:10240
    ds_read_b128 v[68:71], v117 offset:11264
    ds_read_b128 v[72:75], v117 offset:0
    ds_read_b128 v[76:79], v117 offset:1024
    ds_read_b128 v[80:83], v117 offset:2048
    ds_read_b128 v[84:87], v117 offset:3072
    s_mov_b32 s43, 0x100000
    buffer_load_dwordx4 v[16:19], v124, s[4:7], s33 offen sc1
    buffer_load_dwordx4 v[20:23], v124, s[4:7], s33 offen offset:1024 sc1
main_kernel_p2_1_2:
    s_waitcnt vmcnt(0)
main_kernel_p2_1_2c:
    v_max3_u32 v105, v16, v17, v18
    v_max3_u32 v127, v19, v20, v21
    v_max3_u32 v105, v22, v23, v105
    v_max_u32 v105, v105, v127
    v_cmp_eq_u32 vcc, -1, v105
    s_cbranch_vccz main_kernel_p2_1_2done
    s_mov_b64 exec, vcc
    buffer_load_dwordx4 v[16:19], v124, s[4:7], s33 offen sc1
    buffer_load_dwordx4 v[20:23], v124, s[4:7], s33 offen offset:1024 sc1
    s_sub_u32 s43, s43, 1
    s_cbranch_scc0 main_kernel_p2_1_2
main_kernel_p2_1_2done:
    s_mov_b64 exec, -1
    ds_write_b128 v124, v[16:19] offset:16384
    ds_write_b128 v124, v[20:23] offset:17408
    v_smfmac_f32_16x16x64_bf16 v[32:35], v[16:19], a[32:39], v104
    v_smfmac_f32_16x16x64_bf16 v[40:43], v[16:19], a[160:167], v104
    v_smfmac_f32_16x16x64_bf16 v[36:39], v[16:19], a[96:103], v104
    s_waitcnt lgkmcnt(8)
    v_smfmac_f32_16x16x64_bf16 v[44:47], v[16:19], v[56:63], v104
    v_smfmac_f32_16x16x64_bf16 v[48:51], v[16:19], a[224:231], v104
    v_smfmac_f32_16x16x64_bf16 v[52:55], v[16:19], v[160:167], v104
    s_waitcnt lgkmcnt(0)
    s_barrier
    ds_read_b128 v[0:3], v116 offset:16384
    ds_read_b128 v[4:7], v116 offset:17408
    v_smfmac_f32_16x16x64_bf16 v[32:35], v[20:23], a[40:47], v104
    ds_read_b128 v[8:11], v116 offset:18432
    v_smfmac_f32_16x16x64_bf16 v[40:43], v[20:23], a[168:175], v104
    ds_read_b128 v[12:15], v116 offset:19456
    v_smfmac_f32_16x16x64_bf16 v[36:39], v[20:23], a[104:111], v104
    ds_read_b128 v[24:27], v116 offset:22528
    v_smfmac_f32_16x16x64_bf16 v[44:47], v[20:23], v[64:71], v104
    ds_read_b128 v[28:31], v116 offset:23552
    v_smfmac_f32_16x16x64_bf16 v[48:51], v[20:23], a[232:239], v104
    v_smfmac_f32_16x16x64_bf16 v[52:55], v[20:23], v[168:175], v104
    s_waitcnt lgkmcnt(5)
    v_smfmac_f32_16x16x64_bf16 v[32:35], v[0:3], a[0:7], v104
    ds_read_b128 v[56:59], v117 offset:4096
    ds_read_b128 v[60:63], v117 offset:5120
    v_smfmac_f32_16x16x64_bf16 v[40:43], v[0:3], a[128:135], v104
    ds_read_b128 v[64:67], v117 offset:6144
    ds_read_b128 v[68:71], v117 offset:7168
    s_waitcnt lgkmcnt(8)
    v_smfmac_f32_16x16x64_bf16 v[32:35], v[4:7], a[8:15], v104
    s_mov_b32 m0, s67
    s_add_u32 s17, s34, 0x40000
    v_smfmac_f32_16x16x64_bf16 v[40:43], v[4:7], a[136:143], v104
    buffer_load_dwordx4 v124, s[4:7], s34 offen sc1 lds
    s_waitcnt lgkmcnt(7)
    v_smfmac_f32_16x16x64_bf16 v[32:35], v[8:11], a[16:23], v104
    v_smfmac_f32_16x16x64_bf16 v[40:43], v[8:11], a[144:151], v104
    buffer_load_dwordx4 v124, s[4:7], s34 offen offset:1024 sc1 lds
    s_waitcnt lgkmcnt(6)
    v_smfmac_f32_16x16x64_bf16 v[32:35], v[12:15], a[24:31], v104
    v_smfmac_f32_16x16x64_bf16 v[40:43], v[12:15], a[152:159], v104
    buffer_load_dwordx4 v[88:91], v124, s[4:7], s35 offen sc1
    s_waitcnt lgkmcnt(5)
    v_smfmac_f32_16x16x64_bf16 v[32:35], v[24:27], a[48:55], v104
    v_smfmac_f32_16x16x64_bf16 v[40:43], v[24:27], a[176:183], v104
    buffer_load_dwordx4 v[92:95], v124, s[4:7], s35 offen offset:1024 sc1
    s_mov_b32 s34, s17
    s_waitcnt lgkmcnt(4)
    v_smfmac_f32_16x16x64_bf16 v[32:35], v[28:31], a[56:63], v104
    s_add_u32 s35, s35, 0x40000
    v_smfmac_f32_16x16x64_bf16 v[40:43], v[28:31], a[184:191], v104
    v_smfmac_f32_16x16x64_bf16 v[36:39], v[0:3], a[64:71], v104
    v_smfmac_f32_16x16x64_bf16 v[44:47], v[0:3], v[72:79], v104
    ds_read_b128 v[72:75], v117 offset:12288
    ds_read_b128 v[76:79], v117 offset:13312
    v_smfmac_f32_16x16x64_bf16 v[36:39], v[4:7], a[72:79], v104
    v_smfmac_f32_16x16x64_bf16 v[44:47], v[4:7], v[80:87], v104
    ds_read_b128 v[80:83], v117 offset:14336
    ds_read_b128 v[84:87], v117 offset:15360
    v_smfmac_f32_16x16x64_bf16 v[36:39], v[8:11], a[80:87], v104
    v_add_f32 v40, v40, v42
    v_add_f32 v41, v41, v43
    s_waitcnt lgkmcnt(6)
    v_smfmac_f32_16x16x64_bf16 v[44:47], v[8:11], v[56:63], v104
    v_smfmac_f32_16x16x64_bf16 v[36:39], v[12:15], a[88:95], v104
    v_add_f32 v32, v32, v34
    v_add_f32 v33, v33, v35
    s_waitcnt lgkmcnt(4)
    v_smfmac_f32_16x16x64_bf16 v[44:47], v[12:15], v[64:71], v104
    v_smfmac_f32_16x16x64_bf16 v[36:39], v[24:27], a[112:119], v104
    v_cvt_pk_bf16_f32 v40, v40, v41
    v_cvt_pk_bf16_f32 v41, v32, v33
    s_waitcnt lgkmcnt(2)
    v_smfmac_f32_16x16x64_bf16 v[44:47], v[24:27], v[72:79], v104
    v_smfmac_f32_16x16x64_bf16 v[36:39], v[28:31], a[120:127], v104
    ds_write_b64 v118, v[40:41] offset:0
    s_waitcnt lgkmcnt(1)
    v_smfmac_f32_16x16x64_bf16 v[44:47], v[28:31], v[80:87], v104
    ds_read_b128 v[16:19], v116 offset:12288
    ds_read_b128 v[20:23], v116 offset:13312
    v_smfmac_f32_16x16x64_bf16 v[48:51], v[0:3], a[192:199], v104
    v_smfmac_f32_16x16x64_bf16 v[52:55], v[0:3], v[128:135], v104
    ds_read_b128 v[0:3], v116 offset:8192
    s_nop 2
    v_add_f32 v44, v44, v46
    v_add_f32 v45, v45, v47
    v_add_f32 v36, v36, v38
    v_add_f32 v37, v37, v39
    v_cvt_pk_bf16_f32 v44, v44, v45
    v_cvt_pk_bf16_f32 v45, v36, v37
    ds_write_b64 v118, v[44:45] offset:512
    v_smfmac_f32_16x16x64_bf16 v[48:51], v[4:7], a[200:207], v104
    v_smfmac_f32_16x16x64_bf16 v[52:55], v[4:7], v[136:143], v104
    ds_read_b128 v[4:7], v116 offset:9216
    s_waitcnt lgkmcnt(1)
    s_barrier
    ds_read_b64_tr_b16 v[32:33], v119 offset:0
    ds_read_b64_tr_b16 v[34:35], v119 offset:512
    ds_read_b64_tr_b16 v[36:37], v119 offset:1024
    ds_read_b64_tr_b16 v[38:39], v119 offset:1536
    v_smfmac_f32_16x16x64_bf16 v[48:51], v[8:11], a[208:215], v104
    ds_read_b64_tr_b16 v[40:41], v119 offset:2048
    ds_read_b64_tr_b16 v[42:43], v119 offset:2560
    v_smfmac_f32_16x16x64_bf16 v[52:55], v[8:11], v[144:151], v104
    ds_read_b64_tr_b16 v[44:45], v119 offset:3072
    ds_read_b64_tr_b16 v[46:47], v119 offset:3584
    ds_read_b128 v[8:11], v116 offset:10240
    v_smfmac_f32_16x16x64_bf16 v[48:51], v[12:15], a[216:223], v104
    v_smfmac_f32_16x16x64_bf16 v[52:55], v[12:15], v[152:159], v104
    ds_read_b128 v[12:15], v116 offset:11264
    v_smfmac_f32_16x16x64_bf16 v[48:51], v[24:27], a[240:247], v104
    v_smfmac_f32_16x16x64_bf16 v[52:55], v[24:27], v[176:183], v104
    ds_read_b128 v[24:27], v116 offset:14336
    v_smfmac_f32_16x16x64_bf16 v[48:51], v[28:31], a[248:255], v104
    v_smfmac_f32_16x16x64_bf16 v[52:55], v[28:31], v[184:191], v104
    ds_read_b128 v[28:31], v116 offset:15360
    s_waitcnt lgkmcnt(4)
    v_mfma_f32_16x16x32_bf16 v[56:59], v[32:35], v[32:35], 0
    v_mfma_f32_16x16x32_bf16 v[64:67], v[16:19], v[32:35], 0
    buffer_store_dwordx4 v[40:43], v116, s[4:7], s36 offen offset:2048 sc1
    s_add_u32 s36, s36, 0x20000
    v_mfma_f32_16x16x32_bf16 v[56:59], v[36:39], v[36:39], v[56:59]
    v_mfma_f32_16x16x32_bf16 v[64:67], v[20:23], v[36:39], v[64:67]
    v_mfma_f32_16x16x32_bf16 v[56:59], v[40:43], v[40:43], v[56:59]
    v_mfma_f32_16x16x32_bf16 v[60:63], v[0:3], v[32:35], 0
    v_cvt_pk_bf16_f32 v48, v48, v49
    v_cvt_pk_bf16_f32 v49, v50, v51
    v_cvt_pk_bf16_f32 v50, v52, v53
    v_cvt_pk_bf16_f32 v51, v54, v55
    v_mfma_f32_16x16x32_bf16 v[56:59], v[44:47], v[44:47], v[56:59]
    v_mfma_f32_16x16x32_bf16 v[60:63], v[4:7], v[36:39], v[60:63]
    buffer_store_dwordx4 v[48:51], v116, s[4:7], s37 offen sc1
    s_add_u32 s37, s37, 0x20000
    s_waitcnt lgkmcnt(3)
    v_mfma_f32_16x16x32_bf16 v[60:63], v[8:11], v[40:43], v[60:63]
    s_waitcnt lgkmcnt(2)
    v_mfma_f32_16x16x32_bf16 v[60:63], v[12:15], v[44:47], v[60:63]
    s_cmp_eq_u32 s14, 63
    s_cbranch_scc1 main_kernel_done
    s_waitcnt lgkmcnt(1)
    v_mfma_f32_16x16x32_bf16 v[64:67], v[24:27], v[40:43], v[64:67]
    s_waitcnt lgkmcnt(0)
    v_mfma_f32_16x16x32_bf16 v[64:67], v[28:31], v[44:47], v[64:67]
    v_mov_b64 v[16:17], 0
    v_mov_b64 v[18:19], 0
    v_mov_b64 v[20:21], 0
    v_mov_b64 v[22:23], 0
    v_max3_f32 v105, v60, v61, v62
    v_max3_f32 v127, v63, v56, v57
    s_nop 1
    v_max3_f32 v127, v64, v65, v127
    v_max3_f32 v105, v66, v67, v105
    v_max_f32 v105, v105, v127
    v_mov_b32 v127, v105
    v_mov_b64 v[0:1], 0
    v_mov_b64 v[2:3], 0
    v_permlane32_swap_b32 v105, v127
    v_max_f32 v105, v105, v127
    v_mov_b32 v127, v105
    v_mov_b64 v[4:5], 0
    v_mov_b64 v[6:7], 0
    v_permlane16_swap_b32 v105, v127
    v_max_f32 v105, v105, v127
    v_mul_f32 v105, s42, v105
    v_fma_f32 v56, v56, s42, -v105
    v_fma_f32 v57, v57, s42, -v105
    v_exp_f32 v56, v56
    v_exp_f32 v57, v57
    v_fma_f32 v60, v60, s42, -v105
    v_fma_f32 v61, v61, s42, -v105
    v_fma_f32 v62, v62, s42, -v105
    v_fma_f32 v63, v63, s42, -v105
    v_fma_f32 v64, v64, s42, -v105
    v_fma_f32 v65, v65, s42, -v105
    v_fma_f32 v66, v66, s42, -v105
    v_fma_f32 v67, v67, s42, -v105
    v_cvt_pk_bf16_f32 v58, v56, v57
    v_cvt_pk_bf16_f32 v59, v56, v57
    v_exp_f32 v60, v60
    v_exp_f32 v61, v61
    v_mfma_f32_16x16x16_bf16 v[72:75], v[58:59], v[110:111], 0
    v_exp_f32 v62, v62
    v_exp_f32 v63, v63
    v_mfma_f32_16x16x16_bf16 v[76:79], v[58:59], v[48:49], 0
    v_exp_f32 v64, v64
    v_exp_f32 v65, v65
    v_mfma_f32_16x16x16_bf16 v[80:83], v[58:59], v[50:51], 0
    v_exp_f32 v66, v66
    v_exp_f32 v67, v67
    v_cvt_pk_bf16_f32 v84, v60, v61
    v_cvt_pk_bf16_f32 v85, v62, v63
    v_cvt_pk_bf16_f32 v86, v64, v65
    v_cvt_pk_bf16_f32 v87, v66, v67
    v_mov_b64 v[24:25], 0
    v_mov_b64 v[26:27], 0
    v_mfma_f32_16x16x32_bf16 v[72:75], v[84:87], v[106:109], v[72:75]
    v_mov_b64 v[28:29], 0
    v_mov_b64 v[30:31], 0
    v_mfma_f32_16x16x32_bf16 v[76:79], v[84:87], v[96:99], v[76:79]
    v_mfma_f32_16x16x32_bf16 v[80:83], v[84:87], v[100:103], v[80:83]
    ds_read_b128 v[56:59], v117 offset:16384
    ds_read_b128 v[60:63], v117 offset:17408
    ds_read_b128 v[64:67], v117 offset:20480
    ds_read_b128 v[68:71], v117 offset:21504
    v_rcp_f32 v74, v74
    v_rcp_f32 v75, v75
    s_nop 0
    v_mul_f32 v78, v78, v74
    v_mul_f32 v79, v79, v75
    v_cvt_pk_bf16_f32 v76, v78, v79
    ds_write_b32 v120, v76 offset:0
    v_mul_f32 v82, v82, v74
    v_mul_f32 v83, v83, v75
    v_cvt_pk_bf16_f32 v80, v82, v83
    ds_write_b32 v120, v80 offset:256
    s_waitcnt lgkmcnt(0)
    s_barrier
    ds_read_b64_tr_b16 v[80:81], v121 offset:0
    ds_read_b64_tr_b16 v[82:83], v121 offset:128
    ds_read_b64_tr_b16 v[84:85], v121 offset:1024
    ds_read_b64_tr_b16 v[86:87], v121 offset:1152
    v_mov_b64 v[8:9], 0
    v_mov_b64 v[10:11], 0
    v_mov_b64 v[12:13], 0
    v_mov_b64 v[14:15], 0
    s_waitcnt lgkmcnt(2)
    s_bfe_i32 s71, s14, 0x10001
    v_smfmac_f32_16x16x64_bf16 v[0:3], v[80:83], v[192:199], v104
    v_smfmac_f32_16x16x64_bf16 v[4:7], v[80:83], v[208:215], v104
    ds_read_b128 v[72:75], v117 offset:18432
    ds_read_b128 v[76:79], v117 offset:19456
    s_waitcnt lgkmcnt(2)
    v_smfmac_f32_16x16x64_bf16 v[0:3], v[84:87], v[200:207], v104
    ds_read_b128 v[32:35], v117 offset:22528
    ds_read_b128 v[36:39], v117 offset:23552
    v_smfmac_f32_16x16x64_bf16 v[4:7], v[84:87], v[216:223], v104
    ds_read_b128 v[40:43], v117 offset:24576
    ds_read_b128 v[44:47], v117 offset:25600
    v_smfmac_f32_16x16x64_bf16 v[8:11], v[80:83], v[224:231], v104
    ds_read_b128 v[48:51], v117 offset:28672
    ds_read_b128 v[52:55], v117 offset:29696
    v_smfmac_f32_16x16x64_bf16 v[12:15], v[80:83], v[240:247], v104
    v_smfmac_f32_16x16x64_bf16 v[8:11], v[84:87], v[232:239], v104
    v_add_f32 v0, v0, v2
    v_add_f32 v1, v1, v3
    v_add_f32 v4, v4, v6
    v_add_f32 v5, v5, v7
    v_smfmac_f32_16x16x64_bf16 v[12:15], v[84:87], v[248:255], v104
    v_cvt_pk_bf16_f32 v0, v0, v1
    v_cvt_pk_bf16_f32 v1, v4, v5
    v_bfi_b32 v0, 1, s71, v0
    buffer_store_dwordx2 v[0:1], v122, s[4:7], s24 offen
    v_smfmac_f32_16x16x64_bf16 v[16:19], v[80:83], v[56:63], v104
    ds_read_b128 v[56:59], v117 offset:26624
    ds_read_b128 v[60:63], v117 offset:27648
    v_smfmac_f32_16x16x64_bf16 v[20:23], v[80:83], v[64:71], v104
    ds_read_b128 v[64:67], v117 offset:30720
    ds_read_b128 v[68:71], v117 offset:31744
    s_waitcnt lgkmcnt(10)
    v_smfmac_f32_16x16x64_bf16 v[16:19], v[84:87], v[72:79], v104
    v_add_f32 v8, v8, v10
    v_add_f32 v9, v9, v11
    v_add_f32 v12, v12, v14
    v_add_f32 v13, v13, v15
    s_waitcnt lgkmcnt(8)
    v_smfmac_f32_16x16x64_bf16 v[20:23], v[84:87], v[32:39], v104
    v_cvt_pk_bf16_f32 v8, v8, v9
    v_cvt_pk_bf16_f32 v9, v12, v13
    v_bfi_b32 v8, 1, s71, v8
    buffer_store_dwordx2 v[8:9], v122, s[4:7], s25 offen
    s_waitcnt lgkmcnt(6)
    v_smfmac_f32_16x16x64_bf16 v[24:27], v[80:83], v[40:47], v104
    s_waitcnt lgkmcnt(4)
    v_smfmac_f32_16x16x64_bf16 v[28:31], v[80:83], v[48:55], v104
    s_waitcnt lgkmcnt(2)
    v_smfmac_f32_16x16x64_bf16 v[24:27], v[84:87], v[56:63], v104
    v_add_f32 v16, v16, v18
    v_add_f32 v17, v17, v19
    v_add_f32 v20, v20, v22
    v_add_f32 v21, v21, v23
    s_waitcnt lgkmcnt(0)
    v_smfmac_f32_16x16x64_bf16 v[28:31], v[84:87], v[64:71], v104
    v_cvt_pk_bf16_f32 v16, v16, v17
    v_cvt_pk_bf16_f32 v17, v20, v21
    v_bfi_b32 v16, 1, s71, v16
    buffer_store_dwordx2 v[16:17], v122, s[4:7], s26 offen
    v_mov_b64 v[32:33], 0
    v_mov_b64 v[34:35], 0
    v_mov_b64 v[36:37], 0
    v_mov_b64 v[38:39], 0
    v_add_f32 v24, v24, v26
    v_add_f32 v25, v25, v27
    v_add_f32 v28, v28, v30
    v_add_f32 v29, v29, v31
    v_cvt_pk_bf16_f32 v24, v24, v25
    v_cvt_pk_bf16_f32 v25, v28, v29
    v_bfi_b32 v24, 1, s71, v24
    buffer_store_dwordx2 v[24:25], v122, s[4:7], s27 offen
    v_mov_b64 v[40:41], 0
    v_mov_b64 v[42:43], 0
    v_mov_b64 v[44:45], 0
    v_mov_b64 v[46:47], 0
    v_mov_b64 v[48:49], 0
    v_mov_b64 v[50:51], 0
    v_mov_b64 v[52:53], 0
    v_mov_b64 v[54:55], 0
    s_mov_b32 s43, 0x100000
    buffer_load_dwordx4 v[56:59], v123, s[4:7], s30 offen sc1
    buffer_load_dwordx4 v[60:63], v123, s[4:7], s31 offen sc1
main_kernel_p1_1_2:
    s_waitcnt vmcnt(0)
main_kernel_p1_1_2c:
    v_bitop3_b32 v105, v56, v58, s71 bitop3:0x7e
    v_bitop3_b32 v127, v60, v62, s71 bitop3:0x7e
    v_or_b32 v105, v105, v127
    v_and_b32 v105, 1, v105
    v_cmp_ne_u32 vcc, 0, v105
    s_cbranch_vccz main_kernel_p1_1_2done
    s_mov_b64 exec, vcc
    buffer_load_dwordx4 v[56:59], v123, s[4:7], s30 offen sc1
    buffer_load_dwordx4 v[60:63], v123, s[4:7], s31 offen sc1
    s_sub_u32 s43, s43, 1
    s_cbranch_scc0 main_kernel_p1_1_2
main_kernel_p1_1_2done:
    s_mov_b64 exec, -1
    v_mfma_f32_16x16x32_bf16 v[64:67], v[112:115], v[56:59], 0
    v_mfma_f32_16x16x32_bf16 v[64:67], v[112:115], v[60:63], v[64:67]
    v_mov_b64 v[72:73], -1
    v_mov_b64 v[74:75], -1
    s_add_u32 s14, s14, 1
    s_nop 4
    v_add_f32_dpp v68, v64, v64 row_ror:4 row_mask:0xf bank_mask:0xf
    v_add_f32_dpp v69, v65, v65 row_ror:4 row_mask:0xf bank_mask:0xf
    v_add_f32_dpp v70, v66, v66 row_ror:4 row_mask:0xf bank_mask:0xf
    v_add_f32_dpp v71, v67, v67 row_ror:4 row_mask:0xf bank_mask:0xf
    v_add_f32_dpp v64, v68, v68 row_ror:8 row_mask:0xf bank_mask:0xf
    v_add_f32_dpp v65, v69, v69 row_ror:8 row_mask:0xf bank_mask:0xf
    v_add_f32_dpp v66, v70, v70 row_ror:8 row_mask:0xf bank_mask:0xf
    v_add_f32_dpp v67, v71, v71 row_ror:8 row_mask:0xf bank_mask:0xf
    s_mov_b64 exec, s[40:41]
    v_cvt_pk_bf16_f32 v64, v64, v65
    v_cvt_pk_bf16_f32 v65, v66, v67
    buffer_store_dword v64, v125, s[4:7], s32 offen
    buffer_store_dword v65, v125, s[4:7], s32 offen offset:16
    buffer_store_dword v72, v125, s[4:7], s33 offen
    buffer_store_dword v72, v125, s[4:7], s33 offen offset:16
    s_mov_b64 exec, -1
    s_add_u32 s15, s14, 2
    s_cmp_lg_u32 s15, s75
    s_cbranch_scc1 main_kernel_nokv1_2
    v_mov_b32 v127, s69
    buffer_load_dword v126, v127, s[44:47], 0 offen sc1
main_kernel_nokv1_2:
    s_branch main_kernel_wl2
main_kernel_wl3:
    ds_read_b128 v[56:59], v117 offset:12288
    ds_read_b128 v[60:63], v117 offset:13312
    ds_read_b128 v[64:67], v117 offset:14336
    ds_read_b128 v[68:71], v117 offset:15360
    ds_read_b128 v[72:75], v117 offset:0
    ds_read_b128 v[76:79], v117 offset:1024
    ds_read_b128 v[80:83], v117 offset:2048
    ds_read_b128 v[84:87], v117 offset:3072
    s_cmp_eq_u32 s14, 0
    s_cbranch_scc1 main_kernel_m0_3
    s_mov_b32 s43, 0x100000
    buffer_load_dwordx4 v[24:27], v124, s[4:7], s32 offen sc1
    buffer_load_dwordx4 v[28:31], v124, s[4:7], s32 offen offset:1024 sc1
main_kernel_p2_0_3:
    s_waitcnt vmcnt(0)
main_kernel_p2_0_3c:
    v_max3_u32 v105, v24, v25, v26
    v_max3_u32 v127, v27, v28, v29
    v_max3_u32 v105, v30, v31, v105
    v_max_u32 v105, v105, v127
    v_cmp_eq_u32 vcc, -1, v105
    s_cbranch_vccz main_kernel_p2_0_3done
    s_mov_b64 exec, vcc
    buffer_load_dwordx4 v[24:27], v124, s[4:7], s32 offen sc1
    buffer_load_dwordx4 v[28:31], v124, s[4:7], s32 offen offset:1024 sc1
    s_sub_u32 s43, s43, 1
    s_cbranch_scc0 main_kernel_p2_0_3
main_kernel_p2_0_3done:
    s_mov_b64 exec, -1
main_kernel_m0done_3:
    ds_write_b128 v124, v[24:27] offset:16384
    ds_write_b128 v124, v[28:31] offset:17408
    v_smfmac_f32_16x16x64_bf16 v[32:35], v[24:27], a[48:55], v104
    v_smfmac_f32_16x16x64_bf16 v[40:43], v[24:27], a[176:183], v104
    v_smfmac_f32_16x16x64_bf16 v[36:39], v[24:27], a[112:119], v104
    s_waitcnt lgkmcnt(8)
    v_smfmac_f32_16x16x64_bf16 v[44:47], v[24:27], v[56:63], v104
    v_smfmac_f32_16x16x64_bf16 v[48:51], v[24:27], a[240:247], v104
    v_smfmac_f32_16x16x64_bf16 v[52:55], v[24:27], v[176:183], v104
    s_waitcnt lgkmcnt(0)
    s_barrier
    ds_read_b128 v[0:3], v116 offset:16384
    ds_read_b128 v[4:7], v116 offset:17408
    v_smfmac_f32_16x16x64_bf16 v[32:35], v[28:31], a[56:63], v104
    ds_read_b128 v[8:11], v116 offset:18432
    v_smfmac_f32_16x16x64_bf16 v[40:43], v[28:31], a[184:191], v104
    ds_read_b128 v[12:15], v116 offset:19456
    v_smfmac_f32_16x16x64_bf16 v[36:39], v[28:31], a[120:127], v104
    ds_read_b128 v[16:19], v116 offset:20480
    v_smfmac_f32_16x16x64_bf16 v[44:47], v[28:31], v[64:71], v104
    ds_read_b128 v[20:23], v116 offset:21504
    v_smfmac_f32_16x16x64_bf16 v[48:51], v[28:31], a[248:255], v104
    v_smfmac_f32_16x16x64_bf16 v[52:55], v[28:31], v[184:191], v104
    s_waitcnt lgkmcnt(5)
    v_smfmac_f32_16x16x64_bf16 v[32:35], v[0:3], a[0:7], v104
    ds_read_b128 v[56:59], v117 offset:4096
    ds_read_b128 v[60:63], v117 offset:5120
    v_smfmac_f32_16x16x64_bf16 v[40:43], v[0:3], a[128:135], v104
    ds_read_b128 v[64:67], v117 offset:6144
    ds_read_b128 v[68:71], v117 offset:7168
    s_waitcnt lgkmcnt(8)
    v_smfmac_f32_16x16x64_bf16 v[32:35], v[4:7], a[8:15], v104
    s_mov_b32 m0, s68
    s_add_u32 s17, s34, 0x40000
    v_smfmac_f32_16x16x64_bf16 v[40:43], v[4:7], a[136:143], v104
    buffer_load_dwordx4 v124, s[4:7], s34 offen sc1 lds
    s_waitcnt lgkmcnt(7)
    v_smfmac_f32_16x16x64_bf16 v[32:35], v[8:11], a[16:23], v104
    v_smfmac_f32_16x16x64_bf16 v[40:43], v[8:11], a[144:151], v104
    buffer_load_dwordx4 v124, s[4:7], s34 offen offset:1024 sc1 lds
    s_waitcnt lgkmcnt(6)
    v_smfmac_f32_16x16x64_bf16 v[32:35], v[12:15], a[24:31], v104
    v_smfmac_f32_16x16x64_bf16 v[40:43], v[12:15], a[152:159], v104
    buffer_load_dwordx4 v[96:99], v124, s[4:7], s35 offen sc1
    s_waitcnt lgkmcnt(5)
    v_smfmac_f32_16x16x64_bf16 v[32:35], v[16:19], a[32:39], v104
    v_smfmac_f32_16x16x64_bf16 v[40:43], v[16:19], a[160:167], v104
    buffer_load_dwordx4 v[100:103], v124, s[4:7], s35 offen offset:1024 sc1
    s_mov_b32 s34, s17
    s_waitcnt lgkmcnt(4)
    v_smfmac_f32_16x16x64_bf16 v[32:35], v[20:23], a[40:47], v104
    s_add_u32 s35, s35, 0x40000
    v_smfmac_f32_16x16x64_bf16 v[40:43], v[20:23], a[168:175], v104
    v_smfmac_f32_16x16x64_bf16 v[36:39], v[0:3], a[64:71], v104
    v_smfmac_f32_16x16x64_bf16 v[44:47], v[0:3], v[72:79], v104
    ds_read_b128 v[72:75], v117 offset:8192
    ds_read_b128 v[76:79], v117 offset:9216
    v_smfmac_f32_16x16x64_bf16 v[36:39], v[4:7], a[72:79], v104
    v_smfmac_f32_16x16x64_bf16 v[44:47], v[4:7], v[80:87], v104
    ds_read_b128 v[80:83], v117 offset:10240
    ds_read_b128 v[84:87], v117 offset:11264
    v_smfmac_f32_16x16x64_bf16 v[36:39], v[8:11], a[80:87], v104
    v_add_f32 v40, v40, v42
    v_add_f32 v41, v41, v43
    s_waitcnt lgkmcnt(6)
    v_smfmac_f32_16x16x64_bf16 v[44:47], v[8:11], v[56:63], v104
    v_smfmac_f32_16x16x64_bf16 v[36:39], v[12:15], a[88:95], v104
    v_add_f32 v32, v32, v34
    v_add_f32 v33, v33, v35
    s_waitcnt lgkmcnt(4)
    v_smfmac_f32_16x16x64_bf16 v[44:47], v[12:15], v[64:71], v104
    v_smfmac_f32_16x16x64_bf16 v[36:39], v[16:19], a[96:103], v104
    v_cvt_pk_bf16_f32 v40, v40, v41
    v_cvt_pk_bf16_f32 v41, v32, v33
    s_waitcnt lgkmcnt(2)
    v_smfmac_f32_16x16x64_bf16 v[44:47], v[16:19], v[72:79], v104
    v_smfmac_f32_16x16x64_bf16 v[36:39], v[20:23], a[104:111], v104
    ds_write_b64 v118, v[40:41] offset:0
    s_waitcnt lgkmcnt(1)
    v_smfmac_f32_16x16x64_bf16 v[44:47], v[20:23], v[80:87], v104
    ds_read_b128 v[24:27], v116 offset:6144
    ds_read_b128 v[28:31], v116 offset:7168
    v_smfmac_f32_16x16x64_bf16 v[48:51], v[0:3], a[192:199], v104
    v_smfmac_f32_16x16x64_bf16 v[52:55], v[0:3], v[128:135], v104
    ds_read_b128 v[0:3], v116 offset:0
    s_nop 2
    v_add_f32 v44, v44, v46
    v_add_f32 v45, v45, v47
    v_add_f32 v36, v36, v38
    v_add_f32 v37, v37, v39
    v_cvt_pk_bf16_f32 v44, v44, v45
    v_cvt_pk_bf16_f32 v45, v36, v37
    ds_write_b64 v118, v[44:45] offset:512
    v_smfmac_f32_16x16x64_bf16 v[48:51], v[4:7], a[200:207], v104
    v_smfmac_f32_16x16x64_bf16 v[52:55], v[4:7], v[136:143], v104
    ds_read_b128 v[4:7], v116 offset:1024
    s_waitcnt lgkmcnt(1)
    s_barrier
    ds_read_b64_tr_b16 v[32:33], v119 offset:0
    ds_read_b64_tr_b16 v[34:35], v119 offset:512
    ds_read_b64_tr_b16 v[36:37], v119 offset:1024
    ds_read_b64_tr_b16 v[38:39], v119 offset:1536
    v_smfmac_f32_16x16x64_bf16 v[48:51], v[8:11], a[208:215], v104
    ds_read_b64_tr_b16 v[40:41], v119 offset:2048
    ds_read_b64_tr_b16 v[42:43], v119 offset:2560
    v_smfmac_f32_16x16x64_bf16 v[52:55], v[8:11], v[144:151], v104
    ds_read_b64_tr_b16 v[44:45], v119 offset:3072
    ds_read_b64_tr_b16 v[46:47], v119 offset:3584
    ds_read_b128 v[8:11], v116 offset:2048
    v_smfmac_f32_16x16x64_bf16 v[48:51], v[12:15], a[216:223], v104
    v_smfmac_f32_16x16x64_bf16 v[52:55], v[12:15], v[152:159], v104
    ds_read_b128 v[12:15], v116 offset:3072
    v_smfmac_f32_16x16x64_bf16 v[48:51], v[16:19], a[224:231], v104
    v_smfmac_f32_16x16x64_bf16 v[52:55], v[16:19], v[160:167], v104
    ds_read_b128 v[16:19], v116 offset:4096
    v_smfmac_f32_16x16x64_bf16 v[48:51], v[20:23], a[232:239], v104
    v_smfmac_f32_16x16x64_bf16 v[52:55], v[20:23], v[168:175], v104
    ds_read_b128 v[20:23], v116 offset:5120
    s_waitcnt lgkmcnt(4)
    v_mfma_f32_16x16x32_bf16 v[56:59], v[32:35], v[32:35], 0
    v_mfma_f32_16x16x32_bf16 v[64:67], v[24:27], v[40:43], 0
    buffer_store_dwordx4 v[44:47], v116, s[4:7], s36 offen offset:3072 sc1
    s_add_u32 s36, s36, 0x20000
    v_mfma_f32_16x16x32_bf16 v[56:59], v[36:39], v[36:39], v[56:59]
    v_mfma_f32_16x16x32_bf16 v[64:67], v[28:31], v[44:47], v[64:67]
    v_mfma_f32_16x16x32_bf16 v[56:59], v[40:43], v[40:43], v[56:59]
    v_mfma_f32_16x16x32_bf16 v[60:63], v[0:3], v[32:35], 0
    v_cvt_pk_bf16_f32 v48, v48, v49
    v_cvt_pk_bf16_f32 v49, v50, v51
    v_cvt_pk_bf16_f32 v50, v52, v53
    v_cvt_pk_bf16_f32 v51, v54, v55
    v_mfma_f32_16x16x32_bf16 v[56:59], v[44:47], v[44:47], v[56:59]
    v_mfma_f32_16x16x32_bf16 v[60:63], v[4:7], v[36:39], v[60:63]
    buffer_store_dwordx4 v[48:51], v116, s[4:7], s37 offen sc1
    s_add_u32 s37, s37, 0x20000
    s_waitcnt lgkmcnt(3)
    v_mfma_f32_16x16x32_bf16 v[60:63], v[8:11], v[40:43], v[60:63]
    s_waitcnt lgkmcnt(2)
    v_mfma_f32_16x16x32_bf16 v[60:63], v[12:15], v[44:47], v[60:63]
    s_cmp_eq_u32 s14, 63
    s_cbranch_scc1 main_kernel_done
    s_waitcnt lgkmcnt(1)
    v_mfma_f32_16x16x32_bf16 v[64:67], v[16:19], v[32:35], v[64:67]
    s_waitcnt lgkmcnt(0)
    v_mfma_f32_16x16x32_bf16 v[64:67], v[20:23], v[36:39], v[64:67]
    s_nop 1
    v_max3_f32 v105, v60, v61, v62
    v_max3_f32 v127, v63, v56, v57
    s_nop 3
    v_max3_f32 v127, v64, v65, v127
    v_max3_f32 v105, v66, v67, v105
    v_max_f32 v105, v105, v127
    v_mov_b32 v127, v105
    v_mov_b64 v[0:1], 0
    v_mov_b64 v[2:3], 0
    v_permlane32_swap_b32 v105, v127
    v_max_f32 v105, v105, v127
    v_mov_b32 v127, v105
    v_mov_b64 v[4:5], 0
    v_mov_b64 v[6:7], 0
    v_permlane16_swap_b32 v105, v127
    v_max_f32 v105, v105, v127
    v_mul_f32 v105, s42, v105
    v_fma_f32 v56, v56, s42, -v105
    v_fma_f32 v57, v57, s42, -v105
    v_exp_f32 v56, v56
    v_exp_f32 v57, v57
    v_fma_f32 v60, v60, s42, -v105
    v_fma_f32 v61, v61, s42, -v105
    v_fma_f32 v62, v62, s42, -v105
    v_fma_f32 v63, v63, s42, -v105
    v_fma_f32 v64, v64, s42, -v105
    v_fma_f32 v65, v65, s42, -v105
    v_fma_f32 v66, v66, s42, -v105
    v_fma_f32 v67, v67, s42, -v105
    v_cvt_pk_bf16_f32 v58, v56, v57
    v_cvt_pk_bf16_f32 v59, v56, v57
    v_exp_f32 v60, v60
    v_exp_f32 v61, v61
    v_mfma_f32_16x16x16_bf16 v[72:75], v[58:59], v[110:111], 0
    v_exp_f32 v62, v62
    v_exp_f32 v63, v63
    v_mfma_f32_16x16x16_bf16 v[76:79], v[58:59], v[48:49], 0
    v_exp_f32 v64, v64
    v_exp_f32 v65, v65
    v_mfma_f32_16x16x16_bf16 v[80:83], v[58:59], v[50:51], 0
    v_exp_f32 v66, v66
    v_exp_f32 v67, v67
    v_cvt_pk_bf16_f32 v84, v60, v61
    v_cvt_pk_bf16_f32 v85, v62, v63
    v_cvt_pk_bf16_f32 v86, v64, v65
    v_cvt_pk_bf16_f32 v87, v66, v67
    v_mov_b64 v[24:25], 0
    v_mov_b64 v[26:27], 0
    v_mfma_f32_16x16x32_bf16 v[72:75], v[84:87], v[106:109], v[72:75]
    v_mov_b64 v[28:29], 0
    v_mov_b64 v[30:31], 0
    v_mfma_f32_16x16x32_bf16 v[76:79], v[84:87], v[88:91], v[76:79]
    v_mfma_f32_16x16x32_bf16 v[80:83], v[84:87], v[92:95], v[80:83]
    ds_read_b128 v[56:59], v117 offset:16384
    ds_read_b128 v[60:63], v117 offset:17408
    ds_read_b128 v[64:67], v117 offset:20480
    ds_read_b128 v[68:71], v117 offset:21504
    v_rcp_f32 v74, v74
    v_rcp_f32 v75, v75
    s_nop 0
    v_mul_f32 v78, v78, v74
    v_mul_f32 v79, v79, v75
    v_cvt_pk_bf16_f32 v76, v78, v79
    ds_write_b32 v120, v76 offset:0
    v_mul_f32 v82, v82, v74
    v_mul_f32 v83, v83, v75
    v_cvt_pk_bf16_f32 v80, v82, v83
    ds_write_b32 v120, v80 offset:256
    v_mov_b64 v[16:17], 0
    v_mov_b64 v[18:19], 0
    v_mov_b64 v[20:21], 0
    v_mov_b64 v[22:23], 0
    s_waitcnt lgkmcnt(0)
    s_barrier
    ds_read_b64_tr_b16 v[80:81], v121 offset:0
    ds_read_b64_tr_b16 v[82:83], v121 offset:128
    ds_read_b64_tr_b16 v[84:85], v121 offset:1024
    ds_read_b64_tr_b16 v[86:87], v121 offset:1152
    v_mov_b64 v[8:9], 0
    v_mov_b64 v[10:11], 0
    v_mov_b64 v[12:13], 0
    v_mov_b64 v[14:15], 0
    s_waitcnt lgkmcnt(2)
    s_bfe_i32 s71, s14, 0x10001
    v_smfmac_f32_16x16x64_bf16 v[0:3], v[80:83], v[192:199], v104
    v_smfmac_f32_16x16x64_bf16 v[4:7], v[80:83], v[208:215], v104
    ds_read_b128 v[72:75], v117 offset:18432
    ds_read_b128 v[76:79], v117 offset:19456
    s_waitcnt lgkmcnt(2)
    v_smfmac_f32_16x16x64_bf16 v[0:3], v[84:87], v[200:207], v104
    ds_read_b128 v[32:35], v117 offset:22528
    ds_read_b128 v[36:39], v117 offset:23552
    v_smfmac_f32_16x16x64_bf16 v[4:7], v[84:87], v[216:223], v104
    ds_read_b128 v[40:43], v117 offset:24576
    ds_read_b128 v[44:47], v117 offset:25600
    v_smfmac_f32_16x16x64_bf16 v[8:11], v[80:83], v[224:231], v104
    ds_read_b128 v[48:51], v117 offset:28672
    ds_read_b128 v[52:55], v117 offset:29696
    v_smfmac_f32_16x16x64_bf16 v[12:15], v[80:83], v[240:247], v104
    v_smfmac_f32_16x16x64_bf16 v[8:11], v[84:87], v[232:239], v104
    v_add_f32 v0, v0, v2
    v_add_f32 v1, v1, v3
    v_add_f32 v4, v4, v6
    v_add_f32 v5, v5, v7
    v_smfmac_f32_16x16x64_bf16 v[12:15], v[84:87], v[248:255], v104
    v_cvt_pk_bf16_f32 v0, v0, v1
    v_cvt_pk_bf16_f32 v1, v4, v5
    v_bfi_b32 v0, 1, s71, v0
    buffer_store_dwordx2 v[0:1], v122, s[4:7], s20 offen
    v_smfmac_f32_16x16x64_bf16 v[16:19], v[80:83], v[56:63], v104
    ds_read_b128 v[56:59], v117 offset:26624
    ds_read_b128 v[60:63], v117 offset:27648
    v_smfmac_f32_16x16x64_bf16 v[20:23], v[80:83], v[64:71], v104
    ds_read_b128 v[64:67], v117 offset:30720
    ds_read_b128 v[68:71], v117 offset:31744
    s_waitcnt lgkmcnt(10)
    v_smfmac_f32_16x16x64_bf16 v[16:19], v[84:87], v[72:79], v104
    v_add_f32 v8, v8, v10
    v_add_f32 v9, v9, v11
    v_add_f32 v12, v12, v14
    v_add_f32 v13, v13, v15
    s_waitcnt lgkmcnt(8)
    v_smfmac_f32_16x16x64_bf16 v[20:23], v[84:87], v[32:39], v104
    v_cvt_pk_bf16_f32 v8, v8, v9
    v_cvt_pk_bf16_f32 v9, v12, v13
    v_bfi_b32 v8, 1, s71, v8
    buffer_store_dwordx2 v[8:9], v122, s[4:7], s21 offen
    s_waitcnt lgkmcnt(6)
    v_smfmac_f32_16x16x64_bf16 v[24:27], v[80:83], v[40:47], v104
    s_waitcnt lgkmcnt(4)
    v_smfmac_f32_16x16x64_bf16 v[28:31], v[80:83], v[48:55], v104
    s_waitcnt lgkmcnt(2)
    v_smfmac_f32_16x16x64_bf16 v[24:27], v[84:87], v[56:63], v104
    v_add_f32 v16, v16, v18
    v_add_f32 v17, v17, v19
    v_add_f32 v20, v20, v22
    v_add_f32 v21, v21, v23
    s_waitcnt lgkmcnt(0)
    v_smfmac_f32_16x16x64_bf16 v[28:31], v[84:87], v[64:71], v104
    v_cvt_pk_bf16_f32 v16, v16, v17
    v_cvt_pk_bf16_f32 v17, v20, v21
    v_bfi_b32 v16, 1, s71, v16
    buffer_store_dwordx2 v[16:17], v122, s[4:7], s22 offen
    v_mov_b64 v[32:33], 0
    v_mov_b64 v[34:35], 0
    v_mov_b64 v[36:37], 0
    v_mov_b64 v[38:39], 0
    v_add_f32 v24, v24, v26
    v_add_f32 v25, v25, v27
    v_add_f32 v28, v28, v30
    v_add_f32 v29, v29, v31
    v_cvt_pk_bf16_f32 v24, v24, v25
    v_cvt_pk_bf16_f32 v25, v28, v29
    v_bfi_b32 v24, 1, s71, v24
    buffer_store_dwordx2 v[24:25], v122, s[4:7], s23 offen
    v_mov_b64 v[40:41], 0
    v_mov_b64 v[42:43], 0
    v_mov_b64 v[44:45], 0
    v_mov_b64 v[46:47], 0
    v_mov_b64 v[48:49], 0
    v_mov_b64 v[50:51], 0
    v_mov_b64 v[52:53], 0
    v_mov_b64 v[54:55], 0
    s_mov_b32 s43, 0x100000
    buffer_load_dwordx4 v[56:59], v123, s[4:7], s28 offen sc1
    buffer_load_dwordx4 v[60:63], v123, s[4:7], s29 offen sc1
main_kernel_p1_0_3:
    s_waitcnt vmcnt(0)
main_kernel_p1_0_3c:
    v_bitop3_b32 v105, v56, v58, s71 bitop3:0x7e
    v_bitop3_b32 v127, v60, v62, s71 bitop3:0x7e
    v_or_b32 v105, v105, v127
    v_and_b32 v105, 1, v105
    v_cmp_ne_u32 vcc, 0, v105
    s_cbranch_vccz main_kernel_p1_0_3done
    s_mov_b64 exec, vcc
    buffer_load_dwordx4 v[56:59], v123, s[4:7], s28 offen sc1
    buffer_load_dwordx4 v[60:63], v123, s[4:7], s29 offen sc1
    s_sub_u32 s43, s43, 1
    s_cbranch_scc0 main_kernel_p1_0_3
main_kernel_p1_0_3done:
    s_mov_b64 exec, -1
    v_mfma_f32_16x16x32_bf16 v[64:67], v[112:115], v[56:59], 0
    v_mfma_f32_16x16x32_bf16 v[64:67], v[112:115], v[60:63], v[64:67]
    v_mov_b64 v[72:73], -1
    v_mov_b64 v[74:75], -1
    s_add_u32 s14, s14, 1
    s_nop 4
    v_add_f32_dpp v68, v64, v64 row_ror:4 row_mask:0xf bank_mask:0xf
    v_add_f32_dpp v69, v65, v65 row_ror:4 row_mask:0xf bank_mask:0xf
    v_add_f32_dpp v70, v66, v66 row_ror:4 row_mask:0xf bank_mask:0xf
    v_add_f32_dpp v71, v67, v67 row_ror:4 row_mask:0xf bank_mask:0xf
    v_add_f32_dpp v64, v68, v68 row_ror:8 row_mask:0xf bank_mask:0xf
    v_add_f32_dpp v65, v69, v69 row_ror:8 row_mask:0xf bank_mask:0xf
    v_add_f32_dpp v66, v70, v70 row_ror:8 row_mask:0xf bank_mask:0xf
    v_add_f32_dpp v67, v71, v71 row_ror:8 row_mask:0xf bank_mask:0xf
    s_mov_b64 exec, s[40:41]
    v_cvt_pk_bf16_f32 v64, v64, v65
    v_cvt_pk_bf16_f32 v65, v66, v67
    buffer_store_dword v64, v125, s[4:7], s33 offen
    buffer_store_dword v65, v125, s[4:7], s33 offen offset:16
    buffer_store_dword v72, v125, s[4:7], s32 offen
    buffer_store_dword v72, v125, s[4:7], s32 offen offset:16
    s_mov_b64 exec, -1
    s_add_u32 s15, s14, 1
    s_cmp_lg_u32 s15, s75
    s_cbranch_scc1 main_kernel_nokv0_3
    v_readfirstlane_b32 s18, v126
    s_nop 0
    s_cmp_ge_u32 s18, 64
    s_cbranch_scc1 main_kernel_kvok0_3
    s_mov_b32 s43, 0x200000
    v_mov_b32 v127, s69
main_kernel_wkvn3:
    buffer_load_dword v126, v127, s[44:47], 0 offen sc1
    s_waitcnt vmcnt(0)
    v_readfirstlane_b32 s18, v126
    s_nop 0
    s_cmp_ge_u32 s18, 64
    s_cbranch_scc1 main_kernel_wkvn3_ok
    s_sleep 2
    s_sub_u32 s43, s43, 1
    s_cbranch_scc0 main_kernel_wkvn3
main_kernel_wkvn3_ok:
main_kernel_kvok0_3:
    s_min_u32 s15, s75, 8
    s_add_u32 s75, s75, s15
    s_add_u32 s69, s69, 4
    s_cmp_ge_u32 s75, 64
    s_cselect_b32 s75, 0x7fff, s75
main_kernel_nokv0_3:
    ds_read_b128 v[56:59], v117 offset:12288
    ds_read_b128 v[60:63], v117 offset:13312
    ds_read_b128 v[64:67], v117 offset:14336
    ds_read_b128 v[68:71], v117 offset:15360
    ds_read_b128 v[72:75], v117 offset:0
    ds_read_b128 v[76:79], v117 offset:1024
    ds_read_b128 v[80:83], v117 offset:2048
    ds_read_b128 v[84:87], v117 offset:3072
    s_mov_b32 s43, 0x100000
    buffer_load_dwordx4 v[24:27], v124, s[4:7], s33 offen sc1
    buffer_load_dwordx4 v[28:31], v124, s[4:7], s33 offen offset:1024 sc1
main_kernel_p2_1_3:
    s_waitcnt vmcnt(0)
main_kernel_p2_1_3c:
    v_max3_u32 v105, v24, v25, v26
    v_max3_u32 v127, v27, v28, v29
    v_max3_u32 v105, v30, v31, v105
    v_max_u32 v105, v105, v127
    v_cmp_eq_u32 vcc, -1, v105
    s_cbranch_vccz main_kernel_p2_1_3done
    s_mov_b64 exec, vcc
    buffer_load_dwordx4 v[24:27], v124, s[4:7], s33 offen sc1
    buffer_load_dwordx4 v[28:31], v124, s[4:7], s33 offen offset:1024 sc1
    s_sub_u32 s43, s43, 1
    s_cbranch_scc0 main_kernel_p2_1_3
main_kernel_p2_1_3done:
    s_mov_b64 exec, -1
    ds_write_b128 v124, v[24:27] offset:16384
    ds_write_b128 v124, v[28:31] offset:17408
    v_smfmac_f32_16x16x64_bf16 v[32:35], v[24:27], a[48:55], v104
    v_smfmac_f32_16x16x64_bf16 v[40:43], v[24:27], a[176:183], v104
    v_smfmac_f32_16x16x64_bf16 v[36:39], v[24:27], a[112:119], v104
    s_waitcnt lgkmcnt(8)
    v_smfmac_f32_16x16x64_bf16 v[44:47], v[24:27], v[56:63], v104
    v_smfmac_f32_16x16x64_bf16 v[48:51], v[24:27], a[240:247], v104
    v_smfmac_f32_16x16x64_bf16 v[52:55], v[24:27], v[176:183], v104
    s_waitcnt lgkmcnt(0)
    s_barrier
    ds_read_b128 v[0:3], v116 offset:16384
    ds_read_b128 v[4:7], v116 offset:17408
    v_smfmac_f32_16x16x64_bf16 v[32:35], v[28:31], a[56:63], v104
    ds_read_b128 v[8:11], v116 offset:18432
    v_smfmac_f32_16x16x64_bf16 v[40:43], v[28:31], a[184:191], v104
    ds_read_b128 v[12:15], v116 offset:19456
    v_smfmac_f32_16x16x64_bf16 v[36:39], v[28:31], a[120:127], v104
    ds_read_b128 v[16:19], v116 offset:20480
    v_smfmac_f32_16x16x64_bf16 v[44:47], v[28:31], v[64:71], v104
    ds_read_b128 v[20:23], v116 offset:21504
    v_smfmac_f32_16x16x64_bf16 v[48:51], v[28:31], a[248:255], v104
    v_smfmac_f32_16x16x64_bf16 v[52:55], v[28:31], v[184:191], v104
    s_waitcnt lgkmcnt(5)
    v_smfmac_f32_16x16x64_bf16 v[32:35], v[0:3], a[0:7], v104
    ds_read_b128 v[56:59], v117 offset:4096
    ds_read_b128 v[60:63], v117 offset:5120
    v_smfmac_f32_16x16x64_bf16 v[40:43], v[0:3], a[128:135], v104
    ds_read_b128 v[64:67], v117 offset:6144
    ds_read_b128 v[68:71], v117 offset:7168
    s_waitcnt lgkmcnt(8)
    v_smfmac_f32_16x16x64_bf16 v[32:35], v[4:7], a[8:15], v104
    s_mov_b32 m0, s67
    s_add_u32 s17, s34, 0x40000
    v_smfmac_f32_16x16x64_bf16 v[40:43], v[4:7], a[136:143], v104
    buffer_load_dwordx4 v124, s[4:7], s34 offen sc1 lds
    s_waitcnt lgkmcnt(7)
    v_smfmac_f32_16x16x64_bf16 v[32:35], v[8:11], a[16:23], v104
    v_smfmac_f32_16x16x64_bf16 v[40:43], v[8:11], a[144:151], v104
    buffer_load_dwordx4 v124, s[4:7], s34 offen offset:1024 sc1 lds
    s_waitcnt lgkmcnt(6)
    v_smfmac_f32_16x16x64_bf16 v[32:35], v[12:15], a[24:31], v104
    v_smfmac_f32_16x16x64_bf16 v[40:43], v[12:15], a[152:159], v104
    buffer_load_dwordx4 v[88:91], v124, s[4:7], s35 offen sc1
    s_waitcnt lgkmcnt(5)
    v_smfmac_f32_16x16x64_bf16 v[32:35], v[16:19], a[32:39], v104
    v_smfmac_f32_16x16x64_bf16 v[40:43], v[16:19], a[160:167], v104
    buffer_load_dwordx4 v[92:95], v124, s[4:7], s35 offen offset:1024 sc1
    s_mov_b32 s34, s17
    s_waitcnt lgkmcnt(4)
    v_smfmac_f32_16x16x64_bf16 v[32:35], v[20:23], a[40:47], v104
    s_add_u32 s35, s35, 0x40000
    v_smfmac_f32_16x16x64_bf16 v[40:43], v[20:23], a[168:175], v104
    v_smfmac_f32_16x16x64_bf16 v[36:39], v[0:3], a[64:71], v104
    v_smfmac_f32_16x16x64_bf16 v[44:47], v[0:3], v[72:79], v104
    ds_read_b128 v[72:75], v117 offset:8192
    ds_read_b128 v[76:79], v117 offset:9216
    v_smfmac_f32_16x16x64_bf16 v[36:39], v[4:7], a[72:79], v104
    v_smfmac_f32_16x16x64_bf16 v[44:47], v[4:7], v[80:87], v104
    ds_read_b128 v[80:83], v117 offset:10240
    ds_read_b128 v[84:87], v117 offset:11264
    v_smfmac_f32_16x16x64_bf16 v[36:39], v[8:11], a[80:87], v104
    v_add_f32 v40, v40, v42
    v_add_f32 v41, v41, v43
    s_waitcnt lgkmcnt(6)
    v_smfmac_f32_16x16x64_bf16 v[44:47], v[8:11], v[56:63], v104
    v_smfmac_f32_16x16x64_bf16 v[36:39], v[12:15], a[88:95], v104
    v_add_f32 v32, v32, v34
    v_add_f32 v33, v33, v35
    s_waitcnt lgkmcnt(4)
    v_smfmac_f32_16x16x64_bf16 v[44:47], v[12:15], v[64:71], v104
    v_smfmac_f32_16x16x64_bf16 v[36:39], v[16:19], a[96:103], v104
    v_cvt_pk_bf16_f32 v40, v40, v41
    v_cvt_pk_bf16_f32 v41, v32, v33
    s_waitcnt lgkmcnt(2)
    v_smfmac_f32_16x16x64_bf16 v[44:47], v[16:19], v[72:79], v104
    v_smfmac_f32_16x16x64_bf16 v[36:39], v[20:23], a[104:111], v104
    ds_write_b64 v118, v[40:41] offset:0
    s_waitcnt lgkmcnt(1)
    v_smfmac_f32_16x16x64_bf16 v[44:47], v[20:23], v[80:87], v104
    ds_read_b128 v[24:27], v116 offset:14336
    ds_read_b128 v[28:31], v116 offset:15360
    v_smfmac_f32_16x16x64_bf16 v[48:51], v[0:3], a[192:199], v104
    v_smfmac_f32_16x16x64_bf16 v[52:55], v[0:3], v[128:135], v104
    ds_read_b128 v[0:3], v116 offset:8192
    s_nop 2
    v_add_f32 v44, v44, v46
    v_add_f32 v45, v45, v47
    v_add_f32 v36, v36, v38
    v_add_f32 v37, v37, v39
    v_cvt_pk_bf16_f32 v44, v44, v45
    v_cvt_pk_bf16_f32 v45, v36, v37
    ds_write_b64 v118, v[44:45] offset:512
    v_smfmac_f32_16x16x64_bf16 v[48:51], v[4:7], a[200:207], v104
    v_smfmac_f32_16x16x64_bf16 v[52:55], v[4:7], v[136:143], v104
    ds_read_b128 v[4:7], v116 offset:9216
    s_waitcnt lgkmcnt(1)
    s_barrier
    ds_read_b64_tr_b16 v[32:33], v119 offset:0
    ds_read_b64_tr_b16 v[34:35], v119 offset:512
    ds_read_b64_tr_b16 v[36:37], v119 offset:1024
    ds_read_b64_tr_b16 v[38:39], v119 offset:1536
    v_smfmac_f32_16x16x64_bf16 v[48:51], v[8:11], a[208:215], v104
    ds_read_b64_tr_b16 v[40:41], v119 offset:2048
    ds_read_b64_tr_b16 v[42:43], v119 offset:2560
    v_smfmac_f32_16x16x64_bf16 v[52:55], v[8:11], v[144:151], v104
    ds_read_b64_tr_b16 v[44:45], v119 offset:3072
    ds_read_b64_tr_b16 v[46:47], v119 offset:3584
    ds_read_b128 v[8:11], v116 offset:10240
    v_smfmac_f32_16x16x64_bf16 v[48:51], v[12:15], a[216:223], v104
    v_smfmac_f32_16x16x64_bf16 v[52:55], v[12:15], v[152:159], v104
    ds_read_b128 v[12:15], v116 offset:11264
    v_smfmac_f32_16x16x64_bf16 v[48:51], v[16:19], a[224:231], v104
    v_smfmac_f32_16x16x64_bf16 v[52:55], v[16:19], v[160:167], v104
    ds_read_b128 v[16:19], v116 offset:12288
    v_smfmac_f32_16x16x64_bf16 v[48:51], v[20:23], a[232:239], v104
    v_smfmac_f32_16x16x64_bf16 v[52:55], v[20:23], v[168:175], v104
    ds_read_b128 v[20:23], v116 offset:13312
    s_waitcnt lgkmcnt(4)
    v_mfma_f32_16x16x32_bf16 v[56:59], v[32:35], v[32:35], 0
    v_mfma_f32_16x16x32_bf16 v[64:67], v[24:27], v[40:43], 0
    buffer_store_dwordx4 v[44:47], v116, s[4:7], s36 offen offset:3072 sc1
    s_add_u32 s36, s36, 0x20000
    v_mfma_f32_16x16x32_bf16 v[56:59], v[36:39], v[36:39], v[56:59]
    v_mfma_f32_16x16x32_bf16 v[64:67], v[28:31], v[44:47], v[64:67]
    v_mfma_f32_16x16x32_bf16 v[56:59], v[40:43], v[40:43], v[56:59]
    v_mfma_f32_16x16x32_bf16 v[60:63], v[0:3], v[32:35], 0
    v_cvt_pk_bf16_f32 v48, v48, v49
    v_cvt_pk_bf16_f32 v49, v50, v51
    v_cvt_pk_bf16_f32 v50, v52, v53
    v_cvt_pk_bf16_f32 v51, v54, v55
    v_mfma_f32_16x16x32_bf16 v[56:59], v[44:47], v[44:47], v[56:59]
    v_mfma_f32_16x16x32_bf16 v[60:63], v[4:7], v[36:39], v[60:63]
    buffer_store_dwordx4 v[48:51], v116, s[4:7], s37 offen sc1
    s_add_u32 s37, s37, 0x20000
    s_waitcnt lgkmcnt(3)
    v_mfma_f32_16x16x32_bf16 v[60:63], v[8:11], v[40:43], v[60:63]
    s_waitcnt lgkmcnt(2)
    v_mfma_f32_16x16x32_bf16 v[60:63], v[12:15], v[44:47], v[60:63]
    s_cmp_eq_u32 s14, 63
    s_cbranch_scc1 main_kernel_done
    s_waitcnt lgkmcnt(1)
    v_mfma_f32_16x16x32_bf16 v[64:67], v[16:19], v[32:35], v[64:67]
    s_waitcnt lgkmcnt(0)
    v_mfma_f32_16x16x32_bf16 v[64:67], v[20:23], v[36:39], v[64:67]
    s_nop 1
    v_max3_f32 v105, v60, v61, v62
    v_max3_f32 v127, v63, v56, v57
    s_nop 3
    v_max3_f32 v127, v64, v65, v127
    v_max3_f32 v105, v66, v67, v105
    v_max_f32 v105, v105, v127
    v_mov_b32 v127, v105
    v_mov_b64 v[0:1], 0
    v_mov_b64 v[2:3], 0
    v_permlane32_swap_b32 v105, v127
    v_max_f32 v105, v105, v127
    v_mov_b32 v127, v105
    v_mov_b64 v[4:5], 0
    v_mov_b64 v[6:7], 0
    v_permlane16_swap_b32 v105, v127
    v_max_f32 v105, v105, v127
    v_mul_f32 v105, s42, v105
    v_fma_f32 v56, v56, s42, -v105
    v_fma_f32 v57, v57, s42, -v105
    v_exp_f32 v56, v56
    v_exp_f32 v57, v57
    v_fma_f32 v60, v60, s42, -v105
    v_fma_f32 v61, v61, s42, -v105
    v_fma_f32 v62, v62, s42, -v105
    v_fma_f32 v63, v63, s42, -v105
    v_fma_f32 v64, v64, s42, -v105
    v_fma_f32 v65, v65, s42, -v105
    v_fma_f32 v66, v66, s42, -v105
    v_fma_f32 v67, v67, s42, -v105
    v_cvt_pk_bf16_f32 v58, v56, v57
    v_cvt_pk_bf16_f32 v59, v56, v57
    v_exp_f32 v60, v60
    v_exp_f32 v61, v61
    v_mfma_f32_16x16x16_bf16 v[72:75], v[58:59], v[110:111], 0
    v_exp_f32 v62, v62
    v_exp_f32 v63, v63
    v_mfma_f32_16x16x16_bf16 v[76:79], v[58:59], v[48:49], 0
    v_exp_f32 v64, v64
    v_exp_f32 v65, v65
    v_mfma_f32_16x16x16_bf16 v[80:83], v[58:59], v[50:51], 0
    v_exp_f32 v66, v66
    v_exp_f32 v67, v67
    v_cvt_pk_bf16_f32 v84, v60, v61
    v_cvt_pk_bf16_f32 v85, v62, v63
    v_cvt_pk_bf16_f32 v86, v64, v65
    v_cvt_pk_bf16_f32 v87, v66, v67
    v_mov_b64 v[24:25], 0
    v_mov_b64 v[26:27], 0
    v_mfma_f32_16x16x32_bf16 v[72:75], v[84:87], v[106:109], v[72:75]
    v_mov_b64 v[28:29], 0
    v_mov_b64 v[30:31], 0
    v_mfma_f32_16x16x32_bf16 v[76:79], v[84:87], v[96:99], v[76:79]
    v_mfma_f32_16x16x32_bf16 v[80:83], v[84:87], v[100:103], v[80:83]
    ds_read_b128 v[56:59], v117 offset:16384
    ds_read_b128 v[60:63], v117 offset:17408
    ds_read_b128 v[64:67], v117 offset:20480
    ds_read_b128 v[68:71], v117 offset:21504
    v_rcp_f32 v74, v74
    v_rcp_f32 v75, v75
    s_nop 0
    v_mul_f32 v78, v78, v74
    v_mul_f32 v79, v79, v75
    v_cvt_pk_bf16_f32 v76, v78, v79
    ds_write_b32 v120, v76 offset:0
    v_mul_f32 v82, v82, v74
    v_mul_f32 v83, v83, v75
    v_cvt_pk_bf16_f32 v80, v82, v83
    ds_write_b32 v120, v80 offset:256
    v_mov_b64 v[16:17], 0
    v_mov_b64 v[18:19], 0
    v_mov_b64 v[20:21], 0
    v_mov_b64 v[22:23], 0
    s_waitcnt lgkmcnt(0)
    s_barrier
    ds_read_b64_tr_b16 v[80:81], v121 offset:0
    ds_read_b64_tr_b16 v[82:83], v121 offset:128
    ds_read_b64_tr_b16 v[84:85], v121 offset:1024
    ds_read_b64_tr_b16 v[86:87], v121 offset:1152
    v_mov_b64 v[8:9], 0
    v_mov_b64 v[10:11], 0
    v_mov_b64 v[12:13], 0
    v_mov_b64 v[14:15], 0
    s_waitcnt lgkmcnt(2)
    s_bfe_i32 s71, s14, 0x10001
    v_smfmac_f32_16x16x64_bf16 v[0:3], v[80:83], v[192:199], v104
    v_smfmac_f32_16x16x64_bf16 v[4:7], v[80:83], v[208:215], v104
    ds_read_b128 v[72:75], v117 offset:18432
    ds_read_b128 v[76:79], v117 offset:19456
    s_waitcnt lgkmcnt(2)
    v_smfmac_f32_16x16x64_bf16 v[0:3], v[84:87], v[200:207], v104
    ds_read_b128 v[32:35], v117 offset:22528
    ds_read_b128 v[36:39], v117 offset:23552
    v_smfmac_f32_16x16x64_bf16 v[4:7], v[84:87], v[216:223], v104
    ds_read_b128 v[40:43], v117 offset:24576
    ds_read_b128 v[44:47], v117 offset:25600
    v_smfmac_f32_16x16x64_bf16 v[8:11], v[80:83], v[224:231], v104
    ds_read_b128 v[48:51], v117 offset:28672
    ds_read_b128 v[52:55], v117 offset:29696
    v_smfmac_f32_16x16x64_bf16 v[12:15], v[80:83], v[240:247], v104
    v_smfmac_f32_16x16x64_bf16 v[8:11], v[84:87], v[232:239], v104
    v_add_f32 v0, v0, v2
    v_add_f32 v1, v1, v3
    v_add_f32 v4, v4, v6
    v_add_f32 v5, v5, v7
    v_smfmac_f32_16x16x64_bf16 v[12:15], v[84:87], v[248:255], v104
    v_cvt_pk_bf16_f32 v0, v0, v1
    v_cvt_pk_bf16_f32 v1, v4, v5
    v_bfi_b32 v0, 1, s71, v0
    buffer_store_dwordx2 v[0:1], v122, s[4:7], s24 offen
    v_smfmac_f32_16x16x64_bf16 v[16:19], v[80:83], v[56:63], v104
    ds_read_b128 v[56:59], v117 offset:26624
    ds_read_b128 v[60:63], v117 offset:27648
    v_smfmac_f32_16x16x64_bf16 v[20:23], v[80:83], v[64:71], v104
    ds_read_b128 v[64:67], v117 offset:30720
    ds_read_b128 v[68:71], v117 offset:31744
    s_waitcnt lgkmcnt(10)
    v_smfmac_f32_16x16x64_bf16 v[16:19], v[84:87], v[72:79], v104
    v_add_f32 v8, v8, v10
    v_add_f32 v9, v9, v11
    v_add_f32 v12, v12, v14
    v_add_f32 v13, v13, v15
    s_waitcnt lgkmcnt(8)
    v_smfmac_f32_16x16x64_bf16 v[20:23], v[84:87], v[32:39], v104
    v_cvt_pk_bf16_f32 v8, v8, v9
    v_cvt_pk_bf16_f32 v9, v12, v13
    v_bfi_b32 v8, 1, s71, v8
    buffer_store_dwordx2 v[8:9], v122, s[4:7], s25 offen
    s_waitcnt lgkmcnt(6)
    v_smfmac_f32_16x16x64_bf16 v[24:27], v[80:83], v[40:47], v104
    s_waitcnt lgkmcnt(4)
    v_smfmac_f32_16x16x64_bf16 v[28:31], v[80:83], v[48:55], v104
    s_waitcnt lgkmcnt(2)
    v_smfmac_f32_16x16x64_bf16 v[24:27], v[84:87], v[56:63], v104
    v_add_f32 v16, v16, v18
    v_add_f32 v17, v17, v19
    v_add_f32 v20, v20, v22
    v_add_f32 v21, v21, v23
    s_waitcnt lgkmcnt(0)
    v_smfmac_f32_16x16x64_bf16 v[28:31], v[84:87], v[64:71], v104
    v_cvt_pk_bf16_f32 v16, v16, v17
    v_cvt_pk_bf16_f32 v17, v20, v21
    v_bfi_b32 v16, 1, s71, v16
    buffer_store_dwordx2 v[16:17], v122, s[4:7], s26 offen
    v_mov_b64 v[32:33], 0
    v_mov_b64 v[34:35], 0
    v_mov_b64 v[36:37], 0
    v_mov_b64 v[38:39], 0
    v_add_f32 v24, v24, v26
    v_add_f32 v25, v25, v27
    v_add_f32 v28, v28, v30
    v_add_f32 v29, v29, v31
    v_cvt_pk_bf16_f32 v24, v24, v25
    v_cvt_pk_bf16_f32 v25, v28, v29
    v_bfi_b32 v24, 1, s71, v24
    buffer_store_dwordx2 v[24:25], v122, s[4:7], s27 offen
    v_mov_b64 v[40:41], 0
    v_mov_b64 v[42:43], 0
    v_mov_b64 v[44:45], 0
    v_mov_b64 v[46:47], 0
    v_mov_b64 v[48:49], 0
    v_mov_b64 v[50:51], 0
    v_mov_b64 v[52:53], 0
    v_mov_b64 v[54:55], 0
    s_mov_b32 s43, 0x100000
    buffer_load_dwordx4 v[56:59], v123, s[4:7], s30 offen sc1
    buffer_load_dwordx4 v[60:63], v123, s[4:7], s31 offen sc1
main_kernel_p1_1_3:
    s_waitcnt vmcnt(0)
main_kernel_p1_1_3c:
    v_bitop3_b32 v105, v56, v58, s71 bitop3:0x7e
    v_bitop3_b32 v127, v60, v62, s71 bitop3:0x7e
    v_or_b32 v105, v105, v127
    v_and_b32 v105, 1, v105
    v_cmp_ne_u32 vcc, 0, v105
    s_cbranch_vccz main_kernel_p1_1_3done
    s_mov_b64 exec, vcc
    buffer_load_dwordx4 v[56:59], v123, s[4:7], s30 offen sc1
    buffer_load_dwordx4 v[60:63], v123, s[4:7], s31 offen sc1
    s_sub_u32 s43, s43, 1
    s_cbranch_scc0 main_kernel_p1_1_3
main_kernel_p1_1_3done:
    s_mov_b64 exec, -1
    v_mfma_f32_16x16x32_bf16 v[64:67], v[112:115], v[56:59], 0
    v_mfma_f32_16x16x32_bf16 v[64:67], v[112:115], v[60:63], v[64:67]
    v_mov_b64 v[72:73], -1
    v_mov_b64 v[74:75], -1
    s_add_u32 s14, s14, 1
    s_nop 4
    v_add_f32_dpp v68, v64, v64 row_ror:4 row_mask:0xf bank_mask:0xf
    v_add_f32_dpp v69, v65, v65 row_ror:4 row_mask:0xf bank_mask:0xf
    v_add_f32_dpp v70, v66, v66 row_ror:4 row_mask:0xf bank_mask:0xf
    v_add_f32_dpp v71, v67, v67 row_ror:4 row_mask:0xf bank_mask:0xf
    v_add_f32_dpp v64, v68, v68 row_ror:8 row_mask:0xf bank_mask:0xf
    v_add_f32_dpp v65, v69, v69 row_ror:8 row_mask:0xf bank_mask:0xf
    v_add_f32_dpp v66, v70, v70 row_ror:8 row_mask:0xf bank_mask:0xf
    v_add_f32_dpp v67, v71, v71 row_ror:8 row_mask:0xf bank_mask:0xf
    s_mov_b64 exec, s[40:41]
    v_cvt_pk_bf16_f32 v64, v64, v65
    v_cvt_pk_bf16_f32 v65, v66, v67
    buffer_store_dword v64, v125, s[4:7], s32 offen
    buffer_store_dword v65, v125, s[4:7], s32 offen offset:16
    buffer_store_dword v72, v125, s[4:7], s33 offen
    buffer_store_dword v72, v125, s[4:7], s33 offen offset:16
    s_mov_b64 exec, -1
    s_add_u32 s15, s14, 2
    s_cmp_lg_u32 s15, s75
    s_cbranch_scc1 main_kernel_nokv1_3
    v_mov_b32 v127, s69
    buffer_load_dword v126, v127, s[44:47], 0 offen sc1
main_kernel_nokv1_3:
    s_branch main_kernel_wl3
main_kernel_slowmode:
    s_cmp_eq_u32 s13, 1
    s_cbranch_scc1 main_kernel_wl1s
    s_cmp_eq_u32 s13, 2
    s_cbranch_scc1 main_kernel_wl2s
    s_cmp_eq_u32 s13, 3
    s_cbranch_scc1 main_kernel_wl3s
main_kernel_wl0s:
    ds_read_b128 v[56:59], v117 offset:0
    ds_read_b128 v[60:63], v117 offset:1024
    ds_read_b128 v[64:67], v117 offset:2048
    ds_read_b128 v[68:71], v117 offset:3072
    ds_read_b128 v[72:75], v117 offset:4096
    ds_read_b128 v[76:79], v117 offset:5120
    ds_read_b128 v[80:83], v117 offset:6144
    ds_read_b128 v[84:87], v117 offset:7168
    s_cmp_eq_u32 s14, 0
    s_cbranch_scc1 main_kernel_m0_0s
    s_mov_b32 s43, 0x100000
    buffer_load_dwordx4 v[0:3], v124, s[4:7], s32 offen sc1
    buffer_load_dwordx4 v[4:7], v124, s[4:7], s32 offen offset:1024 sc1
main_kernel_p2_0_0s:
    s_waitcnt vmcnt(0)
main_kernel_p2_0_0sc:
    v_max3_u32 v105, v0, v1, v2
    v_max3_u32 v127, v3, v4, v5
    v_max3_u32 v105, v6, v7, v105
    v_max_u32 v105, v105, v127
    v_cmp_eq_u32 vcc, -1, v105
    s_cbranch_vccz main_kernel_p2_0_0sdone
    s_mov_b64 exec, vcc
    buffer_load_dwordx4 v[0:3], v124, s[4:7], s32 offen sc1
    buffer_load_dwordx4 v[4:7], v124, s[4:7], s32 offen offset:1024 sc1
    s_sub_u32 s43, s43, 1
    s_cbranch_scc0 main_kernel_p2_0_0s
main_kernel_p2_0_0sdone:
    s_mov_b64 exec, -1
main_kernel_m0done_0s:
    ds_write_b128 v124, v[0:3] offset:16384
    ds_write_b128 v124, v[4:7] offset:17408
    v_smfmac_f32_16x16x64_bf16 v[32:35], v[0:3], a[0:7], v104
    v_smfmac_f32_16x16x64_bf16 v[40:43], v[0:3], a[128:135], v104
    v_smfmac_f32_16x16x64_bf16 v[36:39], v[0:3], a[64:71], v104
    s_waitcnt lgkmcnt(8)
    v_smfmac_f32_16x16x64_bf16 v[44:47], v[0:3], v[56:63], v104
    v_smfmac_f32_16x16x64_bf16 v[48:51], v[0:3], a[192:199], v104
    v_smfmac_f32_16x16x64_bf16 v[52:55], v[0:3], v[128:135], v104
    s_waitcnt lgkmcnt(0)
    s_barrier
    ds_read_b128 v[8:11], v116 offset:18432
    ds_read_b128 v[12:15], v116 offset:19456
    v_smfmac_f32_16x16x64_bf16 v[32:35], v[4:7], a[8:15], v104
    ds_read_b128 v[16:19], v116 offset:20480
    v_smfmac_f32_16x16x64_bf16 v[40:43], v[4:7], a[136:143], v104
    ds_read_b128 v[20:23], v116 offset:21504
    v_smfmac_f32_16x16x64_bf16 v[36:39], v[4:7], a[72:79], v104
    ds_read_b128 v[24:27], v116 offset:22528
    v_smfmac_f32_16x16x64_bf16 v[44:47], v[4:7], v[64:71], v104
    ds_read_b128 v[28:31], v116 offset:23552
    v_smfmac_f32_16x16x64_bf16 v[48:51], v[4:7], a[200:207], v104
    v_smfmac_f32_16x16x64_bf16 v[52:55], v[4:7], v[136:143], v104
    s_waitcnt lgkmcnt(5)
    v_smfmac_f32_16x16x64_bf16 v[32:35], v[8:11], a[16:23], v104
    ds_read_b128 v[56:59], v117 offset:8192
    ds_read_b128 v[60:63], v117 offset:9216
    v_smfmac_f32_16x16x64_bf16 v[40:43], v[8:11], a[144:151], v104
    ds_read_b128 v[64:67], v117 offset:10240
    ds_read_b128 v[68:71], v117 offset:11264
    s_waitcnt lgkmcnt(8)
    v_smfmac_f32_16x16x64_bf16 v[32:35], v[12:15], a[24:31], v104
    s_mov_b32 m0, s68
    s_add_u32 s17, s34, 0x40000
    v_smfmac_f32_16x16x64_bf16 v[40:43], v[12:15], a[152:159], v104
    buffer_load_dwordx4 v124, s[4:7], s34 offen sc1 lds
    s_waitcnt lgkmcnt(7)
    v_smfmac_f32_16x16x64_bf16 v[32:35], v[16:19], a[32:39], v104
    v_smfmac_f32_16x16x64_bf16 v[40:43], v[16:19], a[160:167], v104
    buffer_load_dwordx4 v124, s[4:7], s34 offen offset:1024 sc1 lds
    s_waitcnt lgkmcnt(6)
    v_smfmac_f32_16x16x64_bf16 v[32:35], v[20:23], a[40:47], v104
    v_smfmac_f32_16x16x64_bf16 v[40:43], v[20:23], a[168:175], v104
    buffer_load_dwordx4 v[96:99], v124, s[4:7], s35 offen sc1
    s_waitcnt lgkmcnt(5)
    v_smfmac_f32_16x16x64_bf16 v[32:35], v[24:27], a[48:55], v104
    v_smfmac_f32_16x16x64_bf16 v[40:43], v[24:27], a[176:183], v104
    buffer_load_dwordx4 v[100:103], v124, s[4:7], s35 offen offset:1024 sc1
    s_mov_b32 s34, s17
    s_waitcnt lgkmcnt(4)
    v_smfmac_f32_16x16x64_bf16 v[32:35], v[28:31], a[56:63], v104
    s_add_u32 s35, s35, 0x40000
    v_smfmac_f32_16x16x64_bf16 v[40:43], v[28:31], a[184:191], v104
    v_smfmac_f32_16x16x64_bf16 v[36:39], v[8:11], a[80:87], v104
    v_lshlrev_b32 v127, 3, v116
    v_mov_b32 v105, s14
    v_smfmac_f32_16x16x64_bf16 v[44:47], v[8:11], v[72:79], v104
    ds_read_b128 v[72:75], v117 offset:12288
    ds_read_b128 v[76:79], v117 offset:13312
    v_smfmac_f32_16x16x64_bf16 v[36:39], v[12:15], a[88:95], v104
    s_mov_b64 exec, s[72:73]
    buffer_store_dword v105, v127, s[4:7], s74 offen sc1
    s_mov_b64 exec, -1
    v_smfmac_f32_16x16x64_bf16 v[44:47], v[12:15], v[80:87], v104
    ds_read_b128 v[80:83], v117 offset:14336
    ds_read_b128 v[84:87], v117 offset:15360
    v_smfmac_f32_16x16x64_bf16 v[36:39], v[16:19], a[96:103], v104
    v_add_f32 v40, v40, v42
    v_add_f32 v41, v41, v43
    s_waitcnt lgkmcnt(6)
    v_smfmac_f32_16x16x64_bf16 v[44:47], v[16:19], v[56:63], v104
    v_smfmac_f32_16x16x64_bf16 v[36:39], v[20:23], a[104:111], v104
    v_add_f32 v32, v32, v34
    v_add_f32 v33, v33, v35
    s_waitcnt lgkmcnt(4)
    v_smfmac_f32_16x16x64_bf16 v[44:47], v[20:23], v[64:71], v104
    v_smfmac_f32_16x16x64_bf16 v[36:39], v[24:27], a[112:119], v104
    v_cvt_pk_bf16_f32 v40, v40, v41
    v_cvt_pk_bf16_f32 v41, v32, v33
    s_waitcnt lgkmcnt(2)
    v_smfmac_f32_16x16x64_bf16 v[44:47], v[24:27], v[72:79], v104
    v_smfmac_f32_16x16x64_bf16 v[36:39], v[28:31], a[120:127], v104
    ds_write_b64 v118, v[40:41] offset:0
    s_waitcnt lgkmcnt(1)
    v_smfmac_f32_16x16x64_bf16 v[44:47], v[28:31], v[80:87], v104
    ds_read_b128 v[0:3], v116 offset:0
    ds_read_b128 v[4:7], v116 offset:1024
    v_smfmac_f32_16x16x64_bf16 v[48:51], v[8:11], a[208:215], v104
    v_smfmac_f32_16x16x64_bf16 v[52:55], v[8:11], v[144:151], v104
    ds_read_b128 v[8:11], v116 offset:2048
    s_nop 2
    v_add_f32 v44, v44, v46
    v_add_f32 v45, v45, v47
    v_add_f32 v36, v36, v38
    v_add_f32 v37, v37, v39
    v_cvt_pk_bf16_f32 v44, v44, v45
    v_cvt_pk_bf16_f32 v45, v36, v37
    ds_write_b64 v118, v[44:45] offset:512
    v_smfmac_f32_16x16x64_bf16 v[48:51], v[12:15], a[216:223], v104
    v_smfmac_f32_16x16x64_bf16 v[52:55], v[12:15], v[152:159], v104
    ds_read_b128 v[12:15], v116 offset:3072
    s_waitcnt lgkmcnt(1)
    s_barrier
    ds_read_b64_tr_b16 v[32:33], v119 offset:0
    ds_read_b64_tr_b16 v[34:35], v119 offset:512
    ds_read_b64_tr_b16 v[36:37], v119 offset:1024
    ds_read_b64_tr_b16 v[38:39], v119 offset:1536
    v_smfmac_f32_16x16x64_bf16 v[48:51], v[16:19], a[224:231], v104
    ds_read_b64_tr_b16 v[40:41], v119 offset:2048
    ds_read_b64_tr_b16 v[42:43], v119 offset:2560
    v_smfmac_f32_16x16x64_bf16 v[52:55], v[16:19], v[160:167], v104
    ds_read_b64_tr_b16 v[44:45], v119 offset:3072
    ds_read_b64_tr_b16 v[46:47], v119 offset:3584
    ds_read_b128 v[16:19], v116 offset:4096
    v_smfmac_f32_16x16x64_bf16 v[48:51], v[20:23], a[232:239], v104
    v_smfmac_f32_16x16x64_bf16 v[52:55], v[20:23], v[168:175], v104
    ds_read_b128 v[20:23], v116 offset:5120
    v_smfmac_f32_16x16x64_bf16 v[48:51], v[24:27], a[240:247], v104
    v_smfmac_f32_16x16x64_bf16 v[52:55], v[24:27], v[176:183], v104
    ds_read_b128 v[24:27], v116 offset:6144
    v_smfmac_f32_16x16x64_bf16 v[48:51], v[28:31], a[248:255], v104
    v_smfmac_f32_16x16x64_bf16 v[52:55], v[28:31], v[184:191], v104
    ds_read_b128 v[28:31], v116 offset:7168
    s_waitcnt lgkmcnt(4)
    v_mfma_f32_16x16x32_bf16 v[56:59], v[32:35], v[32:35], 0
    v_mfma_f32_16x16x32_bf16 v[60:63], v[0:3], v[32:35], 0
    buffer_store_dwordx4 v[32:35], v116, s[4:7], s36 offen offset:0 sc1
    s_add_u32 s36, s36, 0x20000
    v_mfma_f32_16x16x32_bf16 v[56:59], v[36:39], v[36:39], v[56:59]
    v_mfma_f32_16x16x32_bf16 v[60:63], v[4:7], v[36:39], v[60:63]
    v_mfma_f32_16x16x32_bf16 v[56:59], v[40:43], v[40:43], v[56:59]
    v_mfma_f32_16x16x32_bf16 v[60:63], v[8:11], v[40:43], v[60:63]
    v_cvt_pk_bf16_f32 v48, v48, v49
    v_cvt_pk_bf16_f32 v49, v50, v51
    v_cvt_pk_bf16_f32 v50, v52, v53
    v_cvt_pk_bf16_f32 v51, v54, v55
    v_mfma_f32_16x16x32_bf16 v[56:59], v[44:47], v[44:47], v[56:59]
    v_mfma_f32_16x16x32_bf16 v[60:63], v[12:15], v[44:47], v[60:63]
    buffer_store_dwordx4 v[48:51], v116, s[4:7], s37 offen sc1
    s_add_u32 s37, s37, 0x20000
    s_waitcnt lgkmcnt(3)
    v_mfma_f32_16x16x32_bf16 v[64:67], v[16:19], v[32:35], 0
    s_waitcnt lgkmcnt(2)
    v_mfma_f32_16x16x32_bf16 v[64:67], v[20:23], v[36:39], v[64:67]
    s_cmp_eq_u32 s14, 63
    s_cbranch_scc1 main_kernel_done
    s_waitcnt lgkmcnt(1)
    v_mfma_f32_16x16x32_bf16 v[64:67], v[24:27], v[40:43], v[64:67]
    s_waitcnt lgkmcnt(0)
    v_mfma_f32_16x16x32_bf16 v[64:67], v[28:31], v[44:47], v[64:67]
    v_mov_b64 v[16:17], 0
    v_mov_b64 v[18:19], 0
    v_mov_b64 v[20:21], 0
    v_mov_b64 v[22:23], 0
    v_max3_f32 v105, v60, v61, v62
    v_max3_f32 v127, v63, v56, v57
    s_nop 1
    v_max3_f32 v127, v64, v65, v127
    v_max3_f32 v105, v66, v67, v105
    v_max_f32 v105, v105, v127
    v_mov_b32 v127, v105
    v_mov_b64 v[0:1], 0
    v_mov_b64 v[2:3], 0
    v_permlane32_swap_b32 v105, v127
    v_max_f32 v105, v105, v127
    v_mov_b32 v127, v105
    v_mov_b64 v[4:5], 0
    v_mov_b64 v[6:7], 0
    v_permlane16_swap_b32 v105, v127
    v_max_f32 v105, v105, v127
    v_mul_f32 v105, s42, v105
    v_fma_f32 v56, v56, s42, -v105
    v_fma_f32 v57, v57, s42, -v105
    v_exp_f32 v56, v56
    v_exp_f32 v57, v57
    v_fma_f32 v60, v60, s42, -v105
    v_fma_f32 v61, v61, s42, -v105
    v_fma_f32 v62, v62, s42, -v105
    v_fma_f32 v63, v63, s42, -v105
    v_fma_f32 v64, v64, s42, -v105
    v_fma_f32 v65, v65, s42, -v105
    v_fma_f32 v66, v66, s42, -v105
    v_fma_f32 v67, v67, s42, -v105
    v_cvt_pk_bf16_f32 v58, v56, v57
    v_cvt_pk_bf16_f32 v59, v56, v57
    v_exp_f32 v60, v60
    v_exp_f32 v61, v61
    v_mfma_f32_16x16x16_bf16 v[72:75], v[58:59], v[110:111], 0
    v_exp_f32 v62, v62
    v_exp_f32 v63, v63
    v_mfma_f32_16x16x16_bf16 v[76:79], v[58:59], v[48:49], 0
    v_exp_f32 v64, v64
    v_exp_f32 v65, v65
    v_mfma_f32_16x16x16_bf16 v[80:83], v[58:59], v[50:51], 0
    v_exp_f32 v66, v66
    v_exp_f32 v67, v67
    v_cvt_pk_bf16_f32 v84, v60, v61
    v_cvt_pk_bf16_f32 v85, v62, v63
    v_cvt_pk_bf16_f32 v86, v64, v65
    v_cvt_pk_bf16_f32 v87, v66, v67
    v_mov_b64 v[24:25], 0
    v_mov_b64 v[26:27], 0
    v_mfma_f32_16x16x32_bf16 v[72:75], v[84:87], v[106:109], v[72:75]
    v_mov_b64 v[28:29], 0
    v_mov_b64 v[30:31], 0
    v_mfma_f32_16x16x32_bf16 v[76:79], v[84:87], v[88:91], v[76:79]
    v_mfma_f32_16x16x32_bf16 v[80:83], v[84:87], v[92:95], v[80:83]
    ds_read_b128 v[56:59], v117 offset:16384
    ds_read_b128 v[60:63], v117 offset:17408
    ds_read_b128 v[64:67], v117 offset:20480
    ds_read_b128 v[68:71], v117 offset:21504
    v_rcp_f32 v74, v74
    v_rcp_f32 v75, v75
    s_nop 0
    v_mul_f32 v78, v78, v74
    v_mul_f32 v79, v79, v75
    v_cvt_pk_bf16_f32 v76, v78, v79
    ds_write_b32 v120, v76 offset:0
    v_mul_f32 v82, v82, v74
    v_mul_f32 v83, v83, v75
    v_cvt_pk_bf16_f32 v80, v82, v83
    ds_write_b32 v120, v80 offset:256
    s_waitcnt lgkmcnt(0)
    s_barrier
    ds_read_b64_tr_b16 v[80:81], v121 offset:0
    ds_read_b64_tr_b16 v[82:83], v121 offset:128
    ds_read_b64_tr_b16 v[84:85], v121 offset:1024
    ds_read_b64_tr_b16 v[86:87], v121 offset:1152
    v_mov_b64 v[8:9], 0
    v_mov_b64 v[10:11], 0
    v_mov_b64 v[12:13], 0
    v_mov_b64 v[14:15], 0
    s_waitcnt lgkmcnt(2)
    s_bfe_i32 s71, s14, 0x10001
    v_smfmac_f32_16x16x64_bf16 v[0:3], v[80:83], v[192:199], v104
    v_smfmac_f32_16x16x64_bf16 v[4:7], v[80:83], v[208:215], v104
    ds_read_b128 v[72:75], v117 offset:18432
    ds_read_b128 v[76:79], v117 offset:19456
    s_waitcnt lgkmcnt(2)
    v_smfmac_f32_16x16x64_bf16 v[0:3], v[84:87], v[200:207], v104
    ds_read_b128 v[32:35], v117 offset:22528
    ds_read_b128 v[36:39], v117 offset:23552
    v_smfmac_f32_16x16x64_bf16 v[4:7], v[84:87], v[216:223], v104
    ds_read_b128 v[40:43], v117 offset:24576
    ds_read_b128 v[44:47], v117 offset:25600
    v_smfmac_f32_16x16x64_bf16 v[8:11], v[80:83], v[224:231], v104
    ds_read_b128 v[48:51], v117 offset:28672
    ds_read_b128 v[52:55], v117 offset:29696
    v_smfmac_f32_16x16x64_bf16 v[12:15], v[80:83], v[240:247], v104
    v_smfmac_f32_16x16x64_bf16 v[8:11], v[84:87], v[232:239], v104
    v_add_f32 v0, v0, v2
    v_add_f32 v1, v1, v3
    v_add_f32 v4, v4, v6
    v_add_f32 v5, v5, v7
    v_smfmac_f32_16x16x64_bf16 v[12:15], v[84:87], v[248:255], v104
    v_cvt_pk_bf16_f32 v0, v0, v1
    v_cvt_pk_bf16_f32 v1, v4, v5
    v_bfi_b32 v0, 1, s71, v0
    buffer_store_dwordx2 v[0:1], v122, s[4:7], s20 offen sc1
    v_smfmac_f32_16x16x64_bf16 v[16:19], v[80:83], v[56:63], v104
    ds_read_b128 v[56:59], v117 offset:26624
    ds_read_b128 v[60:63], v117 offset:27648
    v_smfmac_f32_16x16x64_bf16 v[20:23], v[80:83], v[64:71], v104
    ds_read_b128 v[64:67], v117 offset:30720
    ds_read_b128 v[68:71], v117 offset:31744
    s_waitcnt lgkmcnt(10)
    v_smfmac_f32_16x16x64_bf16 v[16:19], v[84:87], v[72:79], v104
    v_add_f32 v8, v8, v10
    v_add_f32 v9, v9, v11
    v_add_f32 v12, v12, v14
    v_add_f32 v13, v13, v15
    s_waitcnt lgkmcnt(8)
    v_smfmac_f32_16x16x64_bf16 v[20:23], v[84:87], v[32:39], v104
    v_cvt_pk_bf16_f32 v8, v8, v9
    v_cvt_pk_bf16_f32 v9, v12, v13
    v_bfi_b32 v8, 1, s71, v8
    buffer_store_dwordx2 v[8:9], v122, s[4:7], s21 offen sc1
    s_waitcnt lgkmcnt(6)
    v_smfmac_f32_16x16x64_bf16 v[24:27], v[80:83], v[40:47], v104
    s_waitcnt lgkmcnt(4)
    v_smfmac_f32_16x16x64_bf16 v[28:31], v[80:83], v[48:55], v104
    s_waitcnt lgkmcnt(2)
    v_smfmac_f32_16x16x64_bf16 v[24:27], v[84:87], v[56:63], v104
    v_add_f32 v16, v16, v18
    v_add_f32 v17, v17, v19
    v_add_f32 v20, v20, v22
    v_add_f32 v21, v21, v23
    s_waitcnt lgkmcnt(0)
    v_smfmac_f32_16x16x64_bf16 v[28:31], v[84:87], v[64:71], v104
    v_cvt_pk_bf16_f32 v16, v16, v17
    v_cvt_pk_bf16_f32 v17, v20, v21
    v_bfi_b32 v16, 1, s71, v16
    buffer_store_dwordx2 v[16:17], v122, s[4:7], s22 offen sc1
    v_mov_b64 v[32:33], 0
    v_mov_b64 v[34:35], 0
    v_mov_b64 v[36:37], 0
    v_mov_b64 v[38:39], 0
    v_add_f32 v24, v24, v26
    v_add_f32 v25, v25, v27
    v_add_f32 v28, v28, v30
    v_add_f32 v29, v29, v31
    v_cvt_pk_bf16_f32 v24, v24, v25
    v_cvt_pk_bf16_f32 v25, v28, v29
    v_bfi_b32 v24, 1, s71, v24
    buffer_store_dwordx2 v[24:25], v122, s[4:7], s23 offen sc1
    v_mov_b64 v[40:41], 0
    v_mov_b64 v[42:43], 0
    v_mov_b64 v[44:45], 0
    v_mov_b64 v[46:47], 0
    v_mov_b64 v[48:49], 0
    v_mov_b64 v[50:51], 0
    v_mov_b64 v[52:53], 0
    v_mov_b64 v[54:55], 0
    s_mov_b32 s43, 0x100000
    buffer_load_dwordx4 v[56:59], v123, s[4:7], s28 offen sc1
    buffer_load_dwordx4 v[60:63], v123, s[4:7], s29 offen sc1
main_kernel_p1_0_0s:
    s_waitcnt vmcnt(0)
main_kernel_p1_0_0sc:
    v_bitop3_b32 v105, v56, v58, s71 bitop3:0x7e
    v_bitop3_b32 v127, v60, v62, s71 bitop3:0x7e
    v_or_b32 v105, v105, v127
    v_and_b32 v105, 1, v105
    v_cmp_ne_u32 vcc, 0, v105
    s_cbranch_vccz main_kernel_p1_0_0sdone
    s_mov_b64 exec, vcc
    buffer_load_dwordx4 v[56:59], v123, s[4:7], s28 offen sc1
    buffer_load_dwordx4 v[60:63], v123, s[4:7], s29 offen sc1
    s_sub_u32 s43, s43, 1
    s_cbranch_scc0 main_kernel_p1_0_0s
main_kernel_p1_0_0sdone:
    s_mov_b64 exec, -1
    v_mfma_f32_16x16x32_bf16 v[64:67], v[112:115], v[56:59], 0
    v_mfma_f32_16x16x32_bf16 v[64:67], v[112:115], v[60:63], v[64:67]
    v_mov_b64 v[72:73], -1
    v_mov_b64 v[74:75], -1
    s_add_u32 s14, s14, 1
    s_nop 4
    v_add_f32_dpp v68, v64, v64 row_ror:4 row_mask:0xf bank_mask:0xf
    v_add_f32_dpp v69, v65, v65 row_ror:4 row_mask:0xf bank_mask:0xf
    v_add_f32_dpp v70, v66, v66 row_ror:4 row_mask:0xf bank_mask:0xf
    v_add_f32_dpp v71, v67, v67 row_ror:4 row_mask:0xf bank_mask:0xf
    v_add_f32_dpp v64, v68, v68 row_ror:8 row_mask:0xf bank_mask:0xf
    v_add_f32_dpp v65, v69, v69 row_ror:8 row_mask:0xf bank_mask:0xf
    v_add_f32_dpp v66, v70, v70 row_ror:8 row_mask:0xf bank_mask:0xf
    v_add_f32_dpp v67, v71, v71 row_ror:8 row_mask:0xf bank_mask:0xf
    s_mov_b64 exec, s[40:41]
    v_cvt_pk_bf16_f32 v64, v64, v65
    v_cvt_pk_bf16_f32 v65, v66, v67
    buffer_store_dword v64, v125, s[4:7], s33 offen sc1
    buffer_store_dword v65, v125, s[4:7], s33 offen offset:16 sc1
    buffer_store_dword v72, v125, s[4:7], s32 offen sc1
    buffer_store_dword v72, v125, s[4:7], s32 offen offset:16 sc1
    s_mov_b64 exec, -1
    s_add_u32 s15, s14, 1
    s_cmp_lg_u32 s15, s75
    s_cbranch_scc1 main_kernel_nokv0_0s
    v_readfirstlane_b32 s18, v126
    s_nop 0
    s_cmp_ge_u32 s18, 64
    s_cbranch_scc1 main_kernel_kvok0_0s
    s_mov_b32 s43, 0x200000
    v_mov_b32 v127, s69
main_kernel_wkvn0s:
    buffer_load_dword v126, v127, s[44:47], 0 offen sc1
    s_waitcnt vmcnt(0)
    v_readfirstlane_b32 s18, v126
    s_nop 0
    s_cmp_ge_u32 s18, 64
    s_cbranch_scc1 main_kernel_wkvn0s_ok
    s_sleep 2
    s_sub_u32 s43, s43, 1
    s_cbranch_scc0 main_kernel_wkvn0s
main_kernel_wkvn0s_ok:
main_kernel_kvok0_0s:
    s_min_u32 s15, s75, 8
    s_add_u32 s75, s75, s15
    s_add_u32 s69, s69, 4
    s_cmp_ge_u32 s75, 64
    s_cselect_b32 s75, 0x7fff, s75
main_kernel_nokv0_0s:
    ds_read_b128 v[56:59], v117 offset:0
    ds_read_b128 v[60:63], v117 offset:1024
    ds_read_b128 v[64:67], v117 offset:2048
    ds_read_b128 v[68:71], v117 offset:3072
    ds_read_b128 v[72:75], v117 offset:4096
    ds_read_b128 v[76:79], v117 offset:5120
    ds_read_b128 v[80:83], v117 offset:6144
    ds_read_b128 v[84:87], v117 offset:7168
    s_mov_b32 s43, 0x100000
    buffer_load_dwordx4 v[0:3], v124, s[4:7], s33 offen sc1
    buffer_load_dwordx4 v[4:7], v124, s[4:7], s33 offen offset:1024 sc1
main_kernel_p2_1_0s:
    s_waitcnt vmcnt(0)
main_kernel_p2_1_0sc:
    v_max3_u32 v105, v0, v1, v2
    v_max3_u32 v127, v3, v4, v5
    v_max3_u32 v105, v6, v7, v105
    v_max_u32 v105, v105, v127
    v_cmp_eq_u32 vcc, -1, v105
    s_cbranch_vccz main_kernel_p2_1_0sdone
    s_mov_b64 exec, vcc
    buffer_load_dwordx4 v[0:3], v124, s[4:7], s33 offen sc1
    buffer_load_dwordx4 v[4:7], v124, s[4:7], s33 offen offset:1024 sc1
    s_sub_u32 s43, s43, 1
    s_cbranch_scc0 main_kernel_p2_1_0s
main_kernel_p2_1_0sdone:
    s_mov_b64 exec, -1
    ds_write_b128 v124, v[0:3] offset:16384
    ds_write_b128 v124, v[4:7] offset:17408
    v_smfmac_f32_16x16x64_bf16 v[32:35], v[0:3], a[0:7], v104
    v_smfmac_f32_16x16x64_bf16 v[40:43], v[0:3], a[128:135], v104
    v_smfmac_f32_16x16x64_bf16 v[36:39], v[0:3], a[64:71], v104
    s_waitcnt lgkmcnt(8)
    v_smfmac_f32_16x16x64_bf16 v[44:47], v[0:3], v[56:63], v104
    v_smfmac_f32_16x16x64_bf16 v[48:51], v[0:3], a[192:199], v104
    v_smfmac_f32_16x16x64_bf16 v[52:55], v[0:3], v[128:135], v104
    s_waitcnt lgkmcnt(0)
    s_barrier
    ds_read_b128 v[8:11], v116 offset:18432
    ds_read_b128 v[12:15], v116 offset:19456
    v_smfmac_f32_16x16x64_bf16 v[32:35], v[4:7], a[8:15], v104
    ds_read_b128 v[16:19], v116 offset:20480
    v_smfmac_f32_16x16x64_bf16 v[40:43], v[4:7], a[136:143], v104
    ds_read_b128 v[20:23], v116 offset:21504
    v_smfmac_f32_16x16x64_bf16 v[36:39], v[4:7], a[72:79], v104
    ds_read_b128 v[24:27], v116 offset:22528
    v_smfmac_f32_16x16x64_bf16 v[44:47], v[4:7], v[64:71], v104
    ds_read_b128 v[28:31], v116 offset:23552
    v_smfmac_f32_16x16x64_bf16 v[48:51], v[4:7], a[200:207], v104
    v_smfmac_f32_16x16x64_bf16 v[52:55], v[4:7], v[136:143], v104
    s_waitcnt lgkmcnt(5)
    v_smfmac_f32_16x16x64_bf16 v[32:35], v[8:11], a[16:23], v104
    ds_read_b128 v[56:59], v117 offset:8192
    ds_read_b128 v[60:63], v117 offset:9216
    v_smfmac_f32_16x16x64_bf16 v[40:43], v[8:11], a[144:151], v104
    ds_read_b128 v[64:67], v117 offset:10240
    ds_read_b128 v[68:71], v117 offset:11264
    s_waitcnt lgkmcnt(8)
    v_smfmac_f32_16x16x64_bf16 v[32:35], v[12:15], a[24:31], v104
    s_mov_b32 m0, s67
    s_add_u32 s17, s34, 0x40000
    v_smfmac_f32_16x16x64_bf16 v[40:43], v[12:15], a[152:159], v104
    buffer_load_dwordx4 v124, s[4:7], s34 offen sc1 lds
    s_waitcnt lgkmcnt(7)
    v_smfmac_f32_16x16x64_bf16 v[32:35], v[16:19], a[32:39], v104
    v_smfmac_f32_16x16x64_bf16 v[40:43], v[16:19], a[160:167], v104
    buffer_load_dwordx4 v124, s[4:7], s34 offen offset:1024 sc1 lds
    s_waitcnt lgkmcnt(6)
    v_smfmac_f32_16x16x64_bf16 v[32:35], v[20:23], a[40:47], v104
    v_smfmac_f32_16x16x64_bf16 v[40:43], v[20:23], a[168:175], v104
    buffer_load_dwordx4 v[88:91], v124, s[4:7], s35 offen sc1
    s_waitcnt lgkmcnt(5)
    v_smfmac_f32_16x16x64_bf16 v[32:35], v[24:27], a[48:55], v104
    v_smfmac_f32_16x16x64_bf16 v[40:43], v[24:27], a[176:183], v104
    buffer_load_dwordx4 v[92:95], v124, s[4:7], s35 offen offset:1024 sc1
    s_mov_b32 s34, s17
    s_waitcnt lgkmcnt(4)
    v_smfmac_f32_16x16x64_bf16 v[32:35], v[28:31], a[56:63], v104
    s_add_u32 s35, s35, 0x40000
    v_smfmac_f32_16x16x64_bf16 v[40:43], v[28:31], a[184:191], v104
    v_smfmac_f32_16x16x64_bf16 v[36:39], v[8:11], a[80:87], v104
    v_lshlrev_b32 v127, 3, v116
    v_mov_b32 v105, s14
    v_smfmac_f32_16x16x64_bf16 v[44:47], v[8:11], v[72:79], v104
    ds_read_b128 v[72:75], v117 offset:12288
    ds_read_b128 v[76:79], v117 offset:13312
    v_smfmac_f32_16x16x64_bf16 v[36:39], v[12:15], a[88:95], v104
    s_mov_b64 exec, s[72:73]
    buffer_store_dword v105, v127, s[4:7], s74 offen sc1
    s_mov_b64 exec, -1
    v_smfmac_f32_16x16x64_bf16 v[44:47], v[12:15], v[80:87], v104
    ds_read_b128 v[80:83], v117 offset:14336
    ds_read_b128 v[84:87], v117 offset:15360
    v_smfmac_f32_16x16x64_bf16 v[36:39], v[16:19], a[96:103], v104
    v_add_f32 v40, v40, v42
    v_add_f32 v41, v41, v43
    s_waitcnt lgkmcnt(6)
    v_smfmac_f32_16x16x64_bf16 v[44:47], v[16:19], v[56:63], v104
    v_smfmac_f32_16x16x64_bf16 v[36:39], v[20:23], a[104:111], v104
    v_add_f32 v32, v32, v34
    v_add_f32 v33, v33, v35
    s_waitcnt lgkmcnt(4)
    v_smfmac_f32_16x16x64_bf16 v[44:47], v[20:23], v[64:71], v104
    v_smfmac_f32_16x16x64_bf16 v[36:39], v[24:27], a[112:119], v104
    v_cvt_pk_bf16_f32 v40, v40, v41
    v_cvt_pk_bf16_f32 v41, v32, v33
    s_waitcnt lgkmcnt(2)
    v_smfmac_f32_16x16x64_bf16 v[44:47], v[24:27], v[72:79], v104
    v_smfmac_f32_16x16x64_bf16 v[36:39], v[28:31], a[120:127], v104
    ds_write_b64 v118, v[40:41] offset:0
    s_waitcnt lgkmcnt(1)
    v_smfmac_f32_16x16x64_bf16 v[44:47], v[28:31], v[80:87], v104
    ds_read_b128 v[0:3], v116 offset:8192
    ds_read_b128 v[4:7], v116 offset:9216
    v_smfmac_f32_16x16x64_bf16 v[48:51], v[8:11], a[208:215], v104
    v_smfmac_f32_16x16x64_bf16 v[52:55], v[8:11], v[144:151], v104
    ds_read_b128 v[8:11], v116 offset:10240
    s_nop 2
    v_add_f32 v44, v44, v46
    v_add_f32 v45, v45, v47
    v_add_f32 v36, v36, v38
    v_add_f32 v37, v37, v39
    v_cvt_pk_bf16_f32 v44, v44, v45
    v_cvt_pk_bf16_f32 v45, v36, v37
    ds_write_b64 v118, v[44:45] offset:512
    v_smfmac_f32_16x16x64_bf16 v[48:51], v[12:15], a[216:223], v104
    v_smfmac_f32_16x16x64_bf16 v[52:55], v[12:15], v[152:159], v104
    ds_read_b128 v[12:15], v116 offset:11264
    s_waitcnt lgkmcnt(1)
    s_barrier
    ds_read_b64_tr_b16 v[32:33], v119 offset:0
    ds_read_b64_tr_b16 v[34:35], v119 offset:512
    ds_read_b64_tr_b16 v[36:37], v119 offset:1024
    ds_read_b64_tr_b16 v[38:39], v119 offset:1536
    v_smfmac_f32_16x16x64_bf16 v[48:51], v[16:19], a[224:231], v104
    ds_read_b64_tr_b16 v[40:41], v119 offset:2048
    ds_read_b64_tr_b16 v[42:43], v119 offset:2560
    v_smfmac_f32_16x16x64_bf16 v[52:55], v[16:19], v[160:167], v104
    ds_read_b64_tr_b16 v[44:45], v119 offset:3072
    ds_read_b64_tr_b16 v[46:47], v119 offset:3584
    ds_read_b128 v[16:19], v116 offset:12288
    v_smfmac_f32_16x16x64_bf16 v[48:51], v[20:23], a[232:239], v104
    v_smfmac_f32_16x16x64_bf16 v[52:55], v[20:23], v[168:175], v104
    ds_read_b128 v[20:23], v116 offset:13312
    v_smfmac_f32_16x16x64_bf16 v[48:51], v[24:27], a[240:247], v104
    v_smfmac_f32_16x16x64_bf16 v[52:55], v[24:27], v[176:183], v104
    ds_read_b128 v[24:27], v116 offset:14336
    v_smfmac_f32_16x16x64_bf16 v[48:51], v[28:31], a[248:255], v104
    v_smfmac_f32_16x16x64_bf16 v[52:55], v[28:31], v[184:191], v104
    ds_read_b128 v[28:31], v116 offset:15360
    s_waitcnt lgkmcnt(4)
    v_mfma_f32_16x16x32_bf16 v[56:59], v[32:35], v[32:35], 0
    v_mfma_f32_16x16x32_bf16 v[60:63], v[0:3], v[32:35], 0
    buffer_store_dwordx4 v[32:35], v116, s[4:7], s36 offen offset:0 sc1
    s_add_u32 s36, s36, 0x20000
    v_mfma_f32_16x16x32_bf16 v[56:59], v[36:39], v[36:39], v[56:59]
    v_mfma_f32_16x16x32_bf16 v[60:63], v[4:7], v[36:39], v[60:63]
    v_mfma_f32_16x16x32_bf16 v[56:59], v[40:43], v[40:43], v[56:59]
    v_mfma_f32_16x16x32_bf16 v[60:63], v[8:11], v[40:43], v[60:63]
    v_cvt_pk_bf16_f32 v48, v48, v49
    v_cvt_pk_bf16_f32 v49, v50, v51
    v_cvt_pk_bf16_f32 v50, v52, v53
    v_cvt_pk_bf16_f32 v51, v54, v55
    v_mfma_f32_16x16x32_bf16 v[56:59], v[44:47], v[44:47], v[56:59]
    v_mfma_f32_16x16x32_bf16 v[60:63], v[12:15], v[44:47], v[60:63]
    buffer_store_dwordx4 v[48:51], v116, s[4:7], s37 offen sc1
    s_add_u32 s37, s37, 0x20000
    s_waitcnt lgkmcnt(3)
    v_mfma_f32_16x16x32_bf16 v[64:67], v[16:19], v[32:35], 0
    s_waitcnt lgkmcnt(2)
    v_mfma_f32_16x16x32_bf16 v[64:67], v[20:23], v[36:39], v[64:67]
    s_cmp_eq_u32 s14, 63
    s_cbranch_scc1 main_kernel_done
    s_waitcnt lgkmcnt(1)
    v_mfma_f32_16x16x32_bf16 v[64:67], v[24:27], v[40:43], v[64:67]
    s_waitcnt lgkmcnt(0)
    v_mfma_f32_16x16x32_bf16 v[64:67], v[28:31], v[44:47], v[64:67]
    v_mov_b64 v[16:17], 0
    v_mov_b64 v[18:19], 0
    v_mov_b64 v[20:21], 0
    v_mov_b64 v[22:23], 0
    v_max3_f32 v105, v60, v61, v62
    v_max3_f32 v127, v63, v56, v57
    s_nop 1
    v_max3_f32 v127, v64, v65, v127
    v_max3_f32 v105, v66, v67, v105
    v_max_f32 v105, v105, v127
    v_mov_b32 v127, v105
    v_mov_b64 v[0:1], 0
    v_mov_b64 v[2:3], 0
    v_permlane32_swap_b32 v105, v127
    v_max_f32 v105, v105, v127
    v_mov_b32 v127, v105
    v_mov_b64 v[4:5], 0
    v_mov_b64 v[6:7], 0
    v_permlane16_swap_b32 v105, v127
    v_max_f32 v105, v105, v127
    v_mul_f32 v105, s42, v105
    v_fma_f32 v56, v56, s42, -v105
    v_fma_f32 v57, v57, s42, -v105
    v_exp_f32 v56, v56
    v_exp_f32 v57, v57
    v_fma_f32 v60, v60, s42, -v105
    v_fma_f32 v61, v61, s42, -v105
    v_fma_f32 v62, v62, s42, -v105
    v_fma_f32 v63, v63, s42, -v105
    v_fma_f32 v64, v64, s42, -v105
    v_fma_f32 v65, v65, s42, -v105
    v_fma_f32 v66, v66, s42, -v105
    v_fma_f32 v67, v67, s42, -v105
    v_cvt_pk_bf16_f32 v58, v56, v57
    v_cvt_pk_bf16_f32 v59, v56, v57
    v_exp_f32 v60, v60
    v_exp_f32 v61, v61
    v_mfma_f32_16x16x16_bf16 v[72:75], v[58:59], v[110:111], 0
    v_exp_f32 v62, v62
    v_exp_f32 v63, v63
    v_mfma_f32_16x16x16_bf16 v[76:79], v[58:59], v[48:49], 0
    v_exp_f32 v64, v64
    v_exp_f32 v65, v65
    v_mfma_f32_16x16x16_bf16 v[80:83], v[58:59], v[50:51], 0
    v_exp_f32 v66, v66
    v_exp_f32 v67, v67
    v_cvt_pk_bf16_f32 v84, v60, v61
    v_cvt_pk_bf16_f32 v85, v62, v63
    v_cvt_pk_bf16_f32 v86, v64, v65
    v_cvt_pk_bf16_f32 v87, v66, v67
    v_mov_b64 v[24:25], 0
    v_mov_b64 v[26:27], 0
    v_mfma_f32_16x16x32_bf16 v[72:75], v[84:87], v[106:109], v[72:75]
    v_mov_b64 v[28:29], 0
    v_mov_b64 v[30:31], 0
    v_mfma_f32_16x16x32_bf16 v[76:79], v[84:87], v[96:99], v[76:79]
    v_mfma_f32_16x16x32_bf16 v[80:83], v[84:87], v[100:103], v[80:83]
    ds_read_b128 v[56:59], v117 offset:16384
    ds_read_b128 v[60:63], v117 offset:17408
    ds_read_b128 v[64:67], v117 offset:20480
    ds_read_b128 v[68:71], v117 offset:21504
    v_rcp_f32 v74, v74
    v_rcp_f32 v75, v75
    s_nop 0
    v_mul_f32 v78, v78, v74
    v_mul_f32 v79, v79, v75
    v_cvt_pk_bf16_f32 v76, v78, v79
    ds_write_b32 v120, v76 offset:0
    v_mul_f32 v82, v82, v74
    v_mul_f32 v83, v83, v75
    v_cvt_pk_bf16_f32 v80, v82, v83
    ds_write_b32 v120, v80 offset:256
    s_waitcnt lgkmcnt(0)
    s_barrier
    ds_read_b64_tr_b16 v[80:81], v121 offset:0
    ds_read_b64_tr_b16 v[82:83], v121 offset:128
    ds_read_b64_tr_b16 v[84:85], v121 offset:1024
    ds_read_b64_tr_b16 v[86:87], v121 offset:1152
    v_mov_b64 v[8:9], 0
    v_mov_b64 v[10:11], 0
    v_mov_b64 v[12:13], 0
    v_mov_b64 v[14:15], 0
    s_waitcnt lgkmcnt(2)
    s_bfe_i32 s71, s14, 0x10001
    v_smfmac_f32_16x16x64_bf16 v[0:3], v[80:83], v[192:199], v104
    v_smfmac_f32_16x16x64_bf16 v[4:7], v[80:83], v[208:215], v104
    ds_read_b128 v[72:75], v117 offset:18432
    ds_read_b128 v[76:79], v117 offset:19456
    s_waitcnt lgkmcnt(2)
    v_smfmac_f32_16x16x64_bf16 v[0:3], v[84:87], v[200:207], v104
    ds_read_b128 v[32:35], v117 offset:22528
    ds_read_b128 v[36:39], v117 offset:23552
    v_smfmac_f32_16x16x64_bf16 v[4:7], v[84:87], v[216:223], v104
    ds_read_b128 v[40:43], v117 offset:24576
    ds_read_b128 v[44:47], v117 offset:25600
    v_smfmac_f32_16x16x64_bf16 v[8:11], v[80:83], v[224:231], v104
    ds_read_b128 v[48:51], v117 offset:28672
    ds_read_b128 v[52:55], v117 offset:29696
    v_smfmac_f32_16x16x64_bf16 v[12:15], v[80:83], v[240:247], v104
    v_smfmac_f32_16x16x64_bf16 v[8:11], v[84:87], v[232:239], v104
    v_add_f32 v0, v0, v2
    v_add_f32 v1, v1, v3
    v_add_f32 v4, v4, v6
    v_add_f32 v5, v5, v7
    v_smfmac_f32_16x16x64_bf16 v[12:15], v[84:87], v[248:255], v104
    v_cvt_pk_bf16_f32 v0, v0, v1
    v_cvt_pk_bf16_f32 v1, v4, v5
    v_bfi_b32 v0, 1, s71, v0
    buffer_store_dwordx2 v[0:1], v122, s[4:7], s24 offen sc1
    v_smfmac_f32_16x16x64_bf16 v[16:19], v[80:83], v[56:63], v104
    ds_read_b128 v[56:59], v117 offset:26624
    ds_read_b128 v[60:63], v117 offset:27648
    v_smfmac_f32_16x16x64_bf16 v[20:23], v[80:83], v[64:71], v104
    ds_read_b128 v[64:67], v117 offset:30720
    ds_read_b128 v[68:71], v117 offset:31744
    s_waitcnt lgkmcnt(10)
    v_smfmac_f32_16x16x64_bf16 v[16:19], v[84:87], v[72:79], v104
    v_add_f32 v8, v8, v10
    v_add_f32 v9, v9, v11
    v_add_f32 v12, v12, v14
    v_add_f32 v13, v13, v15
    s_waitcnt lgkmcnt(8)
    v_smfmac_f32_16x16x64_bf16 v[20:23], v[84:87], v[32:39], v104
    v_cvt_pk_bf16_f32 v8, v8, v9
    v_cvt_pk_bf16_f32 v9, v12, v13
    v_bfi_b32 v8, 1, s71, v8
    buffer_store_dwordx2 v[8:9], v122, s[4:7], s25 offen sc1
    s_waitcnt lgkmcnt(6)
    v_smfmac_f32_16x16x64_bf16 v[24:27], v[80:83], v[40:47], v104
    s_waitcnt lgkmcnt(4)
    v_smfmac_f32_16x16x64_bf16 v[28:31], v[80:83], v[48:55], v104
    s_waitcnt lgkmcnt(2)
    v_smfmac_f32_16x16x64_bf16 v[24:27], v[84:87], v[56:63], v104
    v_add_f32 v16, v16, v18
    v_add_f32 v17, v17, v19
    v_add_f32 v20, v20, v22
    v_add_f32 v21, v21, v23
    s_waitcnt lgkmcnt(0)
    v_smfmac_f32_16x16x64_bf16 v[28:31], v[84:87], v[64:71], v104
    v_cvt_pk_bf16_f32 v16, v16, v17
    v_cvt_pk_bf16_f32 v17, v20, v21
    v_bfi_b32 v16, 1, s71, v16
    buffer_store_dwordx2 v[16:17], v122, s[4:7], s26 offen sc1
    v_mov_b64 v[32:33], 0
    v_mov_b64 v[34:35], 0
    v_mov_b64 v[36:37], 0
    v_mov_b64 v[38:39], 0
    v_add_f32 v24, v24, v26
    v_add_f32 v25, v25, v27
    v_add_f32 v28, v28, v30
    v_add_f32 v29, v29, v31
    v_cvt_pk_bf16_f32 v24, v24, v25
    v_cvt_pk_bf16_f32 v25, v28, v29
    v_bfi_b32 v24, 1, s71, v24
    buffer_store_dwordx2 v[24:25], v122, s[4:7], s27 offen sc1
    v_mov_b64 v[40:41], 0
    v_mov_b64 v[42:43], 0
    v_mov_b64 v[44:45], 0
    v_mov_b64 v[46:47], 0
    v_mov_b64 v[48:49], 0
    v_mov_b64 v[50:51], 0
    v_mov_b64 v[52:53], 0
    v_mov_b64 v[54:55], 0
    s_mov_b32 s43, 0x100000
    buffer_load_dwordx4 v[56:59], v123, s[4:7], s30 offen sc1
    buffer_load_dwordx4 v[60:63], v123, s[4:7], s31 offen sc1
main_kernel_p1_1_0s:
    s_waitcnt vmcnt(0)
main_kernel_p1_1_0sc:
    v_bitop3_b32 v105, v56, v58, s71 bitop3:0x7e
    v_bitop3_b32 v127, v60, v62, s71 bitop3:0x7e
    v_or_b32 v105, v105, v127
    v_and_b32 v105, 1, v105
    v_cmp_ne_u32 vcc, 0, v105
    s_cbranch_vccz main_kernel_p1_1_0sdone
    s_mov_b64 exec, vcc
    buffer_load_dwordx4 v[56:59], v123, s[4:7], s30 offen sc1
    buffer_load_dwordx4 v[60:63], v123, s[4:7], s31 offen sc1
    s_sub_u32 s43, s43, 1
    s_cbranch_scc0 main_kernel_p1_1_0s
main_kernel_p1_1_0sdone:
    s_mov_b64 exec, -1
    v_mfma_f32_16x16x32_bf16 v[64:67], v[112:115], v[56:59], 0
    v_mfma_f32_16x16x32_bf16 v[64:67], v[112:115], v[60:63], v[64:67]
    v_mov_b64 v[72:73], -1
    v_mov_b64 v[74:75], -1
    s_add_u32 s14, s14, 1
    s_nop 4
    v_add_f32_dpp v68, v64, v64 row_ror:4 row_mask:0xf bank_mask:0xf
    v_add_f32_dpp v69, v65, v65 row_ror:4 row_mask:0xf bank_mask:0xf
    v_add_f32_dpp v70, v66, v66 row_ror:4 row_mask:0xf bank_mask:0xf
    v_add_f32_dpp v71, v67, v67 row_ror:4 row_mask:0xf bank_mask:0xf
    v_add_f32_dpp v64, v68, v68 row_ror:8 row_mask:0xf bank_mask:0xf
    v_add_f32_dpp v65, v69, v69 row_ror:8 row_mask:0xf bank_mask:0xf
    v_add_f32_dpp v66, v70, v70 row_ror:8 row_mask:0xf bank_mask:0xf
    v_add_f32_dpp v67, v71, v71 row_ror:8 row_mask:0xf bank_mask:0xf
    s_mov_b64 exec, s[40:41]
    v_cvt_pk_bf16_f32 v64, v64, v65
    v_cvt_pk_bf16_f32 v65, v66, v67
    buffer_store_dword v64, v125, s[4:7], s32 offen sc1
    buffer_store_dword v65, v125, s[4:7], s32 offen offset:16 sc1
    buffer_store_dword v72, v125, s[4:7], s33 offen sc1
    buffer_store_dword v72, v125, s[4:7], s33 offen offset:16 sc1
    s_mov_b64 exec, -1
    s_add_u32 s15, s14, 2
    s_cmp_lg_u32 s15, s75
    s_cbranch_scc1 main_kernel_nokv1_0s
    v_mov_b32 v127, s69
    buffer_load_dword v126, v127, s[44:47], 0 offen sc1
main_kernel_nokv1_0s:
    s_branch main_kernel_wl0s
main_kernel_wl1s:
    ds_read_b128 v[56:59], v117 offset:4096
    ds_read_b128 v[60:63], v117 offset:5120
    ds_read_b128 v[64:67], v117 offset:6144
    ds_read_b128 v[68:71], v117 offset:7168
    ds_read_b128 v[72:75], v117 offset:0
    ds_read_b128 v[76:79], v117 offset:1024
    ds_read_b128 v[80:83], v117 offset:2048
    ds_read_b128 v[84:87], v117 offset:3072
    s_cmp_eq_u32 s14, 0
    s_cbranch_scc1 main_kernel_m0_1s
    s_mov_b32 s43, 0x100000
    buffer_load_dwordx4 v[8:11], v124, s[4:7], s32 offen sc1
    buffer_load_dwordx4 v[12:15], v124, s[4:7], s32 offen offset:1024 sc1
main_kernel_p2_0_1s:
    s_waitcnt vmcnt(0)
main_kernel_p2_0_1sc:
    v_max3_u32 v105, v8, v9, v10
    v_max3_u32 v127, v11, v12, v13
    v_max3_u32 v105, v14, v15, v105
    v_max_u32 v105, v105, v127
    v_cmp_eq_u32 vcc, -1, v105
    s_cbranch_vccz main_kernel_p2_0_1sdone
    s_mov_b64 exec, vcc
    buffer_load_dwordx4 v[8:11], v124, s[4:7], s32 offen sc1
    buffer_load_dwordx4 v[12:15], v124, s[4:7], s32 offen offset:1024 sc1
    s_sub_u32 s43, s43, 1
    s_cbranch_scc0 main_kernel_p2_0_1s
main_kernel_p2_0_1sdone:
    s_mov_b64 exec, -1
main_kernel_m0done_1s:
    ds_write_b128 v124, v[8:11] offset:16384
    ds_write_b128 v124, v[12:15] offset:17408
    v_smfmac_f32_16x16x64_bf16 v[32:35], v[8:11], a[16:23], v104
    v_smfmac_f32_16x16x64_bf16 v[40:43], v[8:11], a[144:151], v104
    v_smfmac_f32_16x16x64_bf16 v[36:39], v[8:11], a[80:87], v104
    s_waitcnt lgkmcnt(8)
    v_smfmac_f32_16x16x64_bf16 v[44:47], v[8:11], v[56:63], v104
    v_smfmac_f32_16x16x64_bf16 v[48:51], v[8:11], a[208:215], v104
    v_smfmac_f32_16x16x64_bf16 v[52:55], v[8:11], v[144:151], v104
    s_waitcnt lgkmcnt(0)
    s_barrier
    ds_read_b128 v[0:3], v116 offset:16384
    ds_read_b128 v[4:7], v116 offset:17408
    v_smfmac_f32_16x16x64_bf16 v[32:35], v[12:15], a[24:31], v104
    ds_read_b128 v[16:19], v116 offset:20480
    v_smfmac_f32_16x16x64_bf16 v[40:43], v[12:15], a[152:159], v104
    ds_read_b128 v[20:23], v116 offset:21504
    v_smfmac_f32_16x16x64_bf16 v[36:39], v[12:15], a[88:95], v104
    ds_read_b128 v[24:27], v116 offset:22528
    v_smfmac_f32_16x16x64_bf16 v[44:47], v[12:15], v[64:71], v104
    ds_read_b128 v[28:31], v116 offset:23552
    v_smfmac_f32_16x16x64_bf16 v[48:51], v[12:15], a[216:223], v104
    v_smfmac_f32_16x16x64_bf16 v[52:55], v[12:15], v[152:159], v104
    s_waitcnt lgkmcnt(5)
    v_smfmac_f32_16x16x64_bf16 v[32:35], v[0:3], a[0:7], v104
    ds_read_b128 v[56:59], v117 offset:8192
    ds_read_b128 v[60:63], v117 offset:9216
    v_smfmac_f32_16x16x64_bf16 v[40:43], v[0:3], a[128:135], v104
    ds_read_b128 v[64:67], v117 offset:10240
    ds_read_b128 v[68:71], v117 offset:11264
    s_waitcnt lgkmcnt(8)
    v_smfmac_f32_16x16x64_bf16 v[32:35], v[4:7], a[8:15], v104
    s_mov_b32 m0, s68
    s_add_u32 s17, s34, 0x40000
    v_smfmac_f32_16x16x64_bf16 v[40:43], v[4:7], a[136:143], v104
    buffer_load_dwordx4 v124, s[4:7], s34 offen sc1 lds
    s_waitcnt lgkmcnt(7)
    v_smfmac_f32_16x16x64_bf16 v[32:35], v[16:19], a[32:39], v104
    v_smfmac_f32_16x16x64_bf16 v[40:43], v[16:19], a[160:167], v104
    buffer_load_dwordx4 v124, s[4:7], s34 offen offset:1024 sc1 lds
    s_waitcnt lgkmcnt(6)
    v_smfmac_f32_16x16x64_bf16 v[32:35], v[20:23], a[40:47], v104
    v_smfmac_f32_16x16x64_bf16 v[40:43], v[20:23], a[168:175], v104
    buffer_load_dwordx4 v[96:99], v124, s[4:7], s35 offen sc1
    s_waitcnt lgkmcnt(5)
    v_smfmac_f32_16x16x64_bf16 v[32:35], v[24:27], a[48:55], v104
    v_smfmac_f32_16x16x64_bf16 v[40:43], v[24:27], a[176:183], v104
    buffer_load_dwordx4 v[100:103], v124, s[4:7], s35 offen offset:1024 sc1
    s_mov_b32 s34, s17
    s_waitcnt lgkmcnt(4)
    v_smfmac_f32_16x16x64_bf16 v[32:35], v[28:31], a[56:63], v104
    s_add_u32 s35, s35, 0x40000
    v_smfmac_f32_16x16x64_bf16 v[40:43], v[28:31], a[184:191], v104
    v_smfmac_f32_16x16x64_bf16 v[36:39], v[0:3], a[64:71], v104
    v_smfmac_f32_16x16x64_bf16 v[44:47], v[0:3], v[72:79], v104
    ds_read_b128 v[72:75], v117 offset:12288
    ds_read_b128 v[76:79], v117 offset:13312
    v_smfmac_f32_16x16x64_bf16 v[36:39], v[4:7], a[72:79], v104
    v_smfmac_f32_16x16x64_bf16 v[44:47], v[4:7], v[80:87], v104
    ds_read_b128 v[80:83], v117 offset:14336
    ds_read_b128 v[84:87], v117 offset:15360
    v_smfmac_f32_16x16x64_bf16 v[36:39], v[16:19], a[96:103], v104
    v_add_f32 v40, v40, v42
    v_add_f32 v41, v41, v43
    s_waitcnt lgkmcnt(6)
    v_smfmac_f32_16x16x64_bf16 v[44:47], v[16:19], v[56:63], v104
    v_smfmac_f32_16x16x64_bf16 v[36:39], v[20:23], a[104:111], v104
    v_add_f32 v32, v32, v34
    v_add_f32 v33, v33, v35
    s_waitcnt lgkmcnt(4)
    v_smfmac_f32_16x16x64_bf16 v[44:47], v[20:23], v[64:71], v104
    v_smfmac_f32_16x16x64_bf16 v[36:39], v[24:27], a[112:119], v104
    v_cvt_pk_bf16_f32 v40, v40, v41
    v_cvt_pk_bf16_f32 v41, v32, v33
    s_waitcnt lgkmcnt(2)
    v_smfmac_f32_16x16x64_bf16 v[44:47], v[24:27], v[72:79], v104
    v_smfmac_f32_16x16x64_bf16 v[36:39], v[28:31], a[120:127], v104
    ds_write_b64 v118, v[40:41] offset:0
    s_waitcnt lgkmcnt(1)
    v_smfmac_f32_16x16x64_bf16 v[44:47], v[28:31], v[80:87], v104
    ds_read_b128 v[8:11], v116 offset:2048
    ds_read_b128 v[12:15], v116 offset:3072
    v_smfmac_f32_16x16x64_bf16 v[48:51], v[0:3], a[192:199], v104
    v_smfmac_f32_16x16x64_bf16 v[52:55], v[0:3], v[128:135], v104
    ds_read_b128 v[0:3], v116 offset:0
    s_nop 2
    v_add_f32 v44, v44, v46
    v_add_f32 v45, v45, v47
    v_add_f32 v36, v36, v38
    v_add_f32 v37, v37, v39
    v_cvt_pk_bf16_f32 v44, v44, v45
    v_cvt_pk_bf16_f32 v45, v36, v37
    ds_write_b64 v118, v[44:45] offset:512
    v_smfmac_f32_16x16x64_bf16 v[48:51], v[4:7], a[200:207], v104
    v_smfmac_f32_16x16x64_bf16 v[52:55], v[4:7], v[136:143], v104
    ds_read_b128 v[4:7], v116 offset:1024
    s_waitcnt lgkmcnt(1)
    s_barrier
    ds_read_b64_tr_b16 v[32:33], v119 offset:0
    ds_read_b64_tr_b16 v[34:35], v119 offset:512
    ds_read_b64_tr_b16 v[36:37], v119 offset:1024
    ds_read_b64_tr_b16 v[38:39], v119 offset:1536
    v_smfmac_f32_16x16x64_bf16 v[48:51], v[16:19], a[224:231], v104
    ds_read_b64_tr_b16 v[40:41], v119 offset:2048
    ds_read_b64_tr_b16 v[42:43], v119 offset:2560
    v_smfmac_f32_16x16x64_bf16 v[52:55], v[16:19], v[160:167], v104
    ds_read_b64_tr_b16 v[44:45], v119 offset:3072
    ds_read_b64_tr_b16 v[46:47], v119 offset:3584
    ds_read_b128 v[16:19], v116 offset:4096
    v_smfmac_f32_16x16x64_bf16 v[48:51], v[20:23], a[232:239], v104
    v_smfmac_f32_16x16x64_bf16 v[52:55], v[20:23], v[168:175], v104
    ds_read_b128 v[20:23], v116 offset:5120
    v_smfmac_f32_16x16x64_bf16 v[48:51], v[24:27], a[240:247], v104
    v_smfmac_f32_16x16x64_bf16 v[52:55], v[24:27], v[176:183], v104
    ds_read_b128 v[24:27], v116 offset:6144
    v_smfmac_f32_16x16x64_bf16 v[48:51], v[28:31], a[248:255], v104
    v_smfmac_f32_16x16x64_bf16 v[52:55], v[28:31], v[184:191], v104
    ds_read_b128 v[28:31], v116 offset:7168
    s_waitcnt lgkmcnt(4)
    v_mfma_f32_16x16x32_bf16 v[56:59], v[32:35], v[32:35], 0
    v_mfma_f32_16x16x32_bf16 v[60:63], v[8:11], v[40:43], 0
    buffer_store_dwordx4 v[36:39], v116, s[4:7], s36 offen offset:1024 sc1
    s_add_u32 s36, s36, 0x20000
    v_mfma_f32_16x16x32_bf16 v[56:59], v[36:39], v[36:39], v[56:59]
    v_mfma_f32_16x16x32_bf16 v[60:63], v[12:15], v[44:47], v[60:63]
    v_mfma_f32_16x16x32_bf16 v[56:59], v[40:43], v[40:43], v[56:59]
    v_mfma_f32_16x16x32_bf16 v[60:63], v[0:3], v[32:35], v[60:63]
    v_cvt_pk_bf16_f32 v48, v48, v49
    v_cvt_pk_bf16_f32 v49, v50, v51
    v_cvt_pk_bf16_f32 v50, v52, v53
    v_cvt_pk_bf16_f32 v51, v54, v55
    v_mfma_f32_16x16x32_bf16 v[56:59], v[44:47], v[44:47], v[56:59]
    v_mfma_f32_16x16x32_bf16 v[60:63], v[4:7], v[36:39], v[60:63]
    buffer_store_dwordx4 v[48:51], v116, s[4:7], s37 offen sc1
    s_add_u32 s37, s37, 0x20000
    s_waitcnt lgkmcnt(3)
    v_mfma_f32_16x16x32_bf16 v[64:67], v[16:19], v[32:35], 0
    s_waitcnt lgkmcnt(2)
    v_mfma_f32_16x16x32_bf16 v[64:67], v[20:23], v[36:39], v[64:67]
    s_cmp_eq_u32 s14, 63
    s_cbranch_scc1 main_kernel_done
    s_waitcnt lgkmcnt(1)
    v_mfma_f32_16x16x32_bf16 v[64:67], v[24:27], v[40:43], v[64:67]
    s_waitcnt lgkmcnt(0)
    v_mfma_f32_16x16x32_bf16 v[64:67], v[28:31], v[44:47], v[64:67]
    v_mov_b64 v[16:17], 0
    v_mov_b64 v[18:19], 0
    v_mov_b64 v[20:21], 0
    v_mov_b64 v[22:23], 0
    v_max3_f32 v105, v60, v61, v62
    v_max3_f32 v127, v63, v56, v57
    s_nop 1
    v_max3_f32 v127, v64, v65, v127
    v_max3_f32 v105, v66, v67, v105
    v_max_f32 v105, v105, v127
    v_mov_b32 v127, v105
    v_mov_b64 v[0:1], 0
    v_mov_b64 v[2:3], 0
    v_permlane32_swap_b32 v105, v127
    v_max_f32 v105, v105, v127
    v_mov_b32 v127, v105
    v_mov_b64 v[4:5], 0
    v_mov_b64 v[6:7], 0
    v_permlane16_swap_b32 v105, v127
    v_max_f32 v105, v105, v127
    v_mul_f32 v105, s42, v105
    v_fma_f32 v56, v56, s42, -v105
    v_fma_f32 v57, v57, s42, -v105
    v_exp_f32 v56, v56
    v_exp_f32 v57, v57
    v_fma_f32 v60, v60, s42, -v105
    v_fma_f32 v61, v61, s42, -v105
    v_fma_f32 v62, v62, s42, -v105
    v_fma_f32 v63, v63, s42, -v105
    v_fma_f32 v64, v64, s42, -v105
    v_fma_f32 v65, v65, s42, -v105
    v_fma_f32 v66, v66, s42, -v105
    v_fma_f32 v67, v67, s42, -v105
    v_cvt_pk_bf16_f32 v58, v56, v57
    v_cvt_pk_bf16_f32 v59, v56, v57
    v_exp_f32 v60, v60
    v_exp_f32 v61, v61
    v_mfma_f32_16x16x16_bf16 v[72:75], v[58:59], v[110:111], 0
    v_exp_f32 v62, v62
    v_exp_f32 v63, v63
    v_mfma_f32_16x16x16_bf16 v[76:79], v[58:59], v[48:49], 0
    v_exp_f32 v64, v64
    v_exp_f32 v65, v65
    v_mfma_f32_16x16x16_bf16 v[80:83], v[58:59], v[50:51], 0
    v_exp_f32 v66, v66
    v_exp_f32 v67, v67
    v_cvt_pk_bf16_f32 v84, v60, v61
    v_cvt_pk_bf16_f32 v85, v62, v63
    v_cvt_pk_bf16_f32 v86, v64, v65
    v_cvt_pk_bf16_f32 v87, v66, v67
    v_mov_b64 v[24:25], 0
    v_mov_b64 v[26:27], 0
    v_mfma_f32_16x16x32_bf16 v[72:75], v[84:87], v[106:109], v[72:75]
    v_mov_b64 v[28:29], 0
    v_mov_b64 v[30:31], 0
    v_mfma_f32_16x16x32_bf16 v[76:79], v[84:87], v[88:91], v[76:79]
    v_mfma_f32_16x16x32_bf16 v[80:83], v[84:87], v[92:95], v[80:83]
    ds_read_b128 v[56:59], v117 offset:16384
    ds_read_b128 v[60:63], v117 offset:17408
    ds_read_b128 v[64:67], v117 offset:20480
    ds_read_b128 v[68:71], v117 offset:21504
    v_rcp_f32 v74, v74
    v_rcp_f32 v75, v75
    s_nop 0
    v_mul_f32 v78, v78, v74
    v_mul_f32 v79, v79, v75
    v_cvt_pk_bf16_f32 v76, v78, v79
    ds_write_b32 v120, v76 offset:0
    v_mul_f32 v82, v82, v74
    v_mul_f32 v83, v83, v75
    v_cvt_pk_bf16_f32 v80, v82, v83
    ds_write_b32 v120, v80 offset:256
    s_waitcnt lgkmcnt(0)
    s_barrier
    ds_read_b64_tr_b16 v[80:81], v121 offset:0
    ds_read_b64_tr_b16 v[82:83], v121 offset:128
    ds_read_b64_tr_b16 v[84:85], v121 offset:1024
    ds_read_b64_tr_b16 v[86:87], v121 offset:1152
    v_mov_b64 v[8:9], 0
    v_mov_b64 v[10:11], 0
    v_mov_b64 v[12:13], 0
    v_mov_b64 v[14:15], 0
    s_waitcnt lgkmcnt(2)
    s_bfe_i32 s71, s14, 0x10001
    v_smfmac_f32_16x16x64_bf16 v[0:3], v[80:83], v[192:199], v104
    v_smfmac_f32_16x16x64_bf16 v[4:7], v[80:83], v[208:215], v104
    ds_read_b128 v[72:75], v117 offset:18432
    ds_read_b128 v[76:79], v117 offset:19456
    s_waitcnt lgkmcnt(2)
    v_smfmac_f32_16x16x64_bf16 v[0:3], v[84:87], v[200:207], v104
    ds_read_b128 v[32:35], v117 offset:22528
    ds_read_b128 v[36:39], v117 offset:23552
    v_smfmac_f32_16x16x64_bf16 v[4:7], v[84:87], v[216:223], v104
    ds_read_b128 v[40:43], v117 offset:24576
    ds_read_b128 v[44:47], v117 offset:25600
    v_smfmac_f32_16x16x64_bf16 v[8:11], v[80:83], v[224:231], v104
    ds_read_b128 v[48:51], v117 offset:28672
    ds_read_b128 v[52:55], v117 offset:29696
    v_smfmac_f32_16x16x64_bf16 v[12:15], v[80:83], v[240:247], v104
    v_smfmac_f32_16x16x64_bf16 v[8:11], v[84:87], v[232:239], v104
    v_add_f32 v0, v0, v2
    v_add_f32 v1, v1, v3
    v_add_f32 v4, v4, v6
    v_add_f32 v5, v5, v7
    v_smfmac_f32_16x16x64_bf16 v[12:15], v[84:87], v[248:255], v104
    v_cvt_pk_bf16_f32 v0, v0, v1
    v_cvt_pk_bf16_f32 v1, v4, v5
    v_bfi_b32 v0, 1, s71, v0
    buffer_store_dwordx2 v[0:1], v122, s[4:7], s20 offen sc1
    v_smfmac_f32_16x16x64_bf16 v[16:19], v[80:83], v[56:63], v104
    ds_read_b128 v[56:59], v117 offset:26624
    ds_read_b128 v[60:63], v117 offset:27648
    v_smfmac_f32_16x16x64_bf16 v[20:23], v[80:83], v[64:71], v104
    ds_read_b128 v[64:67], v117 offset:30720
    ds_read_b128 v[68:71], v117 offset:31744
    s_waitcnt lgkmcnt(10)
    v_smfmac_f32_16x16x64_bf16 v[16:19], v[84:87], v[72:79], v104
    v_add_f32 v8, v8, v10
    v_add_f32 v9, v9, v11
    v_add_f32 v12, v12, v14
    v_add_f32 v13, v13, v15
    s_waitcnt lgkmcnt(8)
    v_smfmac_f32_16x16x64_bf16 v[20:23], v[84:87], v[32:39], v104
    v_cvt_pk_bf16_f32 v8, v8, v9
    v_cvt_pk_bf16_f32 v9, v12, v13
    v_bfi_b32 v8, 1, s71, v8
    buffer_store_dwordx2 v[8:9], v122, s[4:7], s21 offen sc1
    s_waitcnt lgkmcnt(6)
    v_smfmac_f32_16x16x64_bf16 v[24:27], v[80:83], v[40:47], v104
    s_waitcnt lgkmcnt(4)
    v_smfmac_f32_16x16x64_bf16 v[28:31], v[80:83], v[48:55], v104
    s_waitcnt lgkmcnt(2)
    v_smfmac_f32_16x16x64_bf16 v[24:27], v[84:87], v[56:63], v104
    v_add_f32 v16, v16, v18
    v_add_f32 v17, v17, v19
    v_add_f32 v20, v20, v22
    v_add_f32 v21, v21, v23
    s_waitcnt lgkmcnt(0)
    v_smfmac_f32_16x16x64_bf16 v[28:31], v[84:87], v[64:71], v104
    v_cvt_pk_bf16_f32 v16, v16, v17
    v_cvt_pk_bf16_f32 v17, v20, v21
    v_bfi_b32 v16, 1, s71, v16
    buffer_store_dwordx2 v[16:17], v122, s[4:7], s22 offen sc1
    v_mov_b64 v[32:33], 0
    v_mov_b64 v[34:35], 0
    v_mov_b64 v[36:37], 0
    v_mov_b64 v[38:39], 0
    v_add_f32 v24, v24, v26
    v_add_f32 v25, v25, v27
    v_add_f32 v28, v28, v30
    v_add_f32 v29, v29, v31
    v_cvt_pk_bf16_f32 v24, v24, v25
    v_cvt_pk_bf16_f32 v25, v28, v29
    v_bfi_b32 v24, 1, s71, v24
    buffer_store_dwordx2 v[24:25], v122, s[4:7], s23 offen sc1
    v_mov_b64 v[40:41], 0
    v_mov_b64 v[42:43], 0
    v_mov_b64 v[44:45], 0
    v_mov_b64 v[46:47], 0
    v_mov_b64 v[48:49], 0
    v_mov_b64 v[50:51], 0
    v_mov_b64 v[52:53], 0
    v_mov_b64 v[54:55], 0
    s_mov_b32 s43, 0x100000
    buffer_load_dwordx4 v[56:59], v123, s[4:7], s28 offen sc1
    buffer_load_dwordx4 v[60:63], v123, s[4:7], s29 offen sc1
main_kernel_p1_0_1s:
    s_waitcnt vmcnt(0)
main_kernel_p1_0_1sc:
    v_bitop3_b32 v105, v56, v58, s71 bitop3:0x7e
    v_bitop3_b32 v127, v60, v62, s71 bitop3:0x7e
    v_or_b32 v105, v105, v127
    v_and_b32 v105, 1, v105
    v_cmp_ne_u32 vcc, 0, v105
    s_cbranch_vccz main_kernel_p1_0_1sdone
    s_mov_b64 exec, vcc
    buffer_load_dwordx4 v[56:59], v123, s[4:7], s28 offen sc1
    buffer_load_dwordx4 v[60:63], v123, s[4:7], s29 offen sc1
    s_sub_u32 s43, s43, 1
    s_cbranch_scc0 main_kernel_p1_0_1s
main_kernel_p1_0_1sdone:
    s_mov_b64 exec, -1
    v_mfma_f32_16x16x32_bf16 v[64:67], v[112:115], v[56:59], 0
    v_mfma_f32_16x16x32_bf16 v[64:67], v[112:115], v[60:63], v[64:67]
    v_mov_b64 v[72:73], -1
    v_mov_b64 v[74:75], -1
    s_add_u32 s14, s14, 1
    s_nop 4
    v_add_f32_dpp v68, v64, v64 row_ror:4 row_mask:0xf bank_mask:0xf
    v_add_f32_dpp v69, v65, v65 row_ror:4 row_mask:0xf bank_mask:0xf
    v_add_f32_dpp v70, v66, v66 row_ror:4 row_mask:0xf bank_mask:0xf
    v_add_f32_dpp v71, v67, v67 row_ror:4 row_mask:0xf bank_mask:0xf
    v_add_f32_dpp v64, v68, v68 row_ror:8 row_mask:0xf bank_mask:0xf
    v_add_f32_dpp v65, v69, v69 row_ror:8 row_mask:0xf bank_mask:0xf
    v_add_f32_dpp v66, v70, v70 row_ror:8 row_mask:0xf bank_mask:0xf
    v_add_f32_dpp v67, v71, v71 row_ror:8 row_mask:0xf bank_mask:0xf
    s_mov_b64 exec, s[40:41]
    v_cvt_pk_bf16_f32 v64, v64, v65
    v_cvt_pk_bf16_f32 v65, v66, v67
    buffer_store_dword v64, v125, s[4:7], s33 offen sc1
    buffer_store_dword v65, v125, s[4:7], s33 offen offset:16 sc1
    buffer_store_dword v72, v125, s[4:7], s32 offen sc1
    buffer_store_dword v72, v125, s[4:7], s32 offen offset:16 sc1
    s_mov_b64 exec, -1
    s_add_u32 s15, s14, 1
    s_cmp_lg_u32 s15, s75
    s_cbranch_scc1 main_kernel_nokv0_1s
    v_readfirstlane_b32 s18, v126
    s_nop 0
    s_cmp_ge_u32 s18, 64
    s_cbranch_scc1 main_kernel_kvok0_1s
    s_mov_b32 s43, 0x200000
    v_mov_b32 v127, s69
main_kernel_wkvn1s:
    buffer_load_dword v126, v127, s[44:47], 0 offen sc1
    s_waitcnt vmcnt(0)
    v_readfirstlane_b32 s18, v126
    s_nop 0
    s_cmp_ge_u32 s18, 64
    s_cbranch_scc1 main_kernel_wkvn1s_ok
    s_sleep 2
    s_sub_u32 s43, s43, 1
    s_cbranch_scc0 main_kernel_wkvn1s
main_kernel_wkvn1s_ok:
main_kernel_kvok0_1s:
    s_min_u32 s15, s75, 8
    s_add_u32 s75, s75, s15
    s_add_u32 s69, s69, 4
    s_cmp_ge_u32 s75, 64
    s_cselect_b32 s75, 0x7fff, s75
main_kernel_nokv0_1s:
    ds_read_b128 v[56:59], v117 offset:4096
    ds_read_b128 v[60:63], v117 offset:5120
    ds_read_b128 v[64:67], v117 offset:6144
    ds_read_b128 v[68:71], v117 offset:7168
    ds_read_b128 v[72:75], v117 offset:0
    ds_read_b128 v[76:79], v117 offset:1024
    ds_read_b128 v[80:83], v117 offset:2048
    ds_read_b128 v[84:87], v117 offset:3072
    s_mov_b32 s43, 0x100000
    buffer_load_dwordx4 v[8:11], v124, s[4:7], s33 offen sc1
    buffer_load_dwordx4 v[12:15], v124, s[4:7], s33 offen offset:1024 sc1
main_kernel_p2_1_1s:
    s_waitcnt vmcnt(0)
main_kernel_p2_1_1sc:
    v_max3_u32 v105, v8, v9, v10
    v_max3_u32 v127, v11, v12, v13
    v_max3_u32 v105, v14, v15, v105
    v_max_u32 v105, v105, v127
    v_cmp_eq_u32 vcc, -1, v105
    s_cbranch_vccz main_kernel_p2_1_1sdone
    s_mov_b64 exec, vcc
    buffer_load_dwordx4 v[8:11], v124, s[4:7], s33 offen sc1
    buffer_load_dwordx4 v[12:15], v124, s[4:7], s33 offen offset:1024 sc1
    s_sub_u32 s43, s43, 1
    s_cbranch_scc0 main_kernel_p2_1_1s
main_kernel_p2_1_1sdone:
    s_mov_b64 exec, -1
    ds_write_b128 v124, v[8:11] offset:16384
    ds_write_b128 v124, v[12:15] offset:17408
    v_smfmac_f32_16x16x64_bf16 v[32:35], v[8:11], a[16:23], v104
    v_smfmac_f32_16x16x64_bf16 v[40:43], v[8:11], a[144:151], v104
    v_smfmac_f32_16x16x64_bf16 v[36:39], v[8:11], a[80:87], v104
    s_waitcnt lgkmcnt(8)
    v_smfmac_f32_16x16x64_bf16 v[44:47], v[8:11], v[56:63], v104
    v_smfmac_f32_16x16x64_bf16 v[48:51], v[8:11], a[208:215], v104
    v_smfmac_f32_16x16x64_bf16 v[52:55], v[8:11], v[144:151], v104
    s_waitcnt lgkmcnt(0)
    s_barrier
    ds_read_b128 v[0:3], v116 offset:16384
    ds_read_b128 v[4:7], v116 offset:17408
    v_smfmac_f32_16x16x64_bf16 v[32:35], v[12:15], a[24:31], v104
    ds_read_b128 v[16:19], v116 offset:20480
    v_smfmac_f32_16x16x64_bf16 v[40:43], v[12:15], a[152:159], v104
    ds_read_b128 v[20:23], v116 offset:21504
    v_smfmac_f32_16x16x64_bf16 v[36:39], v[12:15], a[88:95], v104
    ds_read_b128 v[24:27], v116 offset:22528
    v_smfmac_f32_16x16x64_bf16 v[44:47], v[12:15], v[64:71], v104
    ds_read_b128 v[28:31], v116 offset:23552
    v_smfmac_f32_16x16x64_bf16 v[48:51], v[12:15], a[216:223], v104
    v_smfmac_f32_16x16x64_bf16 v[52:55], v[12:15], v[152:159], v104
    s_waitcnt lgkmcnt(5)
    v_smfmac_f32_16x16x64_bf16 v[32:35], v[0:3], a[0:7], v104
    ds_read_b128 v[56:59], v117 offset:8192
    ds_read_b128 v[60:63], v117 offset:9216
    v_smfmac_f32_16x16x64_bf16 v[40:43], v[0:3], a[128:135], v104
    ds_read_b128 v[64:67], v117 offset:10240
    ds_read_b128 v[68:71], v117 offset:11264
    s_waitcnt lgkmcnt(8)
    v_smfmac_f32_16x16x64_bf16 v[32:35], v[4:7], a[8:15], v104
    s_mov_b32 m0, s67
    s_add_u32 s17, s34, 0x40000
    v_smfmac_f32_16x16x64_bf16 v[40:43], v[4:7], a[136:143], v104
    buffer_load_dwordx4 v124, s[4:7], s34 offen sc1 lds
    s_waitcnt lgkmcnt(7)
    v_smfmac_f32_16x16x64_bf16 v[32:35], v[16:19], a[32:39], v104
    v_smfmac_f32_16x16x64_bf16 v[40:43], v[16:19], a[160:167], v104
    buffer_load_dwordx4 v124, s[4:7], s34 offen offset:1024 sc1 lds
    s_waitcnt lgkmcnt(6)
    v_smfmac_f32_16x16x64_bf16 v[32:35], v[20:23], a[40:47], v104
    v_smfmac_f32_16x16x64_bf16 v[40:43], v[20:23], a[168:175], v104
    buffer_load_dwordx4 v[88:91], v124, s[4:7], s35 offen sc1
    s_waitcnt lgkmcnt(5)
    v_smfmac_f32_16x16x64_bf16 v[32:35], v[24:27], a[48:55], v104
    v_smfmac_f32_16x16x64_bf16 v[40:43], v[24:27], a[176:183], v104
    buffer_load_dwordx4 v[92:95], v124, s[4:7], s35 offen offset:1024 sc1
    s_mov_b32 s34, s17
    s_waitcnt lgkmcnt(4)
    v_smfmac_f32_16x16x64_bf16 v[32:35], v[28:31], a[56:63], v104
    s_add_u32 s35, s35, 0x40000
    v_smfmac_f32_16x16x64_bf16 v[40:43], v[28:31], a[184:191], v104
    v_smfmac_f32_16x16x64_bf16 v[36:39], v[0:3], a[64:71], v104
    v_smfmac_f32_16x16x64_bf16 v[44:47], v[0:3], v[72:79], v104
    ds_read_b128 v[72:75], v117 offset:12288
    ds_read_b128 v[76:79], v117 offset:13312
    v_smfmac_f32_16x16x64_bf16 v[36:39], v[4:7], a[72:79], v104
    v_smfmac_f32_16x16x64_bf16 v[44:47], v[4:7], v[80:87], v104
    ds_read_b128 v[80:83], v117 offset:14336
    ds_read_b128 v[84:87], v117 offset:15360
    v_smfmac_f32_16x16x64_bf16 v[36:39], v[16:19], a[96:103], v104
    v_add_f32 v40, v40, v42
    v_add_f32 v41, v41, v43
    s_waitcnt lgkmcnt(6)
    v_smfmac_f32_16x16x64_bf16 v[44:47], v[16:19], v[56:63], v104
    v_smfmac_f32_16x16x64_bf16 v[36:39], v[20:23], a[104:111], v104
    v_add_f32 v32, v32, v34
    v_add_f32 v33, v33, v35
    s_waitcnt lgkmcnt(4)
    v_smfmac_f32_16x16x64_bf16 v[44:47], v[20:23], v[64:71], v104
    v_smfmac_f32_16x16x64_bf16 v[36:39], v[24:27], a[112:119], v104
    v_cvt_pk_bf16_f32 v40, v40, v41
    v_cvt_pk_bf16_f32 v41, v32, v33
    s_waitcnt lgkmcnt(2)
    v_smfmac_f32_16x16x64_bf16 v[44:47], v[24:27], v[72:79], v104
    v_smfmac_f32_16x16x64_bf16 v[36:39], v[28:31], a[120:127], v104
    ds_write_b64 v118, v[40:41] offset:0
    s_waitcnt lgkmcnt(1)
    v_smfmac_f32_16x16x64_bf16 v[44:47], v[28:31], v[80:87], v104
    ds_read_b128 v[8:11], v116 offset:10240
    ds_read_b128 v[12:15], v116 offset:11264
    v_smfmac_f32_16x16x64_bf16 v[48:51], v[0:3], a[192:199], v104
    v_smfmac_f32_16x16x64_bf16 v[52:55], v[0:3], v[128:135], v104
    ds_read_b128 v[0:3], v116 offset:8192
    s_nop 2
    v_add_f32 v44, v44, v46
    v_add_f32 v45, v45, v47
    v_add_f32 v36, v36, v38
    v_add_f32 v37, v37, v39
    v_cvt_pk_bf16_f32 v44, v44, v45
    v_cvt_pk_bf16_f32 v45, v36, v37
    ds_write_b64 v118, v[44:45] offset:512
    v_smfmac_f32_16x16x64_bf16 v[48:51], v[4:7], a[200:207], v104
    v_smfmac_f32_16x16x64_bf16 v[52:55], v[4:7], v[136:143], v104
    ds_read_b128 v[4:7], v116 offset:9216
    s_waitcnt lgkmcnt(1)
    s_barrier
    ds_read_b64_tr_b16 v[32:33], v119 offset:0
    ds_read_b64_tr_b16 v[34:35], v119 offset:512
    ds_read_b64_tr_b16 v[36:37], v119 offset:1024
    ds_read_b64_tr_b16 v[38:39], v119 offset:1536
    v_smfmac_f32_16x16x64_bf16 v[48:51], v[16:19], a[224:231], v104
    ds_read_b64_tr_b16 v[40:41], v119 offset:2048
    ds_read_b64_tr_b16 v[42:43], v119 offset:2560
    v_smfmac_f32_16x16x64_bf16 v[52:55], v[16:19], v[160:167], v104
    ds_read_b64_tr_b16 v[44:45], v119 offset:3072
    ds_read_b64_tr_b16 v[46:47], v119 offset:3584
    ds_read_b128 v[16:19], v116 offset:12288
    v_smfmac_f32_16x16x64_bf16 v[48:51], v[20:23], a[232:239], v104
    v_smfmac_f32_16x16x64_bf16 v[52:55], v[20:23], v[168:175], v104
    ds_read_b128 v[20:23], v116 offset:13312
    v_smfmac_f32_16x16x64_bf16 v[48:51], v[24:27], a[240:247], v104
    v_smfmac_f32_16x16x64_bf16 v[52:55], v[24:27], v[176:183], v104
    ds_read_b128 v[24:27], v116 offset:14336
    v_smfmac_f32_16x16x64_bf16 v[48:51], v[28:31], a[248:255], v104
    v_smfmac_f32_16x16x64_bf16 v[52:55], v[28:31], v[184:191], v104
    ds_read_b128 v[28:31], v116 offset:15360
    s_waitcnt lgkmcnt(4)
    v_mfma_f32_16x16x32_bf16 v[56:59], v[32:35], v[32:35], 0
    v_mfma_f32_16x16x32_bf16 v[60:63], v[8:11], v[40:43], 0
    buffer_store_dwordx4 v[36:39], v116, s[4:7], s36 offen offset:1024 sc1
    s_add_u32 s36, s36, 0x20000
    v_mfma_f32_16x16x32_bf16 v[56:59], v[36:39], v[36:39], v[56:59]
    v_mfma_f32_16x16x32_bf16 v[60:63], v[12:15], v[44:47], v[60:63]
    v_mfma_f32_16x16x32_bf16 v[56:59], v[40:43], v[40:43], v[56:59]
    v_mfma_f32_16x16x32_bf16 v[60:63], v[0:3], v[32:35], v[60:63]
    v_cvt_pk_bf16_f32 v48, v48, v49
    v_cvt_pk_bf16_f32 v49, v50, v51
    v_cvt_pk_bf16_f32 v50, v52, v53
    v_cvt_pk_bf16_f32 v51, v54, v55
    v_mfma_f32_16x16x32_bf16 v[56:59], v[44:47], v[44:47], v[56:59]
    v_mfma_f32_16x16x32_bf16 v[60:63], v[4:7], v[36:39], v[60:63]
    buffer_store_dwordx4 v[48:51], v116, s[4:7], s37 offen sc1
    s_add_u32 s37, s37, 0x20000
    s_waitcnt lgkmcnt(3)
    v_mfma_f32_16x16x32_bf16 v[64:67], v[16:19], v[32:35], 0
    s_waitcnt lgkmcnt(2)
    v_mfma_f32_16x16x32_bf16 v[64:67], v[20:23], v[36:39], v[64:67]
    s_cmp_eq_u32 s14, 63
    s_cbranch_scc1 main_kernel_done
    s_waitcnt lgkmcnt(1)
    v_mfma_f32_16x16x32_bf16 v[64:67], v[24:27], v[40:43], v[64:67]
    s_waitcnt lgkmcnt(0)
    v_mfma_f32_16x16x32_bf16 v[64:67], v[28:31], v[44:47], v[64:67]
    v_mov_b64 v[16:17], 0
    v_mov_b64 v[18:19], 0
    v_mov_b64 v[20:21], 0
    v_mov_b64 v[22:23], 0
    v_max3_f32 v105, v60, v61, v62
    v_max3_f32 v127, v63, v56, v57
    s_nop 1
    v_max3_f32 v127, v64, v65, v127
    v_max3_f32 v105, v66, v67, v105
    v_max_f32 v105, v105, v127
    v_mov_b32 v127, v105
    v_mov_b64 v[0:1], 0
    v_mov_b64 v[2:3], 0
    v_permlane32_swap_b32 v105, v127
    v_max_f32 v105, v105, v127
    v_mov_b32 v127, v105
    v_mov_b64 v[4:5], 0
    v_mov_b64 v[6:7], 0
    v_permlane16_swap_b32 v105, v127
    v_max_f32 v105, v105, v127
    v_mul_f32 v105, s42, v105
    v_fma_f32 v56, v56, s42, -v105
    v_fma_f32 v57, v57, s42, -v105
    v_exp_f32 v56, v56
    v_exp_f32 v57, v57
    v_fma_f32 v60, v60, s42, -v105
    v_fma_f32 v61, v61, s42, -v105
    v_fma_f32 v62, v62, s42, -v105
    v_fma_f32 v63, v63, s42, -v105
    v_fma_f32 v64, v64, s42, -v105
    v_fma_f32 v65, v65, s42, -v105
    v_fma_f32 v66, v66, s42, -v105
    v_fma_f32 v67, v67, s42, -v105
    v_cvt_pk_bf16_f32 v58, v56, v57
    v_cvt_pk_bf16_f32 v59, v56, v57
    v_exp_f32 v60, v60
    v_exp_f32 v61, v61
    v_mfma_f32_16x16x16_bf16 v[72:75], v[58:59], v[110:111], 0
    v_exp_f32 v62, v62
    v_exp_f32 v63, v63
    v_mfma_f32_16x16x16_bf16 v[76:79], v[58:59], v[48:49], 0
    v_exp_f32 v64, v64
    v_exp_f32 v65, v65
    v_mfma_f32_16x16x16_bf16 v[80:83], v[58:59], v[50:51], 0
    v_exp_f32 v66, v66
    v_exp_f32 v67, v67
    v_cvt_pk_bf16_f32 v84, v60, v61
    v_cvt_pk_bf16_f32 v85, v62, v63
    v_cvt_pk_bf16_f32 v86, v64, v65
    v_cvt_pk_bf16_f32 v87, v66, v67
    v_mov_b64 v[24:25], 0
    v_mov_b64 v[26:27], 0
    v_mfma_f32_16x16x32_bf16 v[72:75], v[84:87], v[106:109], v[72:75]
    v_mov_b64 v[28:29], 0
    v_mov_b64 v[30:31], 0
    v_mfma_f32_16x16x32_bf16 v[76:79], v[84:87], v[96:99], v[76:79]
    v_mfma_f32_16x16x32_bf16 v[80:83], v[84:87], v[100:103], v[80:83]
    ds_read_b128 v[56:59], v117 offset:16384
    ds_read_b128 v[60:63], v117 offset:17408
    ds_read_b128 v[64:67], v117 offset:20480
    ds_read_b128 v[68:71], v117 offset:21504
    v_rcp_f32 v74, v74
    v_rcp_f32 v75, v75
    s_nop 0
    v_mul_f32 v78, v78, v74
    v_mul_f32 v79, v79, v75
    v_cvt_pk_bf16_f32 v76, v78, v79
    ds_write_b32 v120, v76 offset:0
    v_mul_f32 v82, v82, v74
    v_mul_f32 v83, v83, v75
    v_cvt_pk_bf16_f32 v80, v82, v83
    ds_write_b32 v120, v80 offset:256
    s_waitcnt lgkmcnt(0)
    s_barrier
    ds_read_b64_tr_b16 v[80:81], v121 offset:0
    ds_read_b64_tr_b16 v[82:83], v121 offset:128
    ds_read_b64_tr_b16 v[84:85], v121 offset:1024
    ds_read_b64_tr_b16 v[86:87], v121 offset:1152
    v_mov_b64 v[8:9], 0
    v_mov_b64 v[10:11], 0
    v_mov_b64 v[12:13], 0
    v_mov_b64 v[14:15], 0
    s_waitcnt lgkmcnt(2)
    s_bfe_i32 s71, s14, 0x10001
    v_smfmac_f32_16x16x64_bf16 v[0:3], v[80:83], v[192:199], v104
    v_smfmac_f32_16x16x64_bf16 v[4:7], v[80:83], v[208:215], v104
    ds_read_b128 v[72:75], v117 offset:18432
    ds_read_b128 v[76:79], v117 offset:19456
    s_waitcnt lgkmcnt(2)
    v_smfmac_f32_16x16x64_bf16 v[0:3], v[84:87], v[200:207], v104
    ds_read_b128 v[32:35], v117 offset:22528
    ds_read_b128 v[36:39], v117 offset:23552
    v_smfmac_f32_16x16x64_bf16 v[4:7], v[84:87], v[216:223], v104
    ds_read_b128 v[40:43], v117 offset:24576
    ds_read_b128 v[44:47], v117 offset:25600
    v_smfmac_f32_16x16x64_bf16 v[8:11], v[80:83], v[224:231], v104
    ds_read_b128 v[48:51], v117 offset:28672
    ds_read_b128 v[52:55], v117 offset:29696
    v_smfmac_f32_16x16x64_bf16 v[12:15], v[80:83], v[240:247], v104
    v_smfmac_f32_16x16x64_bf16 v[8:11], v[84:87], v[232:239], v104
    v_add_f32 v0, v0, v2
    v_add_f32 v1, v1, v3
    v_add_f32 v4, v4, v6
    v_add_f32 v5, v5, v7
    v_smfmac_f32_16x16x64_bf16 v[12:15], v[84:87], v[248:255], v104
    v_cvt_pk_bf16_f32 v0, v0, v1
    v_cvt_pk_bf16_f32 v1, v4, v5
    v_bfi_b32 v0, 1, s71, v0
    buffer_store_dwordx2 v[0:1], v122, s[4:7], s24 offen sc1
    v_smfmac_f32_16x16x64_bf16 v[16:19], v[80:83], v[56:63], v104
    ds_read_b128 v[56:59], v117 offset:26624
    ds_read_b128 v[60:63], v117 offset:27648
    v_smfmac_f32_16x16x64_bf16 v[20:23], v[80:83], v[64:71], v104
    ds_read_b128 v[64:67], v117 offset:30720
    ds_read_b128 v[68:71], v117 offset:31744
    s_waitcnt lgkmcnt(10)
    v_smfmac_f32_16x16x64_bf16 v[16:19], v[84:87], v[72:79], v104
    v_add_f32 v8, v8, v10
    v_add_f32 v9, v9, v11
    v_add_f32 v12, v12, v14
    v_add_f32 v13, v13, v15
    s_waitcnt lgkmcnt(8)
    v_smfmac_f32_16x16x64_bf16 v[20:23], v[84:87], v[32:39], v104
    v_cvt_pk_bf16_f32 v8, v8, v9
    v_cvt_pk_bf16_f32 v9, v12, v13
    v_bfi_b32 v8, 1, s71, v8
    buffer_store_dwordx2 v[8:9], v122, s[4:7], s25 offen sc1
    s_waitcnt lgkmcnt(6)
    v_smfmac_f32_16x16x64_bf16 v[24:27], v[80:83], v[40:47], v104
    s_waitcnt lgkmcnt(4)
    v_smfmac_f32_16x16x64_bf16 v[28:31], v[80:83], v[48:55], v104
    s_waitcnt lgkmcnt(2)
    v_smfmac_f32_16x16x64_bf16 v[24:27], v[84:87], v[56:63], v104
    v_add_f32 v16, v16, v18
    v_add_f32 v17, v17, v19
    v_add_f32 v20, v20, v22
    v_add_f32 v21, v21, v23
    s_waitcnt lgkmcnt(0)
    v_smfmac_f32_16x16x64_bf16 v[28:31], v[84:87], v[64:71], v104
    v_cvt_pk_bf16_f32 v16, v16, v17
    v_cvt_pk_bf16_f32 v17, v20, v21
    v_bfi_b32 v16, 1, s71, v16
    buffer_store_dwordx2 v[16:17], v122, s[4:7], s26 offen sc1
    v_mov_b64 v[32:33], 0
    v_mov_b64 v[34:35], 0
    v_mov_b64 v[36:37], 0
    v_mov_b64 v[38:39], 0
    v_add_f32 v24, v24, v26
    v_add_f32 v25, v25, v27
    v_add_f32 v28, v28, v30
    v_add_f32 v29, v29, v31
    v_cvt_pk_bf16_f32 v24, v24, v25
    v_cvt_pk_bf16_f32 v25, v28, v29
    v_bfi_b32 v24, 1, s71, v24
    buffer_store_dwordx2 v[24:25], v122, s[4:7], s27 offen sc1
    v_mov_b64 v[40:41], 0
    v_mov_b64 v[42:43], 0
    v_mov_b64 v[44:45], 0
    v_mov_b64 v[46:47], 0
    v_mov_b64 v[48:49], 0
    v_mov_b64 v[50:51], 0
    v_mov_b64 v[52:53], 0
    v_mov_b64 v[54:55], 0
    s_mov_b32 s43, 0x100000
    buffer_load_dwordx4 v[56:59], v123, s[4:7], s30 offen sc1
    buffer_load_dwordx4 v[60:63], v123, s[4:7], s31 offen sc1
main_kernel_p1_1_1s:
    s_waitcnt vmcnt(0)
main_kernel_p1_1_1sc:
    v_bitop3_b32 v105, v56, v58, s71 bitop3:0x7e
    v_bitop3_b32 v127, v60, v62, s71 bitop3:0x7e
    v_or_b32 v105, v105, v127
    v_and_b32 v105, 1, v105
    v_cmp_ne_u32 vcc, 0, v105
    s_cbranch_vccz main_kernel_p1_1_1sdone
    s_mov_b64 exec, vcc
    buffer_load_dwordx4 v[56:59], v123, s[4:7], s30 offen sc1
    buffer_load_dwordx4 v[60:63], v123, s[4:7], s31 offen sc1
    s_sub_u32 s43, s43, 1
    s_cbranch_scc0 main_kernel_p1_1_1s
main_kernel_p1_1_1sdone:
    s_mov_b64 exec, -1
    v_mfma_f32_16x16x32_bf16 v[64:67], v[112:115], v[56:59], 0
    v_mfma_f32_16x16x32_bf16 v[64:67], v[112:115], v[60:63], v[64:67]
    v_mov_b64 v[72:73], -1
    v_mov_b64 v[74:75], -1
    s_add_u32 s14, s14, 1
    s_nop 4
    v_add_f32_dpp v68, v64, v64 row_ror:4 row_mask:0xf bank_mask:0xf
    v_add_f32_dpp v69, v65, v65 row_ror:4 row_mask:0xf bank_mask:0xf
    v_add_f32_dpp v70, v66, v66 row_ror:4 row_mask:0xf bank_mask:0xf
    v_add_f32_dpp v71, v67, v67 row_ror:4 row_mask:0xf bank_mask:0xf
    v_add_f32_dpp v64, v68, v68 row_ror:8 row_mask:0xf bank_mask:0xf
    v_add_f32_dpp v65, v69, v69 row_ror:8 row_mask:0xf bank_mask:0xf
    v_add_f32_dpp v66, v70, v70 row_ror:8 row_mask:0xf bank_mask:0xf
    v_add_f32_dpp v67, v71, v71 row_ror:8 row_mask:0xf bank_mask:0xf
    s_mov_b64 exec, s[40:41]
    v_cvt_pk_bf16_f32 v64, v64, v65
    v_cvt_pk_bf16_f32 v65, v66, v67
    buffer_store_dword v64, v125, s[4:7], s32 offen sc1
    buffer_store_dword v65, v125, s[4:7], s32 offen offset:16 sc1
    buffer_store_dword v72, v125, s[4:7], s33 offen sc1
    buffer_store_dword v72, v125, s[4:7], s33 offen offset:16 sc1
    s_mov_b64 exec, -1
    s_add_u32 s15, s14, 2
    s_cmp_lg_u32 s15, s75
    s_cbranch_scc1 main_kernel_nokv1_1s
    v_mov_b32 v127, s69
    buffer_load_dword v126, v127, s[44:47], 0 offen sc1
main_kernel_nokv1_1s:
    s_branch main_kernel_wl1s
main_kernel_wl2s:
    ds_read_b128 v[56:59], v117 offset:8192
    ds_read_b128 v[60:63], v117 offset:9216
    ds_read_b128 v[64:67], v117 offset:10240
    ds_read_b128 v[68:71], v117 offset:11264
    ds_read_b128 v[72:75], v117 offset:0
    ds_read_b128 v[76:79], v117 offset:1024
    ds_read_b128 v[80:83], v117 offset:2048
    ds_read_b128 v[84:87], v117 offset:3072
    s_cmp_eq_u32 s14, 0
    s_cbranch_scc1 main_kernel_m0_2s
    s_mov_b32 s43, 0x100000
    buffer_load_dwordx4 v[16:19], v124, s[4:7], s32 offen sc1
    buffer_load_dwordx4 v[20:23], v124, s[4:7], s32 offen offset:1024 sc1
main_kernel_p2_0_2s:
    s_waitcnt vmcnt(0)
main_kernel_p2_0_2sc:
    v_max3_u32 v105, v16, v17, v18
    v_max3_u32 v127, v19, v20, v21
    v_max3_u32 v105, v22, v23, v105
    v_max_u32 v105, v105, v127
    v_cmp_eq_u32 vcc, -1, v105
    s_cbranch_vccz main_kernel_p2_0_2sdone
    s_mov_b64 exec, vcc
    buffer_load_dwordx4 v[16:19], v124, s[4:7], s32 offen sc1
    buffer_load_dwordx4 v[20:23], v124, s[4:7], s32 offen offset:1024 sc1
    s_sub_u32 s43, s43, 1
    s_cbranch_scc0 main_kernel_p2_0_2s
main_kernel_p2_0_2sdone:
    s_mov_b64 exec, -1
main_kernel_m0done_2s:
    ds_write_b128 v124, v[16:19] offset:16384
    ds_write_b128 v124, v[20:23] offset:17408
    v_smfmac_f32_16x16x64_bf16 v[32:35], v[16:19], a[32:39], v104
    v_smfmac_f32_16x16x64_bf16 v[40:43], v[16:19], a[160:167], v104
    v_smfmac_f32_16x16x64_bf16 v[36:39], v[16:19], a[96:103], v104
    s_waitcnt lgkmcnt(8)
    v_smfmac_f32_16x16x64_bf16 v[44:47], v[16:19], v[56:63], v104
    v_smfmac_f32_16x16x64_bf16 v[48:51], v[16:19], a[224:231], v104
    v_smfmac_f32_16x16x64_bf16 v[52:55], v[16:19], v[160:167], v104
    s_waitcnt lgkmcnt(0)
    s_barrier
    ds_read_b128 v[0:3], v116 offset:16384
    ds_read_b128 v[4:7], v116 offset:17408
    v_smfmac_f32_16x16x64_bf16 v[32:35], v[20:23], a[40:47], v104
    ds_read_b128 v[8:11], v116 offset:18432
    v_smfmac_f32_16x16x64_bf16 v[40:43], v[20:23], a[168:175], v104
    ds_read_b128 v[12:15], v116 offset:19456
    v_smfmac_f32_16x16x64_bf16 v[36:39], v[20:23], a[104:111], v104
    ds_read_b128 v[24:27], v116 offset:22528
    v_smfmac_f32_16x16x64_bf16 v[44:47], v[20:23], v[64:71], v104
    ds_read_b128 v[28:31], v116 offset:23552
    v_smfmac_f32_16x16x64_bf16 v[48:51], v[20:23], a[232:239], v104
    v_smfmac_f32_16x16x64_bf16 v[52:55], v[20:23], v[168:175], v104
    s_waitcnt lgkmcnt(5)
    v_smfmac_f32_16x16x64_bf16 v[32:35], v[0:3], a[0:7], v104
    ds_read_b128 v[56:59], v117 offset:4096
    ds_read_b128 v[60:63], v117 offset:5120
    v_smfmac_f32_16x16x64_bf16 v[40:43], v[0:3], a[128:135], v104
    ds_read_b128 v[64:67], v117 offset:6144
    ds_read_b128 v[68:71], v117 offset:7168
    s_waitcnt lgkmcnt(8)
    v_smfmac_f32_16x16x64_bf16 v[32:35], v[4:7], a[8:15], v104
    s_mov_b32 m0, s68
    s_add_u32 s17, s34, 0x40000
    v_smfmac_f32_16x16x64_bf16 v[40:43], v[4:7], a[136:143], v104
    buffer_load_dwordx4 v124, s[4:7], s34 offen sc1 lds
    s_waitcnt lgkmcnt(7)
    v_smfmac_f32_16x16x64_bf16 v[32:35], v[8:11], a[16:23], v104
    v_smfmac_f32_16x16x64_bf16 v[40:43], v[8:11], a[144:151], v104
    buffer_load_dwordx4 v124, s[4:7], s34 offen offset:1024 sc1 lds
    s_waitcnt lgkmcnt(6)
    v_smfmac_f32_16x16x64_bf16 v[32:35], v[12:15], a[24:31], v104
    v_smfmac_f32_16x16x64_bf16 v[40:43], v[12:15], a[152:159], v104
    buffer_load_dwordx4 v[96:99], v124, s[4:7], s35 offen sc1
    s_waitcnt lgkmcnt(5)
    v_smfmac_f32_16x16x64_bf16 v[32:35], v[24:27], a[48:55], v104
    v_smfmac_f32_16x16x64_bf16 v[40:43], v[24:27], a[176:183], v104
    buffer_load_dwordx4 v[100:103], v124, s[4:7], s35 offen offset:1024 sc1
    s_mov_b32 s34, s17
    s_waitcnt lgkmcnt(4)
    v_smfmac_f32_16x16x64_bf16 v[32:35], v[28:31], a[56:63], v104
    s_add_u32 s35, s35, 0x40000
    v_smfmac_f32_16x16x64_bf16 v[40:43], v[28:31], a[184:191], v104
    v_smfmac_f32_16x16x64_bf16 v[36:39], v[0:3], a[64:71], v104
    v_smfmac_f32_16x16x64_bf16 v[44:47], v[0:3], v[72:79], v104
    ds_read_b128 v[72:75], v117 offset:12288
    ds_read_b128 v[76:79], v117 offset:13312
    v_smfmac_f32_16x16x64_bf16 v[36:39], v[4:7], a[72:79], v104
    v_smfmac_f32_16x16x64_bf16 v[44:47], v[4:7], v[80:87], v104
    ds_read_b128 v[80:83], v117 offset:14336
    ds_read_b128 v[84:87], v117 offset:15360
    v_smfmac_f32_16x16x64_bf16 v[36:39], v[8:11], a[80:87], v104
    v_add_f32 v40, v40, v42
    v_add_f32 v41, v41, v43
    s_waitcnt lgkmcnt(6)
    v_smfmac_f32_16x16x64_bf16 v[44:47], v[8:11], v[56:63], v104
    v_smfmac_f32_16x16x64_bf16 v[36:39], v[12:15], a[88:95], v104
    v_add_f32 v32, v32, v34
    v_add_f32 v33, v33, v35
    s_waitcnt lgkmcnt(4)
    v_smfmac_f32_16x16x64_bf16 v[44:47], v[12:15], v[64:71], v104
    v_smfmac_f32_16x16x64_bf16 v[36:39], v[24:27], a[112:119], v104
    v_cvt_pk_bf16_f32 v40, v40, v41
    v_cvt_pk_bf16_f32 v41, v32, v33
    s_waitcnt lgkmcnt(2)
    v_smfmac_f32_16x16x64_bf16 v[44:47], v[24:27], v[72:79], v104
    v_smfmac_f32_16x16x64_bf16 v[36:39], v[28:31], a[120:127], v104
    ds_write_b64 v118, v[40:41] offset:0
    s_waitcnt lgkmcnt(1)
    v_smfmac_f32_16x16x64_bf16 v[44:47], v[28:31], v[80:87], v104
    ds_read_b128 v[16:19], v116 offset:4096
    ds_read_b128 v[20:23], v116 offset:5120
    v_smfmac_f32_16x16x64_bf16 v[48:51], v[0:3], a[192:199], v104
    v_smfmac_f32_16x16x64_bf16 v[52:55], v[0:3], v[128:135], v104
    ds_read_b128 v[0:3], v116 offset:0
    s_nop 2
    v_add_f32 v44, v44, v46
    v_add_f32 v45, v45, v47
    v_add_f32 v36, v36, v38
    v_add_f32 v37, v37, v39
    v_cvt_pk_bf16_f32 v44, v44, v45
    v_cvt_pk_bf16_f32 v45, v36, v37
    ds_write_b64 v118, v[44:45] offset:512
    v_smfmac_f32_16x16x64_bf16 v[48:51], v[4:7], a[200:207], v104
    v_smfmac_f32_16x16x64_bf16 v[52:55], v[4:7], v[136:143], v104
    ds_read_b128 v[4:7], v116 offset:1024
    s_waitcnt lgkmcnt(1)
    s_barrier
    ds_read_b64_tr_b16 v[32:33], v119 offset:0
    ds_read_b64_tr_b16 v[34:35], v119 offset:512
    ds_read_b64_tr_b16 v[36:37], v119 offset:1024
    ds_read_b64_tr_b16 v[38:39], v119 offset:1536
    v_smfmac_f32_16x16x64_bf16 v[48:51], v[8:11], a[208:215], v104
    ds_read_b64_tr_b16 v[40:41], v119 offset:2048
    ds_read_b64_tr_b16 v[42:43], v119 offset:2560
    v_smfmac_f32_16x16x64_bf16 v[52:55], v[8:11], v[144:151], v104
    ds_read_b64_tr_b16 v[44:45], v119 offset:3072
    ds_read_b64_tr_b16 v[46:47], v119 offset:3584
    ds_read_b128 v[8:11], v116 offset:2048
    v_smfmac_f32_16x16x64_bf16 v[48:51], v[12:15], a[216:223], v104
    v_smfmac_f32_16x16x64_bf16 v[52:55], v[12:15], v[152:159], v104
    ds_read_b128 v[12:15], v116 offset:3072
    v_smfmac_f32_16x16x64_bf16 v[48:51], v[24:27], a[240:247], v104
    v_smfmac_f32_16x16x64_bf16 v[52:55], v[24:27], v[176:183], v104
    ds_read_b128 v[24:27], v116 offset:6144
    v_smfmac_f32_16x16x64_bf16 v[48:51], v[28:31], a[248:255], v104
    v_smfmac_f32_16x16x64_bf16 v[52:55], v[28:31], v[184:191], v104
    ds_read_b128 v[28:31], v116 offset:7168
    s_waitcnt lgkmcnt(4)
    v_mfma_f32_16x16x32_bf16 v[56:59], v[32:35], v[32:35], 0
    v_mfma_f32_16x16x32_bf16 v[64:67], v[16:19], v[32:35], 0
    buffer_store_dwordx4 v[40:43], v116, s[4:7], s36 offen offset:2048 sc1
    s_add_u32 s36, s36, 0x20000
    v_mfma_f32_16x16x32_bf16 v[56:59], v[36:39], v[36:39], v[56:59]
    v_mfma_f32_16x16x32_bf16 v[64:67], v[20:23], v[36:39], v[64:67]
    v_mfma_f32_16x16x32_bf16 v[56:59], v[40:43], v[40:43], v[56:59]
    v_mfma_f32_16x16x32_bf16 v[60:63], v[0:3], v[32:35], 0
    v_cvt_pk_bf16_f32 v48, v48, v49
    v_cvt_pk_bf16_f32 v49, v50, v51
    v_cvt_pk_bf16_f32 v50, v52, v53
    v_cvt_pk_bf16_f32 v51, v54, v55
    v_mfma_f32_16x16x32_bf16 v[56:59], v[44:47], v[44:47], v[56:59]
    v_mfma_f32_16x16x32_bf16 v[60:63], v[4:7], v[36:39], v[60:63]
    buffer_store_dwordx4 v[48:51], v116, s[4:7], s37 offen sc1
    s_add_u32 s37, s37, 0x20000
    s_waitcnt lgkmcnt(3)
    v_mfma_f32_16x16x32_bf16 v[60:63], v[8:11], v[40:43], v[60:63]
    s_waitcnt lgkmcnt(2)
    v_mfma_f32_16x16x32_bf16 v[60:63], v[12:15], v[44:47], v[60:63]
    s_cmp_eq_u32 s14, 63
    s_cbranch_scc1 main_kernel_done
    s_waitcnt lgkmcnt(1)
    v_mfma_f32_16x16x32_bf16 v[64:67], v[24:27], v[40:43], v[64:67]
    s_waitcnt lgkmcnt(0)
    v_mfma_f32_16x16x32_bf16 v[64:67], v[28:31], v[44:47], v[64:67]
    v_mov_b64 v[16:17], 0
    v_mov_b64 v[18:19], 0
    v_mov_b64 v[20:21], 0
    v_mov_b64 v[22:23], 0
    v_max3_f32 v105, v60, v61, v62
    v_max3_f32 v127, v63, v56, v57
    s_nop 1
    v_max3_f32 v127, v64, v65, v127
    v_max3_f32 v105, v66, v67, v105
    v_max_f32 v105, v105, v127
    v_mov_b32 v127, v105
    v_mov_b64 v[0:1], 0
    v_mov_b64 v[2:3], 0
    v_permlane32_swap_b32 v105, v127
    v_max_f32 v105, v105, v127
    v_mov_b32 v127, v105
    v_mov_b64 v[4:5], 0
    v_mov_b64 v[6:7], 0
    v_permlane16_swap_b32 v105, v127
    v_max_f32 v105, v105, v127
    v_mul_f32 v105, s42, v105
    v_fma_f32 v56, v56, s42, -v105
    v_fma_f32 v57, v57, s42, -v105
    v_exp_f32 v56, v56
    v_exp_f32 v57, v57
    v_fma_f32 v60, v60, s42, -v105
    v_fma_f32 v61, v61, s42, -v105
    v_fma_f32 v62, v62, s42, -v105
    v_fma_f32 v63, v63, s42, -v105
    v_fma_f32 v64, v64, s42, -v105
    v_fma_f32 v65, v65, s42, -v105
    v_fma_f32 v66, v66, s42, -v105
    v_fma_f32 v67, v67, s42, -v105
    v_cvt_pk_bf16_f32 v58, v56, v57
    v_cvt_pk_bf16_f32 v59, v56, v57
    v_exp_f32 v60, v60
    v_exp_f32 v61, v61
    v_mfma_f32_16x16x16_bf16 v[72:75], v[58:59], v[110:111], 0
    v_exp_f32 v62, v62
    v_exp_f32 v63, v63
    v_mfma_f32_16x16x16_bf16 v[76:79], v[58:59], v[48:49], 0
    v_exp_f32 v64, v64
    v_exp_f32 v65, v65
    v_mfma_f32_16x16x16_bf16 v[80:83], v[58:59], v[50:51], 0
    v_exp_f32 v66, v66
    v_exp_f32 v67, v67
    v_cvt_pk_bf16_f32 v84, v60, v61
    v_cvt_pk_bf16_f32 v85, v62, v63
    v_cvt_pk_bf16_f32 v86, v64, v65
    v_cvt_pk_bf16_f32 v87, v66, v67
    v_mov_b64 v[24:25], 0
    v_mov_b64 v[26:27], 0
    v_mfma_f32_16x16x32_bf16 v[72:75], v[84:87], v[106:109], v[72:75]
    v_mov_b64 v[28:29], 0
    v_mov_b64 v[30:31], 0
    v_mfma_f32_16x16x32_bf16 v[76:79], v[84:87], v[88:91], v[76:79]
    v_mfma_f32_16x16x32_bf16 v[80:83], v[84:87], v[92:95], v[80:83]
    ds_read_b128 v[56:59], v117 offset:16384
    ds_read_b128 v[60:63], v117 offset:17408
    ds_read_b128 v[64:67], v117 offset:20480
    ds_read_b128 v[68:71], v117 offset:21504
    v_rcp_f32 v74, v74
    v_rcp_f32 v75, v75
    s_nop 0
    v_mul_f32 v78, v78, v74
    v_mul_f32 v79, v79, v75
    v_cvt_pk_bf16_f32 v76, v78, v79
    ds_write_b32 v120, v76 offset:0
    v_mul_f32 v82, v82, v74
    v_mul_f32 v83, v83, v75
    v_cvt_pk_bf16_f32 v80, v82, v83
    ds_write_b32 v120, v80 offset:256
    s_waitcnt lgkmcnt(0)
    s_barrier
    ds_read_b64_tr_b16 v[80:81], v121 offset:0
    ds_read_b64_tr_b16 v[82:83], v121 offset:128
    ds_read_b64_tr_b16 v[84:85], v121 offset:1024
    ds_read_b64_tr_b16 v[86:87], v121 offset:1152
    v_mov_b64 v[8:9], 0
    v_mov_b64 v[10:11], 0
    v_mov_b64 v[12:13], 0
    v_mov_b64 v[14:15], 0
    s_waitcnt lgkmcnt(2)
    s_bfe_i32 s71, s14, 0x10001
    v_smfmac_f32_16x16x64_bf16 v[0:3], v[80:83], v[192:199], v104
    v_smfmac_f32_16x16x64_bf16 v[4:7], v[80:83], v[208:215], v104
    ds_read_b128 v[72:75], v117 offset:18432
    ds_read_b128 v[76:79], v117 offset:19456
    s_waitcnt lgkmcnt(2)
    v_smfmac_f32_16x16x64_bf16 v[0:3], v[84:87], v[200:207], v104
    ds_read_b128 v[32:35], v117 offset:22528
    ds_read_b128 v[36:39], v117 offset:23552
    v_smfmac_f32_16x16x64_bf16 v[4:7], v[84:87], v[216:223], v104
    ds_read_b128 v[40:43], v117 offset:24576
    ds_read_b128 v[44:47], v117 offset:25600
    v_smfmac_f32_16x16x64_bf16 v[8:11], v[80:83], v[224:231], v104
    ds_read_b128 v[48:51], v117 offset:28672
    ds_read_b128 v[52:55], v117 offset:29696
    v_smfmac_f32_16x16x64_bf16 v[12:15], v[80:83], v[240:247], v104
    v_smfmac_f32_16x16x64_bf16 v[8:11], v[84:87], v[232:239], v104
    v_add_f32 v0, v0, v2
    v_add_f32 v1, v1, v3
    v_add_f32 v4, v4, v6
    v_add_f32 v5, v5, v7
    v_smfmac_f32_16x16x64_bf16 v[12:15], v[84:87], v[248:255], v104
    v_cvt_pk_bf16_f32 v0, v0, v1
    v_cvt_pk_bf16_f32 v1, v4, v5
    v_bfi_b32 v0, 1, s71, v0
    buffer_store_dwordx2 v[0:1], v122, s[4:7], s20 offen sc1
    v_smfmac_f32_16x16x64_bf16 v[16:19], v[80:83], v[56:63], v104
    ds_read_b128 v[56:59], v117 offset:26624
    ds_read_b128 v[60:63], v117 offset:27648
    v_smfmac_f32_16x16x64_bf16 v[20:23], v[80:83], v[64:71], v104
    ds_read_b128 v[64:67], v117 offset:30720
    ds_read_b128 v[68:71], v117 offset:31744
    s_waitcnt lgkmcnt(10)
    v_smfmac_f32_16x16x64_bf16 v[16:19], v[84:87], v[72:79], v104
    v_add_f32 v8, v8, v10
    v_add_f32 v9, v9, v11
    v_add_f32 v12, v12, v14
    v_add_f32 v13, v13, v15
    s_waitcnt lgkmcnt(8)
    v_smfmac_f32_16x16x64_bf16 v[20:23], v[84:87], v[32:39], v104
    v_cvt_pk_bf16_f32 v8, v8, v9
    v_cvt_pk_bf16_f32 v9, v12, v13
    v_bfi_b32 v8, 1, s71, v8
    buffer_store_dwordx2 v[8:9], v122, s[4:7], s21 offen sc1
    s_waitcnt lgkmcnt(6)
    v_smfmac_f32_16x16x64_bf16 v[24:27], v[80:83], v[40:47], v104
    s_waitcnt lgkmcnt(4)
    v_smfmac_f32_16x16x64_bf16 v[28:31], v[80:83], v[48:55], v104
    s_waitcnt lgkmcnt(2)
    v_smfmac_f32_16x16x64_bf16 v[24:27], v[84:87], v[56:63], v104
    v_add_f32 v16, v16, v18
    v_add_f32 v17, v17, v19
    v_add_f32 v20, v20, v22
    v_add_f32 v21, v21, v23
    s_waitcnt lgkmcnt(0)
    v_smfmac_f32_16x16x64_bf16 v[28:31], v[84:87], v[64:71], v104
    v_cvt_pk_bf16_f32 v16, v16, v17
    v_cvt_pk_bf16_f32 v17, v20, v21
    v_bfi_b32 v16, 1, s71, v16
    buffer_store_dwordx2 v[16:17], v122, s[4:7], s22 offen sc1
    v_mov_b64 v[32:33], 0
    v_mov_b64 v[34:35], 0
    v_mov_b64 v[36:37], 0
    v_mov_b64 v[38:39], 0
    v_add_f32 v24, v24, v26
    v_add_f32 v25, v25, v27
    v_add_f32 v28, v28, v30
    v_add_f32 v29, v29, v31
    v_cvt_pk_bf16_f32 v24, v24, v25
    v_cvt_pk_bf16_f32 v25, v28, v29
    v_bfi_b32 v24, 1, s71, v24
    buffer_store_dwordx2 v[24:25], v122, s[4:7], s23 offen sc1
    v_mov_b64 v[40:41], 0
    v_mov_b64 v[42:43], 0
    v_mov_b64 v[44:45], 0
    v_mov_b64 v[46:47], 0
    v_mov_b64 v[48:49], 0
    v_mov_b64 v[50:51], 0
    v_mov_b64 v[52:53], 0
    v_mov_b64 v[54:55], 0
    s_mov_b32 s43, 0x100000
    buffer_load_dwordx4 v[56:59], v123, s[4:7], s28 offen sc1
    buffer_load_dwordx4 v[60:63], v123, s[4:7], s29 offen sc1
main_kernel_p1_0_2s:
    s_waitcnt vmcnt(0)
main_kernel_p1_0_2sc:
    v_bitop3_b32 v105, v56, v58, s71 bitop3:0x7e
    v_bitop3_b32 v127, v60, v62, s71 bitop3:0x7e
    v_or_b32 v105, v105, v127
    v_and_b32 v105, 1, v105
    v_cmp_ne_u32 vcc, 0, v105
    s_cbranch_vccz main_kernel_p1_0_2sdone
    s_mov_b64 exec, vcc
    buffer_load_dwordx4 v[56:59], v123, s[4:7], s28 offen sc1
    buffer_load_dwordx4 v[60:63], v123, s[4:7], s29 offen sc1
    s_sub_u32 s43, s43, 1
    s_cbranch_scc0 main_kernel_p1_0_2s
main_kernel_p1_0_2sdone:
    s_mov_b64 exec, -1
    v_mfma_f32_16x16x32_bf16 v[64:67], v[112:115], v[56:59], 0
    v_mfma_f32_16x16x32_bf16 v[64:67], v[112:115], v[60:63], v[64:67]
    v_mov_b64 v[72:73], -1
    v_mov_b64 v[74:75], -1
    s_add_u32 s14, s14, 1
    s_nop 4
    v_add_f32_dpp v68, v64, v64 row_ror:4 row_mask:0xf bank_mask:0xf
    v_add_f32_dpp v69, v65, v65 row_ror:4 row_mask:0xf bank_mask:0xf
    v_add_f32_dpp v70, v66, v66 row_ror:4 row_mask:0xf bank_mask:0xf
    v_add_f32_dpp v71, v67, v67 row_ror:4 row_mask:0xf bank_mask:0xf
    v_add_f32_dpp v64, v68, v68 row_ror:8 row_mask:0xf bank_mask:0xf
    v_add_f32_dpp v65, v69, v69 row_ror:8 row_mask:0xf bank_mask:0xf
    v_add_f32_dpp v66, v70, v70 row_ror:8 row_mask:0xf bank_mask:0xf
    v_add_f32_dpp v67, v71, v71 row_ror:8 row_mask:0xf bank_mask:0xf
    s_mov_b64 exec, s[40:41]
    v_cvt_pk_bf16_f32 v64, v64, v65
    v_cvt_pk_bf16_f32 v65, v66, v67
    buffer_store_dword v64, v125, s[4:7], s33 offen sc1
    buffer_store_dword v65, v125, s[4:7], s33 offen offset:16 sc1
    buffer_store_dword v72, v125, s[4:7], s32 offen sc1
    buffer_store_dword v72, v125, s[4:7], s32 offen offset:16 sc1
    s_mov_b64 exec, -1
    s_add_u32 s15, s14, 1
    s_cmp_lg_u32 s15, s75
    s_cbranch_scc1 main_kernel_nokv0_2s
    v_readfirstlane_b32 s18, v126
    s_nop 0
    s_cmp_ge_u32 s18, 64
    s_cbranch_scc1 main_kernel_kvok0_2s
    s_mov_b32 s43, 0x200000
    v_mov_b32 v127, s69
main_kernel_wkvn2s:
    buffer_load_dword v126, v127, s[44:47], 0 offen sc1
    s_waitcnt vmcnt(0)
    v_readfirstlane_b32 s18, v126
    s_nop 0
    s_cmp_ge_u32 s18, 64
    s_cbranch_scc1 main_kernel_wkvn2s_ok
    s_sleep 2
    s_sub_u32 s43, s43, 1
    s_cbranch_scc0 main_kernel_wkvn2s
main_kernel_wkvn2s_ok:
main_kernel_kvok0_2s:
    s_min_u32 s15, s75, 8
    s_add_u32 s75, s75, s15
    s_add_u32 s69, s69, 4
    s_cmp_ge_u32 s75, 64
    s_cselect_b32 s75, 0x7fff, s75
main_kernel_nokv0_2s:
    ds_read_b128 v[56:59], v117 offset:8192
    ds_read_b128 v[60:63], v117 offset:9216
    ds_read_b128 v[64:67], v117 offset:10240
    ds_read_b128 v[68:71], v117 offset:11264
    ds_read_b128 v[72:75], v117 offset:0
    ds_read_b128 v[76:79], v117 offset:1024
    ds_read_b128 v[80:83], v117 offset:2048
    ds_read_b128 v[84:87], v117 offset:3072
    s_mov_b32 s43, 0x100000
    buffer_load_dwordx4 v[16:19], v124, s[4:7], s33 offen sc1
    buffer_load_dwordx4 v[20:23], v124, s[4:7], s33 offen offset:1024 sc1
main_kernel_p2_1_2s:
    s_waitcnt vmcnt(0)
main_kernel_p2_1_2sc:
    v_max3_u32 v105, v16, v17, v18
    v_max3_u32 v127, v19, v20, v21
    v_max3_u32 v105, v22, v23, v105
    v_max_u32 v105, v105, v127
    v_cmp_eq_u32 vcc, -1, v105
    s_cbranch_vccz main_kernel_p2_1_2sdone
    s_mov_b64 exec, vcc
    buffer_load_dwordx4 v[16:19], v124, s[4:7], s33 offen sc1
    buffer_load_dwordx4 v[20:23], v124, s[4:7], s33 offen offset:1024 sc1
    s_sub_u32 s43, s43, 1
    s_cbranch_scc0 main_kernel_p2_1_2s
main_kernel_p2_1_2sdone:
    s_mov_b64 exec, -1
    ds_write_b128 v124, v[16:19] offset:16384
    ds_write_b128 v124, v[20:23] offset:17408
    v_smfmac_f32_16x16x64_bf16 v[32:35], v[16:19], a[32:39], v104
    v_smfmac_f32_16x16x64_bf16 v[40:43], v[16:19], a[160:167], v104
    v_smfmac_f32_16x16x64_bf16 v[36:39], v[16:19], a[96:103], v104
    s_waitcnt lgkmcnt(8)
    v_smfmac_f32_16x16x64_bf16 v[44:47], v[16:19], v[56:63], v104
    v_smfmac_f32_16x16x64_bf16 v[48:51], v[16:19], a[224:231], v104
    v_smfmac_f32_16x16x64_bf16 v[52:55], v[16:19], v[160:167], v104
    s_waitcnt lgkmcnt(0)
    s_barrier
    ds_read_b128 v[0:3], v116 offset:16384
    ds_read_b128 v[4:7], v116 offset:17408
    v_smfmac_f32_16x16x64_bf16 v[32:35], v[20:23], a[40:47], v104
    ds_read_b128 v[8:11], v116 offset:18432
    v_smfmac_f32_16x16x64_bf16 v[40:43], v[20:23], a[168:175], v104
    ds_read_b128 v[12:15], v116 offset:19456
    v_smfmac_f32_16x16x64_bf16 v[36:39], v[20:23], a[104:111], v104
    ds_read_b128 v[24:27], v116 offset:22528
    v_smfmac_f32_16x16x64_bf16 v[44:47], v[20:23], v[64:71], v104
    ds_read_b128 v[28:31], v116 offset:23552
    v_smfmac_f32_16x16x64_bf16 v[48:51], v[20:23], a[232:239], v104
    v_smfmac_f32_16x16x64_bf16 v[52:55], v[20:23], v[168:175], v104
    s_waitcnt lgkmcnt(5)
    v_smfmac_f32_16x16x64_bf16 v[32:35], v[0:3], a[0:7], v104
    ds_read_b128 v[56:59], v117 offset:4096
    ds_read_b128 v[60:63], v117 offset:5120
    v_smfmac_f32_16x16x64_bf16 v[40:43], v[0:3], a[128:135], v104
    ds_read_b128 v[64:67], v117 offset:6144
    ds_read_b128 v[68:71], v117 offset:7168
    s_waitcnt lgkmcnt(8)
    v_smfmac_f32_16x16x64_bf16 v[32:35], v[4:7], a[8:15], v104
    s_mov_b32 m0, s67
    s_add_u32 s17, s34, 0x40000
    v_smfmac_f32_16x16x64_bf16 v[40:43], v[4:7], a[136:143], v104
    buffer_load_dwordx4 v124, s[4:7], s34 offen sc1 lds
    s_waitcnt lgkmcnt(7)
    v_smfmac_f32_16x16x64_bf16 v[32:35], v[8:11], a[16:23], v104
    v_smfmac_f32_16x16x64_bf16 v[40:43], v[8:11], a[144:151], v104
    buffer_load_dwordx4 v124, s[4:7], s34 offen offset:1024 sc1 lds
    s_waitcnt lgkmcnt(6)
    v_smfmac_f32_16x16x64_bf16 v[32:35], v[12:15], a[24:31], v104
    v_smfmac_f32_16x16x64_bf16 v[40:43], v[12:15], a[152:159], v104
    buffer_load_dwordx4 v[88:91], v124, s[4:7], s35 offen sc1
    s_waitcnt lgkmcnt(5)
    v_smfmac_f32_16x16x64_bf16 v[32:35], v[24:27], a[48:55], v104
    v_smfmac_f32_16x16x64_bf16 v[40:43], v[24:27], a[176:183], v104
    buffer_load_dwordx4 v[92:95], v124, s[4:7], s35 offen offset:1024 sc1
    s_mov_b32 s34, s17
    s_waitcnt lgkmcnt(4)
    v_smfmac_f32_16x16x64_bf16 v[32:35], v[28:31], a[56:63], v104
    s_add_u32 s35, s35, 0x40000
    v_smfmac_f32_16x16x64_bf16 v[40:43], v[28:31], a[184:191], v104
    v_smfmac_f32_16x16x64_bf16 v[36:39], v[0:3], a[64:71], v104
    v_smfmac_f32_16x16x64_bf16 v[44:47], v[0:3], v[72:79], v104
    ds_read_b128 v[72:75], v117 offset:12288
    ds_read_b128 v[76:79], v117 offset:13312
    v_smfmac_f32_16x16x64_bf16 v[36:39], v[4:7], a[72:79], v104
    v_smfmac_f32_16x16x64_bf16 v[44:47], v[4:7], v[80:87], v104
    ds_read_b128 v[80:83], v117 offset:14336
    ds_read_b128 v[84:87], v117 offset:15360
    v_smfmac_f32_16x16x64_bf16 v[36:39], v[8:11], a[80:87], v104
    v_add_f32 v40, v40, v42
    v_add_f32 v41, v41, v43
    s_waitcnt lgkmcnt(6)
    v_smfmac_f32_16x16x64_bf16 v[44:47], v[8:11], v[56:63], v104
    v_smfmac_f32_16x16x64_bf16 v[36:39], v[12:15], a[88:95], v104
    v_add_f32 v32, v32, v34
    v_add_f32 v33, v33, v35
    s_waitcnt lgkmcnt(4)
    v_smfmac_f32_16x16x64_bf16 v[44:47], v[12:15], v[64:71], v104
    v_smfmac_f32_16x16x64_bf16 v[36:39], v[24:27], a[112:119], v104
    v_cvt_pk_bf16_f32 v40, v40, v41
    v_cvt_pk_bf16_f32 v41, v32, v33
    s_waitcnt lgkmcnt(2)
    v_smfmac_f32_16x16x64_bf16 v[44:47], v[24:27], v[72:79], v104
    v_smfmac_f32_16x16x64_bf16 v[36:39], v[28:31], a[120:127], v104
    ds_write_b64 v118, v[40:41] offset:0
    s_waitcnt lgkmcnt(1)
    v_smfmac_f32_16x16x64_bf16 v[44:47], v[28:31], v[80:87], v104
    ds_read_b128 v[16:19], v116 offset:12288
    ds_read_b128 v[20:23], v116 offset:13312
    v_smfmac_f32_16x16x64_bf16 v[48:51], v[0:3], a[192:199], v104
    v_smfmac_f32_16x16x64_bf16 v[52:55], v[0:3], v[128:135], v104
    ds_read_b128 v[0:3], v116 offset:8192
    s_nop 2
    v_add_f32 v44, v44, v46
    v_add_f32 v45, v45, v47
    v_add_f32 v36, v36, v38
    v_add_f32 v37, v37, v39
    v_cvt_pk_bf16_f32 v44, v44, v45
    v_cvt_pk_bf16_f32 v45, v36, v37
    ds_write_b64 v118, v[44:45] offset:512
    v_smfmac_f32_16x16x64_bf16 v[48:51], v[4:7], a[200:207], v104
    v_smfmac_f32_16x16x64_bf16 v[52:55], v[4:7], v[136:143], v104
    ds_read_b128 v[4:7], v116 offset:9216
    s_waitcnt lgkmcnt(1)
    s_barrier
    ds_read_b64_tr_b16 v[32:33], v119 offset:0
    ds_read_b64_tr_b16 v[34:35], v119 offset:512
    ds_read_b64_tr_b16 v[36:37], v119 offset:1024
    ds_read_b64_tr_b16 v[38:39], v119 offset:1536
    v_smfmac_f32_16x16x64_bf16 v[48:51], v[8:11], a[208:215], v104
    ds_read_b64_tr_b16 v[40:41], v119 offset:2048
    ds_read_b64_tr_b16 v[42:43], v119 offset:2560
    v_smfmac_f32_16x16x64_bf16 v[52:55], v[8:11], v[144:151], v104
    ds_read_b64_tr_b16 v[44:45], v119 offset:3072
    ds_read_b64_tr_b16 v[46:47], v119 offset:3584
    ds_read_b128 v[8:11], v116 offset:10240
    v_smfmac_f32_16x16x64_bf16 v[48:51], v[12:15], a[216:223], v104
    v_smfmac_f32_16x16x64_bf16 v[52:55], v[12:15], v[152:159], v104
    ds_read_b128 v[12:15], v116 offset:11264
    v_smfmac_f32_16x16x64_bf16 v[48:51], v[24:27], a[240:247], v104
    v_smfmac_f32_16x16x64_bf16 v[52:55], v[24:27], v[176:183], v104
    ds_read_b128 v[24:27], v116 offset:14336
    v_smfmac_f32_16x16x64_bf16 v[48:51], v[28:31], a[248:255], v104
    v_smfmac_f32_16x16x64_bf16 v[52:55], v[28:31], v[184:191], v104
    ds_read_b128 v[28:31], v116 offset:15360
    s_waitcnt lgkmcnt(4)
    v_mfma_f32_16x16x32_bf16 v[56:59], v[32:35], v[32:35], 0
    v_mfma_f32_16x16x32_bf16 v[64:67], v[16:19], v[32:35], 0
    buffer_store_dwordx4 v[40:43], v116, s[4:7], s36 offen offset:2048 sc1
    s_add_u32 s36, s36, 0x20000
    v_mfma_f32_16x16x32_bf16 v[56:59], v[36:39], v[36:39], v[56:59]
    v_mfma_f32_16x16x32_bf16 v[64:67], v[20:23], v[36:39], v[64:67]
    v_mfma_f32_16x16x32_bf16 v[56:59], v[40:43], v[40:43], v[56:59]
    v_mfma_f32_16x16x32_bf16 v[60:63], v[0:3], v[32:35], 0
    v_cvt_pk_bf16_f32 v48, v48, v49
    v_cvt_pk_bf16_f32 v49, v50, v51
    v_cvt_pk_bf16_f32 v50, v52, v53
    v_cvt_pk_bf16_f32 v51, v54, v55
    v_mfma_f32_16x16x32_bf16 v[56:59], v[44:47], v[44:47], v[56:59]
    v_mfma_f32_16x16x32_bf16 v[60:63], v[4:7], v[36:39], v[60:63]
    buffer_store_dwordx4 v[48:51], v116, s[4:7], s37 offen sc1
    s_add_u32 s37, s37, 0x20000
    s_waitcnt lgkmcnt(3)
    v_mfma_f32_16x16x32_bf16 v[60:63], v[8:11], v[40:43], v[60:63]
    s_waitcnt lgkmcnt(2)
    v_mfma_f32_16x16x32_bf16 v[60:63], v[12:15], v[44:47], v[60:63]
    s_cmp_eq_u32 s14, 63
    s_cbranch_scc1 main_kernel_done
    s_waitcnt lgkmcnt(1)
    v_mfma_f32_16x16x32_bf16 v[64:67], v[24:27], v[40:43], v[64:67]
    s_waitcnt lgkmcnt(0)
    v_mfma_f32_16x16x32_bf16 v[64:67], v[28:31], v[44:47], v[64:67]
    v_mov_b64 v[16:17], 0
    v_mov_b64 v[18:19], 0
    v_mov_b64 v[20:21], 0
    v_mov_b64 v[22:23], 0
    v_max3_f32 v105, v60, v61, v62
    v_max3_f32 v127, v63, v56, v57
    s_nop 1
    v_max3_f32 v127, v64, v65, v127
    v_max3_f32 v105, v66, v67, v105
    v_max_f32 v105, v105, v127
    v_mov_b32 v127, v105
    v_mov_b64 v[0:1], 0
    v_mov_b64 v[2:3], 0
    v_permlane32_swap_b32 v105, v127
    v_max_f32 v105, v105, v127
    v_mov_b32 v127, v105
    v_mov_b64 v[4:5], 0
    v_mov_b64 v[6:7], 0
    v_permlane16_swap_b32 v105, v127
    v_max_f32 v105, v105, v127
    v_mul_f32 v105, s42, v105
    v_fma_f32 v56, v56, s42, -v105
    v_fma_f32 v57, v57, s42, -v105
    v_exp_f32 v56, v56
    v_exp_f32 v57, v57
    v_fma_f32 v60, v60, s42, -v105
    v_fma_f32 v61, v61, s42, -v105
    v_fma_f32 v62, v62, s42, -v105
    v_fma_f32 v63, v63, s42, -v105
    v_fma_f32 v64, v64, s42, -v105
    v_fma_f32 v65, v65, s42, -v105
    v_fma_f32 v66, v66, s42, -v105
    v_fma_f32 v67, v67, s42, -v105
    v_cvt_pk_bf16_f32 v58, v56, v57
    v_cvt_pk_bf16_f32 v59, v56, v57
    v_exp_f32 v60, v60
    v_exp_f32 v61, v61
    v_mfma_f32_16x16x16_bf16 v[72:75], v[58:59], v[110:111], 0
    v_exp_f32 v62, v62
    v_exp_f32 v63, v63
    v_mfma_f32_16x16x16_bf16 v[76:79], v[58:59], v[48:49], 0
    v_exp_f32 v64, v64
    v_exp_f32 v65, v65
    v_mfma_f32_16x16x16_bf16 v[80:83], v[58:59], v[50:51], 0
    v_exp_f32 v66, v66
    v_exp_f32 v67, v67
    v_cvt_pk_bf16_f32 v84, v60, v61
    v_cvt_pk_bf16_f32 v85, v62, v63
    v_cvt_pk_bf16_f32 v86, v64, v65
    v_cvt_pk_bf16_f32 v87, v66, v67
    v_mov_b64 v[24:25], 0
    v_mov_b64 v[26:27], 0
    v_mfma_f32_16x16x32_bf16 v[72:75], v[84:87], v[106:109], v[72:75]
    v_mov_b64 v[28:29], 0
    v_mov_b64 v[30:31], 0
    v_mfma_f32_16x16x32_bf16 v[76:79], v[84:87], v[96:99], v[76:79]
    v_mfma_f32_16x16x32_bf16 v[80:83], v[84:87], v[100:103], v[80:83]
    ds_read_b128 v[56:59], v117 offset:16384
    ds_read_b128 v[60:63], v117 offset:17408
    ds_read_b128 v[64:67], v117 offset:20480
    ds_read_b128 v[68:71], v117 offset:21504
    v_rcp_f32 v74, v74
    v_rcp_f32 v75, v75
    s_nop 0
    v_mul_f32 v78, v78, v74
    v_mul_f32 v79, v79, v75
    v_cvt_pk_bf16_f32 v76, v78, v79
    ds_write_b32 v120, v76 offset:0
    v_mul_f32 v82, v82, v74
    v_mul_f32 v83, v83, v75
    v_cvt_pk_bf16_f32 v80, v82, v83
    ds_write_b32 v120, v80 offset:256
    s_waitcnt lgkmcnt(0)
    s_barrier
    ds_read_b64_tr_b16 v[80:81], v121 offset:0
    ds_read_b64_tr_b16 v[82:83], v121 offset:128
    ds_read_b64_tr_b16 v[84:85], v121 offset:1024
    ds_read_b64_tr_b16 v[86:87], v121 offset:1152
    v_mov_b64 v[8:9], 0
    v_mov_b64 v[10:11], 0
    v_mov_b64 v[12:13], 0
    v_mov_b64 v[14:15], 0
    s_waitcnt lgkmcnt(2)
    s_bfe_i32 s71, s14, 0x10001
    v_smfmac_f32_16x16x64_bf16 v[0:3], v[80:83], v[192:199], v104
    v_smfmac_f32_16x16x64_bf16 v[4:7], v[80:83], v[208:215], v104
    ds_read_b128 v[72:75], v117 offset:18432
    ds_read_b128 v[76:79], v117 offset:19456
    s_waitcnt lgkmcnt(2)
    v_smfmac_f32_16x16x64_bf16 v[0:3], v[84:87], v[200:207], v104
    ds_read_b128 v[32:35], v117 offset:22528
    ds_read_b128 v[36:39], v117 offset:23552
    v_smfmac_f32_16x16x64_bf16 v[4:7], v[84:87], v[216:223], v104
    ds_read_b128 v[40:43], v117 offset:24576
    ds_read_b128 v[44:47], v117 offset:25600
    v_smfmac_f32_16x16x64_bf16 v[8:11], v[80:83], v[224:231], v104
    ds_read_b128 v[48:51], v117 offset:28672
    ds_read_b128 v[52:55], v117 offset:29696
    v_smfmac_f32_16x16x64_bf16 v[12:15], v[80:83], v[240:247], v104
    v_smfmac_f32_16x16x64_bf16 v[8:11], v[84:87], v[232:239], v104
    v_add_f32 v0, v0, v2
    v_add_f32 v1, v1, v3
    v_add_f32 v4, v4, v6
    v_add_f32 v5, v5, v7
    v_smfmac_f32_16x16x64_bf16 v[12:15], v[84:87], v[248:255], v104
    v_cvt_pk_bf16_f32 v0, v0, v1
    v_cvt_pk_bf16_f32 v1, v4, v5
    v_bfi_b32 v0, 1, s71, v0
    buffer_store_dwordx2 v[0:1], v122, s[4:7], s24 offen sc1
    v_smfmac_f32_16x16x64_bf16 v[16:19], v[80:83], v[56:63], v104
    ds_read_b128 v[56:59], v117 offset:26624
    ds_read_b128 v[60:63], v117 offset:27648
    v_smfmac_f32_16x16x64_bf16 v[20:23], v[80:83], v[64:71], v104
    ds_read_b128 v[64:67], v117 offset:30720
    ds_read_b128 v[68:71], v117 offset:31744
    s_waitcnt lgkmcnt(10)
    v_smfmac_f32_16x16x64_bf16 v[16:19], v[84:87], v[72:79], v104
    v_add_f32 v8, v8, v10
    v_add_f32 v9, v9, v11
    v_add_f32 v12, v12, v14
    v_add_f32 v13, v13, v15
    s_waitcnt lgkmcnt(8)
    v_smfmac_f32_16x16x64_bf16 v[20:23], v[84:87], v[32:39], v104
    v_cvt_pk_bf16_f32 v8, v8, v9
    v_cvt_pk_bf16_f32 v9, v12, v13
    v_bfi_b32 v8, 1, s71, v8
    buffer_store_dwordx2 v[8:9], v122, s[4:7], s25 offen sc1
    s_waitcnt lgkmcnt(6)
    v_smfmac_f32_16x16x64_bf16 v[24:27], v[80:83], v[40:47], v104
    s_waitcnt lgkmcnt(4)
    v_smfmac_f32_16x16x64_bf16 v[28:31], v[80:83], v[48:55], v104
    s_waitcnt lgkmcnt(2)
    v_smfmac_f32_16x16x64_bf16 v[24:27], v[84:87], v[56:63], v104
    v_add_f32 v16, v16, v18
    v_add_f32 v17, v17, v19
    v_add_f32 v20, v20, v22
    v_add_f32 v21, v21, v23
    s_waitcnt lgkmcnt(0)
    v_smfmac_f32_16x16x64_bf16 v[28:31], v[84:87], v[64:71], v104
    v_cvt_pk_bf16_f32 v16, v16, v17
    v_cvt_pk_bf16_f32 v17, v20, v21
    v_bfi_b32 v16, 1, s71, v16
    buffer_store_dwordx2 v[16:17], v122, s[4:7], s26 offen sc1
    v_mov_b64 v[32:33], 0
    v_mov_b64 v[34:35], 0
    v_mov_b64 v[36:37], 0
    v_mov_b64 v[38:39], 0
    v_add_f32 v24, v24, v26
    v_add_f32 v25, v25, v27
    v_add_f32 v28, v28, v30
    v_add_f32 v29, v29, v31
    v_cvt_pk_bf16_f32 v24, v24, v25
    v_cvt_pk_bf16_f32 v25, v28, v29
    v_bfi_b32 v24, 1, s71, v24
    buffer_store_dwordx2 v[24:25], v122, s[4:7], s27 offen sc1
    v_mov_b64 v[40:41], 0
    v_mov_b64 v[42:43], 0
    v_mov_b64 v[44:45], 0
    v_mov_b64 v[46:47], 0
    v_mov_b64 v[48:49], 0
    v_mov_b64 v[50:51], 0
    v_mov_b64 v[52:53], 0
    v_mov_b64 v[54:55], 0
    s_mov_b32 s43, 0x100000
    buffer_load_dwordx4 v[56:59], v123, s[4:7], s30 offen sc1
    buffer_load_dwordx4 v[60:63], v123, s[4:7], s31 offen sc1
main_kernel_p1_1_2s:
    s_waitcnt vmcnt(0)
main_kernel_p1_1_2sc:
    v_bitop3_b32 v105, v56, v58, s71 bitop3:0x7e
    v_bitop3_b32 v127, v60, v62, s71 bitop3:0x7e
    v_or_b32 v105, v105, v127
    v_and_b32 v105, 1, v105
    v_cmp_ne_u32 vcc, 0, v105
    s_cbranch_vccz main_kernel_p1_1_2sdone
    s_mov_b64 exec, vcc
    buffer_load_dwordx4 v[56:59], v123, s[4:7], s30 offen sc1
    buffer_load_dwordx4 v[60:63], v123, s[4:7], s31 offen sc1
    s_sub_u32 s43, s43, 1
    s_cbranch_scc0 main_kernel_p1_1_2s
main_kernel_p1_1_2sdone:
    s_mov_b64 exec, -1
    v_mfma_f32_16x16x32_bf16 v[64:67], v[112:115], v[56:59], 0
    v_mfma_f32_16x16x32_bf16 v[64:67], v[112:115], v[60:63], v[64:67]
    v_mov_b64 v[72:73], -1
    v_mov_b64 v[74:75], -1
    s_add_u32 s14, s14, 1
    s_nop 4
    v_add_f32_dpp v68, v64, v64 row_ror:4 row_mask:0xf bank_mask:0xf
    v_add_f32_dpp v69, v65, v65 row_ror:4 row_mask:0xf bank_mask:0xf
    v_add_f32_dpp v70, v66, v66 row_ror:4 row_mask:0xf bank_mask:0xf
    v_add_f32_dpp v71, v67, v67 row_ror:4 row_mask:0xf bank_mask:0xf
    v_add_f32_dpp v64, v68, v68 row_ror:8 row_mask:0xf bank_mask:0xf
    v_add_f32_dpp v65, v69, v69 row_ror:8 row_mask:0xf bank_mask:0xf
    v_add_f32_dpp v66, v70, v70 row_ror:8 row_mask:0xf bank_mask:0xf
    v_add_f32_dpp v67, v71, v71 row_ror:8 row_mask:0xf bank_mask:0xf
    s_mov_b64 exec, s[40:41]
    v_cvt_pk_bf16_f32 v64, v64, v65
    v_cvt_pk_bf16_f32 v65, v66, v67
    buffer_store_dword v64, v125, s[4:7], s32 offen sc1
    buffer_store_dword v65, v125, s[4:7], s32 offen offset:16 sc1
    buffer_store_dword v72, v125, s[4:7], s33 offen sc1
    buffer_store_dword v72, v125, s[4:7], s33 offen offset:16 sc1
    s_mov_b64 exec, -1
    s_add_u32 s15, s14, 2
    s_cmp_lg_u32 s15, s75
    s_cbranch_scc1 main_kernel_nokv1_2s
    v_mov_b32 v127, s69
    buffer_load_dword v126, v127, s[44:47], 0 offen sc1
main_kernel_nokv1_2s:
    s_branch main_kernel_wl2s
main_kernel_wl3s:
    ds_read_b128 v[56:59], v117 offset:12288
    ds_read_b128 v[60:63], v117 offset:13312
    ds_read_b128 v[64:67], v117 offset:14336
    ds_read_b128 v[68:71], v117 offset:15360
    ds_read_b128 v[72:75], v117 offset:0
    ds_read_b128 v[76:79], v117 offset:1024
    ds_read_b128 v[80:83], v117 offset:2048
    ds_read_b128 v[84:87], v117 offset:3072
    s_cmp_eq_u32 s14, 0
    s_cbranch_scc1 main_kernel_m0_3s
    s_mov_b32 s43, 0x100000
    buffer_load_dwordx4 v[24:27], v124, s[4:7], s32 offen sc1
    buffer_load_dwordx4 v[28:31], v124, s[4:7], s32 offen offset:1024 sc1
main_kernel_p2_0_3s:
    s_waitcnt vmcnt(0)
main_kernel_p2_0_3sc:
    v_max3_u32 v105, v24, v25, v26
    v_max3_u32 v127, v27, v28, v29
    v_max3_u32 v105, v30, v31, v105
    v_max_u32 v105, v105, v127
    v_cmp_eq_u32 vcc, -1, v105
    s_cbranch_vccz main_kernel_p2_0_3sdone
    s_mov_b64 exec, vcc
    buffer_load_dwordx4 v[24:27], v124, s[4:7], s32 offen sc1
    buffer_load_dwordx4 v[28:31], v124, s[4:7], s32 offen offset:1024 sc1
    s_sub_u32 s43, s43, 1
    s_cbranch_scc0 main_kernel_p2_0_3s
main_kernel_p2_0_3sdone:
    s_mov_b64 exec, -1
main_kernel_m0done_3s:
    ds_write_b128 v124, v[24:27] offset:16384
    ds_write_b128 v124, v[28:31] offset:17408
    v_smfmac_f32_16x16x64_bf16 v[32:35], v[24:27], a[48:55], v104
    v_smfmac_f32_16x16x64_bf16 v[40:43], v[24:27], a[176:183], v104
    v_smfmac_f32_16x16x64_bf16 v[36:39], v[24:27], a[112:119], v104
    s_waitcnt lgkmcnt(8)
    v_smfmac_f32_16x16x64_bf16 v[44:47], v[24:27], v[56:63], v104
    v_smfmac_f32_16x16x64_bf16 v[48:51], v[24:27], a[240:247], v104
    v_smfmac_f32_16x16x64_bf16 v[52:55], v[24:27], v[176:183], v104
    s_waitcnt lgkmcnt(0)
    s_barrier
    ds_read_b128 v[0:3], v116 offset:16384
    ds_read_b128 v[4:7], v116 offset:17408
    v_smfmac_f32_16x16x64_bf16 v[32:35], v[28:31], a[56:63], v104
    ds_read_b128 v[8:11], v116 offset:18432
    v_smfmac_f32_16x16x64_bf16 v[40:43], v[28:31], a[184:191], v104
    ds_read_b128 v[12:15], v116 offset:19456
    v_smfmac_f32_16x16x64_bf16 v[36:39], v[28:31], a[120:127], v104
    ds_read_b128 v[16:19], v116 offset:20480
    v_smfmac_f32_16x16x64_bf16 v[44:47], v[28:31], v[64:71], v104
    ds_read_b128 v[20:23], v116 offset:21504
    v_smfmac_f32_16x16x64_bf16 v[48:51], v[28:31], a[248:255], v104
    v_smfmac_f32_16x16x64_bf16 v[52:55], v[28:31], v[184:191], v104
    s_waitcnt lgkmcnt(5)
    v_smfmac_f32_16x16x64_bf16 v[32:35], v[0:3], a[0:7], v104
    ds_read_b128 v[56:59], v117 offset:4096
    ds_read_b128 v[60:63], v117 offset:5120
    v_smfmac_f32_16x16x64_bf16 v[40:43], v[0:3], a[128:135], v104
    ds_read_b128 v[64:67], v117 offset:6144
    ds_read_b128 v[68:71], v117 offset:7168
    s_waitcnt lgkmcnt(8)
    v_smfmac_f32_16x16x64_bf16 v[32:35], v[4:7], a[8:15], v104
    s_mov_b32 m0, s68
    s_add_u32 s17, s34, 0x40000
    v_smfmac_f32_16x16x64_bf16 v[40:43], v[4:7], a[136:143], v104
    buffer_load_dwordx4 v124, s[4:7], s34 offen sc1 lds
    s_waitcnt lgkmcnt(7)
    v_smfmac_f32_16x16x64_bf16 v[32:35], v[8:11], a[16:23], v104
    v_smfmac_f32_16x16x64_bf16 v[40:43], v[8:11], a[144:151], v104
    buffer_load_dwordx4 v124, s[4:7], s34 offen offset:1024 sc1 lds
    s_waitcnt lgkmcnt(6)
    v_smfmac_f32_16x16x64_bf16 v[32:35], v[12:15], a[24:31], v104
    v_smfmac_f32_16x16x64_bf16 v[40:43], v[12:15], a[152:159], v104
    buffer_load_dwordx4 v[96:99], v124, s[4:7], s35 offen sc1
    s_waitcnt lgkmcnt(5)
    v_smfmac_f32_16x16x64_bf16 v[32:35], v[16:19], a[32:39], v104
    v_smfmac_f32_16x16x64_bf16 v[40:43], v[16:19], a[160:167], v104
    buffer_load_dwordx4 v[100:103], v124, s[4:7], s35 offen offset:1024 sc1
    s_mov_b32 s34, s17
    s_waitcnt lgkmcnt(4)
    v_smfmac_f32_16x16x64_bf16 v[32:35], v[20:23], a[40:47], v104
    s_add_u32 s35, s35, 0x40000
    v_smfmac_f32_16x16x64_bf16 v[40:43], v[20:23], a[168:175], v104
    v_smfmac_f32_16x16x64_bf16 v[36:39], v[0:3], a[64:71], v104
    v_smfmac_f32_16x16x64_bf16 v[44:47], v[0:3], v[72:79], v104
    ds_read_b128 v[72:75], v117 offset:8192
    ds_read_b128 v[76:79], v117 offset:9216
    v_smfmac_f32_16x16x64_bf16 v[36:39], v[4:7], a[72:79], v104
    v_smfmac_f32_16x16x64_bf16 v[44:47], v[4:7], v[80:87], v104
    ds_read_b128 v[80:83], v117 offset:10240
    ds_read_b128 v[84:87], v117 offset:11264
    v_smfmac_f32_16x16x64_bf16 v[36:39], v[8:11], a[80:87], v104
    v_add_f32 v40, v40, v42
    v_add_f32 v41, v41, v43
    s_waitcnt lgkmcnt(6)
    v_smfmac_f32_16x16x64_bf16 v[44:47], v[8:11], v[56:63], v104
    v_smfmac_f32_16x16x64_bf16 v[36:39], v[12:15], a[88:95], v104
    v_add_f32 v32, v32, v34
    v_add_f32 v33, v33, v35
    s_waitcnt lgkmcnt(4)
    v_smfmac_f32_16x16x64_bf16 v[44:47], v[12:15], v[64:71], v104
    v_smfmac_f32_16x16x64_bf16 v[36:39], v[16:19], a[96:103], v104
    v_cvt_pk_bf16_f32 v40, v40, v41
    v_cvt_pk_bf16_f32 v41, v32, v33
    s_waitcnt lgkmcnt(2)
    v_smfmac_f32_16x16x64_bf16 v[44:47], v[16:19], v[72:79], v104
    v_smfmac_f32_16x16x64_bf16 v[36:39], v[20:23], a[104:111], v104
    ds_write_b64 v118, v[40:41] offset:0
    s_waitcnt lgkmcnt(1)
    v_smfmac_f32_16x16x64_bf16 v[44:47], v[20:23], v[80:87], v104
    ds_read_b128 v[24:27], v116 offset:6144
    ds_read_b128 v[28:31], v116 offset:7168
    v_smfmac_f32_16x16x64_bf16 v[48:51], v[0:3], a[192:199], v104
    v_smfmac_f32_16x16x64_bf16 v[52:55], v[0:3], v[128:135], v104
    ds_read_b128 v[0:3], v116 offset:0
    s_nop 2
    v_add_f32 v44, v44, v46
    v_add_f32 v45, v45, v47
    v_add_f32 v36, v36, v38
    v_add_f32 v37, v37, v39
    v_cvt_pk_bf16_f32 v44, v44, v45
    v_cvt_pk_bf16_f32 v45, v36, v37
    ds_write_b64 v118, v[44:45] offset:512
    v_smfmac_f32_16x16x64_bf16 v[48:51], v[4:7], a[200:207], v104
    v_smfmac_f32_16x16x64_bf16 v[52:55], v[4:7], v[136:143], v104
    ds_read_b128 v[4:7], v116 offset:1024
    s_waitcnt lgkmcnt(1)
    s_barrier
    ds_read_b64_tr_b16 v[32:33], v119 offset:0
    ds_read_b64_tr_b16 v[34:35], v119 offset:512
    ds_read_b64_tr_b16 v[36:37], v119 offset:1024
    ds_read_b64_tr_b16 v[38:39], v119 offset:1536
    v_smfmac_f32_16x16x64_bf16 v[48:51], v[8:11], a[208:215], v104
    ds_read_b64_tr_b16 v[40:41], v119 offset:2048
    ds_read_b64_tr_b16 v[42:43], v119 offset:2560
    v_smfmac_f32_16x16x64_bf16 v[52:55], v[8:11], v[144:151], v104
    ds_read_b64_tr_b16 v[44:45], v119 offset:3072
    ds_read_b64_tr_b16 v[46:47], v119 offset:3584
    ds_read_b128 v[8:11], v116 offset:2048
    v_smfmac_f32_16x16x64_bf16 v[48:51], v[12:15], a[216:223], v104
    v_smfmac_f32_16x16x64_bf16 v[52:55], v[12:15], v[152:159], v104
    ds_read_b128 v[12:15], v116 offset:3072
    v_smfmac_f32_16x16x64_bf16 v[48:51], v[16:19], a[224:231], v104
    v_smfmac_f32_16x16x64_bf16 v[52:55], v[16:19], v[160:167], v104
    ds_read_b128 v[16:19], v116 offset:4096
    v_smfmac_f32_16x16x64_bf16 v[48:51], v[20:23], a[232:239], v104
    v_smfmac_f32_16x16x64_bf16 v[52:55], v[20:23], v[168:175], v104
    ds_read_b128 v[20:23], v116 offset:5120
    s_waitcnt lgkmcnt(4)
    v_mfma_f32_16x16x32_bf16 v[56:59], v[32:35], v[32:35], 0
    v_mfma_f32_16x16x32_bf16 v[64:67], v[24:27], v[40:43], 0
    buffer_store_dwordx4 v[44:47], v116, s[4:7], s36 offen offset:3072 sc1
    s_add_u32 s36, s36, 0x20000
    v_mfma_f32_16x16x32_bf16 v[56:59], v[36:39], v[36:39], v[56:59]
    v_mfma_f32_16x16x32_bf16 v[64:67], v[28:31], v[44:47], v[64:67]
    v_mfma_f32_16x16x32_bf16 v[56:59], v[40:43], v[40:43], v[56:59]
    v_mfma_f32_16x16x32_bf16 v[60:63], v[0:3], v[32:35], 0
    v_cvt_pk_bf16_f32 v48, v48, v49
    v_cvt_pk_bf16_f32 v49, v50, v51
    v_cvt_pk_bf16_f32 v50, v52, v53
    v_cvt_pk_bf16_f32 v51, v54, v55
    v_mfma_f32_16x16x32_bf16 v[56:59], v[44:47], v[44:47], v[56:59]
    v_mfma_f32_16x16x32_bf16 v[60:63], v[4:7], v[36:39], v[60:63]
    buffer_store_dwordx4 v[48:51], v116, s[4:7], s37 offen sc1
    s_add_u32 s37, s37, 0x20000
    s_waitcnt lgkmcnt(3)
    v_mfma_f32_16x16x32_bf16 v[60:63], v[8:11], v[40:43], v[60:63]
    s_waitcnt lgkmcnt(2)
    v_mfma_f32_16x16x32_bf16 v[60:63], v[12:15], v[44:47], v[60:63]
    s_cmp_eq_u32 s14, 63
    s_cbranch_scc1 main_kernel_done
    s_waitcnt lgkmcnt(1)
    v_mfma_f32_16x16x32_bf16 v[64:67], v[16:19], v[32:35], v[64:67]
    s_waitcnt lgkmcnt(0)
    v_mfma_f32_16x16x32_bf16 v[64:67], v[20:23], v[36:39], v[64:67]
    s_nop 1
    v_max3_f32 v105, v60, v61, v62
    v_max3_f32 v127, v63, v56, v57
    s_nop 3
    v_max3_f32 v127, v64, v65, v127
    v_max3_f32 v105, v66, v67, v105
    v_max_f32 v105, v105, v127
    v_mov_b32 v127, v105
    v_mov_b64 v[0:1], 0
    v_mov_b64 v[2:3], 0
    v_permlane32_swap_b32 v105, v127
    v_max_f32 v105, v105, v127
    v_mov_b32 v127, v105
    v_mov_b64 v[4:5], 0
    v_mov_b64 v[6:7], 0
    v_permlane16_swap_b32 v105, v127
    v_max_f32 v105, v105, v127
    v_mul_f32 v105, s42, v105
    v_fma_f32 v56, v56, s42, -v105
    v_fma_f32 v57, v57, s42, -v105
    v_exp_f32 v56, v56
    v_exp_f32 v57, v57
    v_fma_f32 v60, v60, s42, -v105
    v_fma_f32 v61, v61, s42, -v105
    v_fma_f32 v62, v62, s42, -v105
    v_fma_f32 v63, v63, s42, -v105
    v_fma_f32 v64, v64, s42, -v105
    v_fma_f32 v65, v65, s42, -v105
    v_fma_f32 v66, v66, s42, -v105
    v_fma_f32 v67, v67, s42, -v105
    v_cvt_pk_bf16_f32 v58, v56, v57
    v_cvt_pk_bf16_f32 v59, v56, v57
    v_exp_f32 v60, v60
    v_exp_f32 v61, v61
    v_mfma_f32_16x16x16_bf16 v[72:75], v[58:59], v[110:111], 0
    v_exp_f32 v62, v62
    v_exp_f32 v63, v63
    v_mfma_f32_16x16x16_bf16 v[76:79], v[58:59], v[48:49], 0
    v_exp_f32 v64, v64
    v_exp_f32 v65, v65
    v_mfma_f32_16x16x16_bf16 v[80:83], v[58:59], v[50:51], 0
    v_exp_f32 v66, v66
    v_exp_f32 v67, v67
    v_cvt_pk_bf16_f32 v84, v60, v61
    v_cvt_pk_bf16_f32 v85, v62, v63
    v_cvt_pk_bf16_f32 v86, v64, v65
    v_cvt_pk_bf16_f32 v87, v66, v67
    v_mov_b64 v[24:25], 0
    v_mov_b64 v[26:27], 0
    v_mfma_f32_16x16x32_bf16 v[72:75], v[84:87], v[106:109], v[72:75]
    v_mov_b64 v[28:29], 0
    v_mov_b64 v[30:31], 0
    v_mfma_f32_16x16x32_bf16 v[76:79], v[84:87], v[88:91], v[76:79]
    v_mfma_f32_16x16x32_bf16 v[80:83], v[84:87], v[92:95], v[80:83]
    ds_read_b128 v[56:59], v117 offset:16384
    ds_read_b128 v[60:63], v117 offset:17408
    ds_read_b128 v[64:67], v117 offset:20480
    ds_read_b128 v[68:71], v117 offset:21504
    v_rcp_f32 v74, v74
    v_rcp_f32 v75, v75
    s_nop 0
    v_mul_f32 v78, v78, v74
    v_mul_f32 v79, v79, v75
    v_cvt_pk_bf16_f32 v76, v78, v79
    ds_write_b32 v120, v76 offset:0
    v_mul_f32 v82, v82, v74
    v_mul_f32 v83, v83, v75
    v_cvt_pk_bf16_f32 v80, v82, v83
    ds_write_b32 v120, v80 offset:256
    v_mov_b64 v[16:17], 0
    v_mov_b64 v[18:19], 0
    v_mov_b64 v[20:21], 0
    v_mov_b64 v[22:23], 0
    s_waitcnt lgkmcnt(0)
    s_barrier
    ds_read_b64_tr_b16 v[80:81], v121 offset:0
    ds_read_b64_tr_b16 v[82:83], v121 offset:128
    ds_read_b64_tr_b16 v[84:85], v121 offset:1024
    ds_read_b64_tr_b16 v[86:87], v121 offset:1152
    v_mov_b64 v[8:9], 0
    v_mov_b64 v[10:11], 0
    v_mov_b64 v[12:13], 0
    v_mov_b64 v[14:15], 0
    s_waitcnt lgkmcnt(2)
    s_bfe_i32 s71, s14, 0x10001
    v_smfmac_f32_16x16x64_bf16 v[0:3], v[80:83], v[192:199], v104
    v_smfmac_f32_16x16x64_bf16 v[4:7], v[80:83], v[208:215], v104
    ds_read_b128 v[72:75], v117 offset:18432
    ds_read_b128 v[76:79], v117 offset:19456
    s_waitcnt lgkmcnt(2)
    v_smfmac_f32_16x16x64_bf16 v[0:3], v[84:87], v[200:207], v104
    ds_read_b128 v[32:35], v117 offset:22528
    ds_read_b128 v[36:39], v117 offset:23552
    v_smfmac_f32_16x16x64_bf16 v[4:7], v[84:87], v[216:223], v104
    ds_read_b128 v[40:43], v117 offset:24576
    ds_read_b128 v[44:47], v117 offset:25600
    v_smfmac_f32_16x16x64_bf16 v[8:11], v[80:83], v[224:231], v104
    ds_read_b128 v[48:51], v117 offset:28672
    ds_read_b128 v[52:55], v117 offset:29696
    v_smfmac_f32_16x16x64_bf16 v[12:15], v[80:83], v[240:247], v104
    v_smfmac_f32_16x16x64_bf16 v[8:11], v[84:87], v[232:239], v104
    v_add_f32 v0, v0, v2
    v_add_f32 v1, v1, v3
    v_add_f32 v4, v4, v6
    v_add_f32 v5, v5, v7
    v_smfmac_f32_16x16x64_bf16 v[12:15], v[84:87], v[248:255], v104
    v_cvt_pk_bf16_f32 v0, v0, v1
    v_cvt_pk_bf16_f32 v1, v4, v5
    v_bfi_b32 v0, 1, s71, v0
    buffer_store_dwordx2 v[0:1], v122, s[4:7], s20 offen sc1
    v_smfmac_f32_16x16x64_bf16 v[16:19], v[80:83], v[56:63], v104
    ds_read_b128 v[56:59], v117 offset:26624
    ds_read_b128 v[60:63], v117 offset:27648
    v_smfmac_f32_16x16x64_bf16 v[20:23], v[80:83], v[64:71], v104
    ds_read_b128 v[64:67], v117 offset:30720
    ds_read_b128 v[68:71], v117 offset:31744
    s_waitcnt lgkmcnt(10)
    v_smfmac_f32_16x16x64_bf16 v[16:19], v[84:87], v[72:79], v104
    v_add_f32 v8, v8, v10
    v_add_f32 v9, v9, v11
    v_add_f32 v12, v12, v14
    v_add_f32 v13, v13, v15
    s_waitcnt lgkmcnt(8)
    v_smfmac_f32_16x16x64_bf16 v[20:23], v[84:87], v[32:39], v104
    v_cvt_pk_bf16_f32 v8, v8, v9
    v_cvt_pk_bf16_f32 v9, v12, v13
    v_bfi_b32 v8, 1, s71, v8
    buffer_store_dwordx2 v[8:9], v122, s[4:7], s21 offen sc1
    s_waitcnt lgkmcnt(6)
    v_smfmac_f32_16x16x64_bf16 v[24:27], v[80:83], v[40:47], v104
    s_waitcnt lgkmcnt(4)
    v_smfmac_f32_16x16x64_bf16 v[28:31], v[80:83], v[48:55], v104
    s_waitcnt lgkmcnt(2)
    v_smfmac_f32_16x16x64_bf16 v[24:27], v[84:87], v[56:63], v104
    v_add_f32 v16, v16, v18
    v_add_f32 v17, v17, v19
    v_add_f32 v20, v20, v22
    v_add_f32 v21, v21, v23
    s_waitcnt lgkmcnt(0)
    v_smfmac_f32_16x16x64_bf16 v[28:31], v[84:87], v[64:71], v104
    v_cvt_pk_bf16_f32 v16, v16, v17
    v_cvt_pk_bf16_f32 v17, v20, v21
    v_bfi_b32 v16, 1, s71, v16
    buffer_store_dwordx2 v[16:17], v122, s[4:7], s22 offen sc1
    v_mov_b64 v[32:33], 0
    v_mov_b64 v[34:35], 0
    v_mov_b64 v[36:37], 0
    v_mov_b64 v[38:39], 0
    v_add_f32 v24, v24, v26
    v_add_f32 v25, v25, v27
    v_add_f32 v28, v28, v30
    v_add_f32 v29, v29, v31
    v_cvt_pk_bf16_f32 v24, v24, v25
    v_cvt_pk_bf16_f32 v25, v28, v29
    v_bfi_b32 v24, 1, s71, v24
    buffer_store_dwordx2 v[24:25], v122, s[4:7], s23 offen sc1
    v_mov_b64 v[40:41], 0
    v_mov_b64 v[42:43], 0
    v_mov_b64 v[44:45], 0
    v_mov_b64 v[46:47], 0
    v_mov_b64 v[48:49], 0
    v_mov_b64 v[50:51], 0
    v_mov_b64 v[52:53], 0
    v_mov_b64 v[54:55], 0
    s_mov_b32 s43, 0x100000
    buffer_load_dwordx4 v[56:59], v123, s[4:7], s28 offen sc1
    buffer_load_dwordx4 v[60:63], v123, s[4:7], s29 offen sc1
main_kernel_p1_0_3s:
    s_waitcnt vmcnt(0)
main_kernel_p1_0_3sc:
    v_bitop3_b32 v105, v56, v58, s71 bitop3:0x7e
    v_bitop3_b32 v127, v60, v62, s71 bitop3:0x7e
    v_or_b32 v105, v105, v127
    v_and_b32 v105, 1, v105
    v_cmp_ne_u32 vcc, 0, v105
    s_cbranch_vccz main_kernel_p1_0_3sdone
    s_mov_b64 exec, vcc
    buffer_load_dwordx4 v[56:59], v123, s[4:7], s28 offen sc1
    buffer_load_dwordx4 v[60:63], v123, s[4:7], s29 offen sc1
    s_sub_u32 s43, s43, 1
    s_cbranch_scc0 main_kernel_p1_0_3s
main_kernel_p1_0_3sdone:
    s_mov_b64 exec, -1
    v_mfma_f32_16x16x32_bf16 v[64:67], v[112:115], v[56:59], 0
    v_mfma_f32_16x16x32_bf16 v[64:67], v[112:115], v[60:63], v[64:67]
    v_mov_b64 v[72:73], -1
    v_mov_b64 v[74:75], -1
    s_add_u32 s14, s14, 1
    s_nop 4
    v_add_f32_dpp v68, v64, v64 row_ror:4 row_mask:0xf bank_mask:0xf
    v_add_f32_dpp v69, v65, v65 row_ror:4 row_mask:0xf bank_mask:0xf
    v_add_f32_dpp v70, v66, v66 row_ror:4 row_mask:0xf bank_mask:0xf
    v_add_f32_dpp v71, v67, v67 row_ror:4 row_mask:0xf bank_mask:0xf
    v_add_f32_dpp v64, v68, v68 row_ror:8 row_mask:0xf bank_mask:0xf
    v_add_f32_dpp v65, v69, v69 row_ror:8 row_mask:0xf bank_mask:0xf
    v_add_f32_dpp v66, v70, v70 row_ror:8 row_mask:0xf bank_mask:0xf
    v_add_f32_dpp v67, v71, v71 row_ror:8 row_mask:0xf bank_mask:0xf
    s_mov_b64 exec, s[40:41]
    v_cvt_pk_bf16_f32 v64, v64, v65
    v_cvt_pk_bf16_f32 v65, v66, v67
    buffer_store_dword v64, v125, s[4:7], s33 offen sc1
    buffer_store_dword v65, v125, s[4:7], s33 offen offset:16 sc1
    buffer_store_dword v72, v125, s[4:7], s32 offen sc1
    buffer_store_dword v72, v125, s[4:7], s32 offen offset:16 sc1
    s_mov_b64 exec, -1
    s_add_u32 s15, s14, 1
    s_cmp_lg_u32 s15, s75
    s_cbranch_scc1 main_kernel_nokv0_3s
    v_readfirstlane_b32 s18, v126
    s_nop 0
    s_cmp_ge_u32 s18, 64
    s_cbranch_scc1 main_kernel_kvok0_3s
    s_mov_b32 s43, 0x200000
    v_mov_b32 v127, s69
main_kernel_wkvn3s:
    buffer_load_dword v126, v127, s[44:47], 0 offen sc1
    s_waitcnt vmcnt(0)
    v_readfirstlane_b32 s18, v126
    s_nop 0
    s_cmp_ge_u32 s18, 64
    s_cbranch_scc1 main_kernel_wkvn3s_ok
    s_sleep 2
    s_sub_u32 s43, s43, 1
    s_cbranch_scc0 main_kernel_wkvn3s
main_kernel_wkvn3s_ok:
main_kernel_kvok0_3s:
    s_min_u32 s15, s75, 8
    s_add_u32 s75, s75, s15
    s_add_u32 s69, s69, 4
    s_cmp_ge_u32 s75, 64
    s_cselect_b32 s75, 0x7fff, s75
main_kernel_nokv0_3s:
    ds_read_b128 v[56:59], v117 offset:12288
    ds_read_b128 v[60:63], v117 offset:13312
    ds_read_b128 v[64:67], v117 offset:14336
    ds_read_b128 v[68:71], v117 offset:15360
    ds_read_b128 v[72:75], v117 offset:0
    ds_read_b128 v[76:79], v117 offset:1024
    ds_read_b128 v[80:83], v117 offset:2048
    ds_read_b128 v[84:87], v117 offset:3072
    s_mov_b32 s43, 0x100000
    buffer_load_dwordx4 v[24:27], v124, s[4:7], s33 offen sc1
    buffer_load_dwordx4 v[28:31], v124, s[4:7], s33 offen offset:1024 sc1
main_kernel_p2_1_3s:
    s_waitcnt vmcnt(0)
main_kernel_p2_1_3sc:
    v_max3_u32 v105, v24, v25, v26
    v_max3_u32 v127, v27, v28, v29
    v_max3_u32 v105, v30, v31, v105
    v_max_u32 v105, v105, v127
    v_cmp_eq_u32 vcc, -1, v105
    s_cbranch_vccz main_kernel_p2_1_3sdone
    s_mov_b64 exec, vcc
    buffer_load_dwordx4 v[24:27], v124, s[4:7], s33 offen sc1
    buffer_load_dwordx4 v[28:31], v124, s[4:7], s33 offen offset:1024 sc1
    s_sub_u32 s43, s43, 1
    s_cbranch_scc0 main_kernel_p2_1_3s
main_kernel_p2_1_3sdone:
    s_mov_b64 exec, -1
    ds_write_b128 v124, v[24:27] offset:16384
    ds_write_b128 v124, v[28:31] offset:17408
    v_smfmac_f32_16x16x64_bf16 v[32:35], v[24:27], a[48:55], v104
    v_smfmac_f32_16x16x64_bf16 v[40:43], v[24:27], a[176:183], v104
    v_smfmac_f32_16x16x64_bf16 v[36:39], v[24:27], a[112:119], v104
    s_waitcnt lgkmcnt(8)
    v_smfmac_f32_16x16x64_bf16 v[44:47], v[24:27], v[56:63], v104
    v_smfmac_f32_16x16x64_bf16 v[48:51], v[24:27], a[240:247], v104
    v_smfmac_f32_16x16x64_bf16 v[52:55], v[24:27], v[176:183], v104
    s_waitcnt lgkmcnt(0)
    s_barrier
    ds_read_b128 v[0:3], v116 offset:16384
    ds_read_b128 v[4:7], v116 offset:17408
    v_smfmac_f32_16x16x64_bf16 v[32:35], v[28:31], a[56:63], v104
    ds_read_b128 v[8:11], v116 offset:18432
    v_smfmac_f32_16x16x64_bf16 v[40:43], v[28:31], a[184:191], v104
    ds_read_b128 v[12:15], v116 offset:19456
    v_smfmac_f32_16x16x64_bf16 v[36:39], v[28:31], a[120:127], v104
    ds_read_b128 v[16:19], v116 offset:20480
    v_smfmac_f32_16x16x64_bf16 v[44:47], v[28:31], v[64:71], v104
    ds_read_b128 v[20:23], v116 offset:21504
    v_smfmac_f32_16x16x64_bf16 v[48:51], v[28:31], a[248:255], v104
    v_smfmac_f32_16x16x64_bf16 v[52:55], v[28:31], v[184:191], v104
    s_waitcnt lgkmcnt(5)
    v_smfmac_f32_16x16x64_bf16 v[32:35], v[0:3], a[0:7], v104
    ds_read_b128 v[56:59], v117 offset:4096
    ds_read_b128 v[60:63], v117 offset:5120
    v_smfmac_f32_16x16x64_bf16 v[40:43], v[0:3], a[128:135], v104
    ds_read_b128 v[64:67], v117 offset:6144
    ds_read_b128 v[68:71], v117 offset:7168
    s_waitcnt lgkmcnt(8)
    v_smfmac_f32_16x16x64_bf16 v[32:35], v[4:7], a[8:15], v104
    s_mov_b32 m0, s67
    s_add_u32 s17, s34, 0x40000
    v_smfmac_f32_16x16x64_bf16 v[40:43], v[4:7], a[136:143], v104
    buffer_load_dwordx4 v124, s[4:7], s34 offen sc1 lds
    s_waitcnt lgkmcnt(7)
    v_smfmac_f32_16x16x64_bf16 v[32:35], v[8:11], a[16:23], v104
    v_smfmac_f32_16x16x64_bf16 v[40:43], v[8:11], a[144:151], v104
    buffer_load_dwordx4 v124, s[4:7], s34 offen offset:1024 sc1 lds
    s_waitcnt lgkmcnt(6)
    v_smfmac_f32_16x16x64_bf16 v[32:35], v[12:15], a[24:31], v104
    v_smfmac_f32_16x16x64_bf16 v[40:43], v[12:15], a[152:159], v104
    buffer_load_dwordx4 v[88:91], v124, s[4:7], s35 offen sc1
    s_waitcnt lgkmcnt(5)
    v_smfmac_f32_16x16x64_bf16 v[32:35], v[16:19], a[32:39], v104
    v_smfmac_f32_16x16x64_bf16 v[40:43], v[16:19], a[160:167], v104
    buffer_load_dwordx4 v[92:95], v124, s[4:7], s35 offen offset:1024 sc1
    s_mov_b32 s34, s17
    s_waitcnt lgkmcnt(4)
    v_smfmac_f32_16x16x64_bf16 v[32:35], v[20:23], a[40:47], v104
    s_add_u32 s35, s35, 0x40000
    v_smfmac_f32_16x16x64_bf16 v[40:43], v[20:23], a[168:175], v104
    v_smfmac_f32_16x16x64_bf16 v[36:39], v[0:3], a[64:71], v104
    v_smfmac_f32_16x16x64_bf16 v[44:47], v[0:3], v[72:79], v104
    ds_read_b128 v[72:75], v117 offset:8192
    ds_read_b128 v[76:79], v117 offset:9216
    v_smfmac_f32_16x16x64_bf16 v[36:39], v[4:7], a[72:79], v104
    v_smfmac_f32_16x16x64_bf16 v[44:47], v[4:7], v[80:87], v104
    ds_read_b128 v[80:83], v117 offset:10240
    ds_read_b128 v[84:87], v117 offset:11264
    v_smfmac_f32_16x16x64_bf16 v[36:39], v[8:11], a[80:87], v104
    v_add_f32 v40, v40, v42
    v_add_f32 v41, v41, v43
    s_waitcnt lgkmcnt(6)
    v_smfmac_f32_16x16x64_bf16 v[44:47], v[8:11], v[56:63], v104
    v_smfmac_f32_16x16x64_bf16 v[36:39], v[12:15], a[88:95], v104
    v_add_f32 v32, v32, v34
    v_add_f32 v33, v33, v35
    s_waitcnt lgkmcnt(4)
    v_smfmac_f32_16x16x64_bf16 v[44:47], v[12:15], v[64:71], v104
    v_smfmac_f32_16x16x64_bf16 v[36:39], v[16:19], a[96:103], v104
    v_cvt_pk_bf16_f32 v40, v40, v41
    v_cvt_pk_bf16_f32 v41, v32, v33
    s_waitcnt lgkmcnt(2)
    v_smfmac_f32_16x16x64_bf16 v[44:47], v[16:19], v[72:79], v104
    v_smfmac_f32_16x16x64_bf16 v[36:39], v[20:23], a[104:111], v104
    ds_write_b64 v118, v[40:41] offset:0
    s_waitcnt lgkmcnt(1)
    v_smfmac_f32_16x16x64_bf16 v[44:47], v[20:23], v[80:87], v104
    ds_read_b128 v[24:27], v116 offset:14336
    ds_read_b128 v[28:31], v116 offset:15360
    v_smfmac_f32_16x16x64_bf16 v[48:51], v[0:3], a[192:199], v104
    v_smfmac_f32_16x16x64_bf16 v[52:55], v[0:3], v[128:135], v104
    ds_read_b128 v[0:3], v116 offset:8192
    s_nop 2
    v_add_f32 v44, v44, v46
    v_add_f32 v45, v45, v47
    v_add_f32 v36, v36, v38
    v_add_f32 v37, v37, v39
    v_cvt_pk_bf16_f32 v44, v44, v45
    v_cvt_pk_bf16_f32 v45, v36, v37
    ds_write_b64 v118, v[44:45] offset:512
    v_smfmac_f32_16x16x64_bf16 v[48:51], v[4:7], a[200:207], v104
    v_smfmac_f32_16x16x64_bf16 v[52:55], v[4:7], v[136:143], v104
    ds_read_b128 v[4:7], v116 offset:9216
    s_waitcnt lgkmcnt(1)
    s_barrier
    ds_read_b64_tr_b16 v[32:33], v119 offset:0
    ds_read_b64_tr_b16 v[34:35], v119 offset:512
    ds_read_b64_tr_b16 v[36:37], v119 offset:1024
    ds_read_b64_tr_b16 v[38:39], v119 offset:1536
    v_smfmac_f32_16x16x64_bf16 v[48:51], v[8:11], a[208:215], v104
    ds_read_b64_tr_b16 v[40:41], v119 offset:2048
    ds_read_b64_tr_b16 v[42:43], v119 offset:2560
    v_smfmac_f32_16x16x64_bf16 v[52:55], v[8:11], v[144:151], v104
    ds_read_b64_tr_b16 v[44:45], v119 offset:3072
    ds_read_b64_tr_b16 v[46:47], v119 offset:3584
    ds_read_b128 v[8:11], v116 offset:10240
    v_smfmac_f32_16x16x64_bf16 v[48:51], v[12:15], a[216:223], v104
    v_smfmac_f32_16x16x64_bf16 v[52:55], v[12:15], v[152:159], v104
    ds_read_b128 v[12:15], v116 offset:11264
    v_smfmac_f32_16x16x64_bf16 v[48:51], v[16:19], a[224:231], v104
    v_smfmac_f32_16x16x64_bf16 v[52:55], v[16:19], v[160:167], v104
    ds_read_b128 v[16:19], v116 offset:12288
    v_smfmac_f32_16x16x64_bf16 v[48:51], v[20:23], a[232:239], v104
    v_smfmac_f32_16x16x64_bf16 v[52:55], v[20:23], v[168:175], v104
    ds_read_b128 v[20:23], v116 offset:13312
    s_waitcnt lgkmcnt(4)
    v_mfma_f32_16x16x32_bf16 v[56:59], v[32:35], v[32:35], 0
    v_mfma_f32_16x16x32_bf16 v[64:67], v[24:27], v[40:43], 0
    buffer_store_dwordx4 v[44:47], v116, s[4:7], s36 offen offset:3072 sc1
    s_add_u32 s36, s36, 0x20000
    v_mfma_f32_16x16x32_bf16 v[56:59], v[36:39], v[36:39], v[56:59]
    v_mfma_f32_16x16x32_bf16 v[64:67], v[28:31], v[44:47], v[64:67]
    v_mfma_f32_16x16x32_bf16 v[56:59], v[40:43], v[40:43], v[56:59]
    v_mfma_f32_16x16x32_bf16 v[60:63], v[0:3], v[32:35], 0
    v_cvt_pk_bf16_f32 v48, v48, v49
    v_cvt_pk_bf16_f32 v49, v50, v51
    v_cvt_pk_bf16_f32 v50, v52, v53
    v_cvt_pk_bf16_f32 v51, v54, v55
    v_mfma_f32_16x16x32_bf16 v[56:59], v[44:47], v[44:47], v[56:59]
    v_mfma_f32_16x16x32_bf16 v[60:63], v[4:7], v[36:39], v[60:63]
    buffer_store_dwordx4 v[48:51], v116, s[4:7], s37 offen sc1
    s_add_u32 s37, s37, 0x20000
    s_waitcnt lgkmcnt(3)
    v_mfma_f32_16x16x32_bf16 v[60:63], v[8:11], v[40:43], v[60:63]
    s_waitcnt lgkmcnt(2)
    v_mfma_f32_16x16x32_bf16 v[60:63], v[12:15], v[44:47], v[60:63]
    s_cmp_eq_u32 s14, 63
    s_cbranch_scc1 main_kernel_done
    s_waitcnt lgkmcnt(1)
    v_mfma_f32_16x16x32_bf16 v[64:67], v[16:19], v[32:35], v[64:67]
    s_waitcnt lgkmcnt(0)
    v_mfma_f32_16x16x32_bf16 v[64:67], v[20:23], v[36:39], v[64:67]
    s_nop 1
    v_max3_f32 v105, v60, v61, v62
    v_max3_f32 v127, v63, v56, v57
    s_nop 3
    v_max3_f32 v127, v64, v65, v127
    v_max3_f32 v105, v66, v67, v105
    v_max_f32 v105, v105, v127
    v_mov_b32 v127, v105
    v_mov_b64 v[0:1], 0
    v_mov_b64 v[2:3], 0
    v_permlane32_swap_b32 v105, v127
    v_max_f32 v105, v105, v127
    v_mov_b32 v127, v105
    v_mov_b64 v[4:5], 0
    v_mov_b64 v[6:7], 0
    v_permlane16_swap_b32 v105, v127
    v_max_f32 v105, v105, v127
    v_mul_f32 v105, s42, v105
    v_fma_f32 v56, v56, s42, -v105
    v_fma_f32 v57, v57, s42, -v105
    v_exp_f32 v56, v56
    v_exp_f32 v57, v57
    v_fma_f32 v60, v60, s42, -v105
    v_fma_f32 v61, v61, s42, -v105
    v_fma_f32 v62, v62, s42, -v105
    v_fma_f32 v63, v63, s42, -v105
    v_fma_f32 v64, v64, s42, -v105
    v_fma_f32 v65, v65, s42, -v105
    v_fma_f32 v66, v66, s42, -v105
    v_fma_f32 v67, v67, s42, -v105
    v_cvt_pk_bf16_f32 v58, v56, v57
    v_cvt_pk_bf16_f32 v59, v56, v57
    v_exp_f32 v60, v60
    v_exp_f32 v61, v61
    v_mfma_f32_16x16x16_bf16 v[72:75], v[58:59], v[110:111], 0
    v_exp_f32 v62, v62
    v_exp_f32 v63, v63
    v_mfma_f32_16x16x16_bf16 v[76:79], v[58:59], v[48:49], 0
    v_exp_f32 v64, v64
    v_exp_f32 v65, v65
    v_mfma_f32_16x16x16_bf16 v[80:83], v[58:59], v[50:51], 0
    v_exp_f32 v66, v66
    v_exp_f32 v67, v67
    v_cvt_pk_bf16_f32 v84, v60, v61
    v_cvt_pk_bf16_f32 v85, v62, v63
    v_cvt_pk_bf16_f32 v86, v64, v65
    v_cvt_pk_bf16_f32 v87, v66, v67
    v_mov_b64 v[24:25], 0
    v_mov_b64 v[26:27], 0
    v_mfma_f32_16x16x32_bf16 v[72:75], v[84:87], v[106:109], v[72:75]
    v_mov_b64 v[28:29], 0
    v_mov_b64 v[30:31], 0
    v_mfma_f32_16x16x32_bf16 v[76:79], v[84:87], v[96:99], v[76:79]
    v_mfma_f32_16x16x32_bf16 v[80:83], v[84:87], v[100:103], v[80:83]
    ds_read_b128 v[56:59], v117 offset:16384
    ds_read_b128 v[60:63], v117 offset:17408
    ds_read_b128 v[64:67], v117 offset:20480
    ds_read_b128 v[68:71], v117 offset:21504
    v_rcp_f32 v74, v74
    v_rcp_f32 v75, v75
    s_nop 0
    v_mul_f32 v78, v78, v74
    v_mul_f32 v79, v79, v75
    v_cvt_pk_bf16_f32 v76, v78, v79
    ds_write_b32 v120, v76 offset:0
    v_mul_f32 v82, v82, v74
    v_mul_f32 v83, v83, v75
    v_cvt_pk_bf16_f32 v80, v82, v83
    ds_write_b32 v120, v80 offset:256
    v_mov_b64 v[16:17], 0
    v_mov_b64 v[18:19], 0
    v_mov_b64 v[20:21], 0
    v_mov_b64 v[22:23], 0
    s_waitcnt lgkmcnt(0)
    s_barrier
    ds_read_b64_tr_b16 v[80:81], v121 offset:0
    ds_read_b64_tr_b16 v[82:83], v121 offset:128
    ds_read_b64_tr_b16 v[84:85], v121 offset:1024
    ds_read_b64_tr_b16 v[86:87], v121 offset:1152
    v_mov_b64 v[8:9], 0
    v_mov_b64 v[10:11], 0
    v_mov_b64 v[12:13], 0
    v_mov_b64 v[14:15], 0
    s_waitcnt lgkmcnt(2)
    s_bfe_i32 s71, s14, 0x10001
    v_smfmac_f32_16x16x64_bf16 v[0:3], v[80:83], v[192:199], v104
    v_smfmac_f32_16x16x64_bf16 v[4:7], v[80:83], v[208:215], v104
    ds_read_b128 v[72:75], v117 offset:18432
    ds_read_b128 v[76:79], v117 offset:19456
    s_waitcnt lgkmcnt(2)
    v_smfmac_f32_16x16x64_bf16 v[0:3], v[84:87], v[200:207], v104
    ds_read_b128 v[32:35], v117 offset:22528
    ds_read_b128 v[36:39], v117 offset:23552
    v_smfmac_f32_16x16x64_bf16 v[4:7], v[84:87], v[216:223], v104
    ds_read_b128 v[40:43], v117 offset:24576
    ds_read_b128 v[44:47], v117 offset:25600
    v_smfmac_f32_16x16x64_bf16 v[8:11], v[80:83], v[224:231], v104
    ds_read_b128 v[48:51], v117 offset:28672
    ds_read_b128 v[52:55], v117 offset:29696
    v_smfmac_f32_16x16x64_bf16 v[12:15], v[80:83], v[240:247], v104
    v_smfmac_f32_16x16x64_bf16 v[8:11], v[84:87], v[232:239], v104
    v_add_f32 v0, v0, v2
    v_add_f32 v1, v1, v3
    v_add_f32 v4, v4, v6
    v_add_f32 v5, v5, v7
    v_smfmac_f32_16x16x64_bf16 v[12:15], v[84:87], v[248:255], v104
    v_cvt_pk_bf16_f32 v0, v0, v1
    v_cvt_pk_bf16_f32 v1, v4, v5
    v_bfi_b32 v0, 1, s71, v0
    buffer_store_dwordx2 v[0:1], v122, s[4:7], s24 offen sc1
    v_smfmac_f32_16x16x64_bf16 v[16:19], v[80:83], v[56:63], v104
    ds_read_b128 v[56:59], v117 offset:26624
    ds_read_b128 v[60:63], v117 offset:27648
    v_smfmac_f32_16x16x64_bf16 v[20:23], v[80:83], v[64:71], v104
    ds_read_b128 v[64:67], v117 offset:30720
    ds_read_b128 v[68:71], v117 offset:31744
    s_waitcnt lgkmcnt(10)
    v_smfmac_f32_16x16x64_bf16 v[16:19], v[84:87], v[72:79], v104
    v_add_f32 v8, v8, v10
    v_add_f32 v9, v9, v11
    v_add_f32 v12, v12, v14
    v_add_f32 v13, v13, v15
    s_waitcnt lgkmcnt(8)
    v_smfmac_f32_16x16x64_bf16 v[20:23], v[84:87], v[32:39], v104
    v_cvt_pk_bf16_f32 v8, v8, v9
    v_cvt_pk_bf16_f32 v9, v12, v13
    v_bfi_b32 v8, 1, s71, v8
    buffer_store_dwordx2 v[8:9], v122, s[4:7], s25 offen sc1
    s_waitcnt lgkmcnt(6)
    v_smfmac_f32_16x16x64_bf16 v[24:27], v[80:83], v[40:47], v104
    s_waitcnt lgkmcnt(4)
    v_smfmac_f32_16x16x64_bf16 v[28:31], v[80:83], v[48:55], v104
    s_waitcnt lgkmcnt(2)
    v_smfmac_f32_16x16x64_bf16 v[24:27], v[84:87], v[56:63], v104
    v_add_f32 v16, v16, v18
    v_add_f32 v17, v17, v19
    v_add_f32 v20, v20, v22
    v_add_f32 v21, v21, v23
    s_waitcnt lgkmcnt(0)
    v_smfmac_f32_16x16x64_bf16 v[28:31], v[84:87], v[64:71], v104
    v_cvt_pk_bf16_f32 v16, v16, v17
    v_cvt_pk_bf16_f32 v17, v20, v21
    v_bfi_b32 v16, 1, s71, v16
    buffer_store_dwordx2 v[16:17], v122, s[4:7], s26 offen sc1
    v_mov_b64 v[32:33], 0
    v_mov_b64 v[34:35], 0
    v_mov_b64 v[36:37], 0
    v_mov_b64 v[38:39], 0
    v_add_f32 v24, v24, v26
    v_add_f32 v25, v25, v27
    v_add_f32 v28, v28, v30
    v_add_f32 v29, v29, v31
    v_cvt_pk_bf16_f32 v24, v24, v25
    v_cvt_pk_bf16_f32 v25, v28, v29
    v_bfi_b32 v24, 1, s71, v24
    buffer_store_dwordx2 v[24:25], v122, s[4:7], s27 offen sc1
    v_mov_b64 v[40:41], 0
    v_mov_b64 v[42:43], 0
    v_mov_b64 v[44:45], 0
    v_mov_b64 v[46:47], 0
    v_mov_b64 v[48:49], 0
    v_mov_b64 v[50:51], 0
    v_mov_b64 v[52:53], 0
    v_mov_b64 v[54:55], 0
    s_mov_b32 s43, 0x100000
    buffer_load_dwordx4 v[56:59], v123, s[4:7], s30 offen sc1
    buffer_load_dwordx4 v[60:63], v123, s[4:7], s31 offen sc1
main_kernel_p1_1_3s:
    s_waitcnt vmcnt(0)
main_kernel_p1_1_3sc:
    v_bitop3_b32 v105, v56, v58, s71 bitop3:0x7e
    v_bitop3_b32 v127, v60, v62, s71 bitop3:0x7e
    v_or_b32 v105, v105, v127
    v_and_b32 v105, 1, v105
    v_cmp_ne_u32 vcc, 0, v105
    s_cbranch_vccz main_kernel_p1_1_3sdone
    s_mov_b64 exec, vcc
    buffer_load_dwordx4 v[56:59], v123, s[4:7], s30 offen sc1
    buffer_load_dwordx4 v[60:63], v123, s[4:7], s31 offen sc1
    s_sub_u32 s43, s43, 1
    s_cbranch_scc0 main_kernel_p1_1_3s
main_kernel_p1_1_3sdone:
    s_mov_b64 exec, -1
    v_mfma_f32_16x16x32_bf16 v[64:67], v[112:115], v[56:59], 0
    v_mfma_f32_16x16x32_bf16 v[64:67], v[112:115], v[60:63], v[64:67]
    v_mov_b64 v[72:73], -1
    v_mov_b64 v[74:75], -1
    s_add_u32 s14, s14, 1
    s_nop 4
    v_add_f32_dpp v68, v64, v64 row_ror:4 row_mask:0xf bank_mask:0xf
    v_add_f32_dpp v69, v65, v65 row_ror:4 row_mask:0xf bank_mask:0xf
    v_add_f32_dpp v70, v66, v66 row_ror:4 row_mask:0xf bank_mask:0xf
    v_add_f32_dpp v71, v67, v67 row_ror:4 row_mask:0xf bank_mask:0xf
    v_add_f32_dpp v64, v68, v68 row_ror:8 row_mask:0xf bank_mask:0xf
    v_add_f32_dpp v65, v69, v69 row_ror:8 row_mask:0xf bank_mask:0xf
    v_add_f32_dpp v66, v70, v70 row_ror:8 row_mask:0xf bank_mask:0xf
    v_add_f32_dpp v67, v71, v71 row_ror:8 row_mask:0xf bank_mask:0xf
    s_mov_b64 exec, s[40:41]
    v_cvt_pk_bf16_f32 v64, v64, v65
    v_cvt_pk_bf16_f32 v65, v66, v67
    buffer_store_dword v64, v125, s[4:7], s32 offen sc1
    buffer_store_dword v65, v125, s[4:7], s32 offen offset:16 sc1
    buffer_store_dword v72, v125, s[4:7], s33 offen sc1
    buffer_store_dword v72, v125, s[4:7], s33 offen offset:16 sc1
    s_mov_b64 exec, -1
    s_add_u32 s15, s14, 2
    s_cmp_lg_u32 s15, s75
    s_cbranch_scc1 main_kernel_nokv1_3s
    v_mov_b32 v127, s69
    buffer_load_dword v126, v127, s[44:47], 0 offen sc1
main_kernel_nokv1_3s:
    s_branch main_kernel_wl3s
main_kernel_m0_0:
    v_mov_b64 v[0:1], v[96:97]
    v_mov_b64 v[2:3], v[98:99]
    v_mov_b64 v[4:5], v[100:101]
    v_mov_b64 v[6:7], v[102:103]
    s_nop 0
    s_branch main_kernel_m0done_0
main_kernel_m0_1:
    v_mov_b64 v[8:9], v[96:97]
    v_mov_b64 v[10:11], v[98:99]
    v_mov_b64 v[12:13], v[100:101]
    v_mov_b64 v[14:15], v[102:103]
    s_nop 0
    s_branch main_kernel_m0done_1
main_kernel_m0_2:
    v_mov_b64 v[16:17], v[96:97]
    v_mov_b64 v[18:19], v[98:99]
    v_mov_b64 v[20:21], v[100:101]
    v_mov_b64 v[22:23], v[102:103]
    s_nop 0
    s_branch main_kernel_m0done_2
main_kernel_m0_3:
    v_mov_b64 v[24:25], v[96:97]
    v_mov_b64 v[26:27], v[98:99]
    v_mov_b64 v[28:29], v[100:101]
    v_mov_b64 v[30:31], v[102:103]
    s_nop 0
    s_branch main_kernel_m0done_3
main_kernel_m0_0s:
    v_mov_b64 v[0:1], v[96:97]
    v_mov_b64 v[2:3], v[98:99]
    v_mov_b64 v[4:5], v[100:101]
    v_mov_b64 v[6:7], v[102:103]
    s_nop 0
    s_branch main_kernel_m0done_0s
main_kernel_m0_1s:
    v_mov_b64 v[8:9], v[96:97]
    v_mov_b64 v[10:11], v[98:99]
    v_mov_b64 v[12:13], v[100:101]
    v_mov_b64 v[14:15], v[102:103]
    s_nop 0
    s_branch main_kernel_m0done_1s
main_kernel_m0_2s:
    v_mov_b64 v[16:17], v[96:97]
    v_mov_b64 v[18:19], v[98:99]
    v_mov_b64 v[20:21], v[100:101]
    v_mov_b64 v[22:23], v[102:103]
    s_nop 0
    s_branch main_kernel_m0done_2s
main_kernel_m0_3s:
    v_mov_b64 v[24:25], v[96:97]
    v_mov_b64 v[26:27], v[98:99]
    v_mov_b64 v[28:29], v[100:101]
    v_mov_b64 v[30:31], v[102:103]
    s_nop 0
    s_branch main_kernel_m0done_3s
main_kernel_done:
    s_waitcnt vmcnt(0)
    s_barrier
    s_cmp_lg_u32 s13, 0
    s_cbranch_scc1 main_kernel_fin
    s_mov_b64 exec, 1
    v_mov_b32 v127, 84
    v_mov_b32 v105, 1
    buffer_atomic_add v105, v127, s[44:47], 0 offen
    s_mov_b64 exec, -1
main_kernel_fin:
    s_cmp_eq_u32 s101, 0
    s_cbranch_scc1 main_kernel_exit
    s_barrier
    s_mov_b32 s48, s13
    s_mov_b32 s96, 0
    s_mov_b32 s97, 0
    s_mov_b32 s87, 2
    s_mov_b32 s86, 99
    s_mov_b32 s99, 0
    s_mov_b32 s101, 0
    s_load_dwordx16 s[52:67], s[0:1], 0
    s_load_dwordx2 s[50:51], s[0:1], 152
    s_waitcnt lgkmcnt(0)
    s_mov_b32 s4, s50
    s_and_b32 s5, s51, 0xffff
    s_mov_b32 s6, 0x10000000
    s_mov_b32 s7, 0x00020000
    v_mbcnt_lo_u32_b32 v0, -1, 0
    v_mbcnt_hi_u32_b32 v0, -1, v0
    s_lshl_b32 s16, s48, 6
    v_add_u32 v0, s16, v0
    s_mov_b32 s49, s100
    s_branch main_kernel_nopf
main_kernel_worker:
    s_mov_b32 s48, s13
    s_mov_b32 s96, 0
    s_mov_b32 s97, 0
    s_mov_b32 s87, 0
    s_cmp_lg_u32 s48, 0
    s_cbranch_scc1 main_kernel_nf0
    s_mov_b64 exec, 1
    v_mov_b32 v253, 68
    v_mov_b32 v254, 1
    buffer_atomic_add v254, v253, s[44:47], 0 offen sc0
    s_mov_b64 exec, -1
main_kernel_nf0:
    s_load_dwordx16 s[52:67], s[0:1], 0
    s_load_dwordx2 s[50:51], s[0:1], 152
    s_waitcnt lgkmcnt(0)
    s_mov_b32 s4, s50
    s_and_b32 s5, s51, 0xffff
    s_mov_b32 s6, 0x10000000
    s_mov_b32 s7, 0x00020000
main_kernel_loop:
    v_mbcnt_lo_u32_b32 v0, -1, 0
    v_mbcnt_hi_u32_b32 v0, -1, v0
    s_lshl_b32 s16, s48, 6
    v_add_u32 v0, s16, v0
    v_mov_b32 v2, 163824
    s_cmp_lg_u32 s48, 0
    s_cbranch_scc1 main_kernel_tkw
    s_waitcnt vmcnt(0)
    s_mov_b64 exec, 1
    ds_write_b32 v2, v254
    v_mov_b32 v4, 99
    s_cmp_lg_u32 s87, 1
    s_cbranch_scc1 main_kernel_nocl
    v_mov_b32 v5, 64
    v_mov_b32 v6, 0xff
    v_mov_b32 v7, 0
    buffer_atomic_cmpswap v[6:7], v5, s[44:47], 0 offen sc0
    s_waitcnt vmcnt(0)
    v_readfirstlane_b32 s16, v6
    s_nop 0
    s_cmp_eq_u32 s16, 0
    s_cselect_b32 s16, 0xff, s16
    s_cmp_lg_u32 s16, 0xff
    s_cbranch_scc1 main_kernel_nocl
    v_mov_b32 v4, 1
    v_mov_b32 v5, 92
    buffer_atomic_add v4, v5, s[44:47], 0 offen sc0
    s_waitcnt vmcnt(0)
main_kernel_nocl:
    ds_write_b32 v2, v4 offset:4
    s_waitcnt lgkmcnt(0)
    s_mov_b64 exec, -1
main_kernel_tkw:
    s_barrier
    ds_read_b64 v[4:5], v2
    s_waitcnt lgkmcnt(0)
    v_readfirstlane_b32 s49, v4
    v_readfirstlane_b32 s86, v5
    s_barrier
    s_add_u32 s87, s87, 1
    s_cmp_ge_u32 s86, 32
    s_cbranch_scc1 main_kernel_nocl2
    s_mov_b32 s101, 1
    s_cmp_ge_u32 s49, 1344
    s_cbranch_scc1 main_kernel_tochain
    s_mov_b32 s101, 0
    s_mov_b32 s99, 0
    s_branch main_kernel_nopf
main_kernel_nocl2:
    s_mov_b32 s99, 0
    s_cmp_lg_u32 s48, 0
    s_cbranch_scc1 main_kernel_nopf
    s_cmp_ge_u32 s49, 864
    s_cbranch_scc1 main_kernel_nopf
    s_cmp_lt_u32 s49, 256
    s_cbranch_scc1 main_kernel_nopf
    s_mov_b64 exec, 1
    v_mov_b32 v253, 68
    v_mov_b32 v254, 1
    buffer_atomic_add v254, v253, s[44:47], 0 offen sc0
    s_mov_b64 exec, -1
    s_mov_b32 s99, 1
main_kernel_nopf:
    s_cmp_ge_u32 s49, 1880
    s_cbranch_scc1 main_kernel_exit
    s_mov_b32 s93, 1
    s_cmp_ge_u32 s49, 1544
    s_cbranch_scc1 main_kernel_t_attn
    s_cmp_ge_u32 s49, 1344
    s_cbranch_scc1 main_kernel_t_mono
    s_cmp_ge_u32 s49, 1088
    s_cbranch_scc1 main_kernel_t_ssm
    s_cmp_ge_u32 s49, 960
    s_cbranch_scc1 main_kernel_t_wof
    s_cmp_ge_u32 s49, 640
    s_cbranch_scc1 main_kernel_t_q
    s_lshr_b32 s16, s49, 6
    s_bfe_u32 s12, s49, 0x10005
    s_and_b32 s13, s49, 31
    s_add_u32 s92, s16, 24
    s_branch main_kernel_t_g
main_kernel_t_q:
    s_sub_u32 s17, s49, 640
    s_lshr_b32 s16, s17, 5
    s_and_b32 s13, s17, 31
    s_mov_b32 s12, 2
    s_add_u32 s92, s16, 34
main_kernel_t_g:
    s_lshl_b32 s14, s16, 2
    s_sub_u32 s14, s14, 8
    s_mov_b32 s33, 4
    s_cmp_lt_u32 s16, 3
    s_cselect_b32 s14, s16, s14
    s_cselect_b32 s33, 2, s33
    s_cmp_lt_u32 s16, 2
    s_cselect_b32 s33, 1, s33
    v_lshrrev_b32 v1, 6, v0
    s_nop 0
    v_readfirstlane_b32 s15, v1
    v_and_b32 v2, 63, v0
    s_mov_b32 s8, s58
    s_mov_b32 s9, s59
    s_cmp_eq_u32 s12, 1
    s_cselect_b32 s8, s60, s8
    s_cselect_b32 s9, s61, s9
    s_cmp_eq_u32 s12, 2
    s_cselect_b32 s8, s56, s8
    s_cselect_b32 s9, s57, s9
    s_and_b32 s9, s9, 0xffff
    s_mov_b32 s10, 0x400000
    s_mov_b32 s11, 0x00020000
    s_mov_b32 s20, s52
    s_and_b32 s21, s53, 0xffff
    s_mov_b32 s22, 0x200000
    s_mov_b32 s23, 0x00020000
    v_and_b32 v106, 15, v0
    v_lshrrev_b32 v107, 4, v0
    v_lshlrev_b32 v108, 4, v106
    v_lshl_add_u32 v109, v107, 13, v108
    s_lshl_b32 s16, s13, 8
    v_add_u32 v109, s16, v109
    v_lshl_add_u32 v104, v107, 8, v108
    v_add_u32 v104, 66560, v104
    v_lshrrev_b32 v3, 5, v2
    v_bfe_u32 v4, v2, 2, 2
    v_lshl_add_u32 v3, v3, 3, v4
    v_lshlrev_b32 v3, 8, v3
    v_bfe_u32 v4, v2, 4, 1
    v_lshl_add_u32 v3, v4, 5, v3
    v_and_b32 v4, 3, v2
    v_lshl_add_u32 v3, v4, 3, v3
    s_and_b32 s16, s15, 1
    s_lshl_b32 s16, s16, 7
    s_add_u32 s16, s16, 66560
    v_add_u32 v105, s16, v3
    v_and_b32 v3, 31, v2
    s_lshr_b32 s16, s15, 1
    s_lshl_b32 s16, s16, 5
    v_add_u32 v3, s16, v3
    v_mul_u32_u24 v3, 1040, v3
    v_lshrrev_b32 v4, 5, v2
    v_lshl_add_u32 v103, v4, 4, v3
    v_lshlrev_b32 v102, 4, v2
    v_and_b32 v3, 15, v2
    v_lshl_add_u32 v3, v4, 4, v3
    v_lshlrev_b32 v3, 4, v3
    v_bfe_u32 v4, v2, 4, 1
    s_cmp_eq_u32 s12, 1
    s_cselect_b32 s16, 10, 12
    v_lshlrev_b32 v4, s16, v4
    v_add_u32 v100, v3, v4
    s_mov_b32 s24, 0x0
    s_mov_b32 s25, 1024
    s_cmp_eq_u32 s12, 1
    s_cselect_b32 s24, 0x1000000, s24
    s_cselect_b32 s25, 2048, s25
    s_cmp_eq_u32 s12, 2
    s_cselect_b32 s24, 0x2000000, s24
    s_lshl_b32 s16, s14, 1
    s_lshr_b32 s17, s15, 1
    s_add_u32 s16, s16, s17
    s_lshl_b32 s16, s16, 5
    s_add_u32 s16, s16, s13
    s_lshl_b32 s16, s16, 13
    s_add_u32 s24, s24, s16
    s_and_b32 s16, s15, 1
    s_lshl_b32 s16, s16, 1
    s_mul_i32 s16, s16, s25
    s_add_u32 s24, s24, s16
    s_add_u32 s26, s24, s25
    s_lshl_b32 s27, s14, 16
    s_lshl_b32 s16, s15, 14
    s_add_u32 s27, s27, s16
    s_mul_i32 s28, s15, 16640
    s_mov_b32 s29, 0
    s_barrier
    s_mov_b32 s16, 0x0
    buffer_load_dwordx4 v[120:123], v109, s[8:11], s16 offen
    s_mov_b32 s16, 0x20000
    buffer_load_dwordx4 v[124:127], v109, s[8:11], s16 offen
    s_mov_b32 s16, 0x40000
    buffer_load_dwordx4 v[128:131], v109, s[8:11], s16 offen
    s_mov_b32 s16, 0x60000
    buffer_load_dwordx4 v[132:135], v109, s[8:11], s16 offen
    s_mov_b32 s16, 0x80000
    buffer_load_dwordx4 v[136:139], v109, s[8:11], s16 offen
    s_mov_b32 s16, 0xa0000
    buffer_load_dwordx4 v[140:143], v109, s[8:11], s16 offen
    s_mov_b32 s16, 0xc0000
    buffer_load_dwordx4 v[144:147], v109, s[8:11], s16 offen
    s_mov_b32 s16, 0xe0000
    buffer_load_dwordx4 v[148:151], v109, s[8:11], s16 offen
    s_mov_b32 s16, 0x100000
    buffer_load_dwordx4 v[152:155], v109, s[8:11], s16 offen
    s_mov_b32 s16, 0x120000
    buffer_load_dwordx4 v[156:159], v109, s[8:11], s16 offen
    s_mov_b32 s16, 0x140000
    buffer_load_dwordx4 v[160:163], v109, s[8:11], s16 offen
    s_mov_b32 s16, 0x160000
    buffer_load_dwordx4 v[164:167], v109, s[8:11], s16 offen
    s_mov_b32 s16, 0x180000
    buffer_load_dwordx4 v[168:171], v109, s[8:11], s16 offen
    s_mov_b32 s16, 0x1a0000
    buffer_load_dwordx4 v[172:175], v109, s[8:11], s16 offen
    s_mov_b32 s16, 0x1c0000
    buffer_load_dwordx4 v[176:179], v109, s[8:11], s16 offen
    s_mov_b32 s16, 0x1e0000
    buffer_load_dwordx4 v[180:183], v109, s[8:11], s16 offen
    s_mov_b32 s16, 0x200000
    buffer_load_dwordx4 v[184:187], v109, s[8:11], s16 offen
    s_mov_b32 s16, 0x220000
    buffer_load_dwordx4 v[188:191], v109, s[8:11], s16 offen
    s_mov_b32 s16, 0x240000
    buffer_load_dwordx4 v[192:195], v109, s[8:11], s16 offen
    s_mov_b32 s16, 0x260000
    buffer_load_dwordx4 v[196:199], v109, s[8:11], s16 offen
    s_mov_b32 s16, 0x280000
    buffer_load_dwordx4 v[200:203], v109, s[8:11], s16 offen
    s_mov_b32 s16, 0x2a0000
    buffer_load_dwordx4 v[204:207], v109, s[8:11], s16 offen
    s_mov_b32 s16, 0x2c0000
    buffer_load_dwordx4 v[208:211], v109, s[8:11], s16 offen
    s_mov_b32 s16, 0x2e0000
    buffer_load_dwordx4 v[212:215], v109, s[8:11], s16 offen
    s_mov_b32 s16, 0x300000
    buffer_load_dwordx4 v[216:219], v109, s[8:11], s16 offen
    s_mov_b32 s16, 0x320000
    buffer_load_dwordx4 v[220:223], v109, s[8:11], s16 offen
    s_mov_b32 s16, 0x340000
    buffer_load_dwordx4 v[224:227], v109, s[8:11], s16 offen
    s_mov_b32 s16, 0x360000
    buffer_load_dwordx4 v[228:231], v109, s[8:11], s16 offen
    s_mov_b32 s16, 0x380000
    buffer_load_dwordx4 v[232:235], v109, s[8:11], s16 offen
    s_mov_b32 s16, 0x3a0000
    buffer_load_dwordx4 v[236:239], v109, s[8:11], s16 offen
    s_mov_b32 s16, 0x3c0000
    buffer_load_dwordx4 v[240:243], v109, s[8:11], s16 offen
    s_mov_b32 s16, 0x3e0000
    buffer_load_dwordx4 v[244:247], v109, s[8:11], s16 offen
    s_add_u32 s30, s28, s29
    s_add_u32 m0, s30, 0
    s_add_u32 s16, s27, 0
    buffer_load_dwordx4 v102, s[20:23], s16 offen lds
    s_add_u32 m0, s30, 1040
    s_add_u32 s16, s27, 1024
    buffer_load_dwordx4 v102, s[20:23], s16 offen lds
    s_add_u32 m0, s30, 2080
    s_add_u32 s16, s27, 2048
    buffer_load_dwordx4 v102, s[20:23], s16 offen lds
    s_add_u32 m0, s30, 3120
    s_add_u32 s16, s27, 3072
    buffer_load_dwordx4 v102, s[20:23], s16 offen lds
    s_add_u32 m0, s30, 4160
    s_add_u32 s16, s27, 4096
    buffer_load_dwordx4 v102, s[20:23], s16 offen lds
    s_add_u32 m0, s30, 5200
    s_add_u32 s16, s27, 5120
    buffer_load_dwordx4 v102, s[20:23], s16 offen lds
    s_add_u32 m0, s30, 6240
    s_add_u32 s16, s27, 6144
    buffer_load_dwordx4 v102, s[20:23], s16 offen lds
    s_add_u32 m0, s30, 7280
    s_add_u32 s16, s27, 7168
    buffer_load_dwordx4 v102, s[20:23], s16 offen lds
    s_add_u32 m0, s30, 8320
    s_add_u32 s16, s27, 8192
    buffer_load_dwordx4 v102, s[20:23], s16 offen lds
    s_add_u32 m0, s30, 9360
    s_add_u32 s16, s27, 9216
    buffer_load_dwordx4 v102, s[20:23], s16 offen lds
    s_add_u32 m0, s30, 10400
    s_add_u32 s16, s27, 10240
    buffer_load_dwordx4 v102, s[20:23], s16 offen lds
    s_add_u32 m0, s30, 11440
    s_add_u32 s16, s27, 11264
    buffer_load_dwordx4 v102, s[20:23], s16 offen lds
    s_add_u32 m0, s30, 12480
    s_add_u32 s16, s27, 12288
    buffer_load_dwordx4 v102, s[20:23], s16 offen lds
    s_add_u32 m0, s30, 13520
    s_add_u32 s16, s27, 13312
    buffer_load_dwordx4 v102, s[20:23], s16 offen lds
    s_add_u32 m0, s30, 14560
    s_add_u32 s16, s27, 14336
    buffer_load_dwordx4 v102, s[20:23], s16 offen lds
    s_add_u32 m0, s30, 15600
    s_add_u32 s16, s27, 15360
    buffer_load_dwordx4 v102, s[20:23], s16 offen lds
    s_add_u32 s27, s27, 65536
    s_xor_b32 s29, s29, 66560
    s_waitcnt vmcnt(44)
    ds_write_b128 v104, v[120:123] offset:0
    ds_write_b128 v104, v[124:127] offset:4096
    ds_write_b128 v104, v[128:131] offset:8192
    ds_write_b128 v104, v[132:135] offset:12288
    s_waitcnt lgkmcnt(0)
    s_barrier
    ds_read_b64_tr_b16 a[0:1], v105 offset:0
    ds_read_b64_tr_b16 a[2:3], v105 offset:1024
    ds_read_b64_tr_b16 a[4:5], v105 offset:4096
    ds_read_b64_tr_b16 a[6:7], v105 offset:5120
    ds_read_b64_tr_b16 a[8:9], v105 offset:8192
    ds_read_b64_tr_b16 a[10:11], v105 offset:9216
    ds_read_b64_tr_b16 a[12:13], v105 offset:12288
    ds_read_b64_tr_b16 a[14:15], v105 offset:13312
    ds_read_b64_tr_b16 a[128:129], v105 offset:64
    ds_read_b64_tr_b16 a[130:131], v105 offset:1088
    ds_read_b64_tr_b16 a[132:133], v105 offset:4160
    ds_read_b64_tr_b16 a[134:135], v105 offset:5184
    ds_read_b64_tr_b16 a[136:137], v105 offset:8256
    ds_read_b64_tr_b16 a[138:139], v105 offset:9280
    ds_read_b64_tr_b16 a[140:141], v105 offset:12352
    ds_read_b64_tr_b16 a[142:143], v105 offset:13376
    s_waitcnt vmcnt(40)
    ds_write_b128 v104, v[136:139] offset:16384
    ds_write_b128 v104, v[140:143] offset:20480
    ds_write_b128 v104, v[144:147] offset:24576
    ds_write_b128 v104, v[148:151] offset:28672
    s_waitcnt lgkmcnt(0)
    s_barrier
    ds_read_b64_tr_b16 a[16:17], v105 offset:16384
    ds_read_b64_tr_b16 a[18:19], v105 offset:17408
    ds_read_b64_tr_b16 a[20:21], v105 offset:20480
    ds_read_b64_tr_b16 a[22:23], v105 offset:21504
    ds_read_b64_tr_b16 a[24:25], v105 offset:24576
    ds_read_b64_tr_b16 a[26:27], v105 offset:25600
    ds_read_b64_tr_b16 a[28:29], v105 offset:28672
    ds_read_b64_tr_b16 a[30:31], v105 offset:29696
    ds_read_b64_tr_b16 a[144:145], v105 offset:16448
    ds_read_b64_tr_b16 a[146:147], v105 offset:17472
    ds_read_b64_tr_b16 a[148:149], v105 offset:20544
    ds_read_b64_tr_b16 a[150:151], v105 offset:21568
    ds_read_b64_tr_b16 a[152:153], v105 offset:24640
    ds_read_b64_tr_b16 a[154:155], v105 offset:25664
    ds_read_b64_tr_b16 a[156:157], v105 offset:28736
    ds_read_b64_tr_b16 a[158:159], v105 offset:29760
    s_waitcnt vmcnt(36)
    ds_write_b128 v104, v[152:155] offset:0
    ds_write_b128 v104, v[156:159] offset:4096
    ds_write_b128 v104, v[160:163] offset:8192
    ds_write_b128 v104, v[164:167] offset:12288
    s_waitcnt lgkmcnt(0)
    s_barrier
    ds_read_b64_tr_b16 a[32:33], v105 offset:0
    ds_read_b64_tr_b16 a[34:35], v105 offset:1024
    ds_read_b64_tr_b16 a[36:37], v105 offset:4096
    ds_read_b64_tr_b16 a[38:39], v105 offset:5120
    ds_read_b64_tr_b16 a[40:41], v105 offset:8192
    ds_read_b64_tr_b16 a[42:43], v105 offset:9216
    ds_read_b64_tr_b16 a[44:45], v105 offset:12288
    ds_read_b64_tr_b16 a[46:47], v105 offset:13312
    ds_read_b64_tr_b16 a[160:161], v105 offset:64
    ds_read_b64_tr_b16 a[162:163], v105 offset:1088
    ds_read_b64_tr_b16 a[164:165], v105 offset:4160
    ds_read_b64_tr_b16 a[166:167], v105 offset:5184
    ds_read_b64_tr_b16 a[168:169], v105 offset:8256
    ds_read_b64_tr_b16 a[170:171], v105 offset:9280
    ds_read_b64_tr_b16 a[172:173], v105 offset:12352
    ds_read_b64_tr_b16 a[174:175], v105 offset:13376
    s_waitcnt vmcnt(32)
    ds_write_b128 v104, v[168:171] offset:16384
    ds_write_b128 v104, v[172:175] offset:20480
    ds_write_b128 v104, v[176:179] offset:24576
    ds_write_b128 v104, v[180:183] offset:28672
    s_waitcnt lgkmcnt(0)
    s_barrier
    ds_read_b64_tr_b16 a[48:49], v105 offset:16384
    ds_read_b64_tr_b16 a[50:51], v105 offset:17408
    ds_read_b64_tr_b16 a[52:53], v105 offset:20480
    ds_read_b64_tr_b16 a[54:55], v105 offset:21504
    ds_read_b64_tr_b16 a[56:57], v105 offset:24576
    ds_read_b64_tr_b16 a[58:59], v105 offset:25600
    ds_read_b64_tr_b16 a[60:61], v105 offset:28672
    ds_read_b64_tr_b16 a[62:63], v105 offset:29696
    ds_read_b64_tr_b16 a[176:177], v105 offset:16448
    ds_read_b64_tr_b16 a[178:179], v105 offset:17472
    ds_read_b64_tr_b16 a[180:181], v105 offset:20544
    ds_read_b64_tr_b16 a[182:183], v105 offset:21568
    ds_read_b64_tr_b16 a[184:185], v105 offset:24640
    ds_read_b64_tr_b16 a[186:187], v105 offset:25664
    ds_read_b64_tr_b16 a[188:189], v105 offset:28736
    ds_read_b64_tr_b16 a[190:191], v105 offset:29760
    s_waitcnt vmcnt(28)
    ds_write_b128 v104, v[184:187] offset:0
    ds_write_b128 v104, v[188:191] offset:4096
    ds_write_b128 v104, v[192:195] offset:8192
    ds_write_b128 v104, v[196:199] offset:12288
    s_waitcnt lgkmcnt(0)
    s_barrier
    ds_read_b64_tr_b16 a[64:65], v105 offset:0
    ds_read_b64_tr_b16 a[66:67], v105 offset:1024
    ds_read_b64_tr_b16 a[68:69], v105 offset:4096
    ds_read_b64_tr_b16 a[70:71], v105 offset:5120
    ds_read_b64_tr_b16 a[72:73], v105 offset:8192
    ds_read_b64_tr_b16 a[74:75], v105 offset:9216
    ds_read_b64_tr_b16 a[76:77], v105 offset:12288
    ds_read_b64_tr_b16 a[78:79], v105 offset:13312
    ds_read_b64_tr_b16 a[192:193], v105 offset:64
    ds_read_b64_tr_b16 a[194:195], v105 offset:1088
    ds_read_b64_tr_b16 a[196:197], v105 offset:4160
    ds_read_b64_tr_b16 a[198:199], v105 offset:5184
    ds_read_b64_tr_b16 a[200:201], v105 offset:8256
    ds_read_b64_tr_b16 a[202:203], v105 offset:9280
    ds_read_b64_tr_b16 a[204:205], v105 offset:12352
    ds_read_b64_tr_b16 a[206:207], v105 offset:13376
    s_waitcnt vmcnt(24)
    ds_write_b128 v104, v[200:203] offset:16384
    ds_write_b128 v104, v[204:207] offset:20480
    ds_write_b128 v104, v[208:211] offset:24576
    ds_write_b128 v104, v[212:215] offset:28672
    s_waitcnt lgkmcnt(0)
    s_barrier
    ds_read_b64_tr_b16 a[80:81], v105 offset:16384
    ds_read_b64_tr_b16 a[82:83], v105 offset:17408
    ds_read_b64_tr_b16 a[84:85], v105 offset:20480
    ds_read_b64_tr_b16 a[86:87], v105 offset:21504
    ds_read_b64_tr_b16 a[88:89], v105 offset:24576
    ds_read_b64_tr_b16 a[90:91], v105 offset:25600
    ds_read_b64_tr_b16 a[92:93], v105 offset:28672
    ds_read_b64_tr_b16 a[94:95], v105 offset:29696
    ds_read_b64_tr_b16 a[208:209], v105 offset:16448
    ds_read_b64_tr_b16 a[210:211], v105 offset:17472
    ds_read_b64_tr_b16 a[212:213], v105 offset:20544
    ds_read_b64_tr_b16 a[214:215], v105 offset:21568
    ds_read_b64_tr_b16 a[216:217], v105 offset:24640
    ds_read_b64_tr_b16 a[218:219], v105 offset:25664
    ds_read_b64_tr_b16 a[220:221], v105 offset:28736
    ds_read_b64_tr_b16 a[222:223], v105 offset:29760
    s_waitcnt vmcnt(20)
    ds_write_b128 v104, v[216:219] offset:0
    ds_write_b128 v104, v[220:223] offset:4096
    ds_write_b128 v104, v[224:227] offset:8192
    ds_write_b128 v104, v[228:231] offset:12288
    s_waitcnt lgkmcnt(0)
    s_barrier
    ds_read_b64_tr_b16 a[96:97], v105 offset:0
    ds_read_b64_tr_b16 a[98:99], v105 offset:1024
    ds_read_b64_tr_b16 a[100:101], v105 offset:4096
    ds_read_b64_tr_b16 a[102:103], v105 offset:5120
    ds_read_b64_tr_b16 a[104:105], v105 offset:8192
    ds_read_b64_tr_b16 a[106:107], v105 offset:9216
    ds_read_b64_tr_b16 a[108:109], v105 offset:12288
    ds_read_b64_tr_b16 a[110:111], v105 offset:13312
    ds_read_b64_tr_b16 a[224:225], v105 offset:64
    ds_read_b64_tr_b16 a[226:227], v105 offset:1088
    ds_read_b64_tr_b16 a[228:229], v105 offset:4160
    ds_read_b64_tr_b16 a[230:231], v105 offset:5184
    ds_read_b64_tr_b16 a[232:233], v105 offset:8256
    ds_read_b64_tr_b16 a[234:235], v105 offset:9280
    ds_read_b64_tr_b16 a[236:237], v105 offset:12352
    ds_read_b64_tr_b16 a[238:239], v105 offset:13376
    s_waitcnt vmcnt(16)
    ds_write_b128 v104, v[232:235] offset:16384
    ds_write_b128 v104, v[236:239] offset:20480
    ds_write_b128 v104, v[240:243] offset:24576
    ds_write_b128 v104, v[244:247] offset:28672
    s_waitcnt lgkmcnt(0)
    s_barrier
    ds_read_b64_tr_b16 a[112:113], v105 offset:16384
    ds_read_b64_tr_b16 a[114:115], v105 offset:17408
    ds_read_b64_tr_b16 a[116:117], v105 offset:20480
    ds_read_b64_tr_b16 a[118:119], v105 offset:21504
    ds_read_b64_tr_b16 a[120:121], v105 offset:24576
    ds_read_b64_tr_b16 a[122:123], v105 offset:25600
    ds_read_b64_tr_b16 a[124:125], v105 offset:28672
    ds_read_b64_tr_b16 a[126:127], v105 offset:29696
    ds_read_b64_tr_b16 a[240:241], v105 offset:16448
    ds_read_b64_tr_b16 a[242:243], v105 offset:17472
    ds_read_b64_tr_b16 a[244:245], v105 offset:20544
    ds_read_b64_tr_b16 a[246:247], v105 offset:21568
    ds_read_b64_tr_b16 a[248:249], v105 offset:24640
    ds_read_b64_tr_b16 a[250:251], v105 offset:25664
    ds_read_b64_tr_b16 a[252:253], v105 offset:28736
    ds_read_b64_tr_b16 a[254:255], v105 offset:29760
    s_waitcnt lgkmcnt(0)
    s_barrier
    s_cmp_eq_u32 s12, 1
    s_cbranch_scc1 main_kernel_g_vpath
    s_mov_b32 s31, 1
    s_mov_b32 s32, 0
    s_waitcnt vmcnt(0)
main_kernel_g_tl0:
    s_waitcnt vmcnt(4)
    s_barrier
    v_add_u32 v101, s32, v103
    s_xor_b32 s32, s32, 66560
    ds_read_b128 v[32:35], v101 offset:0
    ds_read_b128 v[36:39], v101 offset:32
    ds_read_b128 v[40:43], v101 offset:64
    ds_read_b128 v[44:47], v101 offset:96
    ds_read_b128 v[48:51], v101 offset:128
    ds_read_b128 v[52:55], v101 offset:160
    ds_read_b128 v[56:59], v101 offset:192
    ds_read_b128 v[60:63], v101 offset:224
    s_cmp_eq_u32 s31, s33
    s_cbranch_scc1 main_kernel_g_nod0
    s_add_u32 s30, s28, s29
    s_add_u32 m0, s30, 0
    s_add_u32 s16, s27, 0
    buffer_load_dwordx4 v102, s[20:23], s16 offen lds
    s_add_u32 m0, s30, 1040
    s_add_u32 s16, s27, 1024
    buffer_load_dwordx4 v102, s[20:23], s16 offen lds
    s_add_u32 m0, s30, 2080
    s_add_u32 s16, s27, 2048
    buffer_load_dwordx4 v102, s[20:23], s16 offen lds
    s_add_u32 m0, s30, 3120
    s_add_u32 s16, s27, 3072
    buffer_load_dwordx4 v102, s[20:23], s16 offen lds
    s_add_u32 m0, s30, 4160
    s_add_u32 s16, s27, 4096
    buffer_load_dwordx4 v102, s[20:23], s16 offen lds
    s_add_u32 m0, s30, 5200
    s_add_u32 s16, s27, 5120
    buffer_load_dwordx4 v102, s[20:23], s16 offen lds
    s_add_u32 m0, s30, 6240
    s_add_u32 s16, s27, 6144
    buffer_load_dwordx4 v102, s[20:23], s16 offen lds
    s_add_u32 m0, s30, 7280
    s_add_u32 s16, s27, 7168
    buffer_load_dwordx4 v102, s[20:23], s16 offen lds
    s_add_u32 m0, s30, 8320
    s_add_u32 s16, s27, 8192
    buffer_load_dwordx4 v102, s[20:23], s16 offen lds
    s_add_u32 m0, s30, 9360
    s_add_u32 s16, s27, 9216
    buffer_load_dwordx4 v102, s[20:23], s16 offen lds
    s_add_u32 m0, s30, 10400
    s_add_u32 s16, s27, 10240
    buffer_load_dwordx4 v102, s[20:23], s16 offen lds
    s_add_u32 m0, s30, 11440
    s_add_u32 s16, s27, 11264
    buffer_load_dwordx4 v102, s[20:23], s16 offen lds
    s_add_u32 m0, s30, 12480
    s_add_u32 s16, s27, 12288
    buffer_load_dwordx4 v102, s[20:23], s16 offen lds
    s_add_u32 m0, s30, 13520
    s_add_u32 s16, s27, 13312
    buffer_load_dwordx4 v102, s[20:23], s16 offen lds
    s_add_u32 m0, s30, 14560
    s_add_u32 s16, s27, 14336
    buffer_load_dwordx4 v102, s[20:23], s16 offen lds
    s_add_u32 m0, s30, 15600
    s_add_u32 s16, s27, 15360
    buffer_load_dwordx4 v102, s[20:23], s16 offen lds
    s_add_u32 s27, s27, 65536
    s_xor_b32 s29, s29, 66560
main_kernel_g_nod0:
    s_waitcnt lgkmcnt(7)
    v_mfma_f32_32x32x16_bf16 v[0:15], a[0:3], v[32:35], 0
    v_mfma_f32_32x32x16_bf16 v[16:31], a[128:131], v[32:35], 0
    ds_read_b128 v[32:35], v101 offset:256
    s_waitcnt lgkmcnt(7)
    v_mfma_f32_32x32x16_bf16 v[0:15], a[4:7], v[36:39], v[0:15]
    v_mfma_f32_32x32x16_bf16 v[16:31], a[132:135], v[36:39], v[16:31]
    ds_read_b128 v[36:39], v101 offset:288
    s_waitcnt lgkmcnt(7)
    v_mfma_f32_32x32x16_bf16 v[0:15], a[8:11], v[40:43], v[0:15]
    v_mfma_f32_32x32x16_bf16 v[16:31], a[136:139], v[40:43], v[16:31]
    ds_read_b128 v[40:43], v101 offset:320
    s_waitcnt lgkmcnt(7)
    v_mfma_f32_32x32x16_bf16 v[0:15], a[12:15], v[44:47], v[0:15]
    v_mfma_f32_32x32x16_bf16 v[16:31], a[140:143], v[44:47], v[16:31]
    ds_read_b128 v[44:47], v101 offset:352
    s_waitcnt lgkmcnt(7)
    v_mfma_f32_32x32x16_bf16 v[0:15], a[16:19], v[48:51], v[0:15]
    v_mfma_f32_32x32x16_bf16 v[16:31], a[144:147], v[48:51], v[16:31]
    ds_read_b128 v[48:51], v101 offset:384
    s_waitcnt lgkmcnt(7)
    v_mfma_f32_32x32x16_bf16 v[0:15], a[20:23], v[52:55], v[0:15]
    v_mfma_f32_32x32x16_bf16 v[16:31], a[148:151], v[52:55], v[16:31]
    ds_read_b128 v[52:55], v101 offset:416
    s_waitcnt lgkmcnt(7)
    v_mfma_f32_32x32x16_bf16 v[0:15], a[24:27], v[56:59], v[0:15]
    v_mfma_f32_32x32x16_bf16 v[16:31], a[152:155], v[56:59], v[16:31]
    ds_read_b128 v[56:59], v101 offset:448
    s_waitcnt lgkmcnt(7)
    v_mfma_f32_32x32x16_bf16 v[0:15], a[28:31], v[60:63], v[0:15]
    v_mfma_f32_32x32x16_bf16 v[16:31], a[156:159], v[60:63], v[16:31]
    ds_read_b128 v[60:63], v101 offset:480
    s_waitcnt lgkmcnt(7)
    v_mfma_f32_32x32x16_bf16 v[0:15], a[32:35], v[32:35], v[0:15]
    v_mfma_f32_32x32x16_bf16 v[16:31], a[160:163], v[32:35], v[16:31]
    ds_read_b128 v[32:35], v101 offset:512
    s_waitcnt lgkmcnt(7)
    v_mfma_f32_32x32x16_bf16 v[0:15], a[36:39], v[36:39], v[0:15]
    v_mfma_f32_32x32x16_bf16 v[16:31], a[164:167], v[36:39], v[16:31]
    ds_read_b128 v[36:39], v101 offset:544
    s_waitcnt lgkmcnt(7)
    v_mfma_f32_32x32x16_bf16 v[0:15], a[40:43], v[40:43], v[0:15]
    v_mfma_f32_32x32x16_bf16 v[16:31], a[168:171], v[40:43], v[16:31]
    ds_read_b128 v[40:43], v101 offset:576
    s_waitcnt lgkmcnt(7)
    v_mfma_f32_32x32x16_bf16 v[0:15], a[44:47], v[44:47], v[0:15]
    v_mfma_f32_32x32x16_bf16 v[16:31], a[172:175], v[44:47], v[16:31]
    ds_read_b128 v[44:47], v101 offset:608
    s_waitcnt lgkmcnt(7)
    v_mfma_f32_32x32x16_bf16 v[0:15], a[48:51], v[48:51], v[0:15]
    v_mfma_f32_32x32x16_bf16 v[16:31], a[176:179], v[48:51], v[16:31]
    ds_read_b128 v[48:51], v101 offset:640
    s_waitcnt lgkmcnt(7)
    v_mfma_f32_32x32x16_bf16 v[0:15], a[52:55], v[52:55], v[0:15]
    v_mfma_f32_32x32x16_bf16 v[16:31], a[180:183], v[52:55], v[16:31]
    ds_read_b128 v[52:55], v101 offset:672
    s_waitcnt lgkmcnt(7)
    v_mfma_f32_32x32x16_bf16 v[0:15], a[56:59], v[56:59], v[0:15]
    v_mfma_f32_32x32x16_bf16 v[16:31], a[184:187], v[56:59], v[16:31]
    ds_read_b128 v[56:59], v101 offset:704
    s_waitcnt lgkmcnt(7)
    v_mfma_f32_32x32x16_bf16 v[0:15], a[60:63], v[60:63], v[0:15]
    v_mfma_f32_32x32x16_bf16 v[16:31], a[188:191], v[60:63], v[16:31]
    ds_read_b128 v[60:63], v101 offset:736
    s_waitcnt lgkmcnt(7)
    v_mfma_f32_32x32x16_bf16 v[0:15], a[64:67], v[32:35], v[0:15]
    v_mfma_f32_32x32x16_bf16 v[16:31], a[192:195], v[32:35], v[16:31]
    ds_read_b128 v[32:35], v101 offset:768
    s_waitcnt lgkmcnt(7)
    v_mfma_f32_32x32x16_bf16 v[0:15], a[68:71], v[36:39], v[0:15]
    v_mfma_f32_32x32x16_bf16 v[16:31], a[196:199], v[36:39], v[16:31]
    ds_read_b128 v[36:39], v101 offset:800
    s_waitcnt lgkmcnt(7)
    v_mfma_f32_32x32x16_bf16 v[0:15], a[72:75], v[40:43], v[0:15]
    v_mfma_f32_32x32x16_bf16 v[16:31], a[200:203], v[40:43], v[16:31]
    ds_read_b128 v[40:43], v101 offset:832
    s_waitcnt lgkmcnt(7)
    v_mfma_f32_32x32x16_bf16 v[0:15], a[76:79], v[44:47], v[0:15]
    v_mfma_f32_32x32x16_bf16 v[16:31], a[204:207], v[44:47], v[16:31]
    ds_read_b128 v[44:47], v101 offset:864
    s_waitcnt lgkmcnt(7)
    v_mfma_f32_32x32x16_bf16 v[0:15], a[80:83], v[48:51], v[0:15]
    v_mfma_f32_32x32x16_bf16 v[16:31], a[208:211], v[48:51], v[16:31]
    ds_read_b128 v[48:51], v101 offset:896
    s_waitcnt lgkmcnt(7)
    v_mfma_f32_32x32x16_bf16 v[0:15], a[84:87], v[52:55], v[0:15]
    v_mfma_f32_32x32x16_bf16 v[16:31], a[212:215], v[52:55], v[16:31]
    ds_read_b128 v[52:55], v101 offset:928
    s_waitcnt lgkmcnt(7)
    v_mfma_f32_32x32x16_bf16 v[0:15], a[88:91], v[56:59], v[0:15]
    v_mfma_f32_32x32x16_bf16 v[16:31], a[216:219], v[56:59], v[16:31]
    ds_read_b128 v[56:59], v101 offset:960
    s_waitcnt lgkmcnt(7)
    v_mfma_f32_32x32x16_bf16 v[0:15], a[92:95], v[60:63], v[0:15]
    v_mfma_f32_32x32x16_bf16 v[16:31], a[220:223], v[60:63], v[16:31]
    ds_read_b128 v[60:63], v101 offset:992
    s_waitcnt lgkmcnt(7)
    v_mfma_f32_32x32x16_bf16 v[0:15], a[96:99], v[32:35], v[0:15]
    v_mfma_f32_32x32x16_bf16 v[16:31], a[224:227], v[32:35], v[16:31]
    s_waitcnt lgkmcnt(6)
    v_mfma_f32_32x32x16_bf16 v[0:15], a[100:103], v[36:39], v[0:15]
    v_mfma_f32_32x32x16_bf16 v[16:31], a[228:231], v[36:39], v[16:31]
    s_waitcnt lgkmcnt(5)
    v_mfma_f32_32x32x16_bf16 v[0:15], a[104:107], v[40:43], v[0:15]
    v_mfma_f32_32x32x16_bf16 v[16:31], a[232:235], v[40:43], v[16:31]
    s_waitcnt lgkmcnt(4)
    v_mfma_f32_32x32x16_bf16 v[0:15], a[108:111], v[44:47], v[0:15]
    v_mfma_f32_32x32x16_bf16 v[16:31], a[236:239], v[44:47], v[16:31]
    s_waitcnt lgkmcnt(3)
    v_mfma_f32_32x32x16_bf16 v[0:15], a[112:115], v[48:51], v[0:15]
    v_mfma_f32_32x32x16_bf16 v[16:31], a[240:243], v[48:51], v[16:31]
    s_waitcnt lgkmcnt(2)
    v_mfma_f32_32x32x16_bf16 v[0:15], a[116:119], v[52:55], v[0:15]
    v_mfma_f32_32x32x16_bf16 v[16:31], a[244:247], v[52:55], v[16:31]
    s_waitcnt lgkmcnt(1)
    v_mfma_f32_32x32x16_bf16 v[0:15], a[120:123], v[56:59], v[0:15]
    v_mfma_f32_32x32x16_bf16 v[16:31], a[248:251], v[56:59], v[16:31]
    s_waitcnt lgkmcnt(0)
    v_mfma_f32_32x32x16_bf16 v[0:15], a[124:127], v[60:63], v[0:15]
    v_mfma_f32_32x32x16_bf16 v[16:31], a[252:255], v[60:63], v[16:31]
    s_nop 10
    v_cvt_pk_bf16_f32 v112, v0, v1
    v_cvt_pk_bf16_f32 v113, v2, v3
    v_cvt_pk_bf16_f32 v114, v8, v9
    v_cvt_pk_bf16_f32 v115, v10, v11
    buffer_store_dwordx4 v[112:115], v100, s[4:7], s24 offen offset:0 sc1
    v_cvt_pk_bf16_f32 v116, v4, v5
    v_cvt_pk_bf16_f32 v117, v6, v7
    v_cvt_pk_bf16_f32 v118, v12, v13
    v_cvt_pk_bf16_f32 v119, v14, v15
    buffer_store_dwordx4 v[116:119], v100, s[4:7], s24 offen offset:512 sc1
    v_cvt_pk_bf16_f32 v120, v16, v17
    v_cvt_pk_bf16_f32 v121, v18, v19
    v_cvt_pk_bf16_f32 v122, v24, v25
    v_cvt_pk_bf16_f32 v123, v26, v27
    buffer_store_dwordx4 v[120:123], v100, s[4:7], s26 offen offset:0 sc1
    v_cvt_pk_bf16_f32 v124, v20, v21
    v_cvt_pk_bf16_f32 v125, v22, v23
    v_cvt_pk_bf16_f32 v126, v28, v29
    v_cvt_pk_bf16_f32 v127, v30, v31
    buffer_store_dwordx4 v[124:127], v100, s[4:7], s26 offen offset:512 sc1
    s_add_u32 s24, s24, 0x80000
    s_add_u32 s26, s26, 0x80000
    s_add_u32 s31, s31, 1
    s_cmp_le_u32 s31, s33
    s_cbranch_scc1 main_kernel_g_tl0
    s_branch main_kernel_g_end
main_kernel_g_vpath:
    s_mov_b32 s31, 1
    s_mov_b32 s32, 0
    s_waitcnt vmcnt(0)
main_kernel_g_tl1:
    s_waitcnt vmcnt(4)
    s_barrier
    v_add_u32 v101, s32, v103
    s_xor_b32 s32, s32, 66560
    ds_read_b128 v[32:35], v101 offset:0
    ds_read_b128 v[36:39], v101 offset:32
    ds_read_b128 v[40:43], v101 offset:64
    ds_read_b128 v[44:47], v101 offset:96
    ds_read_b128 v[48:51], v101 offset:128
    ds_read_b128 v[52:55], v101 offset:160
    ds_read_b128 v[56:59], v101 offset:192
    ds_read_b128 v[60:63], v101 offset:224
    s_cmp_eq_u32 s31, s33
    s_cbranch_scc1 main_kernel_g_nod1
    s_add_u32 s30, s28, s29
    s_add_u32 m0, s30, 0
    s_add_u32 s16, s27, 0
    buffer_load_dwordx4 v102, s[20:23], s16 offen lds
    s_add_u32 m0, s30, 1040
    s_add_u32 s16, s27, 1024
    buffer_load_dwordx4 v102, s[20:23], s16 offen lds
    s_add_u32 m0, s30, 2080
    s_add_u32 s16, s27, 2048
    buffer_load_dwordx4 v102, s[20:23], s16 offen lds
    s_add_u32 m0, s30, 3120
    s_add_u32 s16, s27, 3072
    buffer_load_dwordx4 v102, s[20:23], s16 offen lds
    s_add_u32 m0, s30, 4160
    s_add_u32 s16, s27, 4096
    buffer_load_dwordx4 v102, s[20:23], s16 offen lds
    s_add_u32 m0, s30, 5200
    s_add_u32 s16, s27, 5120
    buffer_load_dwordx4 v102, s[20:23], s16 offen lds
    s_add_u32 m0, s30, 6240
    s_add_u32 s16, s27, 6144
    buffer_load_dwordx4 v102, s[20:23], s16 offen lds
    s_add_u32 m0, s30, 7280
    s_add_u32 s16, s27, 7168
    buffer_load_dwordx4 v102, s[20:23], s16 offen lds
    s_add_u32 m0, s30, 8320
    s_add_u32 s16, s27, 8192
    buffer_load_dwordx4 v102, s[20:23], s16 offen lds
    s_add_u32 m0, s30, 9360
    s_add_u32 s16, s27, 9216
    buffer_load_dwordx4 v102, s[20:23], s16 offen lds
    s_add_u32 m0, s30, 10400
    s_add_u32 s16, s27, 10240
    buffer_load_dwordx4 v102, s[20:23], s16 offen lds
    s_add_u32 m0, s30, 11440
    s_add_u32 s16, s27, 11264
    buffer_load_dwordx4 v102, s[20:23], s16 offen lds
    s_add_u32 m0, s30, 12480
    s_add_u32 s16, s27, 12288
    buffer_load_dwordx4 v102, s[20:23], s16 offen lds
    s_add_u32 m0, s30, 13520
    s_add_u32 s16, s27, 13312
    buffer_load_dwordx4 v102, s[20:23], s16 offen lds
    s_add_u32 m0, s30, 14560
    s_add_u32 s16, s27, 14336
    buffer_load_dwordx4 v102, s[20:23], s16 offen lds
    s_add_u32 m0, s30, 15600
    s_add_u32 s16, s27, 15360
    buffer_load_dwordx4 v102, s[20:23], s16 offen lds
    s_add_u32 s27, s27, 65536
    s_xor_b32 s29, s29, 66560
main_kernel_g_nod1:
    s_waitcnt lgkmcnt(7)
    v_mfma_f32_32x32x16_bf16 v[0:15], v[32:35], a[0:3], 0
    v_mfma_f32_32x32x16_bf16 v[16:31], v[32:35], a[128:131], 0
    ds_read_b128 v[32:35], v101 offset:256
    s_waitcnt lgkmcnt(7)
    v_mfma_f32_32x32x16_bf16 v[0:15], v[36:39], a[4:7], v[0:15]
    v_mfma_f32_32x32x16_bf16 v[16:31], v[36:39], a[132:135], v[16:31]
    ds_read_b128 v[36:39], v101 offset:288
    s_waitcnt lgkmcnt(7)
    v_mfma_f32_32x32x16_bf16 v[0:15], v[40:43], a[8:11], v[0:15]
    v_mfma_f32_32x32x16_bf16 v[16:31], v[40:43], a[136:139], v[16:31]
    ds_read_b128 v[40:43], v101 offset:320
    s_waitcnt lgkmcnt(7)
    v_mfma_f32_32x32x16_bf16 v[0:15], v[44:47], a[12:15], v[0:15]
    v_mfma_f32_32x32x16_bf16 v[16:31], v[44:47], a[140:143], v[16:31]
    ds_read_b128 v[44:47], v101 offset:352
    s_waitcnt lgkmcnt(7)
    v_mfma_f32_32x32x16_bf16 v[0:15], v[48:51], a[16:19], v[0:15]
    v_mfma_f32_32x32x16_bf16 v[16:31], v[48:51], a[144:147], v[16:31]
    ds_read_b128 v[48:51], v101 offset:384
    s_waitcnt lgkmcnt(7)
    v_mfma_f32_32x32x16_bf16 v[0:15], v[52:55], a[20:23], v[0:15]
    v_mfma_f32_32x32x16_bf16 v[16:31], v[52:55], a[148:151], v[16:31]
    ds_read_b128 v[52:55], v101 offset:416
    s_waitcnt lgkmcnt(7)
    v_mfma_f32_32x32x16_bf16 v[0:15], v[56:59], a[24:27], v[0:15]
    v_mfma_f32_32x32x16_bf16 v[16:31], v[56:59], a[152:155], v[16:31]
    ds_read_b128 v[56:59], v101 offset:448
    s_waitcnt lgkmcnt(7)
    v_mfma_f32_32x32x16_bf16 v[0:15], v[60:63], a[28:31], v[0:15]
    v_mfma_f32_32x32x16_bf16 v[16:31], v[60:63], a[156:159], v[16:31]
    ds_read_b128 v[60:63], v101 offset:480
    s_waitcnt lgkmcnt(7)
    v_mfma_f32_32x32x16_bf16 v[0:15], v[32:35], a[32:35], v[0:15]
    v_mfma_f32_32x32x16_bf16 v[16:31], v[32:35], a[160:163], v[16:31]
    ds_read_b128 v[32:35], v101 offset:512
    s_waitcnt lgkmcnt(7)
    v_mfma_f32_32x32x16_bf16 v[0:15], v[36:39], a[36:39], v[0:15]
    v_mfma_f32_32x32x16_bf16 v[16:31], v[36:39], a[164:167], v[16:31]
    ds_read_b128 v[36:39], v101 offset:544
    s_waitcnt lgkmcnt(7)
    v_mfma_f32_32x32x16_bf16 v[0:15], v[40:43], a[40:43], v[0:15]
    v_mfma_f32_32x32x16_bf16 v[16:31], v[40:43], a[168:171], v[16:31]
    ds_read_b128 v[40:43], v101 offset:576
    s_waitcnt lgkmcnt(7)
    v_mfma_f32_32x32x16_bf16 v[0:15], v[44:47], a[44:47], v[0:15]
    v_mfma_f32_32x32x16_bf16 v[16:31], v[44:47], a[172:175], v[16:31]
    ds_read_b128 v[44:47], v101 offset:608
    s_waitcnt lgkmcnt(7)
    v_mfma_f32_32x32x16_bf16 v[0:15], v[48:51], a[48:51], v[0:15]
    v_mfma_f32_32x32x16_bf16 v[16:31], v[48:51], a[176:179], v[16:31]
    ds_read_b128 v[48:51], v101 offset:640
    s_waitcnt lgkmcnt(7)
    v_mfma_f32_32x32x16_bf16 v[0:15], v[52:55], a[52:55], v[0:15]
    v_mfma_f32_32x32x16_bf16 v[16:31], v[52:55], a[180:183], v[16:31]
    ds_read_b128 v[52:55], v101 offset:672
    s_waitcnt lgkmcnt(7)
    v_mfma_f32_32x32x16_bf16 v[0:15], v[56:59], a[56:59], v[0:15]
    v_mfma_f32_32x32x16_bf16 v[16:31], v[56:59], a[184:187], v[16:31]
    ds_read_b128 v[56:59], v101 offset:704
    s_waitcnt lgkmcnt(7)
    v_mfma_f32_32x32x16_bf16 v[0:15], v[60:63], a[60:63], v[0:15]
    v_mfma_f32_32x32x16_bf16 v[16:31], v[60:63], a[188:191], v[16:31]
    ds_read_b128 v[60:63], v101 offset:736
    s_waitcnt lgkmcnt(7)
    v_mfma_f32_32x32x16_bf16 v[0:15], v[32:35], a[64:67], v[0:15]
    v_mfma_f32_32x32x16_bf16 v[16:31], v[32:35], a[192:195], v[16:31]
    ds_read_b128 v[32:35], v101 offset:768
    s_waitcnt lgkmcnt(7)
    v_mfma_f32_32x32x16_bf16 v[0:15], v[36:39], a[68:71], v[0:15]
    v_mfma_f32_32x32x16_bf16 v[16:31], v[36:39], a[196:199], v[16:31]
    ds_read_b128 v[36:39], v101 offset:800
    s_waitcnt lgkmcnt(7)
    v_mfma_f32_32x32x16_bf16 v[0:15], v[40:43], a[72:75], v[0:15]
    v_mfma_f32_32x32x16_bf16 v[16:31], v[40:43], a[200:203], v[16:31]
    ds_read_b128 v[40:43], v101 offset:832
    s_waitcnt lgkmcnt(7)
    v_mfma_f32_32x32x16_bf16 v[0:15], v[44:47], a[76:79], v[0:15]
    v_mfma_f32_32x32x16_bf16 v[16:31], v[44:47], a[204:207], v[16:31]
    ds_read_b128 v[44:47], v101 offset:864
    s_waitcnt lgkmcnt(7)
    v_mfma_f32_32x32x16_bf16 v[0:15], v[48:51], a[80:83], v[0:15]
    v_mfma_f32_32x32x16_bf16 v[16:31], v[48:51], a[208:211], v[16:31]
    ds_read_b128 v[48:51], v101 offset:896
    s_waitcnt lgkmcnt(7)
    v_mfma_f32_32x32x16_bf16 v[0:15], v[52:55], a[84:87], v[0:15]
    v_mfma_f32_32x32x16_bf16 v[16:31], v[52:55], a[212:215], v[16:31]
    ds_read_b128 v[52:55], v101 offset:928
    s_waitcnt lgkmcnt(7)
    v_mfma_f32_32x32x16_bf16 v[0:15], v[56:59], a[88:91], v[0:15]
    v_mfma_f32_32x32x16_bf16 v[16:31], v[56:59], a[216:219], v[16:31]
    ds_read_b128 v[56:59], v101 offset:960
    s_waitcnt lgkmcnt(7)
    v_mfma_f32_32x32x16_bf16 v[0:15], v[60:63], a[92:95], v[0:15]
    v_mfma_f32_32x32x16_bf16 v[16:31], v[60:63], a[220:223], v[16:31]
    ds_read_b128 v[60:63], v101 offset:992
    s_waitcnt lgkmcnt(7)
    v_mfma_f32_32x32x16_bf16 v[0:15], v[32:35], a[96:99], v[0:15]
    v_mfma_f32_32x32x16_bf16 v[16:31], v[32:35], a[224:227], v[16:31]
    s_waitcnt lgkmcnt(6)
    v_mfma_f32_32x32x16_bf16 v[0:15], v[36:39], a[100:103], v[0:15]
    v_mfma_f32_32x32x16_bf16 v[16:31], v[36:39], a[228:231], v[16:31]
    s_waitcnt lgkmcnt(5)
    v_mfma_f32_32x32x16_bf16 v[0:15], v[40:43], a[104:107], v[0:15]
    v_mfma_f32_32x32x16_bf16 v[16:31], v[40:43], a[232:235], v[16:31]
    s_waitcnt lgkmcnt(4)
    v_mfma_f32_32x32x16_bf16 v[0:15], v[44:47], a[108:111], v[0:15]
    v_mfma_f32_32x32x16_bf16 v[16:31], v[44:47], a[236:239], v[16:31]
    s_waitcnt lgkmcnt(3)
    v_mfma_f32_32x32x16_bf16 v[0:15], v[48:51], a[112:115], v[0:15]
    v_mfma_f32_32x32x16_bf16 v[16:31], v[48:51], a[240:243], v[16:31]
    s_waitcnt lgkmcnt(2)
    v_mfma_f32_32x32x16_bf16 v[0:15], v[52:55], a[116:119], v[0:15]
    v_mfma_f32_32x32x16_bf16 v[16:31], v[52:55], a[244:247], v[16:31]
    s_waitcnt lgkmcnt(1)
    v_mfma_f32_32x32x16_bf16 v[0:15], v[56:59], a[120:123], v[0:15]
    v_mfma_f32_32x32x16_bf16 v[16:31], v[56:59], a[248:251], v[16:31]
    s_waitcnt lgkmcnt(0)
    v_mfma_f32_32x32x16_bf16 v[0:15], v[60:63], a[124:127], v[0:15]
    v_mfma_f32_32x32x16_bf16 v[16:31], v[60:63], a[252:255], v[16:31]
    s_nop 10
    v_cvt_pk_bf16_f32 v112, v0, v1
    v_cvt_pk_bf16_f32 v113, v2, v3
    v_cvt_pk_bf16_f32 v114, v8, v9
    v_cvt_pk_bf16_f32 v115, v10, v11
    buffer_store_dwordx4 v[112:115], v100, s[4:7], s24 offen offset:0 sc1
    v_cvt_pk_bf16_f32 v116, v4, v5
    v_cvt_pk_bf16_f32 v117, v6, v7
    v_cvt_pk_bf16_f32 v118, v12, v13
    v_cvt_pk_bf16_f32 v119, v14, v15
    buffer_store_dwordx4 v[116:119], v100, s[4:7], s24 offen offset:512 sc1
    v_cvt_pk_bf16_f32 v120, v16, v17
    v_cvt_pk_bf16_f32 v121, v18, v19
    v_cvt_pk_bf16_f32 v122, v24, v25
    v_cvt_pk_bf16_f32 v123, v26, v27
    buffer_store_dwordx4 v[120:123], v100, s[4:7], s26 offen offset:0 sc1
    v_cvt_pk_bf16_f32 v124, v20, v21
    v_cvt_pk_bf16_f32 v125, v22, v23
    v_cvt_pk_bf16_f32 v126, v28, v29
    v_cvt_pk_bf16_f32 v127, v30, v31
    buffer_store_dwordx4 v[124:127], v100, s[4:7], s26 offen offset:512 sc1
    s_add_u32 s24, s24, 0x80000
    s_add_u32 s26, s26, 0x80000
    s_add_u32 s31, s31, 1
    s_cmp_le_u32 s31, s33
    s_cbranch_scc1 main_kernel_g_tl1
main_kernel_g_end:
    s_branch main_kernel_sig
main_kernel_t_wof:
    s_sub_u32 s49, s49, 960
    s_mov_b32 s92, 18
    s_mov_b32 s8, s62
    s_and_b32 s9, s63, 0xffff
    s_mov_b32 s10, 0x400000
    s_mov_b32 s11, 0x00020000
    v_and_b32 v2, 63, v0
    v_lshrrev_b32 v1, 6, v0
    s_nop 0
    v_readfirstlane_b32 s15, v1
    v_lshlrev_b32 v3, 4, v2
    v_lshl_add_u32 v4, v1, 10, v3
    v_mul_u32_u24 v5, 1056, v1
    v_add_u32 v5, v5, v3
    s_lshl_b32 s16, s49, 15
    s_barrier
    s_add_u32 s17, s16, 0
    buffer_load_dwordx4 v[8:11], v4, s[8:11], s17 offen
    s_add_u32 s17, s16, 4096
    buffer_load_dwordx4 v[12:15], v4, s[8:11], s17 offen
    s_add_u32 s17, s16, 8192
    buffer_load_dwordx4 v[16:19], v4, s[8:11], s17 offen
    s_add_u32 s17, s16, 12288
    buffer_load_dwordx4 v[20:23], v4, s[8:11], s17 offen
    s_add_u32 s17, s16, 16384
    buffer_load_dwordx4 v[24:27], v4, s[8:11], s17 offen
    s_add_u32 s17, s16, 20480
    buffer_load_dwordx4 v[28:31], v4, s[8:11], s17 offen
    s_add_u32 s17, s16, 24576
    buffer_load_dwordx4 v[32:35], v4, s[8:11], s17 offen
    s_add_u32 s17, s16, 28672
    buffer_load_dwordx4 v[36:39], v4, s[8:11], s17 offen
    s_waitcnt vmcnt(7)
    ds_write_b128 v5, v[8:11] offset:0
    s_waitcnt vmcnt(6)
    ds_write_b128 v5, v[12:15] offset:4224
    s_waitcnt vmcnt(5)
    ds_write_b128 v5, v[16:19] offset:8448
    s_waitcnt vmcnt(4)
    ds_write_b128 v5, v[20:23] offset:12672
    s_waitcnt vmcnt(3)
    ds_write_b128 v5, v[24:27] offset:16896
    s_waitcnt vmcnt(2)
    ds_write_b128 v5, v[28:31] offset:21120
    s_waitcnt vmcnt(1)
    ds_write_b128 v5, v[32:35] offset:25344
    s_waitcnt vmcnt(0)
    ds_write_b128 v5, v[36:39] offset:29568
    v_lshrrev_b32 v6, 2, v2
    v_mul_u32_u24 v6, 1056, v6
    v_and_b32 v7, 3, v2
    v_lshl_add_u32 v6, v7, 3, v6
    s_lshl_b32 s17, s15, 8
    v_add_u32 v6, s17, v6
    s_waitcnt lgkmcnt(0)
    s_barrier
    ds_read_b64_tr_b16 v[8:9], v6 offset:0
    ds_read_b64_tr_b16 v[10:11], v6 offset:16896
    ds_read_b64_tr_b16 v[12:13], v6 offset:32
    ds_read_b64_tr_b16 v[14:15], v6 offset:16928
    ds_read_b64_tr_b16 v[16:17], v6 offset:64
    ds_read_b64_tr_b16 v[18:19], v6 offset:16960
    ds_read_b64_tr_b16 v[20:21], v6 offset:96
    ds_read_b64_tr_b16 v[22:23], v6 offset:16992
    ds_read_b64_tr_b16 v[24:25], v6 offset:128
    ds_read_b64_tr_b16 v[26:27], v6 offset:17024
    ds_read_b64_tr_b16 v[28:29], v6 offset:160
    ds_read_b64_tr_b16 v[30:31], v6 offset:17056
    ds_read_b64_tr_b16 v[32:33], v6 offset:192
    ds_read_b64_tr_b16 v[34:35], v6 offset:17088
    ds_read_b64_tr_b16 v[36:37], v6 offset:224
    ds_read_b64_tr_b16 v[38:39], v6 offset:17120
    s_lshl_b32 s17, s15, 13
    s_add_u32 s16, s16, s17
    s_add_u32 s16, s16, 0x4800000
    s_waitcnt lgkmcnt(14)
    buffer_store_dwordx4 v[8:11], v3, s[4:7], s16 offen offset:0 sc1
    s_waitcnt lgkmcnt(12)
    buffer_store_dwordx4 v[12:15], v3, s[4:7], s16 offen offset:1024 sc1
    s_waitcnt lgkmcnt(10)
    buffer_store_dwordx4 v[16:19], v3, s[4:7], s16 offen offset:2048 sc1
    s_waitcnt lgkmcnt(8)
    buffer_store_dwordx4 v[20:23], v3, s[4:7], s16 offen offset:3072 sc1
    s_waitcnt lgkmcnt(6)
    s_add_u32 s16, s16, 4096
    buffer_store_dwordx4 v[24:27], v3, s[4:7], s16 offen offset:0 sc1
    s_waitcnt lgkmcnt(4)
    buffer_store_dwordx4 v[28:31], v3, s[4:7], s16 offen offset:1024 sc1
    s_waitcnt lgkmcnt(2)
    buffer_store_dwordx4 v[32:35], v3, s[4:7], s16 offen offset:2048 sc1
    s_waitcnt lgkmcnt(0)
    buffer_store_dwordx4 v[36:39], v3, s[4:7], s16 offen offset:3072 sc1
    s_branch main_kernel_sig
main_kernel_t_ssm:
    s_sub_u32 s49, s49, 1088
    s_mov_b32 s92, 19
    v_lshrrev_b32 v1, 6, v0
    s_nop 0
    v_readfirstlane_b32 s15, v1
    v_and_b32 v2, 63, v0
    s_lshr_b32 s12, s15, 1
    s_and_b32 s13, s15, 1
    s_lshl_b32 s14, s49, 1
    s_add_u32 s14, s14, s12
    s_load_dwordx16 s[68:83], s[0:1], 64
    s_mul_i32 s20, s12, 36032
    s_mov_b32 s8, s52
    s_and_b32 s9, s53, 0xffff
    s_mov_b32 s10, 0x200000
    s_mov_b32 s11, 0x00020000
    s_waitcnt lgkmcnt(0)
    s_barrier
    v_lshlrev_b32 v3, 10, v0
    s_lshl_b32 s16, s49, 2
    v_add_u32 v3, s16, v3
    s_mov_b32 s16, 0
    buffer_load_dword v100, v3, s[8:11], s16 offen
    s_mov_b32 s16, 262144
    buffer_load_dword v101, v3, s[8:11], s16 offen
    s_mov_b32 s16, 524288
    buffer_load_dword v102, v3, s[8:11], s16 offen
    s_mov_b32 s16, 786432
    buffer_load_dword v103, v3, s[8:11], s16 offen
    s_mov_b32 s16, 1048576
    buffer_load_dword v104, v3, s[8:11], s16 offen
    s_mov_b32 s16, 1310720
    buffer_load_dword v105, v3, s[8:11], s16 offen
    s_mov_b32 s16, 1572864
    buffer_load_dword v106, v3, s[8:11], s16 offen
    s_mov_b32 s16, 1835008
    buffer_load_dword v107, v3, s[8:11], s16 offen
    v_lshlrev_b32 v4, 1, v2
    s_lshl_b32 s16, s14, 8
    v_add_u32 v4, s16, v4
    s_mov_b32 s24, s68
    s_and_b32 s25, s69, 0xffff
    s_mov_b32 s26, 0x20000
    s_mov_b32 s27, 0x00020000
    buffer_load_ushort v10, v4, s[24:27], 0 offen
    buffer_load_ushort v11, v4, s[24:27], 0 offen offset:128
    s_mov_b32 s24, s70
    s_and_b32 s25, s71, 0xffff
    s_mov_b32 s26, 0x20000
    s_mov_b32 s27, 0x00020000
    buffer_load_ushort v12, v4, s[24:27], 0 offen
    buffer_load_ushort v13, v4, s[24:27], 0 offen offset:128
    s_mov_b32 s24, s72
    s_and_b32 s25, s73, 0xffff
    s_mov_b32 s26, 0x20000
    s_mov_b32 s27, 0x00020000
    buffer_load_ushort v14, v4, s[24:27], 0 offen
    buffer_load_ushort v15, v4, s[24:27], 0 offen offset:128
    s_mov_b32 s24, s74
    s_and_b32 s25, s75, 0xffff
    s_mov_b32 s26, 0x20000
    s_mov_b32 s27, 0x00020000
    buffer_load_ushort v16, v4, s[24:27], 0 offen
    buffer_load_ushort v17, v4, s[24:27], 0 offen offset:128
    s_mov_b32 s24, s76
    s_and_b32 s25, s77, 0xffff
    s_mov_b32 s26, 0x20000
    s_mov_b32 s27, 0x00020000
    buffer_load_ushort v18, v4, s[24:27], 0 offen
    buffer_load_ushort v19, v4, s[24:27], 0 offen offset:128
    s_mov_b32 s24, s78
    s_and_b32 s25, s79, 0xffff
    s_mov_b32 s26, 0x20000
    s_mov_b32 s27, 0x00020000
    buffer_load_ushort v20, v4, s[24:27], 0 offen
    buffer_load_ushort v21, v4, s[24:27], 0 offen offset:128
    s_lshl_b32 s16, s14, 1
    v_mov_b32 v5, s16
    s_mov_b32 s24, s80
    s_and_b32 s25, s81, 0xffff
    s_mov_b32 s26, 0x400
    s_mov_b32 s27, 0x00020000
    buffer_load_ushort v22, v5, s[24:27], 0 offen
    s_mov_b32 s28, s82
    s_and_b32 s29, s83, 0xffff
    s_mov_b32 s30, 0x400
    s_mov_b32 s31, 0x00020000
    buffer_load_ushort v23, v5, s[28:31], 0 offen
    v_mov_b32 v6, 0
    v_and_b32 v7, 127, v0
    v_lshlrev_b32 v7, 2, v7
    v_add_u32 v7, s20, v7
    ds_write_b32 v7, v6 offset:17024
    s_mov_b64 exec, 0xffff
    v_lshlrev_b32 v8, 2, v2
    v_add_u32 v8, s20, v8
    ds_write_b32 v8, v6 offset:4160
    ds_write_b32 v8, v6 offset:8380
    ds_write_b32 v8, v6 offset:12608
    ds_write_b32 v8, v6 offset:16828
    s_mov_b64 exec, -1
    v_lshlrev_b32 v9, 1, v0
    s_waitcnt vmcnt(14)
    ds_write_b16 v9, v100 offset:17536
    ds_write_b16_d16_hi v9, v100 offset:53568
    ds_write_b16 v9, v101 offset:18048
    ds_write_b16_d16_hi v9, v101 offset:54080
    ds_write_b16 v9, v102 offset:18560
    ds_write_b16_d16_hi v9, v102 offset:54592
    ds_write_b16 v9, v103 offset:19072
    ds_write_b16_d16_hi v9, v103 offset:55104
    ds_write_b16 v9, v104 offset:19584
    ds_write_b16_d16_hi v9, v104 offset:55616
    ds_write_b16 v9, v105 offset:20096
    ds_write_b16_d16_hi v9, v105 offset:56128
    ds_write_b16 v9, v106 offset:20608
    ds_write_b16_d16_hi v9, v106 offset:56640
    ds_write_b16 v9, v107 offset:21120
    ds_write_b16_d16_hi v9, v107 offset:57152
    s_waitcnt vmcnt(0)
    v_lshlrev_b32 v10, 16, v10
    v_lshlrev_b32 v11, 16, v11
    v_lshlrev_b32 v12, 16, v12
    v_lshlrev_b32 v13, 16, v13
    v_lshlrev_b32 v14, 16, v14
    v_lshlrev_b32 v15, 16, v15
    v_lshlrev_b32 v16, 16, v16
    v_lshlrev_b32 v17, 16, v17
    v_lshlrev_b32 v18, 16, v18
    v_lshlrev_b32 v19, 16, v19
    v_lshlrev_b32 v20, 16, v20
    v_lshlrev_b32 v21, 16, v21
    v_lshlrev_b32 v22, 16, v22
    v_lshlrev_b32 v23, 16, v23
    v_mul_f32 v22, 0x3fb8aa3b, v22
    v_exp_f32 v22, v22
    s_nop 0
    v_cvt_pk_bf16_f32 v22, v22, v22
    v_and_b32 v22, 0xffff0000, v22
    v_mul_f32 v10, v22, v10
    v_mul_f32 v10, 0x3fb8aa3b, v10
    v_mul_f32 v12, v22, v12
    v_mul_f32 v12, 0.15915494, v12
    v_mul_f32 v14, v22, v14
    v_mul_f32 v16, v22, v16
    v_mul_f32 v24, v18, v14
    v_mul_f32 v25, v18, v16
    v_fma_f32 v26, -v20, v16, v24
    v_fma_f32 v28, v20, v14, v25
    v_mul_f32 v11, v22, v11
    v_mul_f32 v11, 0x3fb8aa3b, v11
    v_mul_f32 v13, v22, v13
    v_mul_f32 v13, 0.15915494, v13
    v_mul_f32 v15, v22, v15
    v_mul_f32 v17, v22, v17
    v_mul_f32 v24, v19, v15
    v_mul_f32 v25, v19, v17
    v_fma_f32 v27, -v21, v17, v24
    v_fma_f32 v29, v21, v15, v25
    v_lshlrev_b32 v8, 4, v2
    v_add_u32 v8, s20, v8
    v_mov_b32 v32, v10
    v_mov_b32 v33, v12
    v_mov_b32 v34, v26
    v_mov_b32 v35, v28
    ds_write_b128 v8, v[32:35] offset:29888
    v_mov_b32 v32, v11
    v_mov_b32 v33, v13
    v_mov_b32 v34, v27
    v_mov_b32 v35, v29
    ds_write_b128 v8, v[32:35] offset:30912
    v_mul_f32 v36, 0x45000000, v10
    v_mul_f32 v38, 0x45000000, v12
    v_exp_f32 v36, v36
    v_fract_f32 v38, v38
    v_cos_f32 v40, v38
    v_sin_f32 v38, v38
    v_mul_f32 v40, v26, v40
    v_fma_f32 v40, -v28, v38, v40
    v_mul_f32 v40, v36, v40
    v_mul_f32 v37, 0x45000000, v11
    v_mul_f32 v39, 0x45000000, v13
    v_exp_f32 v37, v37
    v_fract_f32 v39, v39
    v_cos_f32 v41, v39
    v_sin_f32 v39, v39
    v_mul_f32 v41, v27, v41
    v_fma_f32 v41, -v29, v39, v41
    v_mul_f32 v41, v37, v41
    v_add_f32 v40, v40, v41
    s_nop 1
    v_mov_b32_dpp v41, v40 row_ror:1 row_mask:0xf bank_mask:0xf
    v_add_f32 v40, v40, v41
    s_nop 1
    v_mov_b32_dpp v41, v40 row_ror:2 row_mask:0xf bank_mask:0xf
    v_add_f32 v40, v40, v41
    s_nop 1
    v_mov_b32_dpp v41, v40 row_ror:4 row_mask:0xf bank_mask:0xf
    v_add_f32 v40, v40, v41
    s_nop 1
    v_mov_b32_dpp v41, v40 row_ror:8 row_mask:0xf bank_mask:0xf
    v_add_f32 v40, v40, v41
    v_mov_b32 v41, v40
    s_nop 1
    v_permlane32_swap_b32 v40, v41
    v_add_f32 v40, v40, v41
    v_mov_b32 v41, v40
    s_nop 1
    v_permlane16_swap_b32 v40, v41
    v_add_f32 v40, v40, v41
    v_mov_b32 v8, s20
    ds_write_b32 v8, v40 offset:29824
    v_and_b32 v3, 15, v2
    v_lshrrev_b32 v4, 4, v2
    v_cvt_f32_u32 v30, v3
    v_add_f32 v31, 0x41800000, v30
    s_lshl_b32 s21, s13, 10
    v_cvt_f32_u32 v32, s21
    s_mov_b32 s22, 0x42000000
    v_fma_f32 v28, v30, s22, v32
    v_fma_f32 v29, v31, s22, v32
    v_lshlrev_b32 v9, 6, v4
    v_add_u32 v9, s20, v9
    v_add_u32 v9, 29888, v9
    v_mov_b64 v[32:33], 0
    v_mov_b64 v[34:35], 0
    v_mov_b64 v[36:37], 0
    v_mov_b64 v[38:39], 0
    v_mov_b64 v[40:41], 0
    v_mov_b64 v[42:43], 0
    v_mov_b64 v[44:45], 0
    v_mov_b64 v[46:47], 0
    s_waitcnt lgkmcnt(0)
    s_barrier
    s_mov_b32 s21, 0
main_kernel_s_kl:
    ds_read_b128 v[48:51], v9 offset:0
    ds_read_b128 v[52:55], v9 offset:16
    ds_read_b128 v[56:59], v9 offset:32
    ds_read_b128 v[60:63], v9 offset:48
    v_add_u32 v9, 256, v9
    s_waitcnt lgkmcnt(3)
    v_mul_f32 v96, v48, v28
    v_mul_f32 v100, v49, v28
    s_waitcnt lgkmcnt(2)
    v_mul_f32 v97, v52, v28
    v_mul_f32 v101, v53, v28
    s_waitcnt lgkmcnt(1)
    v_mul_f32 v98, v56, v28
    v_mul_f32 v102, v57, v28
    s_waitcnt lgkmcnt(0)
    v_mul_f32 v99, v60, v28
    v_mul_f32 v103, v61, v28
    v_exp_f32 v96, v96
    v_fract_f32 v100, v100
    v_exp_f32 v97, v97
    v_fract_f32 v101, v101
    v_exp_f32 v98, v98
    v_fract_f32 v102, v102
    v_exp_f32 v99, v99
    v_fract_f32 v103, v103
    v_cos_f32 v104, v100
    v_sin_f32 v100, v100
    v_cos_f32 v105, v101
    v_sin_f32 v101, v101
    v_cos_f32 v106, v102
    v_sin_f32 v102, v102
    v_cos_f32 v107, v103
    v_sin_f32 v103, v103
    v_mul_f32 v108, v50, v104
    v_mul_f32 v109, v50, v100
    v_fma_f32 v108, -v51, v100, v108
    v_fma_f32 v109, v51, v104, v109
    v_mul_f32 v108, v96, v108
    v_mul_f32_e64 v109, -v96, v109
    v_cvt_pk_bf16_f32 v64, v108, v109
    v_lshlrev_b32 v110, 16, v64
    v_and_b32 v111, 0xffff0000, v64
    v_sub_f32 v108, v108, v110
    v_sub_f32 v109, v109, v111
    v_cvt_pk_bf16_f32 v80, v108, v109
    v_mul_f32 v108, v54, v105
    v_mul_f32 v109, v54, v101
    v_fma_f32 v108, -v55, v101, v108
    v_fma_f32 v109, v55, v105, v109
    v_mul_f32 v108, v97, v108
    v_mul_f32_e64 v109, -v97, v109
    v_cvt_pk_bf16_f32 v65, v108, v109
    v_lshlrev_b32 v110, 16, v65
    v_and_b32 v111, 0xffff0000, v65
    v_sub_f32 v108, v108, v110
    v_sub_f32 v109, v109, v111
    v_cvt_pk_bf16_f32 v81, v108, v109
    v_mul_f32 v108, v58, v106
    v_mul_f32 v109, v58, v102
    v_fma_f32 v108, -v59, v102, v108
    v_fma_f32 v109, v59, v106, v109
    v_mul_f32 v108, v98, v108
    v_mul_f32_e64 v109, -v98, v109
    v_cvt_pk_bf16_f32 v66, v108, v109
    v_lshlrev_b32 v110, 16, v66
    v_and_b32 v111, 0xffff0000, v66
    v_sub_f32 v108, v108, v110
    v_sub_f32 v109, v109, v111
    v_cvt_pk_bf16_f32 v82, v108, v109
    v_mul_f32 v108, v62, v107
    v_mul_f32 v109, v62, v103
    v_fma_f32 v108, -v63, v103, v108
    v_fma_f32 v109, v63, v107, v109
    v_mul_f32 v108, v99, v108
    v_mul_f32_e64 v109, -v99, v109
    v_cvt_pk_bf16_f32 v67, v108, v109
    v_lshlrev_b32 v110, 16, v67
    v_and_b32 v111, 0xffff0000, v67
    v_sub_f32 v108, v108, v110
    v_sub_f32 v109, v109, v111
    v_cvt_pk_bf16_f32 v83, v108, v109
    v_mul_f32 v96, v48, v29
    v_mul_f32 v100, v49, v29
    v_mul_f32 v97, v52, v29
    v_mul_f32 v101, v53, v29
    v_mul_f32 v98, v56, v29
    v_mul_f32 v102, v57, v29
    v_mul_f32 v99, v60, v29
    v_mul_f32 v103, v61, v29
    v_exp_f32 v96, v96
    v_fract_f32 v100, v100
    v_exp_f32 v97, v97
    v_fract_f32 v101, v101
    v_exp_f32 v98, v98
    v_fract_f32 v102, v102
    v_exp_f32 v99, v99
    v_fract_f32 v103, v103
    v_cos_f32 v104, v100
    v_sin_f32 v100, v100
    v_cos_f32 v105, v101
    v_sin_f32 v101, v101
    v_cos_f32 v106, v102
    v_sin_f32 v102, v102
    v_cos_f32 v107, v103
    v_sin_f32 v103, v103
    v_mul_f32 v108, v50, v104
    v_mul_f32 v109, v50, v100
    v_fma_f32 v108, -v51, v100, v108
    v_fma_f32 v109, v51, v104, v109
    v_mul_f32 v108, v96, v108
    v_mul_f32_e64 v109, -v96, v109
    v_cvt_pk_bf16_f32 v68, v108, v109
    v_lshlrev_b32 v110, 16, v68
    v_and_b32 v111, 0xffff0000, v68
    v_sub_f32 v108, v108, v110
    v_sub_f32 v109, v109, v111
    v_cvt_pk_bf16_f32 v84, v108, v109
    v_mul_f32 v108, v54, v105
    v_mul_f32 v109, v54, v101
    v_fma_f32 v108, -v55, v101, v108
    v_fma_f32 v109, v55, v105, v109
    v_mul_f32 v108, v97, v108
    v_mul_f32_e64 v109, -v97, v109
    v_cvt_pk_bf16_f32 v69, v108, v109
    v_lshlrev_b32 v110, 16, v69
    v_and_b32 v111, 0xffff0000, v69
    v_sub_f32 v108, v108, v110
    v_sub_f32 v109, v109, v111
    v_cvt_pk_bf16_f32 v85, v108, v109
    v_mul_f32 v108, v58, v106
    v_mul_f32 v109, v58, v102
    v_fma_f32 v108, -v59, v102, v108
    v_fma_f32 v109, v59, v106, v109
    v_mul_f32 v108, v98, v108
    v_mul_f32_e64 v109, -v98, v109
    v_cvt_pk_bf16_f32 v70, v108, v109
    v_lshlrev_b32 v110, 16, v70
    v_and_b32 v111, 0xffff0000, v70
    v_sub_f32 v108, v108, v110
    v_sub_f32 v109, v109, v111
    v_cvt_pk_bf16_f32 v86, v108, v109
    v_mul_f32 v108, v62, v107
    v_mul_f32 v109, v62, v103
    v_fma_f32 v108, -v63, v103, v108
    v_fma_f32 v109, v63, v107, v109
    v_mul_f32 v108, v99, v108
    v_mul_f32_e64 v109, -v99, v109
    v_cvt_pk_bf16_f32 v71, v108, v109
    v_lshlrev_b32 v110, 16, v71
    v_and_b32 v111, 0xffff0000, v71
    v_sub_f32 v108, v108, v110
    v_sub_f32 v109, v109, v111
    v_cvt_pk_bf16_f32 v87, v108, v109
    v_mul_f32 v96, v48, v30
    v_mul_f32 v100, v49, v30
    v_mul_f32 v97, v52, v30
    v_mul_f32 v101, v53, v30
    v_mul_f32 v98, v56, v30
    v_mul_f32 v102, v57, v30
    v_mul_f32 v99, v60, v30
    v_mul_f32 v103, v61, v30
    v_exp_f32 v96, v96
    v_fract_f32 v100, v100
    v_exp_f32 v97, v97
    v_fract_f32 v101, v101
    v_exp_f32 v98, v98
    v_fract_f32 v102, v102
    v_exp_f32 v99, v99
    v_fract_f32 v103, v103
    v_cos_f32 v104, v100
    v_sin_f32 v100, v100
    v_cos_f32 v105, v101
    v_sin_f32 v101, v101
    v_cos_f32 v106, v102
    v_sin_f32 v102, v102
    v_cos_f32 v107, v103
    v_sin_f32 v103, v103
    v_mul_f32 v108, v96, v104
    v_mul_f32 v109, v96, v100
    v_cvt_pk_bf16_f32 v72, v108, v109
    v_lshlrev_b32 v110, 16, v72
    v_and_b32 v111, 0xffff0000, v72
    v_sub_f32 v108, v108, v110
    v_sub_f32 v109, v109, v111
    v_cvt_pk_bf16_f32 v88, v108, v109
    v_mul_f32 v108, v97, v105
    v_mul_f32 v109, v97, v101
    v_cvt_pk_bf16_f32 v73, v108, v109
    v_lshlrev_b32 v110, 16, v73
    v_and_b32 v111, 0xffff0000, v73
    v_sub_f32 v108, v108, v110
    v_sub_f32 v109, v109, v111
    v_cvt_pk_bf16_f32 v89, v108, v109
    v_mul_f32 v108, v98, v106
    v_mul_f32 v109, v98, v102
    v_cvt_pk_bf16_f32 v74, v108, v109
    v_lshlrev_b32 v110, 16, v74
    v_and_b32 v111, 0xffff0000, v74
    v_sub_f32 v108, v108, v110
    v_sub_f32 v109, v109, v111
    v_cvt_pk_bf16_f32 v90, v108, v109
    v_mul_f32 v108, v99, v107
    v_mul_f32 v109, v99, v103
    v_cvt_pk_bf16_f32 v75, v108, v109
    v_lshlrev_b32 v110, 16, v75
    v_and_b32 v111, 0xffff0000, v75
    v_sub_f32 v108, v108, v110
    v_sub_f32 v109, v109, v111
    v_cvt_pk_bf16_f32 v91, v108, v109
    v_mul_f32 v96, v48, v31
    v_mul_f32 v100, v49, v31
    v_mul_f32 v97, v52, v31
    v_mul_f32 v101, v53, v31
    v_mul_f32 v98, v56, v31
    v_mul_f32 v102, v57, v31
    v_mul_f32 v99, v60, v31
    v_mul_f32 v103, v61, v31
    v_exp_f32 v96, v96
    v_fract_f32 v100, v100
    v_exp_f32 v97, v97
    v_fract_f32 v101, v101
    v_exp_f32 v98, v98
    v_fract_f32 v102, v102
    v_exp_f32 v99, v99
    v_fract_f32 v103, v103
    v_cos_f32 v104, v100
    v_sin_f32 v100, v100
    v_cos_f32 v105, v101
    v_sin_f32 v101, v101
    v_cos_f32 v106, v102
    v_sin_f32 v102, v102
    v_cos_f32 v107, v103
    v_sin_f32 v103, v103
    v_mul_f32 v108, v96, v104
    v_mul_f32 v109, v96, v100
    v_cvt_pk_bf16_f32 v76, v108, v109
    v_lshlrev_b32 v110, 16, v76
    v_and_b32 v111, 0xffff0000, v76
    v_sub_f32 v108, v108, v110
    v_sub_f32 v109, v109, v111
    v_cvt_pk_bf16_f32 v92, v108, v109
    v_mul_f32 v108, v97, v105
    v_mul_f32 v109, v97, v101
    v_cvt_pk_bf16_f32 v77, v108, v109
    v_lshlrev_b32 v110, 16, v77
    v_and_b32 v111, 0xffff0000, v77
    v_sub_f32 v108, v108, v110
    v_sub_f32 v109, v109, v111
    v_cvt_pk_bf16_f32 v93, v108, v109
    v_mul_f32 v108, v98, v106
    v_mul_f32 v109, v98, v102
    v_cvt_pk_bf16_f32 v78, v108, v109
    v_lshlrev_b32 v110, 16, v78
    v_and_b32 v111, 0xffff0000, v78
    v_sub_f32 v108, v108, v110
    v_sub_f32 v109, v109, v111
    v_cvt_pk_bf16_f32 v94, v108, v109
    v_mul_f32 v108, v99, v107
    v_mul_f32 v109, v99, v103
    v_cvt_pk_bf16_f32 v79, v108, v109
    v_lshlrev_b32 v110, 16, v79
    v_and_b32 v111, 0xffff0000, v79
    v_sub_f32 v108, v108, v110
    v_sub_f32 v109, v109, v111
    v_cvt_pk_bf16_f32 v95, v108, v109
    v_mfma_f32_16x16x32_bf16 v[32:35], v[64:67], v[72:75], v[32:35]
    v_mfma_f32_16x16x32_bf16 v[32:35], v[64:67], v[88:91], v[32:35]
    v_mfma_f32_16x16x32_bf16 v[32:35], v[80:83], v[72:75], v[32:35]
    v_mfma_f32_16x16x32_bf16 v[36:39], v[64:67], v[76:79], v[36:39]
    v_mfma_f32_16x16x32_bf16 v[36:39], v[64:67], v[92:95], v[36:39]
    v_mfma_f32_16x16x32_bf16 v[36:39], v[80:83], v[76:79], v[36:39]
    v_mfma_f32_16x16x32_bf16 v[40:43], v[68:71], v[72:75], v[40:43]
    v_mfma_f32_16x16x32_bf16 v[40:43], v[68:71], v[88:91], v[40:43]
    v_mfma_f32_16x16x32_bf16 v[40:43], v[84:87], v[72:75], v[40:43]
    v_mfma_f32_16x16x32_bf16 v[44:47], v[68:71], v[76:79], v[44:47]
    v_mfma_f32_16x16x32_bf16 v[44:47], v[68:71], v[92:95], v[44:47]
    v_mfma_f32_16x16x32_bf16 v[44:47], v[84:87], v[76:79], v[44:47]
    s_add_u32 s21, s21, 1
    s_cmp_lt_u32 s21, 8
    s_nop 4
    s_cbranch_scc1 main_kernel_s_kl
    v_lshlrev_b32 v8, 9, v4
    v_lshl_add_u32 v8, v3, 2, v8
    s_lshl_b32 s21, s13, 12
    s_add_u32 s21, s21, s20
    v_add_u32 v8, s21, v8
    ds_write_b32 v8, v32 offset:21632
    ds_write_b32 v8, v33 offset:21760
    ds_write_b32 v8, v34 offset:21888
    ds_write_b32 v8, v35 offset:22016
    ds_write_b32 v8, v36 offset:21696
    ds_write_b32 v8, v37 offset:21824
    ds_write_b32 v8, v38 offset:21952
    ds_write_b32 v8, v39 offset:22080
    ds_write_b32 v8, v40 offset:23680
    ds_write_b32 v8, v41 offset:23808
    ds_write_b32 v8, v42 offset:23936
    ds_write_b32 v8, v43 offset:24064
    ds_write_b32 v8, v44 offset:23744
    ds_write_b32 v8, v45 offset:23872
    ds_write_b32 v8, v46 offset:24000
    ds_write_b32 v8, v47 offset:24128
    s_waitcnt lgkmcnt(0)
    s_barrier
    v_and_b32 v7, 127, v0
    v_add_u32 v8, 0, v7
    v_lshlrev_b32 v9, 2, v8
    v_add_u32 v9, s20, v9
    ds_read_b32 v60, v9 offset:21632
    v_add_u32 v8, 128, v7
    v_lshlrev_b32 v9, 2, v8
    v_add_u32 v9, s20, v9
    ds_read_b32 v61, v9 offset:21632
    v_add_u32 v8, 256, v7
    v_cvt_f32_u32 v9, v8
    v_cvt_pk_bf16_f32 v9, v9, v9
    v_and_b32 v9, 0xffff0000, v9
    v_cvt_u32_f32 v9, v9
    v_lshlrev_b32 v9, 2, v9
    v_add_u32 v9, s20, v9
    ds_read_b32 v62, v9 offset:21632
    v_add_u32 v8, 384, v7
    v_cvt_f32_u32 v9, v8
    v_cvt_pk_bf16_f32 v9, v9, v9
    v_and_b32 v9, 0xffff0000, v9
    v_cvt_u32_f32 v9, v9
    v_lshlrev_b32 v9, 2, v9
    v_add_u32 v9, s20, v9
    ds_read_b32 v63, v9 offset:21632
    v_add_u32 v8, 512, v7
    v_cvt_f32_u32 v9, v8
    v_cvt_pk_bf16_f32 v9, v9, v9
    v_and_b32 v9, 0xffff0000, v9
    v_cvt_u32_f32 v9, v9
    v_lshlrev_b32 v9, 2, v9
    v_add_u32 v9, s20, v9
    ds_read_b32 v64, v9 offset:21632
    v_add_u32 v8, 640, v7
    v_cvt_f32_u32 v9, v8
    v_cvt_pk_bf16_f32 v9, v9, v9
    v_and_b32 v9, 0xffff0000, v9
    v_cvt_u32_f32 v9, v9
    v_lshlrev_b32 v9, 2, v9
    v_add_u32 v9, s20, v9
    ds_read_b32 v65, v9 offset:21632
    v_add_u32 v8, 768, v7
    v_cvt_f32_u32 v9, v8
    v_cvt_pk_bf16_f32 v9, v9, v9
    v_and_b32 v9, 0xffff0000, v9
    v_cvt_u32_f32 v9, v9
    v_lshlrev_b32 v9, 2, v9
    v_add_u32 v9, s20, v9
    ds_read_b32 v66, v9 offset:21632
    v_add_u32 v8, 896, v7
    v_cvt_f32_u32 v9, v8
    v_cvt_pk_bf16_f32 v9, v9, v9
    v_and_b32 v9, 0xffff0000, v9
    v_cvt_u32_f32 v9, v9
    v_lshlrev_b32 v9, 2, v9
    v_add_u32 v9, s20, v9
    ds_read_b32 v67, v9 offset:21632
    v_add_u32 v8, 1024, v7
    v_cvt_f32_u32 v9, v8
    v_cvt_pk_bf16_f32 v9, v9, v9
    v_and_b32 v9, 0xffff0000, v9
    v_cvt_u32_f32 v9, v9
    v_lshlrev_b32 v9, 2, v9
    v_add_u32 v9, s20, v9
    ds_read_b32 v68, v9 offset:21632
    v_add_u32 v8, 1152, v7
    v_cvt_f32_u32 v9, v8
    v_cvt_pk_bf16_f32 v9, v9, v9
    v_and_b32 v9, 0xffff0000, v9
    v_cvt_u32_f32 v9, v9
    v_lshlrev_b32 v9, 2, v9
    v_add_u32 v9, s20, v9
    ds_read_b32 v69, v9 offset:21632
    v_add_u32 v8, 1280, v7
    v_cvt_f32_u32 v9, v8
    v_cvt_pk_bf16_f32 v9, v9, v9
    v_and_b32 v9, 0xffff0000, v9
    v_cvt_u32_f32 v9, v9
    v_lshlrev_b32 v9, 2, v9
    v_add_u32 v9, s20, v9
    ds_read_b32 v70, v9 offset:21632
    v_add_u32 v8, 1408, v7
    v_cvt_f32_u32 v9, v8
    v_cvt_pk_bf16_f32 v9, v9, v9
    v_and_b32 v9, 0xffff0000, v9
    v_cvt_u32_f32 v9, v9
    v_lshlrev_b32 v9, 2, v9
    v_add_u32 v9, s20, v9
    ds_read_b32 v71, v9 offset:21632
    v_add_u32 v8, 1536, v7
    v_cvt_f32_u32 v9, v8
    v_cvt_pk_bf16_f32 v9, v9, v9
    v_and_b32 v9, 0xffff0000, v9
    v_cvt_u32_f32 v9, v9
    v_lshlrev_b32 v9, 2, v9
    v_add_u32 v9, s20, v9
    ds_read_b32 v72, v9 offset:21632
    v_add_u32 v8, 1664, v7
    v_cvt_f32_u32 v9, v8
    v_cvt_pk_bf16_f32 v9, v9, v9
    v_and_b32 v9, 0xffff0000, v9
    v_cvt_u32_f32 v9, v9
    v_lshlrev_b32 v9, 2, v9
    v_add_u32 v9, s20, v9
    ds_read_b32 v73, v9 offset:21632
    v_add_u32 v8, 1792, v7
    v_cvt_f32_u32 v9, v8
    v_cvt_pk_bf16_f32 v9, v9, v9
    v_and_b32 v9, 0xffff0000, v9
    v_cvt_u32_f32 v9, v9
    v_lshlrev_b32 v9, 2, v9
    v_add_u32 v9, s20, v9
    ds_read_b32 v74, v9 offset:21632
    v_add_u32 v8, 1920, v7
    v_cvt_f32_u32 v9, v8
    v_cvt_pk_bf16_f32 v9, v9, v9
    v_and_b32 v9, 0xffff0000, v9
    v_cvt_u32_f32 v9, v9
    v_lshlrev_b32 v9, 2, v9
    v_add_u32 v9, s20, v9
    ds_read_b32 v75, v9 offset:21632
    v_lshlrev_b32 v8, 1, v7
    v_sub_u32 v8, 254, v8
    v_add_u32 v8, s20, v8
    s_waitcnt lgkmcnt(15)
    v_cvt_pk_bf16_f32 v9, v60, v60
    v_and_b32 v10, 0xffff0000, v9
    v_sub_f32 v10, v60, v10
    v_cvt_pk_bf16_f32 v60, v10, v10
    v_mov_b32 v80, v9
    s_waitcnt lgkmcnt(14)
    v_cvt_pk_bf16_f32 v9, v61, v61
    v_and_b32 v10, 0xffff0000, v9
    v_sub_f32 v10, v61, v10
    v_cvt_pk_bf16_f32 v61, v10, v10
    v_mov_b32 v81, v9
    s_waitcnt lgkmcnt(13)
    v_cvt_pk_bf16_f32 v9, v62, v62
    v_and_b32 v10, 0xffff0000, v9
    v_sub_f32 v10, v62, v10
    v_cvt_pk_bf16_f32 v62, v10, v10
    v_mov_b32 v82, v9
    s_waitcnt lgkmcnt(12)
    v_cvt_pk_bf16_f32 v9, v63, v63
    v_and_b32 v10, 0xffff0000, v9
    v_sub_f32 v10, v63, v10
    v_cvt_pk_bf16_f32 v63, v10, v10
    v_mov_b32 v83, v9
    s_waitcnt lgkmcnt(11)
    v_cvt_pk_bf16_f32 v9, v64, v64
    v_and_b32 v10, 0xffff0000, v9
    v_sub_f32 v10, v64, v10
    v_cvt_pk_bf16_f32 v64, v10, v10
    v_mov_b32 v84, v9
    s_waitcnt lgkmcnt(10)
    v_cvt_pk_bf16_f32 v9, v65, v65
    v_and_b32 v10, 0xffff0000, v9
    v_sub_f32 v10, v65, v10
    v_cvt_pk_bf16_f32 v65, v10, v10
    v_mov_b32 v85, v9
    s_waitcnt lgkmcnt(9)
    v_cvt_pk_bf16_f32 v9, v66, v66
    v_and_b32 v10, 0xffff0000, v9
    v_sub_f32 v10, v66, v10
    v_cvt_pk_bf16_f32 v66, v10, v10
    v_mov_b32 v86, v9
    s_waitcnt lgkmcnt(8)
    v_cvt_pk_bf16_f32 v9, v67, v67
    v_and_b32 v10, 0xffff0000, v9
    v_sub_f32 v10, v67, v10
    v_cvt_pk_bf16_f32 v67, v10, v10
    v_mov_b32 v87, v9
    s_waitcnt lgkmcnt(7)
    v_cvt_pk_bf16_f32 v9, v68, v68
    v_and_b32 v10, 0xffff0000, v9
    v_sub_f32 v10, v68, v10
    v_cvt_pk_bf16_f32 v68, v10, v10
    v_mov_b32 v88, v9
    s_waitcnt lgkmcnt(6)
    v_cvt_pk_bf16_f32 v9, v69, v69
    v_and_b32 v10, 0xffff0000, v9
    v_sub_f32 v10, v69, v10
    v_cvt_pk_bf16_f32 v69, v10, v10
    v_mov_b32 v89, v9
    s_waitcnt lgkmcnt(5)
    v_cvt_pk_bf16_f32 v9, v70, v70
    v_and_b32 v10, 0xffff0000, v9
    v_sub_f32 v10, v70, v10
    v_cvt_pk_bf16_f32 v70, v10, v10
    v_mov_b32 v90, v9
    s_waitcnt lgkmcnt(4)
    v_cvt_pk_bf16_f32 v9, v71, v71
    v_and_b32 v10, 0xffff0000, v9
    v_sub_f32 v10, v71, v10
    v_cvt_pk_bf16_f32 v71, v10, v10
    v_mov_b32 v91, v9
    s_waitcnt lgkmcnt(3)
    v_cvt_pk_bf16_f32 v9, v72, v72
    v_and_b32 v10, 0xffff0000, v9
    v_sub_f32 v10, v72, v10
    v_cvt_pk_bf16_f32 v72, v10, v10
    v_mov_b32 v92, v9
    s_waitcnt lgkmcnt(2)
    v_cvt_pk_bf16_f32 v9, v73, v73
    v_and_b32 v10, 0xffff0000, v9
    v_sub_f32 v10, v73, v10
    v_cvt_pk_bf16_f32 v73, v10, v10
    v_mov_b32 v93, v9
    s_waitcnt lgkmcnt(1)
    v_cvt_pk_bf16_f32 v9, v74, v74
    v_and_b32 v10, 0xffff0000, v9
    v_sub_f32 v10, v74, v10
    v_cvt_pk_bf16_f32 v74, v10, v10
    v_mov_b32 v94, v9
    s_waitcnt lgkmcnt(0)
    v_cvt_pk_bf16_f32 v9, v75, v75
    v_and_b32 v10, 0xffff0000, v9
    v_sub_f32 v10, v75, v10
    v_cvt_pk_bf16_f32 v75, v10, v10
    v_mov_b32 v95, v9
    s_waitcnt lgkmcnt(0)
    ds_write_b16 v8, v80 offset:3904
    ds_write_b16 v8, v60 offset:12352
    ds_write_b16 v8, v80 offset:8126
    ds_write_b16 v8, v60 offset:16574
    ds_write_b16 v8, v81 offset:3648
    ds_write_b16 v8, v61 offset:12096
    ds_write_b16 v8, v81 offset:7870
    ds_write_b16 v8, v61 offset:16318
    ds_write_b16 v8, v82 offset:3392
    ds_write_b16 v8, v62 offset:11840
    ds_write_b16 v8, v82 offset:7614
    ds_write_b16 v8, v62 offset:16062
    ds_write_b16 v8, v83 offset:3136
    ds_write_b16 v8, v63 offset:11584
    ds_write_b16 v8, v83 offset:7358
    ds_write_b16 v8, v63 offset:15806
    ds_write_b16 v8, v84 offset:2880
    ds_write_b16 v8, v64 offset:11328
    ds_write_b16 v8, v84 offset:7102
    ds_write_b16 v8, v64 offset:15550
    ds_write_b16 v8, v85 offset:2624
    ds_write_b16 v8, v65 offset:11072
    ds_write_b16 v8, v85 offset:6846
    ds_write_b16 v8, v65 offset:15294
    ds_write_b16 v8, v86 offset:2368
    ds_write_b16 v8, v66 offset:10816
    ds_write_b16 v8, v86 offset:6590
    ds_write_b16 v8, v66 offset:15038
    ds_write_b16 v8, v87 offset:2112
    ds_write_b16 v8, v67 offset:10560
    ds_write_b16 v8, v87 offset:6334
    ds_write_b16 v8, v67 offset:14782
    ds_write_b16 v8, v88 offset:1856
    ds_write_b16 v8, v68 offset:10304
    ds_write_b16 v8, v88 offset:6078
    ds_write_b16 v8, v68 offset:14526
    ds_write_b16 v8, v89 offset:1600
    ds_write_b16 v8, v69 offset:10048
    ds_write_b16 v8, v89 offset:5822
    ds_write_b16 v8, v69 offset:14270
    ds_write_b16 v8, v90 offset:1344
    ds_write_b16 v8, v70 offset:9792
    ds_write_b16 v8, v90 offset:5566
    ds_write_b16 v8, v70 offset:14014
    ds_write_b16 v8, v91 offset:1088
    ds_write_b16 v8, v71 offset:9536
    ds_write_b16 v8, v91 offset:5310
    ds_write_b16 v8, v71 offset:13758
    ds_write_b16 v8, v92 offset:832
    ds_write_b16 v8, v72 offset:9280
    ds_write_b16 v8, v92 offset:5054
    ds_write_b16 v8, v72 offset:13502
    ds_write_b16 v8, v93 offset:576
    ds_write_b16 v8, v73 offset:9024
    ds_write_b16 v8, v93 offset:4798
    ds_write_b16 v8, v73 offset:13246
    ds_write_b16 v8, v94 offset:320
    ds_write_b16 v8, v74 offset:8768
    ds_write_b16 v8, v94 offset:4542
    ds_write_b16 v8, v74 offset:12990
    ds_write_b16 v8, v95 offset:64
    ds_write_b16 v8, v75 offset:8512
    ds_write_b16 v8, v95 offset:4286
    ds_write_b16 v8, v75 offset:12734
    v_and_b32 v3, 15, v2
    v_lshrrev_b32 v4, 4, v2
    v_lshlrev_b32 v5, 4, v4
    v_lshlrev_b32 v6, 1, v3
    v_sub_u32 v5, v5, v6
    v_add_u32 v5, 94, v5
    v_add_u32 v5, s20, v5
    v_and_b32 v6, 1, v3
    v_xor_b32 v6, 1, v6
    v_mul_u32_u24 v6, 4222, v6
    v_add_u32 v5, v5, v6
    v_lshlrev_b32 v6, 5, v3
    v_lshl_add_u32 v6, v4, 4, v6
    v_add_u32 v6, 17056, v6
    v_add_u32 v6, s20, v6
    v_lshlrev_b32 v7, 5, v3
    v_lshl_add_u32 v7, v4, 3, v7
    v_add_u32 v7, s20, v7
    s_waitcnt lgkmcnt(0)
    s_barrier
    s_cmp_eq_u32 s13, 1
    s_cbranch_scc1 main_kernel_s_cv1
    v_add_u32 v120, 3584, v5
    v_add_u32 v121, 12032, v5
    ds_read2_b32 v[64:65], v120 offset0:112 offset1:113
    ds_read2_b32 v[66:67], v120 offset0:114 offset1:115
    ds_read2_b32 v[68:69], v121 offset0:112 offset1:113
    ds_read2_b32 v[70:71], v121 offset0:114 offset1:115
    ds_read_b128 v[96:99], v6 offset:448
    ds_read_b128 v[100:103], v6 offset:1984
    ds_read_b128 v[104:107], v6 offset:2496
    ds_read_b128 v[108:111], v6 offset:4032
    ds_read2_b32 v[72:73], v120 offset0:96 offset1:97
    ds_read2_b32 v[74:75], v120 offset0:98 offset1:99
    ds_read2_b32 v[76:77], v121 offset0:96 offset1:97
    ds_read2_b32 v[78:79], v121 offset0:98 offset1:99
    ds_read_b128 v[112:115], v6 offset:384
    s_waitcnt lgkmcnt(9)
    s_waitcnt lgkmcnt(8)
    v_mfma_f32_16x16x32_bf16 v[32:35], v[64:67], v[96:99], 0
    v_mfma_f32_16x16x32_bf16 v[32:35], v[68:71], v[96:99], v[32:35]
    ds_read_b128 v[116:119], v6 offset:1920
    s_waitcnt lgkmcnt(8)
    v_mfma_f32_16x16x32_bf16 v[36:39], v[64:67], v[100:103], 0
    v_mfma_f32_16x16x32_bf16 v[36:39], v[68:71], v[100:103], v[36:39]
    ds_read_b128 v[96:99], v6 offset:2432
    s_waitcnt lgkmcnt(8)
    v_mfma_f32_16x16x32_bf16 v[40:43], v[64:67], v[104:107], 0
    v_mfma_f32_16x16x32_bf16 v[40:43], v[68:71], v[104:107], v[40:43]
    ds_read_b128 v[100:103], v6 offset:3968
    ds_read2_b32 v[80:81], v120 offset0:80 offset1:81
    ds_read2_b32 v[82:83], v120 offset0:82 offset1:83
    ds_read2_b32 v[84:85], v121 offset0:80 offset1:81
    ds_read2_b32 v[86:87], v121 offset0:82 offset1:83
    s_waitcnt lgkmcnt(12)
    v_mfma_f32_16x16x32_bf16 v[44:47], v[64:67], v[108:111], 0
    v_mfma_f32_16x16x32_bf16 v[44:47], v[68:71], v[108:111], v[44:47]
    ds_read_b128 v[104:107], v6 offset:320
    s_waitcnt lgkmcnt(9)
    s_waitcnt lgkmcnt(8)
    v_mfma_f32_16x16x32_bf16 v[32:35], v[72:75], v[112:115], v[32:35]
    v_mfma_f32_16x16x32_bf16 v[32:35], v[76:79], v[112:115], v[32:35]
    ds_read_b128 v[108:111], v6 offset:1856
    s_waitcnt lgkmcnt(8)
    v_mfma_f32_16x16x32_bf16 v[36:39], v[72:75], v[116:119], v[36:39]
    v_mfma_f32_16x16x32_bf16 v[36:39], v[76:79], v[116:119], v[36:39]
    ds_read_b128 v[112:115], v6 offset:2368
    s_waitcnt lgkmcnt(8)
    v_mfma_f32_16x16x32_bf16 v[40:43], v[72:75], v[96:99], v[40:43]
    v_mfma_f32_16x16x32_bf16 v[40:43], v[76:79], v[96:99], v[40:43]
    ds_read_b128 v[116:119], v6 offset:3904
    ds_read2_b32 v[64:65], v120 offset0:64 offset1:65
    ds_read2_b32 v[66:67], v120 offset0:66 offset1:67
    ds_read2_b32 v[68:69], v121 offset0:64 offset1:65
    ds_read2_b32 v[70:71], v121 offset0:66 offset1:67
    s_waitcnt lgkmcnt(12)
    v_mfma_f32_16x16x32_bf16 v[44:47], v[72:75], v[100:103], v[44:47]
    v_mfma_f32_16x16x32_bf16 v[44:47], v[76:79], v[100:103], v[44:47]
    ds_read_b128 v[96:99], v6 offset:256
    s_waitcnt lgkmcnt(9)
    s_waitcnt lgkmcnt(8)
    v_mfma_f32_16x16x32_bf16 v[32:35], v[80:83], v[104:107], v[32:35]
    v_mfma_f32_16x16x32_bf16 v[32:35], v[84:87], v[104:107], v[32:35]
    ds_read_b128 v[100:103], v6 offset:1792
    s_waitcnt lgkmcnt(8)
    v_mfma_f32_16x16x32_bf16 v[36:39], v[80:83], v[108:111], v[36:39]
    v_mfma_f32_16x16x32_bf16 v[36:39], v[84:87], v[108:111], v[36:39]
    ds_read_b128 v[104:107], v6 offset:2304
    s_waitcnt lgkmcnt(8)
    v_mfma_f32_16x16x32_bf16 v[40:43], v[80:83], v[112:115], v[40:43]
    v_mfma_f32_16x16x32_bf16 v[40:43], v[84:87], v[112:115], v[40:43]
    ds_read_b128 v[108:111], v6 offset:3840
    ds_read2_b32 v[72:73], v120 offset0:48 offset1:49
    ds_read2_b32 v[74:75], v120 offset0:50 offset1:51
    ds_read2_b32 v[76:77], v121 offset0:48 offset1:49
    ds_read2_b32 v[78:79], v121 offset0:50 offset1:51
    s_waitcnt lgkmcnt(12)
    v_mfma_f32_16x16x32_bf16 v[44:47], v[80:83], v[116:119], v[44:47]
    v_mfma_f32_16x16x32_bf16 v[44:47], v[84:87], v[116:119], v[44:47]
    ds_read_b128 v[112:115], v6 offset:192
    s_waitcnt lgkmcnt(9)
    s_waitcnt lgkmcnt(8)
    v_mfma_f32_16x16x32_bf16 v[32:35], v[64:67], v[96:99], v[32:35]
    v_mfma_f32_16x16x32_bf16 v[32:35], v[68:71], v[96:99], v[32:35]
    ds_read_b128 v[116:119], v6 offset:1728
    s_waitcnt lgkmcnt(8)
    v_mfma_f32_16x16x32_bf16 v[36:39], v[64:67], v[100:103], v[36:39]
    v_mfma_f32_16x16x32_bf16 v[36:39], v[68:71], v[100:103], v[36:39]
    ds_read_b128 v[96:99], v6 offset:2240
    s_waitcnt lgkmcnt(8)
    v_mfma_f32_16x16x32_bf16 v[40:43], v[64:67], v[104:107], v[40:43]
    v_mfma_f32_16x16x32_bf16 v[40:43], v[68:71], v[104:107], v[40:43]
    ds_read_b128 v[100:103], v6 offset:3776
    ds_read2_b32 v[80:81], v120 offset0:32 offset1:33
    ds_read2_b32 v[82:83], v120 offset0:34 offset1:35
    ds_read2_b32 v[84:85], v121 offset0:32 offset1:33
    ds_read2_b32 v[86:87], v121 offset0:34 offset1:35
    s_waitcnt lgkmcnt(12)
    v_mfma_f32_16x16x32_bf16 v[44:47], v[64:67], v[108:111], v[44:47]
    v_mfma_f32_16x16x32_bf16 v[44:47], v[68:71], v[108:111], v[44:47]
    ds_read_b128 v[104:107], v6 offset:128
    s_waitcnt lgkmcnt(9)
    s_waitcnt lgkmcnt(8)
    v_mfma_f32_16x16x32_bf16 v[32:35], v[72:75], v[112:115], v[32:35]
    v_mfma_f32_16x16x32_bf16 v[32:35], v[76:79], v[112:115], v[32:35]
    ds_read_b128 v[108:111], v6 offset:1664
    s_waitcnt lgkmcnt(8)
    v_mfma_f32_16x16x32_bf16 v[36:39], v[72:75], v[116:119], v[36:39]
    v_mfma_f32_16x16x32_bf16 v[36:39], v[76:79], v[116:119], v[36:39]
    ds_read_b128 v[112:115], v6 offset:2176
    s_waitcnt lgkmcnt(8)
    v_mfma_f32_16x16x32_bf16 v[40:43], v[72:75], v[96:99], v[40:43]
    v_mfma_f32_16x16x32_bf16 v[40:43], v[76:79], v[96:99], v[40:43]
    ds_read_b128 v[116:119], v6 offset:3712
    ds_read2_b32 v[64:65], v120 offset0:16 offset1:17
    ds_read2_b32 v[66:67], v120 offset0:18 offset1:19
    ds_read2_b32 v[68:69], v121 offset0:16 offset1:17
    ds_read2_b32 v[70:71], v121 offset0:18 offset1:19
    s_waitcnt lgkmcnt(12)
    v_mfma_f32_16x16x32_bf16 v[44:47], v[72:75], v[100:103], v[44:47]
    v_mfma_f32_16x16x32_bf16 v[44:47], v[76:79], v[100:103], v[44:47]
    ds_read_b128 v[96:99], v6 offset:64
    s_waitcnt lgkmcnt(9)
    s_waitcnt lgkmcnt(8)
    v_mfma_f32_16x16x32_bf16 v[32:35], v[80:83], v[104:107], v[32:35]
    v_mfma_f32_16x16x32_bf16 v[32:35], v[84:87], v[104:107], v[32:35]
    ds_read_b128 v[100:103], v6 offset:1600
    s_waitcnt lgkmcnt(8)
    v_mfma_f32_16x16x32_bf16 v[36:39], v[80:83], v[108:111], v[36:39]
    v_mfma_f32_16x16x32_bf16 v[36:39], v[84:87], v[108:111], v[36:39]
    ds_read_b128 v[104:107], v6 offset:2112
    s_waitcnt lgkmcnt(8)
    v_mfma_f32_16x16x32_bf16 v[40:43], v[80:83], v[112:115], v[40:43]
    v_mfma_f32_16x16x32_bf16 v[40:43], v[84:87], v[112:115], v[40:43]
    ds_read_b128 v[108:111], v6 offset:3648
    ds_read2_b32 v[72:73], v120 offset0:0 offset1:1
    ds_read2_b32 v[74:75], v120 offset0:2 offset1:3
    ds_read2_b32 v[76:77], v121 offset0:0 offset1:1
    ds_read2_b32 v[78:79], v121 offset0:2 offset1:3
    s_waitcnt lgkmcnt(12)
    v_mfma_f32_16x16x32_bf16 v[44:47], v[80:83], v[116:119], v[44:47]
    v_mfma_f32_16x16x32_bf16 v[44:47], v[84:87], v[116:119], v[44:47]
    ds_read_b128 v[112:115], v6 offset:0
    s_waitcnt lgkmcnt(9)
    s_waitcnt lgkmcnt(8)
    v_mfma_f32_16x16x32_bf16 v[32:35], v[64:67], v[96:99], v[32:35]
    v_mfma_f32_16x16x32_bf16 v[32:35], v[68:71], v[96:99], v[32:35]
    ds_read_b128 v[116:119], v6 offset:1536
    s_waitcnt lgkmcnt(8)
    v_mfma_f32_16x16x32_bf16 v[36:39], v[64:67], v[100:103], v[36:39]
    v_mfma_f32_16x16x32_bf16 v[36:39], v[68:71], v[100:103], v[36:39]
    ds_read_b128 v[96:99], v6 offset:2048
    s_waitcnt lgkmcnt(8)
    v_mfma_f32_16x16x32_bf16 v[40:43], v[64:67], v[104:107], v[40:43]
    v_mfma_f32_16x16x32_bf16 v[40:43], v[68:71], v[104:107], v[40:43]
    ds_read_b128 v[100:103], v6 offset:3584
    v_add_u32 v120, 3072, v5
    v_add_u32 v121, 11520, v5
    ds_read2_b32 v[80:81], v120 offset0:112 offset1:113
    ds_read2_b32 v[82:83], v120 offset0:114 offset1:115
    ds_read2_b32 v[84:85], v121 offset0:112 offset1:113
    ds_read2_b32 v[86:87], v121 offset0:114 offset1:115
    s_waitcnt lgkmcnt(12)
    v_mfma_f32_16x16x32_bf16 v[44:47], v[64:67], v[108:111], v[44:47]
    v_mfma_f32_16x16x32_bf16 v[44:47], v[68:71], v[108:111], v[44:47]
    ds_read_b128 v[104:107], v6 offset:1472
    s_waitcnt lgkmcnt(9)
    s_waitcnt lgkmcnt(8)
    v_mfma_f32_16x16x32_bf16 v[32:35], v[72:75], v[112:115], v[32:35]
    v_mfma_f32_16x16x32_bf16 v[32:35], v[76:79], v[112:115], v[32:35]
    ds_read_b128 v[108:111], v6 offset:1984
    s_waitcnt lgkmcnt(8)
    v_mfma_f32_16x16x32_bf16 v[36:39], v[72:75], v[116:119], v[36:39]
    v_mfma_f32_16x16x32_bf16 v[36:39], v[76:79], v[116:119], v[36:39]
    ds_read_b128 v[112:115], v6 offset:3520
    ds_read2_b32 v[64:65], v120 offset0:96 offset1:97
    ds_read2_b32 v[66:67], v120 offset0:98 offset1:99
    ds_read2_b32 v[68:69], v121 offset0:96 offset1:97
    ds_read2_b32 v[70:71], v121 offset0:98 offset1:99
    s_waitcnt lgkmcnt(12)
    v_mfma_f32_16x16x32_bf16 v[40:43], v[72:75], v[96:99], v[40:43]
    v_mfma_f32_16x16x32_bf16 v[40:43], v[76:79], v[96:99], v[40:43]
    ds_read_b128 v[116:119], v6 offset:1408
    s_waitcnt lgkmcnt(12)
    v_mfma_f32_16x16x32_bf16 v[44:47], v[72:75], v[100:103], v[44:47]
    v_mfma_f32_16x16x32_bf16 v[44:47], v[76:79], v[100:103], v[44:47]
    ds_read_b128 v[96:99], v6 offset:1920
    s_waitcnt lgkmcnt(9)
    s_waitcnt lgkmcnt(8)
    v_mfma_f32_16x16x32_bf16 v[36:39], v[80:83], v[104:107], v[36:39]
    v_mfma_f32_16x16x32_bf16 v[36:39], v[84:87], v[104:107], v[36:39]
    ds_read_b128 v[100:103], v6 offset:3456
    ds_read2_b32 v[72:73], v120 offset0:80 offset1:81
    ds_read2_b32 v[74:75], v120 offset0:82 offset1:83
    ds_read2_b32 v[76:77], v121 offset0:80 offset1:81
    ds_read2_b32 v[78:79], v121 offset0:82 offset1:83
    s_waitcnt lgkmcnt(12)
    v_mfma_f32_16x16x32_bf16 v[40:43], v[80:83], v[108:111], v[40:43]
    v_mfma_f32_16x16x32_bf16 v[40:43], v[84:87], v[108:111], v[40:43]
    ds_read_b128 v[104:107], v6 offset:1344
    s_waitcnt lgkmcnt(12)
    v_mfma_f32_16x16x32_bf16 v[44:47], v[80:83], v[112:115], v[44:47]
    v_mfma_f32_16x16x32_bf16 v[44:47], v[84:87], v[112:115], v[44:47]
    ds_read_b128 v[108:111], v6 offset:1856
    s_waitcnt lgkmcnt(9)
    s_waitcnt lgkmcnt(8)
    v_mfma_f32_16x16x32_bf16 v[36:39], v[64:67], v[116:119], v[36:39]
    v_mfma_f32_16x16x32_bf16 v[36:39], v[68:71], v[116:119], v[36:39]
    ds_read_b128 v[112:115], v6 offset:3392
    ds_read2_b32 v[80:81], v120 offset0:64 offset1:65
    ds_read2_b32 v[82:83], v120 offset0:66 offset1:67
    ds_read2_b32 v[84:85], v121 offset0:64 offset1:65
    ds_read2_b32 v[86:87], v121 offset0:66 offset1:67
    s_waitcnt lgkmcnt(12)
    v_mfma_f32_16x16x32_bf16 v[40:43], v[64:67], v[96:99], v[40:43]
    v_mfma_f32_16x16x32_bf16 v[40:43], v[68:71], v[96:99], v[40:43]
    ds_read_b128 v[116:119], v6 offset:1280
    s_waitcnt lgkmcnt(12)
    v_mfma_f32_16x16x32_bf16 v[44:47], v[64:67], v[100:103], v[44:47]
    v_mfma_f32_16x16x32_bf16 v[44:47], v[68:71], v[100:103], v[44:47]
    ds_read_b128 v[96:99], v6 offset:1792
    s_waitcnt lgkmcnt(9)
    s_waitcnt lgkmcnt(8)
    v_mfma_f32_16x16x32_bf16 v[36:39], v[72:75], v[104:107], v[36:39]
    v_mfma_f32_16x16x32_bf16 v[36:39], v[76:79], v[104:107], v[36:39]
    ds_read_b128 v[100:103], v6 offset:3328
    ds_read2_b32 v[64:65], v120 offset0:48 offset1:49
    ds_read2_b32 v[66:67], v120 offset0:50 offset1:51
    ds_read2_b32 v[68:69], v121 offset0:48 offset1:49
    ds_read2_b32 v[70:71], v121 offset0:50 offset1:51
    s_waitcnt lgkmcnt(12)
    v_mfma_f32_16x16x32_bf16 v[40:43], v[72:75], v[108:111], v[40:43]
    v_mfma_f32_16x16x32_bf16 v[40:43], v[76:79], v[108:111], v[40:43]
    ds_read_b128 v[104:107], v6 offset:1216
    s_waitcnt lgkmcnt(12)
    v_mfma_f32_16x16x32_bf16 v[44:47], v[72:75], v[112:115], v[44:47]
    v_mfma_f32_16x16x32_bf16 v[44:47], v[76:79], v[112:115], v[44:47]
    ds_read_b128 v[108:111], v6 offset:1728
    s_waitcnt lgkmcnt(9)
    s_waitcnt lgkmcnt(8)
    v_mfma_f32_16x16x32_bf16 v[36:39], v[80:83], v[116:119], v[36:39]
    v_mfma_f32_16x16x32_bf16 v[36:39], v[84:87], v[116:119], v[36:39]
    ds_read_b128 v[112:115], v6 offset:3264
    ds_read2_b32 v[72:73], v120 offset0:32 offset1:33
    ds_read2_b32 v[74:75], v120 offset0:34 offset1:35
    ds_read2_b32 v[76:77], v121 offset0:32 offset1:33
    ds_read2_b32 v[78:79], v121 offset0:34 offset1:35
    s_waitcnt lgkmcnt(12)
    v_mfma_f32_16x16x32_bf16 v[40:43], v[80:83], v[96:99], v[40:43]
    v_mfma_f32_16x16x32_bf16 v[40:43], v[84:87], v[96:99], v[40:43]
    ds_read_b128 v[116:119], v6 offset:1152
    s_waitcnt lgkmcnt(12)
    v_mfma_f32_16x16x32_bf16 v[44:47], v[80:83], v[100:103], v[44:47]
    v_mfma_f32_16x16x32_bf16 v[44:47], v[84:87], v[100:103], v[44:47]
    ds_read_b128 v[96:99], v6 offset:1664
    s_waitcnt lgkmcnt(9)
    s_waitcnt lgkmcnt(8)
    v_mfma_f32_16x16x32_bf16 v[36:39], v[64:67], v[104:107], v[36:39]
    v_mfma_f32_16x16x32_bf16 v[36:39], v[68:71], v[104:107], v[36:39]
    ds_read_b128 v[100:103], v6 offset:3200
    ds_read2_b32 v[80:81], v120 offset0:16 offset1:17
    ds_read2_b32 v[82:83], v120 offset0:18 offset1:19
    ds_read2_b32 v[84:85], v121 offset0:16 offset1:17
    ds_read2_b32 v[86:87], v121 offset0:18 offset1:19
    s_waitcnt lgkmcnt(12)
    v_mfma_f32_16x16x32_bf16 v[40:43], v[64:67], v[108:111], v[40:43]
    v_mfma_f32_16x16x32_bf16 v[40:43], v[68:71], v[108:111], v[40:43]
    ds_read_b128 v[104:107], v6 offset:1088
    s_waitcnt lgkmcnt(12)
    v_mfma_f32_16x16x32_bf16 v[44:47], v[64:67], v[112:115], v[44:47]
    v_mfma_f32_16x16x32_bf16 v[44:47], v[68:71], v[112:115], v[44:47]
    ds_read_b128 v[108:111], v6 offset:1600
    s_waitcnt lgkmcnt(9)
    s_waitcnt lgkmcnt(8)
    v_mfma_f32_16x16x32_bf16 v[36:39], v[72:75], v[116:119], v[36:39]
    v_mfma_f32_16x16x32_bf16 v[36:39], v[76:79], v[116:119], v[36:39]
    ds_read_b128 v[112:115], v6 offset:3136
    ds_read2_b32 v[64:65], v120 offset0:0 offset1:1
    ds_read2_b32 v[66:67], v120 offset0:2 offset1:3
    ds_read2_b32 v[68:69], v121 offset0:0 offset1:1
    ds_read2_b32 v[70:71], v121 offset0:2 offset1:3
    s_waitcnt lgkmcnt(12)
    v_mfma_f32_16x16x32_bf16 v[40:43], v[72:75], v[96:99], v[40:43]
    v_mfma_f32_16x16x32_bf16 v[40:43], v[76:79], v[96:99], v[40:43]
    ds_read_b128 v[116:119], v6 offset:1024
    s_waitcnt lgkmcnt(12)
    v_mfma_f32_16x16x32_bf16 v[44:47], v[72:75], v[100:103], v[44:47]
    v_mfma_f32_16x16x32_bf16 v[44:47], v[76:79], v[100:103], v[44:47]
    ds_read_b128 v[96:99], v6 offset:1536
    s_waitcnt lgkmcnt(9)
    s_waitcnt lgkmcnt(8)
    v_mfma_f32_16x16x32_bf16 v[36:39], v[80:83], v[104:107], v[36:39]
    v_mfma_f32_16x16x32_bf16 v[36:39], v[84:87], v[104:107], v[36:39]
    ds_read_b128 v[100:103], v6 offset:3072
    v_add_u32 v120, 2560, v5
    v_add_u32 v121, 11008, v5
    ds_read2_b32 v[72:73], v120 offset0:112 offset1:113
    ds_read2_b32 v[74:75], v120 offset0:114 offset1:115
    ds_read2_b32 v[76:77], v121 offset0:112 offset1:113
    ds_read2_b32 v[78:79], v121 offset0:114 offset1:115
    s_waitcnt lgkmcnt(12)
    v_mfma_f32_16x16x32_bf16 v[40:43], v[80:83], v[108:111], v[40:43]
    v_mfma_f32_16x16x32_bf16 v[40:43], v[84:87], v[108:111], v[40:43]
    ds_read_b128 v[104:107], v6 offset:960
    s_waitcnt lgkmcnt(12)
    v_mfma_f32_16x16x32_bf16 v[44:47], v[80:83], v[112:115], v[44:47]
    v_mfma_f32_16x16x32_bf16 v[44:47], v[84:87], v[112:115], v[44:47]
    ds_read_b128 v[108:111], v6 offset:1472
    s_waitcnt lgkmcnt(9)
    s_waitcnt lgkmcnt(8)
    v_mfma_f32_16x16x32_bf16 v[36:39], v[64:67], v[116:119], v[36:39]
    v_mfma_f32_16x16x32_bf16 v[36:39], v[68:71], v[116:119], v[36:39]
    ds_read_b128 v[112:115], v6 offset:3008
    ds_read2_b32 v[80:81], v120 offset0:96 offset1:97
    ds_read2_b32 v[82:83], v120 offset0:98 offset1:99
    ds_read2_b32 v[84:85], v121 offset0:96 offset1:97
    ds_read2_b32 v[86:87], v121 offset0:98 offset1:99
    s_waitcnt lgkmcnt(12)
    v_mfma_f32_16x16x32_bf16 v[40:43], v[64:67], v[96:99], v[40:43]
    v_mfma_f32_16x16x32_bf16 v[40:43], v[68:71], v[96:99], v[40:43]
    ds_read_b128 v[116:119], v6 offset:896
    s_waitcnt lgkmcnt(12)
    v_mfma_f32_16x16x32_bf16 v[44:47], v[64:67], v[100:103], v[44:47]
    v_mfma_f32_16x16x32_bf16 v[44:47], v[68:71], v[100:103], v[44:47]
    ds_read_b128 v[96:99], v6 offset:1408
    s_waitcnt lgkmcnt(9)
    s_waitcnt lgkmcnt(8)
    v_mfma_f32_16x16x32_bf16 v[36:39], v[72:75], v[104:107], v[36:39]
    v_mfma_f32_16x16x32_bf16 v[36:39], v[76:79], v[104:107], v[36:39]
    ds_read_b128 v[100:103], v6 offset:2944
    ds_read2_b32 v[64:65], v120 offset0:80 offset1:81
    ds_read2_b32 v[66:67], v120 offset0:82 offset1:83
    ds_read2_b32 v[68:69], v121 offset0:80 offset1:81
    ds_read2_b32 v[70:71], v121 offset0:82 offset1:83
    s_waitcnt lgkmcnt(12)
    v_mfma_f32_16x16x32_bf16 v[40:43], v[72:75], v[108:111], v[40:43]
    v_mfma_f32_16x16x32_bf16 v[40:43], v[76:79], v[108:111], v[40:43]
    ds_read_b128 v[104:107], v6 offset:832
    s_waitcnt lgkmcnt(12)
    v_mfma_f32_16x16x32_bf16 v[44:47], v[72:75], v[112:115], v[44:47]
    v_mfma_f32_16x16x32_bf16 v[44:47], v[76:79], v[112:115], v[44:47]
    ds_read_b128 v[108:111], v6 offset:1344
    s_waitcnt lgkmcnt(9)
    s_waitcnt lgkmcnt(8)
    v_mfma_f32_16x16x32_bf16 v[36:39], v[80:83], v[116:119], v[36:39]
    v_mfma_f32_16x16x32_bf16 v[36:39], v[84:87], v[116:119], v[36:39]
    ds_read_b128 v[112:115], v6 offset:2880
    ds_read2_b32 v[72:73], v120 offset0:64 offset1:65
    ds_read2_b32 v[74:75], v120 offset0:66 offset1:67
    ds_read2_b32 v[76:77], v121 offset0:64 offset1:65
    ds_read2_b32 v[78:79], v121 offset0:66 offset1:67
    s_waitcnt lgkmcnt(12)
    v_mfma_f32_16x16x32_bf16 v[40:43], v[80:83], v[96:99], v[40:43]
    v_mfma_f32_16x16x32_bf16 v[40:43], v[84:87], v[96:99], v[40:43]
    ds_read_b128 v[116:119], v6 offset:768
    s_waitcnt lgkmcnt(12)
    v_mfma_f32_16x16x32_bf16 v[44:47], v[80:83], v[100:103], v[44:47]
    v_mfma_f32_16x16x32_bf16 v[44:47], v[84:87], v[100:103], v[44:47]
    ds_read_b128 v[96:99], v6 offset:1280
    s_waitcnt lgkmcnt(9)
    s_waitcnt lgkmcnt(8)
    v_mfma_f32_16x16x32_bf16 v[36:39], v[64:67], v[104:107], v[36:39]
    v_mfma_f32_16x16x32_bf16 v[36:39], v[68:71], v[104:107], v[36:39]
    ds_read_b128 v[100:103], v6 offset:2816
    ds_read2_b32 v[80:81], v120 offset0:48 offset1:49
    ds_read2_b32 v[82:83], v120 offset0:50 offset1:51
    ds_read2_b32 v[84:85], v121 offset0:48 offset1:49
    ds_read2_b32 v[86:87], v121 offset0:50 offset1:51
    s_waitcnt lgkmcnt(12)
    v_mfma_f32_16x16x32_bf16 v[40:43], v[64:67], v[108:111], v[40:43]
    v_mfma_f32_16x16x32_bf16 v[40:43], v[68:71], v[108:111], v[40:43]
    ds_read_b128 v[104:107], v6 offset:704
    s_waitcnt lgkmcnt(12)
    v_mfma_f32_16x16x32_bf16 v[44:47], v[64:67], v[112:115], v[44:47]
    v_mfma_f32_16x16x32_bf16 v[44:47], v[68:71], v[112:115], v[44:47]
    ds_read_b128 v[108:111], v6 offset:1216
    s_waitcnt lgkmcnt(9)
    s_waitcnt lgkmcnt(8)
    v_mfma_f32_16x16x32_bf16 v[36:39], v[72:75], v[116:119], v[36:39]
    v_mfma_f32_16x16x32_bf16 v[36:39], v[76:79], v[116:119], v[36:39]
    ds_read_b128 v[112:115], v6 offset:2752
    ds_read2_b32 v[64:65], v120 offset0:32 offset1:33
    ds_read2_b32 v[66:67], v120 offset0:34 offset1:35
    ds_read2_b32 v[68:69], v121 offset0:32 offset1:33
    ds_read2_b32 v[70:71], v121 offset0:34 offset1:35
    s_waitcnt lgkmcnt(12)
    v_mfma_f32_16x16x32_bf16 v[40:43], v[72:75], v[96:99], v[40:43]
    v_mfma_f32_16x16x32_bf16 v[40:43], v[76:79], v[96:99], v[40:43]
    ds_read_b128 v[116:119], v6 offset:640
    s_waitcnt lgkmcnt(12)
    v_mfma_f32_16x16x32_bf16 v[44:47], v[72:75], v[100:103], v[44:47]
    v_mfma_f32_16x16x32_bf16 v[44:47], v[76:79], v[100:103], v[44:47]
    ds_read_b128 v[96:99], v6 offset:1152
    s_waitcnt lgkmcnt(9)
    s_waitcnt lgkmcnt(8)
    v_mfma_f32_16x16x32_bf16 v[36:39], v[80:83], v[104:107], v[36:39]
    v_mfma_f32_16x16x32_bf16 v[36:39], v[84:87], v[104:107], v[36:39]
    ds_read_b128 v[100:103], v6 offset:2688
    ds_read2_b32 v[72:73], v120 offset0:16 offset1:17
    ds_read2_b32 v[74:75], v120 offset0:18 offset1:19
    ds_read2_b32 v[76:77], v121 offset0:16 offset1:17
    ds_read2_b32 v[78:79], v121 offset0:18 offset1:19
    s_waitcnt lgkmcnt(12)
    v_mfma_f32_16x16x32_bf16 v[40:43], v[80:83], v[108:111], v[40:43]
    v_mfma_f32_16x16x32_bf16 v[40:43], v[84:87], v[108:111], v[40:43]
    ds_read_b128 v[104:107], v6 offset:576
    s_waitcnt lgkmcnt(12)
    v_mfma_f32_16x16x32_bf16 v[44:47], v[80:83], v[112:115], v[44:47]
    v_mfma_f32_16x16x32_bf16 v[44:47], v[84:87], v[112:115], v[44:47]
    ds_read_b128 v[108:111], v6 offset:1088
    s_waitcnt lgkmcnt(9)
    s_waitcnt lgkmcnt(8)
    v_mfma_f32_16x16x32_bf16 v[36:39], v[64:67], v[116:119], v[36:39]
    v_mfma_f32_16x16x32_bf16 v[36:39], v[68:71], v[116:119], v[36:39]
    ds_read_b128 v[112:115], v6 offset:2624
    ds_read2_b32 v[80:81], v120 offset0:0 offset1:1
    ds_read2_b32 v[82:83], v120 offset0:2 offset1:3
    ds_read2_b32 v[84:85], v121 offset0:0 offset1:1
    ds_read2_b32 v[86:87], v121 offset0:2 offset1:3
    s_waitcnt lgkmcnt(12)
    v_mfma_f32_16x16x32_bf16 v[40:43], v[64:67], v[96:99], v[40:43]
    v_mfma_f32_16x16x32_bf16 v[40:43], v[68:71], v[96:99], v[40:43]
    ds_read_b128 v[116:119], v6 offset:512
    s_waitcnt lgkmcnt(12)
    v_mfma_f32_16x16x32_bf16 v[44:47], v[64:67], v[100:103], v[44:47]
    v_mfma_f32_16x16x32_bf16 v[44:47], v[68:71], v[100:103], v[44:47]
    ds_read_b128 v[96:99], v6 offset:1024
    s_waitcnt lgkmcnt(9)
    s_waitcnt lgkmcnt(8)
    v_mfma_f32_16x16x32_bf16 v[36:39], v[72:75], v[104:107], v[36:39]
    v_mfma_f32_16x16x32_bf16 v[36:39], v[76:79], v[104:107], v[36:39]
    ds_read_b128 v[100:103], v6 offset:2560
    v_add_u32 v120, 2048, v5
    v_add_u32 v121, 10496, v5
    ds_read2_b32 v[64:65], v120 offset0:112 offset1:113
    ds_read2_b32 v[66:67], v120 offset0:114 offset1:115
    ds_read2_b32 v[68:69], v121 offset0:112 offset1:113
    ds_read2_b32 v[70:71], v121 offset0:114 offset1:115
    s_waitcnt lgkmcnt(12)
    v_mfma_f32_16x16x32_bf16 v[40:43], v[72:75], v[108:111], v[40:43]
    v_mfma_f32_16x16x32_bf16 v[40:43], v[76:79], v[108:111], v[40:43]
    ds_read_b128 v[104:107], v6 offset:448
    s_waitcnt lgkmcnt(12)
    v_mfma_f32_16x16x32_bf16 v[44:47], v[72:75], v[112:115], v[44:47]
    v_mfma_f32_16x16x32_bf16 v[44:47], v[76:79], v[112:115], v[44:47]
    ds_read_b128 v[108:111], v6 offset:960
    s_waitcnt lgkmcnt(9)
    s_waitcnt lgkmcnt(8)
    v_mfma_f32_16x16x32_bf16 v[36:39], v[80:83], v[116:119], v[36:39]
    v_mfma_f32_16x16x32_bf16 v[36:39], v[84:87], v[116:119], v[36:39]
    ds_read_b128 v[112:115], v6 offset:2496
    ds_read2_b32 v[72:73], v120 offset0:96 offset1:97
    ds_read2_b32 v[74:75], v120 offset0:98 offset1:99
    ds_read2_b32 v[76:77], v121 offset0:96 offset1:97
    ds_read2_b32 v[78:79], v121 offset0:98 offset1:99
    s_waitcnt lgkmcnt(12)
    v_mfma_f32_16x16x32_bf16 v[40:43], v[80:83], v[96:99], v[40:43]
    v_mfma_f32_16x16x32_bf16 v[40:43], v[84:87], v[96:99], v[40:43]
    ds_read_b128 v[116:119], v6 offset:384
    s_waitcnt lgkmcnt(12)
    v_mfma_f32_16x16x32_bf16 v[44:47], v[80:83], v[100:103], v[44:47]
    v_mfma_f32_16x16x32_bf16 v[44:47], v[84:87], v[100:103], v[44:47]
    ds_read_b128 v[96:99], v6 offset:896
    s_waitcnt lgkmcnt(9)
    s_waitcnt lgkmcnt(8)
    v_mfma_f32_16x16x32_bf16 v[36:39], v[64:67], v[104:107], v[36:39]
    v_mfma_f32_16x16x32_bf16 v[36:39], v[68:71], v[104:107], v[36:39]
    ds_read_b128 v[100:103], v6 offset:2432
    ds_read2_b32 v[80:81], v120 offset0:80 offset1:81
    ds_read2_b32 v[82:83], v120 offset0:82 offset1:83
    ds_read2_b32 v[84:85], v121 offset0:80 offset1:81
    ds_read2_b32 v[86:87], v121 offset0:82 offset1:83
    s_waitcnt lgkmcnt(12)
    v_mfma_f32_16x16x32_bf16 v[40:43], v[64:67], v[108:111], v[40:43]
    v_mfma_f32_16x16x32_bf16 v[40:43], v[68:71], v[108:111], v[40:43]
    ds_read_b128 v[104:107], v6 offset:320
    s_waitcnt lgkmcnt(12)
    v_mfma_f32_16x16x32_bf16 v[44:47], v[64:67], v[112:115], v[44:47]
    v_mfma_f32_16x16x32_bf16 v[44:47], v[68:71], v[112:115], v[44:47]
    ds_read_b128 v[108:111], v6 offset:832
    s_waitcnt lgkmcnt(9)
    s_waitcnt lgkmcnt(8)
    v_mfma_f32_16x16x32_bf16 v[36:39], v[72:75], v[116:119], v[36:39]
    v_mfma_f32_16x16x32_bf16 v[36:39], v[76:79], v[116:119], v[36:39]
    ds_read_b128 v[112:115], v6 offset:2368
    ds_read2_b32 v[64:65], v120 offset0:64 offset1:65
    ds_read2_b32 v[66:67], v120 offset0:66 offset1:67
    ds_read2_b32 v[68:69], v121 offset0:64 offset1:65
    ds_read2_b32 v[70:71], v121 offset0:66 offset1:67
    s_waitcnt lgkmcnt(12)
    v_mfma_f32_16x16x32_bf16 v[40:43], v[72:75], v[96:99], v[40:43]
    v_mfma_f32_16x16x32_bf16 v[40:43], v[76:79], v[96:99], v[40:43]
    ds_read_b128 v[116:119], v6 offset:256
    s_waitcnt lgkmcnt(12)
    v_mfma_f32_16x16x32_bf16 v[44:47], v[72:75], v[100:103], v[44:47]
    v_mfma_f32_16x16x32_bf16 v[44:47], v[76:79], v[100:103], v[44:47]
    ds_read_b128 v[96:99], v6 offset:768
    s_waitcnt lgkmcnt(9)
    s_waitcnt lgkmcnt(8)
    v_mfma_f32_16x16x32_bf16 v[36:39], v[80:83], v[104:107], v[36:39]
    v_mfma_f32_16x16x32_bf16 v[36:39], v[84:87], v[104:107], v[36:39]
    ds_read_b128 v[100:103], v6 offset:2304
    ds_read2_b32 v[72:73], v120 offset0:48 offset1:49
    ds_read2_b32 v[74:75], v120 offset0:50 offset1:51
    ds_read2_b32 v[76:77], v121 offset0:48 offset1:49
    ds_read2_b32 v[78:79], v121 offset0:50 offset1:51
    s_waitcnt lgkmcnt(12)
    v_mfma_f32_16x16x32_bf16 v[40:43], v[80:83], v[108:111], v[40:43]
    v_mfma_f32_16x16x32_bf16 v[40:43], v[84:87], v[108:111], v[40:43]
    ds_read_b128 v[104:107], v6 offset:192
    s_waitcnt lgkmcnt(12)
    v_mfma_f32_16x16x32_bf16 v[44:47], v[80:83], v[112:115], v[44:47]
    v_mfma_f32_16x16x32_bf16 v[44:47], v[84:87], v[112:115], v[44:47]
    ds_read_b128 v[108:111], v6 offset:704
    s_waitcnt lgkmcnt(9)
    s_waitcnt lgkmcnt(8)
    v_mfma_f32_16x16x32_bf16 v[36:39], v[64:67], v[116:119], v[36:39]
    v_mfma_f32_16x16x32_bf16 v[36:39], v[68:71], v[116:119], v[36:39]
    ds_read_b128 v[112:115], v6 offset:2240
    ds_read2_b32 v[80:81], v120 offset0:32 offset1:33
    ds_read2_b32 v[82:83], v120 offset0:34 offset1:35
    ds_read2_b32 v[84:85], v121 offset0:32 offset1:33
    ds_read2_b32 v[86:87], v121 offset0:34 offset1:35
    s_waitcnt lgkmcnt(12)
    v_mfma_f32_16x16x32_bf16 v[40:43], v[64:67], v[96:99], v[40:43]
    v_mfma_f32_16x16x32_bf16 v[40:43], v[68:71], v[96:99], v[40:43]
    ds_read_b128 v[116:119], v6 offset:128
    s_waitcnt lgkmcnt(12)
    v_mfma_f32_16x16x32_bf16 v[44:47], v[64:67], v[100:103], v[44:47]
    v_mfma_f32_16x16x32_bf16 v[44:47], v[68:71], v[100:103], v[44:47]
    ds_read_b128 v[96:99], v6 offset:640
    s_waitcnt lgkmcnt(9)
    s_waitcnt lgkmcnt(8)
    v_mfma_f32_16x16x32_bf16 v[36:39], v[72:75], v[104:107], v[36:39]
    v_mfma_f32_16x16x32_bf16 v[36:39], v[76:79], v[104:107], v[36:39]
    ds_read_b128 v[100:103], v6 offset:2176
    ds_read2_b32 v[64:65], v120 offset0:16 offset1:17
    ds_read2_b32 v[66:67], v120 offset0:18 offset1:19
    ds_read2_b32 v[68:69], v121 offset0:16 offset1:17
    ds_read2_b32 v[70:71], v121 offset0:18 offset1:19
    s_waitcnt lgkmcnt(12)
    v_mfma_f32_16x16x32_bf16 v[40:43], v[72:75], v[108:111], v[40:43]
    v_mfma_f32_16x16x32_bf16 v[40:43], v[76:79], v[108:111], v[40:43]
    ds_read_b128 v[104:107], v6 offset:64
    s_waitcnt lgkmcnt(12)
    v_mfma_f32_16x16x32_bf16 v[44:47], v[72:75], v[112:115], v[44:47]
    v_mfma_f32_16x16x32_bf16 v[44:47], v[76:79], v[112:115], v[44:47]
    ds_read_b128 v[108:111], v6 offset:576
    s_waitcnt lgkmcnt(9)
    s_waitcnt lgkmcnt(8)
    v_mfma_f32_16x16x32_bf16 v[36:39], v[80:83], v[116:119], v[36:39]
    v_mfma_f32_16x16x32_bf16 v[36:39], v[84:87], v[116:119], v[36:39]
    ds_read_b128 v[112:115], v6 offset:2112
    ds_read2_b32 v[72:73], v120 offset0:0 offset1:1
    ds_read2_b32 v[74:75], v120 offset0:2 offset1:3
    ds_read2_b32 v[76:77], v121 offset0:0 offset1:1
    ds_read2_b32 v[78:79], v121 offset0:2 offset1:3
    s_waitcnt lgkmcnt(12)
    v_mfma_f32_16x16x32_bf16 v[40:43], v[80:83], v[96:99], v[40:43]
    v_mfma_f32_16x16x32_bf16 v[40:43], v[84:87], v[96:99], v[40:43]
    ds_read_b128 v[116:119], v6 offset:0
    s_waitcnt lgkmcnt(12)
    v_mfma_f32_16x16x32_bf16 v[44:47], v[80:83], v[100:103], v[44:47]
    v_mfma_f32_16x16x32_bf16 v[44:47], v[84:87], v[100:103], v[44:47]
    ds_read_b128 v[96:99], v6 offset:512
    s_waitcnt lgkmcnt(9)
    s_waitcnt lgkmcnt(8)
    v_mfma_f32_16x16x32_bf16 v[36:39], v[64:67], v[104:107], v[36:39]
    v_mfma_f32_16x16x32_bf16 v[36:39], v[68:71], v[104:107], v[36:39]
    ds_read_b128 v[100:103], v6 offset:2048
    v_add_u32 v120, 1536, v5
    v_add_u32 v121, 9984, v5
    ds_read2_b32 v[80:81], v120 offset0:112 offset1:113
    ds_read2_b32 v[82:83], v120 offset0:114 offset1:115
    ds_read2_b32 v[84:85], v121 offset0:112 offset1:113
    ds_read2_b32 v[86:87], v121 offset0:114 offset1:115
    s_waitcnt lgkmcnt(12)
    v_mfma_f32_16x16x32_bf16 v[40:43], v[64:67], v[108:111], v[40:43]
    v_mfma_f32_16x16x32_bf16 v[40:43], v[68:71], v[108:111], v[40:43]
    ds_read_b128 v[104:107], v6 offset:448
    s_waitcnt lgkmcnt(12)
    v_mfma_f32_16x16x32_bf16 v[44:47], v[64:67], v[112:115], v[44:47]
    v_mfma_f32_16x16x32_bf16 v[44:47], v[68:71], v[112:115], v[44:47]
    ds_read_b128 v[108:111], v6 offset:1984
    ds_read2_b32 v[64:65], v120 offset0:96 offset1:97
    ds_read2_b32 v[66:67], v120 offset0:98 offset1:99
    ds_read2_b32 v[68:69], v121 offset0:96 offset1:97
    ds_read2_b32 v[70:71], v121 offset0:98 offset1:99
    s_waitcnt lgkmcnt(13)
    s_waitcnt lgkmcnt(12)
    v_mfma_f32_16x16x32_bf16 v[36:39], v[72:75], v[116:119], v[36:39]
    v_mfma_f32_16x16x32_bf16 v[36:39], v[76:79], v[116:119], v[36:39]
    ds_read_b128 v[112:115], v6 offset:384
    s_waitcnt lgkmcnt(12)
    v_mfma_f32_16x16x32_bf16 v[40:43], v[72:75], v[96:99], v[40:43]
    v_mfma_f32_16x16x32_bf16 v[40:43], v[76:79], v[96:99], v[40:43]
    ds_read_b128 v[116:119], v6 offset:1920
    s_waitcnt lgkmcnt(12)
    v_mfma_f32_16x16x32_bf16 v[44:47], v[72:75], v[100:103], v[44:47]
    v_mfma_f32_16x16x32_bf16 v[44:47], v[76:79], v[100:103], v[44:47]
    ds_read2_b32 v[72:73], v120 offset0:80 offset1:81
    ds_read2_b32 v[74:75], v120 offset0:82 offset1:83
    ds_read2_b32 v[76:77], v121 offset0:80 offset1:81
    ds_read2_b32 v[78:79], v121 offset0:82 offset1:83
    ds_read_b128 v[96:99], v6 offset:320
    s_waitcnt lgkmcnt(13)
    s_waitcnt lgkmcnt(12)
    v_mfma_f32_16x16x32_bf16 v[40:43], v[80:83], v[104:107], v[40:43]
    v_mfma_f32_16x16x32_bf16 v[40:43], v[84:87], v[104:107], v[40:43]
    ds_read_b128 v[100:103], v6 offset:1856
    s_waitcnt lgkmcnt(12)
    v_mfma_f32_16x16x32_bf16 v[44:47], v[80:83], v[108:111], v[44:47]
    v_mfma_f32_16x16x32_bf16 v[44:47], v[84:87], v[108:111], v[44:47]
    ds_read2_b32 v[80:81], v120 offset0:64 offset1:65
    ds_read2_b32 v[82:83], v120 offset0:66 offset1:67
    ds_read2_b32 v[84:85], v121 offset0:64 offset1:65
    ds_read2_b32 v[86:87], v121 offset0:66 offset1:67
    ds_read_b128 v[104:107], v6 offset:256
    s_waitcnt lgkmcnt(13)
    s_waitcnt lgkmcnt(12)
    v_mfma_f32_16x16x32_bf16 v[40:43], v[64:67], v[112:115], v[40:43]
    v_mfma_f32_16x16x32_bf16 v[40:43], v[68:71], v[112:115], v[40:43]
    ds_read_b128 v[108:111], v6 offset:1792
    s_waitcnt lgkmcnt(12)
    v_mfma_f32_16x16x32_bf16 v[44:47], v[64:67], v[116:119], v[44:47]
    v_mfma_f32_16x16x32_bf16 v[44:47], v[68:71], v[116:119], v[44:47]
    ds_read2_b32 v[64:65], v120 offset0:48 offset1:49
    ds_read2_b32 v[66:67], v120 offset0:50 offset1:51
    ds_read2_b32 v[68:69], v121 offset0:48 offset1:49
    ds_read2_b32 v[70:71], v121 offset0:50 offset1:51
    ds_read_b128 v[112:115], v6 offset:192
    s_waitcnt lgkmcnt(13)
    s_waitcnt lgkmcnt(12)
    v_mfma_f32_16x16x32_bf16 v[40:43], v[72:75], v[96:99], v[40:43]
    v_mfma_f32_16x16x32_bf16 v[40:43], v[76:79], v[96:99], v[40:43]
    ds_read_b128 v[116:119], v6 offset:1728
    s_waitcnt lgkmcnt(12)
    v_mfma_f32_16x16x32_bf16 v[44:47], v[72:75], v[100:103], v[44:47]
    v_mfma_f32_16x16x32_bf16 v[44:47], v[76:79], v[100:103], v[44:47]
    ds_read2_b32 v[72:73], v120 offset0:32 offset1:33
    ds_read2_b32 v[74:75], v120 offset0:34 offset1:35
    ds_read2_b32 v[76:77], v121 offset0:32 offset1:33
    ds_read2_b32 v[78:79], v121 offset0:34 offset1:35
    ds_read_b128 v[96:99], v6 offset:128
    s_waitcnt lgkmcnt(13)
    s_waitcnt lgkmcnt(12)
    v_mfma_f32_16x16x32_bf16 v[40:43], v[80:83], v[104:107], v[40:43]
    v_mfma_f32_16x16x32_bf16 v[40:43], v[84:87], v[104:107], v[40:43]
    ds_read_b128 v[100:103], v6 offset:1664
    s_waitcnt lgkmcnt(12)
    v_mfma_f32_16x16x32_bf16 v[44:47], v[80:83], v[108:111], v[44:47]
    v_mfma_f32_16x16x32_bf16 v[44:47], v[84:87], v[108:111], v[44:47]
    ds_read2_b32 v[80:81], v120 offset0:16 offset1:17
    ds_read2_b32 v[82:83], v120 offset0:18 offset1:19
    ds_read2_b32 v[84:85], v121 offset0:16 offset1:17
    ds_read2_b32 v[86:87], v121 offset0:18 offset1:19
    ds_read_b128 v[104:107], v6 offset:64
    s_waitcnt lgkmcnt(13)
    s_waitcnt lgkmcnt(12)
    v_mfma_f32_16x16x32_bf16 v[40:43], v[64:67], v[112:115], v[40:43]
    v_mfma_f32_16x16x32_bf16 v[40:43], v[68:71], v[112:115], v[40:43]
    ds_read_b128 v[108:111], v6 offset:1600
    s_waitcnt lgkmcnt(12)
    v_mfma_f32_16x16x32_bf16 v[44:47], v[64:67], v[116:119], v[44:47]
    v_mfma_f32_16x16x32_bf16 v[44:47], v[68:71], v[116:119], v[44:47]
    ds_read2_b32 v[64:65], v120 offset0:0 offset1:1
    ds_read2_b32 v[66:67], v120 offset0:2 offset1:3
    ds_read2_b32 v[68:69], v121 offset0:0 offset1:1
    ds_read2_b32 v[70:71], v121 offset0:2 offset1:3
    ds_read_b128 v[112:115], v6 offset:0
    s_waitcnt lgkmcnt(13)
    s_waitcnt lgkmcnt(12)
    v_mfma_f32_16x16x32_bf16 v[40:43], v[72:75], v[96:99], v[40:43]
    v_mfma_f32_16x16x32_bf16 v[40:43], v[76:79], v[96:99], v[40:43]
    ds_read_b128 v[116:119], v6 offset:1536
    s_waitcnt lgkmcnt(12)
    v_mfma_f32_16x16x32_bf16 v[44:47], v[72:75], v[100:103], v[44:47]
    v_mfma_f32_16x16x32_bf16 v[44:47], v[76:79], v[100:103], v[44:47]
    v_add_u32 v120, 1024, v5
    v_add_u32 v121, 9472, v5
    ds_read2_b32 v[72:73], v120 offset0:112 offset1:113
    ds_read2_b32 v[74:75], v120 offset0:114 offset1:115
    ds_read2_b32 v[76:77], v121 offset0:112 offset1:113
    ds_read2_b32 v[78:79], v121 offset0:114 offset1:115
    ds_read_b128 v[96:99], v6 offset:1472
    s_waitcnt lgkmcnt(13)
    s_waitcnt lgkmcnt(12)
    v_mfma_f32_16x16x32_bf16 v[40:43], v[80:83], v[104:107], v[40:43]
    v_mfma_f32_16x16x32_bf16 v[40:43], v[84:87], v[104:107], v[40:43]
    s_waitcnt lgkmcnt(11)
    v_mfma_f32_16x16x32_bf16 v[44:47], v[80:83], v[108:111], v[44:47]
    v_mfma_f32_16x16x32_bf16 v[44:47], v[84:87], v[108:111], v[44:47]
    ds_read2_b32 v[80:81], v120 offset0:96 offset1:97
    ds_read2_b32 v[82:83], v120 offset0:98 offset1:99
    ds_read2_b32 v[84:85], v121 offset0:96 offset1:97
    ds_read2_b32 v[86:87], v121 offset0:98 offset1:99
    ds_read_b128 v[100:103], v6 offset:1408
    s_waitcnt lgkmcnt(12)
    s_waitcnt lgkmcnt(11)
    v_mfma_f32_16x16x32_bf16 v[40:43], v[64:67], v[112:115], v[40:43]
    v_mfma_f32_16x16x32_bf16 v[40:43], v[68:71], v[112:115], v[40:43]
    s_waitcnt lgkmcnt(10)
    v_mfma_f32_16x16x32_bf16 v[44:47], v[64:67], v[116:119], v[44:47]
    v_mfma_f32_16x16x32_bf16 v[44:47], v[68:71], v[116:119], v[44:47]
    ds_read2_b32 v[64:65], v120 offset0:80 offset1:81
    ds_read2_b32 v[66:67], v120 offset0:82 offset1:83
    ds_read2_b32 v[68:69], v121 offset0:80 offset1:81
    ds_read2_b32 v[70:71], v121 offset0:82 offset1:83
    ds_read_b128 v[104:107], v6 offset:1344
    s_waitcnt lgkmcnt(11)
    s_waitcnt lgkmcnt(10)
    v_mfma_f32_16x16x32_bf16 v[44:47], v[72:75], v[96:99], v[44:47]
    v_mfma_f32_16x16x32_bf16 v[44:47], v[76:79], v[96:99], v[44:47]
    ds_read2_b32 v[72:73], v120 offset0:64 offset1:65
    ds_read2_b32 v[74:75], v120 offset0:66 offset1:67
    ds_read2_b32 v[76:77], v121 offset0:64 offset1:65
    ds_read2_b32 v[78:79], v121 offset0:66 offset1:67
    ds_read_b128 v[108:111], v6 offset:1280
    s_waitcnt lgkmcnt(11)
    s_waitcnt lgkmcnt(10)
    v_mfma_f32_16x16x32_bf16 v[44:47], v[80:83], v[100:103], v[44:47]
    v_mfma_f32_16x16x32_bf16 v[44:47], v[84:87], v[100:103], v[44:47]
    ds_read2_b32 v[80:81], v120 offset0:48 offset1:49
    ds_read2_b32 v[82:83], v120 offset0:50 offset1:51
    ds_read2_b32 v[84:85], v121 offset0:48 offset1:49
    ds_read2_b32 v[86:87], v121 offset0:50 offset1:51
    ds_read_b128 v[112:115], v6 offset:1216
    s_waitcnt lgkmcnt(11)
    s_waitcnt lgkmcnt(10)
    v_mfma_f32_16x16x32_bf16 v[44:47], v[64:67], v[104:107], v[44:47]
    v_mfma_f32_16x16x32_bf16 v[44:47], v[68:71], v[104:107], v[44:47]
    ds_read2_b32 v[64:65], v120 offset0:32 offset1:33
    ds_read2_b32 v[66:67], v120 offset0:34 offset1:35
    ds_read2_b32 v[68:69], v121 offset0:32 offset1:33
    ds_read2_b32 v[70:71], v121 offset0:34 offset1:35
    ds_read_b128 v[116:119], v6 offset:1152
    s_waitcnt lgkmcnt(11)
    s_waitcnt lgkmcnt(10)
    v_mfma_f32_16x16x32_bf16 v[44:47], v[72:75], v[108:111], v[44:47]
    v_mfma_f32_16x16x32_bf16 v[44:47], v[76:79], v[108:111], v[44:47]
    ds_read2_b32 v[72:73], v120 offset0:16 offset1:17
    ds_read2_b32 v[74:75], v120 offset0:18 offset1:19
    ds_read2_b32 v[76:77], v121 offset0:16 offset1:17
    ds_read2_b32 v[78:79], v121 offset0:18 offset1:19
    ds_read_b128 v[96:99], v6 offset:1088
    s_waitcnt lgkmcnt(11)
    s_waitcnt lgkmcnt(10)
    v_mfma_f32_16x16x32_bf16 v[44:47], v[80:83], v[112:115], v[44:47]
    v_mfma_f32_16x16x32_bf16 v[44:47], v[84:87], v[112:115], v[44:47]
    ds_read2_b32 v[80:81], v120 offset0:0 offset1:1
    ds_read2_b32 v[82:83], v120 offset0:2 offset1:3
    ds_read2_b32 v[84:85], v121 offset0:0 offset1:1
    ds_read2_b32 v[86:87], v121 offset0:2 offset1:3
    ds_read_b128 v[100:103], v6 offset:1024
    s_waitcnt lgkmcnt(11)
    s_waitcnt lgkmcnt(10)
    v_mfma_f32_16x16x32_bf16 v[44:47], v[64:67], v[116:119], v[44:47]
    v_mfma_f32_16x16x32_bf16 v[44:47], v[68:71], v[116:119], v[44:47]
    v_add_u32 v120, 512, v5
    v_add_u32 v121, 8960, v5
    ds_read2_b32 v[64:65], v120 offset0:112 offset1:113
    ds_read2_b32 v[66:67], v120 offset0:114 offset1:115
    ds_read2_b32 v[68:69], v121 offset0:112 offset1:113
    ds_read2_b32 v[70:71], v121 offset0:114 offset1:115
    ds_read_b128 v[104:107], v6 offset:960
    s_waitcnt lgkmcnt(11)
    s_waitcnt lgkmcnt(10)
    v_mfma_f32_16x16x32_bf16 v[44:47], v[72:75], v[96:99], v[44:47]
    v_mfma_f32_16x16x32_bf16 v[44:47], v[76:79], v[96:99], v[44:47]
    ds_read2_b32 v[72:73], v120 offset0:96 offset1:97
    ds_read2_b32 v[74:75], v120 offset0:98 offset1:99
    ds_read2_b32 v[76:77], v121 offset0:96 offset1:97
    ds_read2_b32 v[78:79], v121 offset0:98 offset1:99
    ds_read_b128 v[108:111], v6 offset:896
    s_waitcnt lgkmcnt(11)
    s_waitcnt lgkmcnt(10)
    v_mfma_f32_16x16x32_bf16 v[44:47], v[80:83], v[100:103], v[44:47]
    v_mfma_f32_16x16x32_bf16 v[44:47], v[84:87], v[100:103], v[44:47]
    ds_read2_b32 v[80:81], v120 offset0:80 offset1:81
    ds_read2_b32 v[82:83], v120 offset0:82 offset1:83
    ds_read2_b32 v[84:85], v121 offset0:80 offset1:81
    ds_read2_b32 v[86:87], v121 offset0:82 offset1:83
    ds_read_b128 v[112:115], v6 offset:832
    s_waitcnt lgkmcnt(11)
    s_waitcnt lgkmcnt(10)
    v_mfma_f32_16x16x32_bf16 v[44:47], v[64:67], v[104:107], v[44:47]
    v_mfma_f32_16x16x32_bf16 v[44:47], v[68:71], v[104:107], v[44:47]
    ds_read2_b32 v[64:65], v120 offset0:64 offset1:65
    ds_read2_b32 v[66:67], v120 offset0:66 offset1:67
    ds_read2_b32 v[68:69], v121 offset0:64 offset1:65
    ds_read2_b32 v[70:71], v121 offset0:66 offset1:67
    ds_read_b128 v[116:119], v6 offset:768
    s_waitcnt lgkmcnt(11)
    s_waitcnt lgkmcnt(10)
    v_mfma_f32_16x16x32_bf16 v[44:47], v[72:75], v[108:111], v[44:47]
    v_mfma_f32_16x16x32_bf16 v[44:47], v[76:79], v[108:111], v[44:47]
    ds_read2_b32 v[72:73], v120 offset0:48 offset1:49
    ds_read2_b32 v[74:75], v120 offset0:50 offset1:51
    ds_read2_b32 v[76:77], v121 offset0:48 offset1:49
    ds_read2_b32 v[78:79], v121 offset0:50 offset1:51
    ds_read_b128 v[96:99], v6 offset:704
    s_waitcnt lgkmcnt(11)
    s_waitcnt lgkmcnt(10)
    v_mfma_f32_16x16x32_bf16 v[44:47], v[80:83], v[112:115], v[44:47]
    v_mfma_f32_16x16x32_bf16 v[44:47], v[84:87], v[112:115], v[44:47]
    ds_read2_b32 v[80:81], v120 offset0:32 offset1:33
    ds_read2_b32 v[82:83], v120 offset0:34 offset1:35
    ds_read2_b32 v[84:85], v121 offset0:32 offset1:33
    ds_read2_b32 v[86:87], v121 offset0:34 offset1:35
    ds_read_b128 v[100:103], v6 offset:640
    s_waitcnt lgkmcnt(11)
    s_waitcnt lgkmcnt(10)
    v_mfma_f32_16x16x32_bf16 v[44:47], v[64:67], v[116:119], v[44:47]
    v_mfma_f32_16x16x32_bf16 v[44:47], v[68:71], v[116:119], v[44:47]
    ds_read2_b32 v[64:65], v120 offset0:16 offset1:17
    ds_read2_b32 v[66:67], v120 offset0:18 offset1:19
    ds_read2_b32 v[68:69], v121 offset0:16 offset1:17
    ds_read2_b32 v[70:71], v121 offset0:18 offset1:19
    ds_read_b128 v[104:107], v6 offset:576
    s_waitcnt lgkmcnt(11)
    s_waitcnt lgkmcnt(10)
    v_mfma_f32_16x16x32_bf16 v[44:47], v[72:75], v[96:99], v[44:47]
    v_mfma_f32_16x16x32_bf16 v[44:47], v[76:79], v[96:99], v[44:47]
    ds_read2_b32 v[72:73], v120 offset0:0 offset1:1
    ds_read2_b32 v[74:75], v120 offset0:2 offset1:3
    ds_read2_b32 v[76:77], v121 offset0:0 offset1:1
    ds_read2_b32 v[78:79], v121 offset0:2 offset1:3
    ds_read_b128 v[108:111], v6 offset:512
    s_waitcnt lgkmcnt(11)
    s_waitcnt lgkmcnt(10)
    v_mfma_f32_16x16x32_bf16 v[44:47], v[80:83], v[100:103], v[44:47]
    v_mfma_f32_16x16x32_bf16 v[44:47], v[84:87], v[100:103], v[44:47]
    v_add_u32 v120, 0, v5
    v_add_u32 v121, 8448, v5
    ds_read2_b32 v[80:81], v120 offset0:112 offset1:113
    ds_read2_b32 v[82:83], v120 offset0:114 offset1:115
    ds_read2_b32 v[84:85], v121 offset0:112 offset1:113
    ds_read2_b32 v[86:87], v121 offset0:114 offset1:115
    ds_read_b128 v[112:115], v6 offset:448
    s_waitcnt lgkmcnt(11)
    s_waitcnt lgkmcnt(10)
    v_mfma_f32_16x16x32_bf16 v[44:47], v[64:67], v[104:107], v[44:47]
    v_mfma_f32_16x16x32_bf16 v[44:47], v[68:71], v[104:107], v[44:47]
    ds_read2_b32 v[64:65], v120 offset0:96 offset1:97
    ds_read2_b32 v[66:67], v120 offset0:98 offset1:99
    ds_read2_b32 v[68:69], v121 offset0:96 offset1:97
    ds_read2_b32 v[70:71], v121 offset0:98 offset1:99
    ds_read_b128 v[116:119], v6 offset:384
    s_waitcnt lgkmcnt(11)
    s_waitcnt lgkmcnt(10)
    v_mfma_f32_16x16x32_bf16 v[44:47], v[72:75], v[108:111], v[44:47]
    v_mfma_f32_16x16x32_bf16 v[44:47], v[76:79], v[108:111], v[44:47]
    ds_read2_b32 v[72:73], v120 offset0:80 offset1:81
    ds_read2_b32 v[74:75], v120 offset0:82 offset1:83
    ds_read2_b32 v[76:77], v121 offset0:80 offset1:81
    ds_read2_b32 v[78:79], v121 offset0:82 offset1:83
    ds_read_b128 v[96:99], v6 offset:320
    s_waitcnt lgkmcnt(11)
    s_waitcnt lgkmcnt(10)
    v_mfma_f32_16x16x32_bf16 v[44:47], v[80:83], v[112:115], v[44:47]
    v_mfma_f32_16x16x32_bf16 v[44:47], v[84:87], v[112:115], v[44:47]
    ds_read2_b32 v[80:81], v120 offset0:64 offset1:65
    ds_read2_b32 v[82:83], v120 offset0:66 offset1:67
    ds_read2_b32 v[84:85], v121 offset0:64 offset1:65
    ds_read2_b32 v[86:87], v121 offset0:66 offset1:67
    ds_read_b128 v[100:103], v6 offset:256
    s_waitcnt lgkmcnt(11)
    s_waitcnt lgkmcnt(10)
    v_mfma_f32_16x16x32_bf16 v[44:47], v[64:67], v[116:119], v[44:47]
    v_mfma_f32_16x16x32_bf16 v[44:47], v[68:71], v[116:119], v[44:47]
    ds_read2_b32 v[64:65], v120 offset0:48 offset1:49
    ds_read2_b32 v[66:67], v120 offset0:50 offset1:51
    ds_read2_b32 v[68:69], v121 offset0:48 offset1:49
    ds_read2_b32 v[70:71], v121 offset0:50 offset1:51
    ds_read_b128 v[104:107], v6 offset:192
    s_waitcnt lgkmcnt(11)
    s_waitcnt lgkmcnt(10)
    v_mfma_f32_16x16x32_bf16 v[44:47], v[72:75], v[96:99], v[44:47]
    v_mfma_f32_16x16x32_bf16 v[44:47], v[76:79], v[96:99], v[44:47]
    ds_read2_b32 v[72:73], v120 offset0:32 offset1:33
    ds_read2_b32 v[74:75], v120 offset0:34 offset1:35
    ds_read2_b32 v[76:77], v121 offset0:32 offset1:33
    ds_read2_b32 v[78:79], v121 offset0:34 offset1:35
    ds_read_b128 v[108:111], v6 offset:128
    s_waitcnt lgkmcnt(11)
    s_waitcnt lgkmcnt(10)
    v_mfma_f32_16x16x32_bf16 v[44:47], v[80:83], v[100:103], v[44:47]
    v_mfma_f32_16x16x32_bf16 v[44:47], v[84:87], v[100:103], v[44:47]
    ds_read2_b32 v[80:81], v120 offset0:16 offset1:17
    ds_read2_b32 v[82:83], v120 offset0:18 offset1:19
    ds_read2_b32 v[84:85], v121 offset0:16 offset1:17
    ds_read2_b32 v[86:87], v121 offset0:18 offset1:19
    ds_read_b128 v[112:115], v6 offset:64
    s_waitcnt lgkmcnt(11)
    s_waitcnt lgkmcnt(10)
    v_mfma_f32_16x16x32_bf16 v[44:47], v[64:67], v[104:107], v[44:47]
    v_mfma_f32_16x16x32_bf16 v[44:47], v[68:71], v[104:107], v[44:47]
    ds_read2_b32 v[64:65], v120 offset0:0 offset1:1
    ds_read2_b32 v[66:67], v120 offset0:2 offset1:3
    ds_read2_b32 v[68:69], v121 offset0:0 offset1:1
    ds_read2_b32 v[70:71], v121 offset0:2 offset1:3
    ds_read_b128 v[116:119], v6 offset:0
    s_waitcnt lgkmcnt(11)
    s_waitcnt lgkmcnt(10)
    v_mfma_f32_16x16x32_bf16 v[44:47], v[72:75], v[108:111], v[44:47]
    v_mfma_f32_16x16x32_bf16 v[44:47], v[76:79], v[108:111], v[44:47]
    s_waitcnt lgkmcnt(6)
    s_waitcnt lgkmcnt(5)
    v_mfma_f32_16x16x32_bf16 v[44:47], v[80:83], v[112:115], v[44:47]
    v_mfma_f32_16x16x32_bf16 v[44:47], v[84:87], v[112:115], v[44:47]
    s_waitcnt lgkmcnt(1)
    s_waitcnt lgkmcnt(0)
    v_mfma_f32_16x16x32_bf16 v[44:47], v[64:67], v[116:119], v[44:47]
    v_mfma_f32_16x16x32_bf16 v[44:47], v[68:71], v[116:119], v[44:47]
    ds_read_b64 v[64:65], v7 offset:17536
    ds_read_b64 v[66:67], v7 offset:19072
    ds_read_b64 v[68:69], v7 offset:19584
    ds_read_b64 v[70:71], v7 offset:21120
    s_waitcnt lgkmcnt(3)
    s_waitcnt lgkmcnt(0)
    v_cvt_pk_bf16_f32 v80, v32, v33
    v_lshlrev_b32 v81, 16, v64
    v_and_b32 v82, 0xffff0000, v64
    v_mul_f32 v81, v81, v23
    v_mul_f32 v82, v82, v23
    v_cvt_pk_bf16_f32 v81, v81, v82
    v_lshlrev_b32 v82, 16, v80
    v_and_b32 v80, 0xffff0000, v80
    v_lshlrev_b32 v83, 16, v81
    v_and_b32 v81, 0xffff0000, v81
    v_add_f32 v82, v82, v83
    v_add_f32 v80, v80, v81
    v_cvt_pk_bf16_f32 v72, v82, v80
    v_cvt_pk_bf16_f32 v80, v34, v35
    v_lshlrev_b32 v81, 16, v65
    v_and_b32 v82, 0xffff0000, v65
    v_mul_f32 v81, v81, v23
    v_mul_f32 v82, v82, v23
    v_cvt_pk_bf16_f32 v81, v81, v82
    v_lshlrev_b32 v82, 16, v80
    v_and_b32 v80, 0xffff0000, v80
    v_lshlrev_b32 v83, 16, v81
    v_and_b32 v81, 0xffff0000, v81
    v_add_f32 v82, v82, v83
    v_add_f32 v80, v80, v81
    v_cvt_pk_bf16_f32 v73, v82, v80
    ds_write_b64 v7, v[72:73] offset:31936
    s_waitcnt lgkmcnt(3)
    s_waitcnt lgkmcnt(0)
    v_cvt_pk_bf16_f32 v80, v36, v37
    v_lshlrev_b32 v81, 16, v66
    v_and_b32 v82, 0xffff0000, v66
    v_mul_f32 v81, v81, v23
    v_mul_f32 v82, v82, v23
    v_cvt_pk_bf16_f32 v81, v81, v82
    v_lshlrev_b32 v82, 16, v80
    v_and_b32 v80, 0xffff0000, v80
    v_lshlrev_b32 v83, 16, v81
    v_and_b32 v81, 0xffff0000, v81
    v_add_f32 v82, v82, v83
    v_add_f32 v80, v80, v81
    v_cvt_pk_bf16_f32 v74, v82, v80
    v_cvt_pk_bf16_f32 v80, v38, v39
    v_lshlrev_b32 v81, 16, v67
    v_and_b32 v82, 0xffff0000, v67
    v_mul_f32 v81, v81, v23
    v_mul_f32 v82, v82, v23
    v_cvt_pk_bf16_f32 v81, v81, v82
    v_lshlrev_b32 v82, 16, v80
    v_and_b32 v80, 0xffff0000, v80
    v_lshlrev_b32 v83, 16, v81
    v_and_b32 v81, 0xffff0000, v81
    v_add_f32 v82, v82, v83
    v_add_f32 v80, v80, v81
    v_cvt_pk_bf16_f32 v75, v82, v80
    ds_write_b64 v7, v[74:75] offset:33472
    s_waitcnt lgkmcnt(3)
    s_waitcnt lgkmcnt(0)
    v_cvt_pk_bf16_f32 v80, v40, v41
    v_lshlrev_b32 v81, 16, v68
    v_and_b32 v82, 0xffff0000, v68
    v_mul_f32 v81, v81, v23
    v_mul_f32 v82, v82, v23
    v_cvt_pk_bf16_f32 v81, v81, v82
    v_lshlrev_b32 v82, 16, v80
    v_and_b32 v80, 0xffff0000, v80
    v_lshlrev_b32 v83, 16, v81
    v_and_b32 v81, 0xffff0000, v81
    v_add_f32 v82, v82, v83
    v_add_f32 v80, v80, v81
    v_cvt_pk_bf16_f32 v76, v82, v80
    v_cvt_pk_bf16_f32 v80, v42, v43
    v_lshlrev_b32 v81, 16, v69
    v_and_b32 v82, 0xffff0000, v69
    v_mul_f32 v81, v81, v23
    v_mul_f32 v82, v82, v23
    v_cvt_pk_bf16_f32 v81, v81, v82
    v_lshlrev_b32 v82, 16, v80
    v_and_b32 v80, 0xffff0000, v80
    v_lshlrev_b32 v83, 16, v81
    v_and_b32 v81, 0xffff0000, v81
    v_add_f32 v82, v82, v83
    v_add_f32 v80, v80, v81
    v_cvt_pk_bf16_f32 v77, v82, v80
    ds_write_b64 v7, v[76:77] offset:33984
    s_waitcnt lgkmcnt(3)
    s_waitcnt lgkmcnt(0)
    v_cvt_pk_bf16_f32 v80, v44, v45
    v_lshlrev_b32 v81, 16, v70
    v_and_b32 v82, 0xffff0000, v70
    v_mul_f32 v81, v81, v23
    v_mul_f32 v82, v82, v23
    v_cvt_pk_bf16_f32 v81, v81, v82
    v_lshlrev_b32 v82, 16, v80
    v_and_b32 v80, 0xffff0000, v80
    v_lshlrev_b32 v83, 16, v81
    v_and_b32 v81, 0xffff0000, v81
    v_add_f32 v82, v82, v83
    v_add_f32 v80, v80, v81
    v_cvt_pk_bf16_f32 v78, v82, v80
    v_cvt_pk_bf16_f32 v80, v46, v47
    v_lshlrev_b32 v81, 16, v71
    v_and_b32 v82, 0xffff0000, v71
    v_mul_f32 v81, v81, v23
    v_mul_f32 v82, v82, v23
    v_cvt_pk_bf16_f32 v81, v81, v82
    v_lshlrev_b32 v82, 16, v80
    v_and_b32 v80, 0xffff0000, v80
    v_lshlrev_b32 v83, 16, v81
    v_and_b32 v81, 0xffff0000, v81
    v_add_f32 v82, v82, v83
    v_add_f32 v80, v80, v81
    v_cvt_pk_bf16_f32 v79, v82, v80
    ds_write_b64 v7, v[78:79] offset:35520
    s_branch main_kernel_s_cvend
main_kernel_s_cv1:
    v_add_u32 v120, 3584, v5
    v_add_u32 v121, 12032, v5
    ds_read2_b32 v[64:65], v120 offset0:112 offset1:113
    ds_read2_b32 v[66:67], v120 offset0:114 offset1:115
    ds_read2_b32 v[68:69], v121 offset0:112 offset1:113
    ds_read2_b32 v[70:71], v121 offset0:114 offset1:115
    ds_read_b128 v[96:99], v6 offset:960
    ds_read_b128 v[100:103], v6 offset:1472
    ds_read_b128 v[104:107], v6 offset:3008
    ds_read_b128 v[108:111], v6 offset:3520
    ds_read2_b32 v[72:73], v120 offset0:96 offset1:97
    ds_read2_b32 v[74:75], v120 offset0:98 offset1:99
    ds_read2_b32 v[76:77], v121 offset0:96 offset1:97
    ds_read2_b32 v[78:79], v121 offset0:98 offset1:99
    ds_read_b128 v[112:115], v6 offset:896
    s_waitcnt lgkmcnt(9)
    s_waitcnt lgkmcnt(8)
    v_mfma_f32_16x16x32_bf16 v[32:35], v[64:67], v[96:99], 0
    v_mfma_f32_16x16x32_bf16 v[32:35], v[68:71], v[96:99], v[32:35]
    ds_read_b128 v[116:119], v6 offset:1408
    s_waitcnt lgkmcnt(8)
    v_mfma_f32_16x16x32_bf16 v[36:39], v[64:67], v[100:103], 0
    v_mfma_f32_16x16x32_bf16 v[36:39], v[68:71], v[100:103], v[36:39]
    ds_read_b128 v[96:99], v6 offset:2944
    s_waitcnt lgkmcnt(8)
    v_mfma_f32_16x16x32_bf16 v[40:43], v[64:67], v[104:107], 0
    v_mfma_f32_16x16x32_bf16 v[40:43], v[68:71], v[104:107], v[40:43]
    ds_read_b128 v[100:103], v6 offset:3456
    ds_read2_b32 v[80:81], v120 offset0:80 offset1:81
    ds_read2_b32 v[82:83], v120 offset0:82 offset1:83
    ds_read2_b32 v[84:85], v121 offset0:80 offset1:81
    ds_read2_b32 v[86:87], v121 offset0:82 offset1:83
    s_waitcnt lgkmcnt(12)
    v_mfma_f32_16x16x32_bf16 v[44:47], v[64:67], v[108:111], 0
    v_mfma_f32_16x16x32_bf16 v[44:47], v[68:71], v[108:111], v[44:47]
    ds_read_b128 v[104:107], v6 offset:832
    s_waitcnt lgkmcnt(9)
    s_waitcnt lgkmcnt(8)
    v_mfma_f32_16x16x32_bf16 v[32:35], v[72:75], v[112:115], v[32:35]
    v_mfma_f32_16x16x32_bf16 v[32:35], v[76:79], v[112:115], v[32:35]
    ds_read_b128 v[108:111], v6 offset:1344
    s_waitcnt lgkmcnt(8)
    v_mfma_f32_16x16x32_bf16 v[36:39], v[72:75], v[116:119], v[36:39]
    v_mfma_f32_16x16x32_bf16 v[36:39], v[76:79], v[116:119], v[36:39]
    ds_read_b128 v[112:115], v6 offset:2880
    s_waitcnt lgkmcnt(8)
    v_mfma_f32_16x16x32_bf16 v[40:43], v[72:75], v[96:99], v[40:43]
    v_mfma_f32_16x16x32_bf16 v[40:43], v[76:79], v[96:99], v[40:43]
    ds_read_b128 v[116:119], v6 offset:3392
    ds_read2_b32 v[64:65], v120 offset0:64 offset1:65
    ds_read2_b32 v[66:67], v120 offset0:66 offset1:67
    ds_read2_b32 v[68:69], v121 offset0:64 offset1:65
    ds_read2_b32 v[70:71], v121 offset0:66 offset1:67
    s_waitcnt lgkmcnt(12)
    v_mfma_f32_16x16x32_bf16 v[44:47], v[72:75], v[100:103], v[44:47]
    v_mfma_f32_16x16x32_bf16 v[44:47], v[76:79], v[100:103], v[44:47]
    ds_read_b128 v[96:99], v6 offset:768
    s_waitcnt lgkmcnt(9)
    s_waitcnt lgkmcnt(8)
    v_mfma_f32_16x16x32_bf16 v[32:35], v[80:83], v[104:107], v[32:35]
    v_mfma_f32_16x16x32_bf16 v[32:35], v[84:87], v[104:107], v[32:35]
    ds_read_b128 v[100:103], v6 offset:1280
    s_waitcnt lgkmcnt(8)
    v_mfma_f32_16x16x32_bf16 v[36:39], v[80:83], v[108:111], v[36:39]
    v_mfma_f32_16x16x32_bf16 v[36:39], v[84:87], v[108:111], v[36:39]
    ds_read_b128 v[104:107], v6 offset:2816
    s_waitcnt lgkmcnt(8)
    v_mfma_f32_16x16x32_bf16 v[40:43], v[80:83], v[112:115], v[40:43]
    v_mfma_f32_16x16x32_bf16 v[40:43], v[84:87], v[112:115], v[40:43]
    ds_read_b128 v[108:111], v6 offset:3328
    ds_read2_b32 v[72:73], v120 offset0:48 offset1:49
    ds_read2_b32 v[74:75], v120 offset0:50 offset1:51
    ds_read2_b32 v[76:77], v121 offset0:48 offset1:49
    ds_read2_b32 v[78:79], v121 offset0:50 offset1:51
    s_waitcnt lgkmcnt(12)
    v_mfma_f32_16x16x32_bf16 v[44:47], v[80:83], v[116:119], v[44:47]
    v_mfma_f32_16x16x32_bf16 v[44:47], v[84:87], v[116:119], v[44:47]
    ds_read_b128 v[112:115], v6 offset:704
    s_waitcnt lgkmcnt(9)
    s_waitcnt lgkmcnt(8)
    v_mfma_f32_16x16x32_bf16 v[32:35], v[64:67], v[96:99], v[32:35]
    v_mfma_f32_16x16x32_bf16 v[32:35], v[68:71], v[96:99], v[32:35]
    ds_read_b128 v[116:119], v6 offset:1216
    s_waitcnt lgkmcnt(8)
    v_mfma_f32_16x16x32_bf16 v[36:39], v[64:67], v[100:103], v[36:39]
    v_mfma_f32_16x16x32_bf16 v[36:39], v[68:71], v[100:103], v[36:39]
    ds_read_b128 v[96:99], v6 offset:2752
    s_waitcnt lgkmcnt(8)
    v_mfma_f32_16x16x32_bf16 v[40:43], v[64:67], v[104:107], v[40:43]
    v_mfma_f32_16x16x32_bf16 v[40:43], v[68:71], v[104:107], v[40:43]
    ds_read_b128 v[100:103], v6 offset:3264
    ds_read2_b32 v[80:81], v120 offset0:32 offset1:33
    ds_read2_b32 v[82:83], v120 offset0:34 offset1:35
    ds_read2_b32 v[84:85], v121 offset0:32 offset1:33
    ds_read2_b32 v[86:87], v121 offset0:34 offset1:35
    s_waitcnt lgkmcnt(12)
    v_mfma_f32_16x16x32_bf16 v[44:47], v[64:67], v[108:111], v[44:47]
    v_mfma_f32_16x16x32_bf16 v[44:47], v[68:71], v[108:111], v[44:47]
    ds_read_b128 v[104:107], v6 offset:640
    s_waitcnt lgkmcnt(9)
    s_waitcnt lgkmcnt(8)
    v_mfma_f32_16x16x32_bf16 v[32:35], v[72:75], v[112:115], v[32:35]
    v_mfma_f32_16x16x32_bf16 v[32:35], v[76:79], v[112:115], v[32:35]
    ds_read_b128 v[108:111], v6 offset:1152
    s_waitcnt lgkmcnt(8)
    v_mfma_f32_16x16x32_bf16 v[36:39], v[72:75], v[116:119], v[36:39]
    v_mfma_f32_16x16x32_bf16 v[36:39], v[76:79], v[116:119], v[36:39]
    ds_read_b128 v[112:115], v6 offset:2688
    s_waitcnt lgkmcnt(8)
    v_mfma_f32_16x16x32_bf16 v[40:43], v[72:75], v[96:99], v[40:43]
    v_mfma_f32_16x16x32_bf16 v[40:43], v[76:79], v[96:99], v[40:43]
    ds_read_b128 v[116:119], v6 offset:3200
    ds_read2_b32 v[64:65], v120 offset0:16 offset1:17
    ds_read2_b32 v[66:67], v120 offset0:18 offset1:19
    ds_read2_b32 v[68:69], v121 offset0:16 offset1:17
    ds_read2_b32 v[70:71], v121 offset0:18 offset1:19
    s_waitcnt lgkmcnt(12)
    v_mfma_f32_16x16x32_bf16 v[44:47], v[72:75], v[100:103], v[44:47]
    v_mfma_f32_16x16x32_bf16 v[44:47], v[76:79], v[100:103], v[44:47]
    ds_read_b128 v[96:99], v6 offset:576
    s_waitcnt lgkmcnt(9)
    s_waitcnt lgkmcnt(8)
    v_mfma_f32_16x16x32_bf16 v[32:35], v[80:83], v[104:107], v[32:35]
    v_mfma_f32_16x16x32_bf16 v[32:35], v[84:87], v[104:107], v[32:35]
    ds_read_b128 v[100:103], v6 offset:1088
    s_waitcnt lgkmcnt(8)
    v_mfma_f32_16x16x32_bf16 v[36:39], v[80:83], v[108:111], v[36:39]
    v_mfma_f32_16x16x32_bf16 v[36:39], v[84:87], v[108:111], v[36:39]
    ds_read_b128 v[104:107], v6 offset:2624
    s_waitcnt lgkmcnt(8)
    v_mfma_f32_16x16x32_bf16 v[40:43], v[80:83], v[112:115], v[40:43]
    v_mfma_f32_16x16x32_bf16 v[40:43], v[84:87], v[112:115], v[40:43]
    ds_read_b128 v[108:111], v6 offset:3136
    ds_read2_b32 v[72:73], v120 offset0:0 offset1:1
    ds_read2_b32 v[74:75], v120 offset0:2 offset1:3
    ds_read2_b32 v[76:77], v121 offset0:0 offset1:1
    ds_read2_b32 v[78:79], v121 offset0:2 offset1:3
    s_waitcnt lgkmcnt(12)
    v_mfma_f32_16x16x32_bf16 v[44:47], v[80:83], v[116:119], v[44:47]
    v_mfma_f32_16x16x32_bf16 v[44:47], v[84:87], v[116:119], v[44:47]
    ds_read_b128 v[112:115], v6 offset:512
    s_waitcnt lgkmcnt(9)
    s_waitcnt lgkmcnt(8)
    v_mfma_f32_16x16x32_bf16 v[32:35], v[64:67], v[96:99], v[32:35]
    v_mfma_f32_16x16x32_bf16 v[32:35], v[68:71], v[96:99], v[32:35]
    ds_read_b128 v[116:119], v6 offset:1024
    s_waitcnt lgkmcnt(8)
    v_mfma_f32_16x16x32_bf16 v[36:39], v[64:67], v[100:103], v[36:39]
    v_mfma_f32_16x16x32_bf16 v[36:39], v[68:71], v[100:103], v[36:39]
    ds_read_b128 v[96:99], v6 offset:2560
    s_waitcnt lgkmcnt(8)
    v_mfma_f32_16x16x32_bf16 v[40:43], v[64:67], v[104:107], v[40:43]
    v_mfma_f32_16x16x32_bf16 v[40:43], v[68:71], v[104:107], v[40:43]
    ds_read_b128 v[100:103], v6 offset:3072
    v_add_u32 v120, 3072, v5
    v_add_u32 v121, 11520, v5
    ds_read2_b32 v[80:81], v120 offset0:112 offset1:113
    ds_read2_b32 v[82:83], v120 offset0:114 offset1:115
    ds_read2_b32 v[84:85], v121 offset0:112 offset1:113
    ds_read2_b32 v[86:87], v121 offset0:114 offset1:115
    s_waitcnt lgkmcnt(12)
    v_mfma_f32_16x16x32_bf16 v[44:47], v[64:67], v[108:111], v[44:47]
    v_mfma_f32_16x16x32_bf16 v[44:47], v[68:71], v[108:111], v[44:47]
    ds_read_b128 v[104:107], v6 offset:448
    s_waitcnt lgkmcnt(9)
    s_waitcnt lgkmcnt(8)
    v_mfma_f32_16x16x32_bf16 v[32:35], v[72:75], v[112:115], v[32:35]
    v_mfma_f32_16x16x32_bf16 v[32:35], v[76:79], v[112:115], v[32:35]
    ds_read_b128 v[108:111], v6 offset:960
    s_waitcnt lgkmcnt(8)
    v_mfma_f32_16x16x32_bf16 v[36:39], v[72:75], v[116:119], v[36:39]
    v_mfma_f32_16x16x32_bf16 v[36:39], v[76:79], v[116:119], v[36:39]
    ds_read_b128 v[112:115], v6 offset:2496
    s_waitcnt lgkmcnt(8)
    v_mfma_f32_16x16x32_bf16 v[40:43], v[72:75], v[96:99], v[40:43]
    v_mfma_f32_16x16x32_bf16 v[40:43], v[76:79], v[96:99], v[40:43]
    ds_read_b128 v[116:119], v6 offset:3008
    ds_read2_b32 v[64:65], v120 offset0:96 offset1:97
    ds_read2_b32 v[66:67], v120 offset0:98 offset1:99
    ds_read2_b32 v[68:69], v121 offset0:96 offset1:97
    ds_read2_b32 v[70:71], v121 offset0:98 offset1:99
    s_waitcnt lgkmcnt(12)
    v_mfma_f32_16x16x32_bf16 v[44:47], v[72:75], v[100:103], v[44:47]
    v_mfma_f32_16x16x32_bf16 v[44:47], v[76:79], v[100:103], v[44:47]
    ds_read_b128 v[96:99], v6 offset:384
    s_waitcnt lgkmcnt(9)
    s_waitcnt lgkmcnt(8)
    v_mfma_f32_16x16x32_bf16 v[32:35], v[80:83], v[104:107], v[32:35]
    v_mfma_f32_16x16x32_bf16 v[32:35], v[84:87], v[104:107], v[32:35]
    ds_read_b128 v[100:103], v6 offset:896
    s_waitcnt lgkmcnt(8)
    v_mfma_f32_16x16x32_bf16 v[36:39], v[80:83], v[108:111], v[36:39]
    v_mfma_f32_16x16x32_bf16 v[36:39], v[84:87], v[108:111], v[36:39]
    ds_read_b128 v[104:107], v6 offset:2432
    s_waitcnt lgkmcnt(8)
    v_mfma_f32_16x16x32_bf16 v[40:43], v[80:83], v[112:115], v[40:43]
    v_mfma_f32_16x16x32_bf16 v[40:43], v[84:87], v[112:115], v[40:43]
    ds_read_b128 v[108:111], v6 offset:2944
    ds_read2_b32 v[72:73], v120 offset0:80 offset1:81
    ds_read2_b32 v[74:75], v120 offset0:82 offset1:83
    ds_read2_b32 v[76:77], v121 offset0:80 offset1:81
    ds_read2_b32 v[78:79], v121 offset0:82 offset1:83
    s_waitcnt lgkmcnt(12)
    v_mfma_f32_16x16x32_bf16 v[44:47], v[80:83], v[116:119], v[44:47]
    v_mfma_f32_16x16x32_bf16 v[44:47], v[84:87], v[116:119], v[44:47]
    ds_read_b128 v[112:115], v6 offset:320
    s_waitcnt lgkmcnt(9)
    s_waitcnt lgkmcnt(8)
    v_mfma_f32_16x16x32_bf16 v[32:35], v[64:67], v[96:99], v[32:35]
    v_mfma_f32_16x16x32_bf16 v[32:35], v[68:71], v[96:99], v[32:35]
    ds_read_b128 v[116:119], v6 offset:832
    s_waitcnt lgkmcnt(8)
    v_mfma_f32_16x16x32_bf16 v[36:39], v[64:67], v[100:103], v[36:39]
    v_mfma_f32_16x16x32_bf16 v[36:39], v[68:71], v[100:103], v[36:39]
    ds_read_b128 v[96:99], v6 offset:2368
    s_waitcnt lgkmcnt(8)
    v_mfma_f32_16x16x32_bf16 v[40:43], v[64:67], v[104:107], v[40:43]
    v_mfma_f32_16x16x32_bf16 v[40:43], v[68:71], v[104:107], v[40:43]
    ds_read_b128 v[100:103], v6 offset:2880
    ds_read2_b32 v[80:81], v120 offset0:64 offset1:65
    ds_read2_b32 v[82:83], v120 offset0:66 offset1:67
    ds_read2_b32 v[84:85], v121 offset0:64 offset1:65
    ds_read2_b32 v[86:87], v121 offset0:66 offset1:67
    s_waitcnt lgkmcnt(12)
    v_mfma_f32_16x16x32_bf16 v[44:47], v[64:67], v[108:111], v[44:47]
    v_mfma_f32_16x16x32_bf16 v[44:47], v[68:71], v[108:111], v[44:47]
    ds_read_b128 v[104:107], v6 offset:256
    s_waitcnt lgkmcnt(9)
    s_waitcnt lgkmcnt(8)
    v_mfma_f32_16x16x32_bf16 v[32:35], v[72:75], v[112:115], v[32:35]
    v_mfma_f32_16x16x32_bf16 v[32:35], v[76:79], v[112:115], v[32:35]
    ds_read_b128 v[108:111], v6 offset:768
    s_waitcnt lgkmcnt(8)
    v_mfma_f32_16x16x32_bf16 v[36:39], v[72:75], v[116:119], v[36:39]
    v_mfma_f32_16x16x32_bf16 v[36:39], v[76:79], v[116:119], v[36:39]
    ds_read_b128 v[112:115], v6 offset:2304
    s_waitcnt lgkmcnt(8)
    v_mfma_f32_16x16x32_bf16 v[40:43], v[72:75], v[96:99], v[40:43]
    v_mfma_f32_16x16x32_bf16 v[40:43], v[76:79], v[96:99], v[40:43]
    ds_read_b128 v[116:119], v6 offset:2816
    ds_read2_b32 v[64:65], v120 offset0:48 offset1:49
    ds_read2_b32 v[66:67], v120 offset0:50 offset1:51
    ds_read2_b32 v[68:69], v121 offset0:48 offset1:49
    ds_read2_b32 v[70:71], v121 offset0:50 offset1:51
    s_waitcnt lgkmcnt(12)
    v_mfma_f32_16x16x32_bf16 v[44:47], v[72:75], v[100:103], v[44:47]
    v_mfma_f32_16x16x32_bf16 v[44:47], v[76:79], v[100:103], v[44:47]
    ds_read_b128 v[96:99], v6 offset:192
    s_waitcnt lgkmcnt(9)
    s_waitcnt lgkmcnt(8)
    v_mfma_f32_16x16x32_bf16 v[32:35], v[80:83], v[104:107], v[32:35]
    v_mfma_f32_16x16x32_bf16 v[32:35], v[84:87], v[104:107], v[32:35]
    ds_read_b128 v[100:103], v6 offset:704
    s_waitcnt lgkmcnt(8)
    v_mfma_f32_16x16x32_bf16 v[36:39], v[80:83], v[108:111], v[36:39]
    v_mfma_f32_16x16x32_bf16 v[36:39], v[84:87], v[108:111], v[36:39]
    ds_read_b128 v[104:107], v6 offset:2240
    s_waitcnt lgkmcnt(8)
    v_mfma_f32_16x16x32_bf16 v[40:43], v[80:83], v[112:115], v[40:43]
    v_mfma_f32_16x16x32_bf16 v[40:43], v[84:87], v[112:115], v[40:43]
    ds_read_b128 v[108:111], v6 offset:2752
    ds_read2_b32 v[72:73], v120 offset0:32 offset1:33
    ds_read2_b32 v[74:75], v120 offset0:34 offset1:35
    ds_read2_b32 v[76:77], v121 offset0:32 offset1:33
    ds_read2_b32 v[78:79], v121 offset0:34 offset1:35
    s_waitcnt lgkmcnt(12)
    v_mfma_f32_16x16x32_bf16 v[44:47], v[80:83], v[116:119], v[44:47]
    v_mfma_f32_16x16x32_bf16 v[44:47], v[84:87], v[116:119], v[44:47]
    ds_read_b128 v[112:115], v6 offset:128
    s_waitcnt lgkmcnt(9)
    s_waitcnt lgkmcnt(8)
    v_mfma_f32_16x16x32_bf16 v[32:35], v[64:67], v[96:99], v[32:35]
    v_mfma_f32_16x16x32_bf16 v[32:35], v[68:71], v[96:99], v[32:35]
    ds_read_b128 v[116:119], v6 offset:640
    s_waitcnt lgkmcnt(8)
    v_mfma_f32_16x16x32_bf16 v[36:39], v[64:67], v[100:103], v[36:39]
    v_mfma_f32_16x16x32_bf16 v[36:39], v[68:71], v[100:103], v[36:39]
    ds_read_b128 v[96:99], v6 offset:2176
    s_waitcnt lgkmcnt(8)
    v_mfma_f32_16x16x32_bf16 v[40:43], v[64:67], v[104:107], v[40:43]
    v_mfma_f32_16x16x32_bf16 v[40:43], v[68:71], v[104:107], v[40:43]
    ds_read_b128 v[100:103], v6 offset:2688
    ds_read2_b32 v[80:81], v120 offset0:16 offset1:17
    ds_read2_b32 v[82:83], v120 offset0:18 offset1:19
    ds_read2_b32 v[84:85], v121 offset0:16 offset1:17
    ds_read2_b32 v[86:87], v121 offset0:18 offset1:19
    s_waitcnt lgkmcnt(12)
    v_mfma_f32_16x16x32_bf16 v[44:47], v[64:67], v[108:111], v[44:47]
    v_mfma_f32_16x16x32_bf16 v[44:47], v[68:71], v[108:111], v[44:47]
    ds_read_b128 v[104:107], v6 offset:64
    s_waitcnt lgkmcnt(9)
    s_waitcnt lgkmcnt(8)
    v_mfma_f32_16x16x32_bf16 v[32:35], v[72:75], v[112:115], v[32:35]
    v_mfma_f32_16x16x32_bf16 v[32:35], v[76:79], v[112:115], v[32:35]
    ds_read_b128 v[108:111], v6 offset:576
    s_waitcnt lgkmcnt(8)
    v_mfma_f32_16x16x32_bf16 v[36:39], v[72:75], v[116:119], v[36:39]
    v_mfma_f32_16x16x32_bf16 v[36:39], v[76:79], v[116:119], v[36:39]
    ds_read_b128 v[112:115], v6 offset:2112
    s_waitcnt lgkmcnt(8)
    v_mfma_f32_16x16x32_bf16 v[40:43], v[72:75], v[96:99], v[40:43]
    v_mfma_f32_16x16x32_bf16 v[40:43], v[76:79], v[96:99], v[40:43]
    ds_read_b128 v[116:119], v6 offset:2624
    ds_read2_b32 v[64:65], v120 offset0:0 offset1:1
    ds_read2_b32 v[66:67], v120 offset0:2 offset1:3
    ds_read2_b32 v[68:69], v121 offset0:0 offset1:1
    ds_read2_b32 v[70:71], v121 offset0:2 offset1:3
    s_waitcnt lgkmcnt(12)
    v_mfma_f32_16x16x32_bf16 v[44:47], v[72:75], v[100:103], v[44:47]
    v_mfma_f32_16x16x32_bf16 v[44:47], v[76:79], v[100:103], v[44:47]
    ds_read_b128 v[96:99], v6 offset:0
    s_waitcnt lgkmcnt(9)
    s_waitcnt lgkmcnt(8)
    v_mfma_f32_16x16x32_bf16 v[32:35], v[80:83], v[104:107], v[32:35]
    v_mfma_f32_16x16x32_bf16 v[32:35], v[84:87], v[104:107], v[32:35]
    ds_read_b128 v[100:103], v6 offset:512
    s_waitcnt lgkmcnt(8)
    v_mfma_f32_16x16x32_bf16 v[36:39], v[80:83], v[108:111], v[36:39]
    v_mfma_f32_16x16x32_bf16 v[36:39], v[84:87], v[108:111], v[36:39]
    ds_read_b128 v[104:107], v6 offset:2048
    s_waitcnt lgkmcnt(8)
    v_mfma_f32_16x16x32_bf16 v[40:43], v[80:83], v[112:115], v[40:43]
    v_mfma_f32_16x16x32_bf16 v[40:43], v[84:87], v[112:115], v[40:43]
    ds_read_b128 v[108:111], v6 offset:2560
    v_add_u32 v120, 2560, v5
    v_add_u32 v121, 11008, v5
    ds_read2_b32 v[72:73], v120 offset0:112 offset1:113
    ds_read2_b32 v[74:75], v120 offset0:114 offset1:115
    ds_read2_b32 v[76:77], v121 offset0:112 offset1:113
    ds_read2_b32 v[78:79], v121 offset0:114 offset1:115
    s_waitcnt lgkmcnt(12)
    v_mfma_f32_16x16x32_bf16 v[44:47], v[80:83], v[116:119], v[44:47]
    v_mfma_f32_16x16x32_bf16 v[44:47], v[84:87], v[116:119], v[44:47]
    ds_read_b128 v[112:115], v6 offset:448
    s_waitcnt lgkmcnt(9)
    s_waitcnt lgkmcnt(8)
    v_mfma_f32_16x16x32_bf16 v[32:35], v[64:67], v[96:99], v[32:35]
    v_mfma_f32_16x16x32_bf16 v[32:35], v[68:71], v[96:99], v[32:35]
    ds_read_b128 v[116:119], v6 offset:1984
    s_waitcnt lgkmcnt(8)
    v_mfma_f32_16x16x32_bf16 v[36:39], v[64:67], v[100:103], v[36:39]
    v_mfma_f32_16x16x32_bf16 v[36:39], v[68:71], v[100:103], v[36:39]
    ds_read_b128 v[96:99], v6 offset:2496
    ds_read2_b32 v[80:81], v120 offset0:96 offset1:97
    ds_read2_b32 v[82:83], v120 offset0:98 offset1:99
    ds_read2_b32 v[84:85], v121 offset0:96 offset1:97
    ds_read2_b32 v[86:87], v121 offset0:98 offset1:99
    s_waitcnt lgkmcnt(12)
    v_mfma_f32_16x16x32_bf16 v[40:43], v[64:67], v[104:107], v[40:43]
    v_mfma_f32_16x16x32_bf16 v[40:43], v[68:71], v[104:107], v[40:43]
    ds_read_b128 v[100:103], v6 offset:384
    s_waitcnt lgkmcnt(12)
    v_mfma_f32_16x16x32_bf16 v[44:47], v[64:67], v[108:111], v[44:47]
    v_mfma_f32_16x16x32_bf16 v[44:47], v[68:71], v[108:111], v[44:47]
    ds_read_b128 v[104:107], v6 offset:1920
    s_waitcnt lgkmcnt(9)
    s_waitcnt lgkmcnt(8)
    v_mfma_f32_16x16x32_bf16 v[36:39], v[72:75], v[112:115], v[36:39]
    v_mfma_f32_16x16x32_bf16 v[36:39], v[76:79], v[112:115], v[36:39]
    ds_read_b128 v[108:111], v6 offset:2432
    ds_read2_b32 v[64:65], v120 offset0:80 offset1:81
    ds_read2_b32 v[66:67], v120 offset0:82 offset1:83
    ds_read2_b32 v[68:69], v121 offset0:80 offset1:81
    ds_read2_b32 v[70:71], v121 offset0:82 offset1:83
    s_waitcnt lgkmcnt(12)
    v_mfma_f32_16x16x32_bf16 v[40:43], v[72:75], v[116:119], v[40:43]
    v_mfma_f32_16x16x32_bf16 v[40:43], v[76:79], v[116:119], v[40:43]
    ds_read_b128 v[112:115], v6 offset:320
    s_waitcnt lgkmcnt(12)
    v_mfma_f32_16x16x32_bf16 v[44:47], v[72:75], v[96:99], v[44:47]
    v_mfma_f32_16x16x32_bf16 v[44:47], v[76:79], v[96:99], v[44:47]
    ds_read_b128 v[116:119], v6 offset:1856
    s_waitcnt lgkmcnt(9)
    s_waitcnt lgkmcnt(8)
    v_mfma_f32_16x16x32_bf16 v[36:39], v[80:83], v[100:103], v[36:39]
    v_mfma_f32_16x16x32_bf16 v[36:39], v[84:87], v[100:103], v[36:39]
    ds_read_b128 v[96:99], v6 offset:2368
    ds_read2_b32 v[72:73], v120 offset0:64 offset1:65
    ds_read2_b32 v[74:75], v120 offset0:66 offset1:67
    ds_read2_b32 v[76:77], v121 offset0:64 offset1:65
    ds_read2_b32 v[78:79], v121 offset0:66 offset1:67
    s_waitcnt lgkmcnt(12)
    v_mfma_f32_16x16x32_bf16 v[40:43], v[80:83], v[104:107], v[40:43]
    v_mfma_f32_16x16x32_bf16 v[40:43], v[84:87], v[104:107], v[40:43]
    ds_read_b128 v[100:103], v6 offset:256
    s_waitcnt lgkmcnt(12)
    v_mfma_f32_16x16x32_bf16 v[44:47], v[80:83], v[108:111], v[44:47]
    v_mfma_f32_16x16x32_bf16 v[44:47], v[84:87], v[108:111], v[44:47]
    ds_read_b128 v[104:107], v6 offset:1792
    s_waitcnt lgkmcnt(9)
    s_waitcnt lgkmcnt(8)
    v_mfma_f32_16x16x32_bf16 v[36:39], v[64:67], v[112:115], v[36:39]
    v_mfma_f32_16x16x32_bf16 v[36:39], v[68:71], v[112:115], v[36:39]
    ds_read_b128 v[108:111], v6 offset:2304
    ds_read2_b32 v[80:81], v120 offset0:48 offset1:49
    ds_read2_b32 v[82:83], v120 offset0:50 offset1:51
    ds_read2_b32 v[84:85], v121 offset0:48 offset1:49
    ds_read2_b32 v[86:87], v121 offset0:50 offset1:51
    s_waitcnt lgkmcnt(12)
    v_mfma_f32_16x16x32_bf16 v[40:43], v[64:67], v[116:119], v[40:43]
    v_mfma_f32_16x16x32_bf16 v[40:43], v[68:71], v[116:119], v[40:43]
    ds_read_b128 v[112:115], v6 offset:192
    s_waitcnt lgkmcnt(12)
    v_mfma_f32_16x16x32_bf16 v[44:47], v[64:67], v[96:99], v[44:47]
    v_mfma_f32_16x16x32_bf16 v[44:47], v[68:71], v[96:99], v[44:47]
    ds_read_b128 v[116:119], v6 offset:1728
    s_waitcnt lgkmcnt(9)
    s_waitcnt lgkmcnt(8)
    v_mfma_f32_16x16x32_bf16 v[36:39], v[72:75], v[100:103], v[36:39]
    v_mfma_f32_16x16x32_bf16 v[36:39], v[76:79], v[100:103], v[36:39]
    ds_read_b128 v[96:99], v6 offset:2240
    ds_read2_b32 v[64:65], v120 offset0:32 offset1:33
    ds_read2_b32 v[66:67], v120 offset0:34 offset1:35
    ds_read2_b32 v[68:69], v121 offset0:32 offset1:33
    ds_read2_b32 v[70:71], v121 offset0:34 offset1:35
    s_waitcnt lgkmcnt(12)
    v_mfma_f32_16x16x32_bf16 v[40:43], v[72:75], v[104:107], v[40:43]
    v_mfma_f32_16x16x32_bf16 v[40:43], v[76:79], v[104:107], v[40:43]
    ds_read_b128 v[100:103], v6 offset:128
    s_waitcnt lgkmcnt(12)
    v_mfma_f32_16x16x32_bf16 v[44:47], v[72:75], v[108:111], v[44:47]
    v_mfma_f32_16x16x32_bf16 v[44:47], v[76:79], v[108:111], v[44:47]
    ds_read_b128 v[104:107], v6 offset:1664
    s_waitcnt lgkmcnt(9)
    s_waitcnt lgkmcnt(8)
    v_mfma_f32_16x16x32_bf16 v[36:39], v[80:83], v[112:115], v[36:39]
    v_mfma_f32_16x16x32_bf16 v[36:39], v[84:87], v[112:115], v[36:39]
    ds_read_b128 v[108:111], v6 offset:2176
    ds_read2_b32 v[72:73], v120 offset0:16 offset1:17
    ds_read2_b32 v[74:75], v120 offset0:18 offset1:19
    ds_read2_b32 v[76:77], v121 offset0:16 offset1:17
    ds_read2_b32 v[78:79], v121 offset0:18 offset1:19
    s_waitcnt lgkmcnt(12)
    v_mfma_f32_16x16x32_bf16 v[40:43], v[80:83], v[116:119], v[40:43]
    v_mfma_f32_16x16x32_bf16 v[40:43], v[84:87], v[116:119], v[40:43]
    ds_read_b128 v[112:115], v6 offset:64
    s_waitcnt lgkmcnt(12)
    v_mfma_f32_16x16x32_bf16 v[44:47], v[80:83], v[96:99], v[44:47]
    v_mfma_f32_16x16x32_bf16 v[44:47], v[84:87], v[96:99], v[44:47]
    ds_read_b128 v[116:119], v6 offset:1600
    s_waitcnt lgkmcnt(9)
    s_waitcnt lgkmcnt(8)
    v_mfma_f32_16x16x32_bf16 v[36:39], v[64:67], v[100:103], v[36:39]
    v_mfma_f32_16x16x32_bf16 v[36:39], v[68:71], v[100:103], v[36:39]
    ds_read_b128 v[96:99], v6 offset:2112
    ds_read2_b32 v[80:81], v120 offset0:0 offset1:1
    ds_read2_b32 v[82:83], v120 offset0:2 offset1:3
    ds_read2_b32 v[84:85], v121 offset0:0 offset1:1
    ds_read2_b32 v[86:87], v121 offset0:2 offset1:3
    s_waitcnt lgkmcnt(12)
    v_mfma_f32_16x16x32_bf16 v[40:43], v[64:67], v[104:107], v[40:43]
    v_mfma_f32_16x16x32_bf16 v[40:43], v[68:71], v[104:107], v[40:43]
    ds_read_b128 v[100:103], v6 offset:0
    s_waitcnt lgkmcnt(12)
    v_mfma_f32_16x16x32_bf16 v[44:47], v[64:67], v[108:111], v[44:47]
    v_mfma_f32_16x16x32_bf16 v[44:47], v[68:71], v[108:111], v[44:47]
    ds_read_b128 v[104:107], v6 offset:1536
    s_waitcnt lgkmcnt(9)
    s_waitcnt lgkmcnt(8)
    v_mfma_f32_16x16x32_bf16 v[36:39], v[72:75], v[112:115], v[36:39]
    v_mfma_f32_16x16x32_bf16 v[36:39], v[76:79], v[112:115], v[36:39]
    ds_read_b128 v[108:111], v6 offset:2048
    v_add_u32 v120, 2048, v5
    v_add_u32 v121, 10496, v5
    ds_read2_b32 v[64:65], v120 offset0:112 offset1:113
    ds_read2_b32 v[66:67], v120 offset0:114 offset1:115
    ds_read2_b32 v[68:69], v121 offset0:112 offset1:113
    ds_read2_b32 v[70:71], v121 offset0:114 offset1:115
    s_waitcnt lgkmcnt(12)
    v_mfma_f32_16x16x32_bf16 v[40:43], v[72:75], v[116:119], v[40:43]
    v_mfma_f32_16x16x32_bf16 v[40:43], v[76:79], v[116:119], v[40:43]
    ds_read_b128 v[112:115], v6 offset:1472
    s_waitcnt lgkmcnt(12)
    v_mfma_f32_16x16x32_bf16 v[44:47], v[72:75], v[96:99], v[44:47]
    v_mfma_f32_16x16x32_bf16 v[44:47], v[76:79], v[96:99], v[44:47]
    ds_read_b128 v[116:119], v6 offset:1984
    ds_read2_b32 v[72:73], v120 offset0:96 offset1:97
    ds_read2_b32 v[74:75], v120 offset0:98 offset1:99
    ds_read2_b32 v[76:77], v121 offset0:96 offset1:97
    ds_read2_b32 v[78:79], v121 offset0:98 offset1:99
    s_waitcnt lgkmcnt(13)
    s_waitcnt lgkmcnt(12)
    v_mfma_f32_16x16x32_bf16 v[36:39], v[80:83], v[100:103], v[36:39]
    v_mfma_f32_16x16x32_bf16 v[36:39], v[84:87], v[100:103], v[36:39]
    ds_read_b128 v[96:99], v6 offset:1408
    s_waitcnt lgkmcnt(12)
    v_mfma_f32_16x16x32_bf16 v[40:43], v[80:83], v[104:107], v[40:43]
    v_mfma_f32_16x16x32_bf16 v[40:43], v[84:87], v[104:107], v[40:43]
    ds_read_b128 v[100:103], v6 offset:1920
    s_waitcnt lgkmcnt(12)
    v_mfma_f32_16x16x32_bf16 v[44:47], v[80:83], v[108:111], v[44:47]
    v_mfma_f32_16x16x32_bf16 v[44:47], v[84:87], v[108:111], v[44:47]
    ds_read2_b32 v[80:81], v120 offset0:80 offset1:81
    ds_read2_b32 v[82:83], v120 offset0:82 offset1:83
    ds_read2_b32 v[84:85], v121 offset0:80 offset1:81
    ds_read2_b32 v[86:87], v121 offset0:82 offset1:83
    ds_read_b128 v[104:107], v6 offset:1344
    s_waitcnt lgkmcnt(13)
    s_waitcnt lgkmcnt(12)
    v_mfma_f32_16x16x32_bf16 v[40:43], v[64:67], v[112:115], v[40:43]
    v_mfma_f32_16x16x32_bf16 v[40:43], v[68:71], v[112:115], v[40:43]
    ds_read_b128 v[108:111], v6 offset:1856
    s_waitcnt lgkmcnt(12)
    v_mfma_f32_16x16x32_bf16 v[44:47], v[64:67], v[116:119], v[44:47]
    v_mfma_f32_16x16x32_bf16 v[44:47], v[68:71], v[116:119], v[44:47]
    ds_read2_b32 v[64:65], v120 offset0:64 offset1:65
    ds_read2_b32 v[66:67], v120 offset0:66 offset1:67
    ds_read2_b32 v[68:69], v121 offset0:64 offset1:65
    ds_read2_b32 v[70:71], v121 offset0:66 offset1:67
    ds_read_b128 v[112:115], v6 offset:1280
    s_waitcnt lgkmcnt(13)
    s_waitcnt lgkmcnt(12)
    v_mfma_f32_16x16x32_bf16 v[40:43], v[72:75], v[96:99], v[40:43]
    v_mfma_f32_16x16x32_bf16 v[40:43], v[76:79], v[96:99], v[40:43]
    ds_read_b128 v[116:119], v6 offset:1792
    s_waitcnt lgkmcnt(12)
    v_mfma_f32_16x16x32_bf16 v[44:47], v[72:75], v[100:103], v[44:47]
    v_mfma_f32_16x16x32_bf16 v[44:47], v[76:79], v[100:103], v[44:47]
    ds_read2_b32 v[72:73], v120 offset0:48 offset1:49
    ds_read2_b32 v[74:75], v120 offset0:50 offset1:51
    ds_read2_b32 v[76:77], v121 offset0:48 offset1:49
    ds_read2_b32 v[78:79], v121 offset0:50 offset1:51
    ds_read_b128 v[96:99], v6 offset:1216
    s_waitcnt lgkmcnt(13)
    s_waitcnt lgkmcnt(12)
    v_mfma_f32_16x16x32_bf16 v[40:43], v[80:83], v[104:107], v[40:43]
    v_mfma_f32_16x16x32_bf16 v[40:43], v[84:87], v[104:107], v[40:43]
    ds_read_b128 v[100:103], v6 offset:1728
    s_waitcnt lgkmcnt(12)
    v_mfma_f32_16x16x32_bf16 v[44:47], v[80:83], v[108:111], v[44:47]
    v_mfma_f32_16x16x32_bf16 v[44:47], v[84:87], v[108:111], v[44:47]
    ds_read2_b32 v[80:81], v120 offset0:32 offset1:33
    ds_read2_b32 v[82:83], v120 offset0:34 offset1:35
    ds_read2_b32 v[84:85], v121 offset0:32 offset1:33
    ds_read2_b32 v[86:87], v121 offset0:34 offset1:35
    ds_read_b128 v[104:107], v6 offset:1152
    s_waitcnt lgkmcnt(13)
    s_waitcnt lgkmcnt(12)
    v_mfma_f32_16x16x32_bf16 v[40:43], v[64:67], v[112:115], v[40:43]
    v_mfma_f32_16x16x32_bf16 v[40:43], v[68:71], v[112:115], v[40:43]
    ds_read_b128 v[108:111], v6 offset:1664
    s_waitcnt lgkmcnt(12)
    v_mfma_f32_16x16x32_bf16 v[44:47], v[64:67], v[116:119], v[44:47]
    v_mfma_f32_16x16x32_bf16 v[44:47], v[68:71], v[116:119], v[44:47]
    ds_read2_b32 v[64:65], v120 offset0:16 offset1:17
    ds_read2_b32 v[66:67], v120 offset0:18 offset1:19
    ds_read2_b32 v[68:69], v121 offset0:16 offset1:17
    ds_read2_b32 v[70:71], v121 offset0:18 offset1:19
    ds_read_b128 v[112:115], v6 offset:1088
    s_waitcnt lgkmcnt(13)
    s_waitcnt lgkmcnt(12)
    v_mfma_f32_16x16x32_bf16 v[40:43], v[72:75], v[96:99], v[40:43]
    v_mfma_f32_16x16x32_bf16 v[40:43], v[76:79], v[96:99], v[40:43]
    ds_read_b128 v[116:119], v6 offset:1600
    s_waitcnt lgkmcnt(12)
    v_mfma_f32_16x16x32_bf16 v[44:47], v[72:75], v[100:103], v[44:47]
    v_mfma_f32_16x16x32_bf16 v[44:47], v[76:79], v[100:103], v[44:47]
    ds_read2_b32 v[72:73], v120 offset0:0 offset1:1
    ds_read2_b32 v[74:75], v120 offset0:2 offset1:3
    ds_read2_b32 v[76:77], v121 offset0:0 offset1:1
    ds_read2_b32 v[78:79], v121 offset0:2 offset1:3
    ds_read_b128 v[96:99], v6 offset:1024
    s_waitcnt lgkmcnt(13)
    s_waitcnt lgkmcnt(12)
    v_mfma_f32_16x16x32_bf16 v[40:43], v[80:83], v[104:107], v[40:43]
    v_mfma_f32_16x16x32_bf16 v[40:43], v[84:87], v[104:107], v[40:43]
    ds_read_b128 v[100:103], v6 offset:1536
    s_waitcnt lgkmcnt(12)
    v_mfma_f32_16x16x32_bf16 v[44:47], v[80:83], v[108:111], v[44:47]
    v_mfma_f32_16x16x32_bf16 v[44:47], v[84:87], v[108:111], v[44:47]
    v_add_u32 v120, 1536, v5
    v_add_u32 v121, 9984, v5
    ds_read2_b32 v[80:81], v120 offset0:112 offset1:113
    ds_read2_b32 v[82:83], v120 offset0:114 offset1:115
    ds_read2_b32 v[84:85], v121 offset0:112 offset1:113
    ds_read2_b32 v[86:87], v121 offset0:114 offset1:115
    ds_read_b128 v[104:107], v6 offset:960
    s_waitcnt lgkmcnt(13)
    s_waitcnt lgkmcnt(12)
    v_mfma_f32_16x16x32_bf16 v[40:43], v[64:67], v[112:115], v[40:43]
    v_mfma_f32_16x16x32_bf16 v[40:43], v[68:71], v[112:115], v[40:43]
    ds_read_b128 v[108:111], v6 offset:1472
    s_waitcnt lgkmcnt(12)
    v_mfma_f32_16x16x32_bf16 v[44:47], v[64:67], v[116:119], v[44:47]
    v_mfma_f32_16x16x32_bf16 v[44:47], v[68:71], v[116:119], v[44:47]
    ds_read2_b32 v[64:65], v120 offset0:96 offset1:97
    ds_read2_b32 v[66:67], v120 offset0:98 offset1:99
    ds_read2_b32 v[68:69], v121 offset0:96 offset1:97
    ds_read2_b32 v[70:71], v121 offset0:98 offset1:99
    ds_read_b128 v[112:115], v6 offset:896
    s_waitcnt lgkmcnt(13)
    s_waitcnt lgkmcnt(12)
    v_mfma_f32_16x16x32_bf16 v[40:43], v[72:75], v[96:99], v[40:43]
    v_mfma_f32_16x16x32_bf16 v[40:43], v[76:79], v[96:99], v[40:43]
    ds_read_b128 v[116:119], v6 offset:1408
    s_waitcnt lgkmcnt(12)
    v_mfma_f32_16x16x32_bf16 v[44:47], v[72:75], v[100:103], v[44:47]
    v_mfma_f32_16x16x32_bf16 v[44:47], v[76:79], v[100:103], v[44:47]
    ds_read2_b32 v[72:73], v120 offset0:80 offset1:81
    ds_read2_b32 v[74:75], v120 offset0:82 offset1:83
    ds_read2_b32 v[76:77], v121 offset0:80 offset1:81
    ds_read2_b32 v[78:79], v121 offset0:82 offset1:83
    ds_read_b128 v[96:99], v6 offset:832
    s_waitcnt lgkmcnt(13)
    s_waitcnt lgkmcnt(12)
    v_mfma_f32_16x16x32_bf16 v[40:43], v[80:83], v[104:107], v[40:43]
    v_mfma_f32_16x16x32_bf16 v[40:43], v[84:87], v[104:107], v[40:43]
    ds_read_b128 v[100:103], v6 offset:1344
    s_waitcnt lgkmcnt(12)
    v_mfma_f32_16x16x32_bf16 v[44:47], v[80:83], v[108:111], v[44:47]
    v_mfma_f32_16x16x32_bf16 v[44:47], v[84:87], v[108:111], v[44:47]
    ds_read2_b32 v[80:81], v120 offset0:64 offset1:65
    ds_read2_b32 v[82:83], v120 offset0:66 offset1:67
    ds_read2_b32 v[84:85], v121 offset0:64 offset1:65
    ds_read2_b32 v[86:87], v121 offset0:66 offset1:67
    ds_read_b128 v[104:107], v6 offset:768
    s_waitcnt lgkmcnt(13)
    s_waitcnt lgkmcnt(12)
    v_mfma_f32_16x16x32_bf16 v[40:43], v[64:67], v[112:115], v[40:43]
    v_mfma_f32_16x16x32_bf16 v[40:43], v[68:71], v[112:115], v[40:43]
    ds_read_b128 v[108:111], v6 offset:1280
    s_waitcnt lgkmcnt(12)
    v_mfma_f32_16x16x32_bf16 v[44:47], v[64:67], v[116:119], v[44:47]
    v_mfma_f32_16x16x32_bf16 v[44:47], v[68:71], v[116:119], v[44:47]
    ds_read2_b32 v[64:65], v120 offset0:48 offset1:49
    ds_read2_b32 v[66:67], v120 offset0:50 offset1:51
    ds_read2_b32 v[68:69], v121 offset0:48 offset1:49
    ds_read2_b32 v[70:71], v121 offset0:50 offset1:51
    ds_read_b128 v[112:115], v6 offset:704
    s_waitcnt lgkmcnt(13)
    s_waitcnt lgkmcnt(12)
    v_mfma_f32_16x16x32_bf16 v[40:43], v[72:75], v[96:99], v[40:43]
    v_mfma_f32_16x16x32_bf16 v[40:43], v[76:79], v[96:99], v[40:43]
    ds_read_b128 v[116:119], v6 offset:1216
    s_waitcnt lgkmcnt(12)
    v_mfma_f32_16x16x32_bf16 v[44:47], v[72:75], v[100:103], v[44:47]
    v_mfma_f32_16x16x32_bf16 v[44:47], v[76:79], v[100:103], v[44:47]
    ds_read2_b32 v[72:73], v120 offset0:32 offset1:33
    ds_read2_b32 v[74:75], v120 offset0:34 offset1:35
    ds_read2_b32 v[76:77], v121 offset0:32 offset1:33
    ds_read2_b32 v[78:79], v121 offset0:34 offset1:35
    ds_read_b128 v[96:99], v6 offset:640
    s_waitcnt lgkmcnt(13)
    s_waitcnt lgkmcnt(12)
    v_mfma_f32_16x16x32_bf16 v[40:43], v[80:83], v[104:107], v[40:43]
    v_mfma_f32_16x16x32_bf16 v[40:43], v[84:87], v[104:107], v[40:43]
    ds_read_b128 v[100:103], v6 offset:1152
    s_waitcnt lgkmcnt(12)
    v_mfma_f32_16x16x32_bf16 v[44:47], v[80:83], v[108:111], v[44:47]
    v_mfma_f32_16x16x32_bf16 v[44:47], v[84:87], v[108:111], v[44:47]
    ds_read2_b32 v[80:81], v120 offset0:16 offset1:17
    ds_read2_b32 v[82:83], v120 offset0:18 offset1:19
    ds_read2_b32 v[84:85], v121 offset0:16 offset1:17
    ds_read2_b32 v[86:87], v121 offset0:18 offset1:19
    ds_read_b128 v[104:107], v6 offset:576
    s_waitcnt lgkmcnt(13)
    s_waitcnt lgkmcnt(12)
    v_mfma_f32_16x16x32_bf16 v[40:43], v[64:67], v[112:115], v[40:43]
    v_mfma_f32_16x16x32_bf16 v[40:43], v[68:71], v[112:115], v[40:43]
    ds_read_b128 v[108:111], v6 offset:1088
    s_waitcnt lgkmcnt(12)
    v_mfma_f32_16x16x32_bf16 v[44:47], v[64:67], v[116:119], v[44:47]
    v_mfma_f32_16x16x32_bf16 v[44:47], v[68:71], v[116:119], v[44:47]
    ds_read2_b32 v[64:65], v120 offset0:0 offset1:1
    ds_read2_b32 v[66:67], v120 offset0:2 offset1:3
    ds_read2_b32 v[68:69], v121 offset0:0 offset1:1
    ds_read2_b32 v[70:71], v121 offset0:2 offset1:3
    ds_read_b128 v[112:115], v6 offset:512
    s_waitcnt lgkmcnt(13)
    s_waitcnt lgkmcnt(12)
    v_mfma_f32_16x16x32_bf16 v[40:43], v[72:75], v[96:99], v[40:43]
    v_mfma_f32_16x16x32_bf16 v[40:43], v[76:79], v[96:99], v[40:43]
    ds_read_b128 v[116:119], v6 offset:1024
    s_waitcnt lgkmcnt(12)
    v_mfma_f32_16x16x32_bf16 v[44:47], v[72:75], v[100:103], v[44:47]
    v_mfma_f32_16x16x32_bf16 v[44:47], v[76:79], v[100:103], v[44:47]
    v_add_u32 v120, 1024, v5
    v_add_u32 v121, 9472, v5
    ds_read2_b32 v[72:73], v120 offset0:112 offset1:113
    ds_read2_b32 v[74:75], v120 offset0:114 offset1:115
    ds_read2_b32 v[76:77], v121 offset0:112 offset1:113
    ds_read2_b32 v[78:79], v121 offset0:114 offset1:115
    ds_read_b128 v[96:99], v6 offset:448
    s_waitcnt lgkmcnt(13)
    s_waitcnt lgkmcnt(12)
    v_mfma_f32_16x16x32_bf16 v[40:43], v[80:83], v[104:107], v[40:43]
    v_mfma_f32_16x16x32_bf16 v[40:43], v[84:87], v[104:107], v[40:43]
    ds_read_b128 v[100:103], v6 offset:960
    s_waitcnt lgkmcnt(12)
    v_mfma_f32_16x16x32_bf16 v[44:47], v[80:83], v[108:111], v[44:47]
    v_mfma_f32_16x16x32_bf16 v[44:47], v[84:87], v[108:111], v[44:47]
    ds_read2_b32 v[80:81], v120 offset0:96 offset1:97
    ds_read2_b32 v[82:83], v120 offset0:98 offset1:99
    ds_read2_b32 v[84:85], v121 offset0:96 offset1:97
    ds_read2_b32 v[86:87], v121 offset0:98 offset1:99
    ds_read_b128 v[104:107], v6 offset:384
    s_waitcnt lgkmcnt(13)
    s_waitcnt lgkmcnt(12)
    v_mfma_f32_16x16x32_bf16 v[40:43], v[64:67], v[112:115], v[40:43]
    v_mfma_f32_16x16x32_bf16 v[40:43], v[68:71], v[112:115], v[40:43]
    ds_read_b128 v[108:111], v6 offset:896
    s_waitcnt lgkmcnt(12)
    v_mfma_f32_16x16x32_bf16 v[44:47], v[64:67], v[116:119], v[44:47]
    v_mfma_f32_16x16x32_bf16 v[44:47], v[68:71], v[116:119], v[44:47]
    ds_read2_b32 v[64:65], v120 offset0:80 offset1:81
    ds_read2_b32 v[66:67], v120 offset0:82 offset1:83
    ds_read2_b32 v[68:69], v121 offset0:80 offset1:81
    ds_read2_b32 v[70:71], v121 offset0:82 offset1:83
    ds_read_b128 v[112:115], v6 offset:320
    s_waitcnt lgkmcnt(13)
    s_waitcnt lgkmcnt(12)
    v_mfma_f32_16x16x32_bf16 v[40:43], v[72:75], v[96:99], v[40:43]
    v_mfma_f32_16x16x32_bf16 v[40:43], v[76:79], v[96:99], v[40:43]
    ds_read_b128 v[116:119], v6 offset:832
    s_waitcnt lgkmcnt(12)
    v_mfma_f32_16x16x32_bf16 v[44:47], v[72:75], v[100:103], v[44:47]
    v_mfma_f32_16x16x32_bf16 v[44:47], v[76:79], v[100:103], v[44:47]
    ds_read2_b32 v[72:73], v120 offset0:64 offset1:65
    ds_read2_b32 v[74:75], v120 offset0:66 offset1:67
    ds_read2_b32 v[76:77], v121 offset0:64 offset1:65
    ds_read2_b32 v[78:79], v121 offset0:66 offset1:67
    ds_read_b128 v[96:99], v6 offset:256
    s_waitcnt lgkmcnt(13)
    s_waitcnt lgkmcnt(12)
    v_mfma_f32_16x16x32_bf16 v[40:43], v[80:83], v[104:107], v[40:43]
    v_mfma_f32_16x16x32_bf16 v[40:43], v[84:87], v[104:107], v[40:43]
    ds_read_b128 v[100:103], v6 offset:768
    s_waitcnt lgkmcnt(12)
    v_mfma_f32_16x16x32_bf16 v[44:47], v[80:83], v[108:111], v[44:47]
    v_mfma_f32_16x16x32_bf16 v[44:47], v[84:87], v[108:111], v[44:47]
    ds_read2_b32 v[80:81], v120 offset0:48 offset1:49
    ds_read2_b32 v[82:83], v120 offset0:50 offset1:51
    ds_read2_b32 v[84:85], v121 offset0:48 offset1:49
    ds_read2_b32 v[86:87], v121 offset0:50 offset1:51
    ds_read_b128 v[104:107], v6 offset:192
    s_waitcnt lgkmcnt(13)
    s_waitcnt lgkmcnt(12)
    v_mfma_f32_16x16x32_bf16 v[40:43], v[64:67], v[112:115], v[40:43]
    v_mfma_f32_16x16x32_bf16 v[40:43], v[68:71], v[112:115], v[40:43]
    ds_read_b128 v[108:111], v6 offset:704
    s_waitcnt lgkmcnt(12)
    v_mfma_f32_16x16x32_bf16 v[44:47], v[64:67], v[116:119], v[44:47]
    v_mfma_f32_16x16x32_bf16 v[44:47], v[68:71], v[116:119], v[44:47]
    ds_read2_b32 v[64:65], v120 offset0:32 offset1:33
    ds_read2_b32 v[66:67], v120 offset0:34 offset1:35
    ds_read2_b32 v[68:69], v121 offset0:32 offset1:33
    ds_read2_b32 v[70:71], v121 offset0:34 offset1:35
    ds_read_b128 v[112:115], v6 offset:128
    s_waitcnt lgkmcnt(13)
    s_waitcnt lgkmcnt(12)
    v_mfma_f32_16x16x32_bf16 v[40:43], v[72:75], v[96:99], v[40:43]
    v_mfma_f32_16x16x32_bf16 v[40:43], v[76:79], v[96:99], v[40:43]
    ds_read_b128 v[116:119], v6 offset:640
    s_waitcnt lgkmcnt(12)
    v_mfma_f32_16x16x32_bf16 v[44:47], v[72:75], v[100:103], v[44:47]
    v_mfma_f32_16x16x32_bf16 v[44:47], v[76:79], v[100:103], v[44:47]
    ds_read2_b32 v[72:73], v120 offset0:16 offset1:17
    ds_read2_b32 v[74:75], v120 offset0:18 offset1:19
    ds_read2_b32 v[76:77], v121 offset0:16 offset1:17
    ds_read2_b32 v[78:79], v121 offset0:18 offset1:19
    ds_read_b128 v[96:99], v6 offset:64
    s_waitcnt lgkmcnt(13)
    s_waitcnt lgkmcnt(12)
    v_mfma_f32_16x16x32_bf16 v[40:43], v[80:83], v[104:107], v[40:43]
    v_mfma_f32_16x16x32_bf16 v[40:43], v[84:87], v[104:107], v[40:43]
    ds_read_b128 v[100:103], v6 offset:576
    s_waitcnt lgkmcnt(12)
    v_mfma_f32_16x16x32_bf16 v[44:47], v[80:83], v[108:111], v[44:47]
    v_mfma_f32_16x16x32_bf16 v[44:47], v[84:87], v[108:111], v[44:47]
    ds_read2_b32 v[80:81], v120 offset0:0 offset1:1
    ds_read2_b32 v[82:83], v120 offset0:2 offset1:3
    ds_read2_b32 v[84:85], v121 offset0:0 offset1:1
    ds_read2_b32 v[86:87], v121 offset0:2 offset1:3
    ds_read_b128 v[104:107], v6 offset:0
    s_waitcnt lgkmcnt(13)
    s_waitcnt lgkmcnt(12)
    v_mfma_f32_16x16x32_bf16 v[40:43], v[64:67], v[112:115], v[40:43]
    v_mfma_f32_16x16x32_bf16 v[40:43], v[68:71], v[112:115], v[40:43]
    ds_read_b128 v[108:111], v6 offset:512
    s_waitcnt lgkmcnt(12)
    v_mfma_f32_16x16x32_bf16 v[44:47], v[64:67], v[116:119], v[44:47]
    v_mfma_f32_16x16x32_bf16 v[44:47], v[68:71], v[116:119], v[44:47]
    v_add_u32 v120, 512, v5
    v_add_u32 v121, 8960, v5
    ds_read2_b32 v[64:65], v120 offset0:112 offset1:113
    ds_read2_b32 v[66:67], v120 offset0:114 offset1:115
    ds_read2_b32 v[68:69], v121 offset0:112 offset1:113
    ds_read2_b32 v[70:71], v121 offset0:114 offset1:115
    ds_read_b128 v[112:115], v6 offset:448
    s_waitcnt lgkmcnt(13)
    s_waitcnt lgkmcnt(12)
    v_mfma_f32_16x16x32_bf16 v[40:43], v[72:75], v[96:99], v[40:43]
    v_mfma_f32_16x16x32_bf16 v[40:43], v[76:79], v[96:99], v[40:43]
    s_waitcnt lgkmcnt(11)
    v_mfma_f32_16x16x32_bf16 v[44:47], v[72:75], v[100:103], v[44:47]
    v_mfma_f32_16x16x32_bf16 v[44:47], v[76:79], v[100:103], v[44:47]
    ds_read2_b32 v[72:73], v120 offset0:96 offset1:97
    ds_read2_b32 v[74:75], v120 offset0:98 offset1:99
    ds_read2_b32 v[76:77], v121 offset0:96 offset1:97
    ds_read2_b32 v[78:79], v121 offset0:98 offset1:99
    ds_read_b128 v[116:119], v6 offset:384
    s_waitcnt lgkmcnt(12)
    s_waitcnt lgkmcnt(11)
    v_mfma_f32_16x16x32_bf16 v[40:43], v[80:83], v[104:107], v[40:43]
    v_mfma_f32_16x16x32_bf16 v[40:43], v[84:87], v[104:107], v[40:43]
    s_waitcnt lgkmcnt(10)
    v_mfma_f32_16x16x32_bf16 v[44:47], v[80:83], v[108:111], v[44:47]
    v_mfma_f32_16x16x32_bf16 v[44:47], v[84:87], v[108:111], v[44:47]
    ds_read2_b32 v[80:81], v120 offset0:80 offset1:81
    ds_read2_b32 v[82:83], v120 offset0:82 offset1:83
    ds_read2_b32 v[84:85], v121 offset0:80 offset1:81
    ds_read2_b32 v[86:87], v121 offset0:82 offset1:83
    ds_read_b128 v[96:99], v6 offset:320
    s_waitcnt lgkmcnt(11)
    s_waitcnt lgkmcnt(10)
    v_mfma_f32_16x16x32_bf16 v[44:47], v[64:67], v[112:115], v[44:47]
    v_mfma_f32_16x16x32_bf16 v[44:47], v[68:71], v[112:115], v[44:47]
    ds_read2_b32 v[64:65], v120 offset0:64 offset1:65
    ds_read2_b32 v[66:67], v120 offset0:66 offset1:67
    ds_read2_b32 v[68:69], v121 offset0:64 offset1:65
    ds_read2_b32 v[70:71], v121 offset0:66 offset1:67
    ds_read_b128 v[100:103], v6 offset:256
    s_waitcnt lgkmcnt(11)
    s_waitcnt lgkmcnt(10)
    v_mfma_f32_16x16x32_bf16 v[44:47], v[72:75], v[116:119], v[44:47]
    v_mfma_f32_16x16x32_bf16 v[44:47], v[76:79], v[116:119], v[44:47]
    ds_read2_b32 v[72:73], v120 offset0:48 offset1:49
    ds_read2_b32 v[74:75], v120 offset0:50 offset1:51
    ds_read2_b32 v[76:77], v121 offset0:48 offset1:49
    ds_read2_b32 v[78:79], v121 offset0:50 offset1:51
    ds_read_b128 v[104:107], v6 offset:192
    s_waitcnt lgkmcnt(11)
    s_waitcnt lgkmcnt(10)
    v_mfma_f32_16x16x32_bf16 v[44:47], v[80:83], v[96:99], v[44:47]
    v_mfma_f32_16x16x32_bf16 v[44:47], v[84:87], v[96:99], v[44:47]
    ds_read2_b32 v[80:81], v120 offset0:32 offset1:33
    ds_read2_b32 v[82:83], v120 offset0:34 offset1:35
    ds_read2_b32 v[84:85], v121 offset0:32 offset1:33
    ds_read2_b32 v[86:87], v121 offset0:34 offset1:35
    ds_read_b128 v[108:111], v6 offset:128
    s_waitcnt lgkmcnt(11)
    s_waitcnt lgkmcnt(10)
    v_mfma_f32_16x16x32_bf16 v[44:47], v[64:67], v[100:103], v[44:47]
    v_mfma_f32_16x16x32_bf16 v[44:47], v[68:71], v[100:103], v[44:47]
    ds_read2_b32 v[64:65], v120 offset0:16 offset1:17
    ds_read2_b32 v[66:67], v120 offset0:18 offset1:19
    ds_read2_b32 v[68:69], v121 offset0:16 offset1:17
    ds_read2_b32 v[70:71], v121 offset0:18 offset1:19
    ds_read_b128 v[112:115], v6 offset:64
    s_waitcnt lgkmcnt(11)
    s_waitcnt lgkmcnt(10)
    v_mfma_f32_16x16x32_bf16 v[44:47], v[72:75], v[104:107], v[44:47]
    v_mfma_f32_16x16x32_bf16 v[44:47], v[76:79], v[104:107], v[44:47]
    ds_read2_b32 v[72:73], v120 offset0:0 offset1:1
    ds_read2_b32 v[74:75], v120 offset0:2 offset1:3
    ds_read2_b32 v[76:77], v121 offset0:0 offset1:1
    ds_read2_b32 v[78:79], v121 offset0:2 offset1:3
    ds_read_b128 v[116:119], v6 offset:0
    s_waitcnt lgkmcnt(11)
    s_waitcnt lgkmcnt(10)
    v_mfma_f32_16x16x32_bf16 v[44:47], v[80:83], v[108:111], v[44:47]
    v_mfma_f32_16x16x32_bf16 v[44:47], v[84:87], v[108:111], v[44:47]
    s_waitcnt lgkmcnt(6)
    s_waitcnt lgkmcnt(5)
    v_mfma_f32_16x16x32_bf16 v[44:47], v[64:67], v[112:115], v[44:47]
    v_mfma_f32_16x16x32_bf16 v[44:47], v[68:71], v[112:115], v[44:47]
    s_waitcnt lgkmcnt(1)
    s_waitcnt lgkmcnt(0)
    v_mfma_f32_16x16x32_bf16 v[44:47], v[72:75], v[116:119], v[44:47]
    v_mfma_f32_16x16x32_bf16 v[44:47], v[76:79], v[116:119], v[44:47]
    ds_read_b64 v[64:65], v7 offset:18048
    ds_read_b64 v[66:67], v7 offset:18560
    ds_read_b64 v[68:69], v7 offset:20096
    ds_read_b64 v[70:71], v7 offset:20608
    s_waitcnt lgkmcnt(3)
    s_waitcnt lgkmcnt(0)
    v_cvt_pk_bf16_f32 v80, v32, v33
    v_lshlrev_b32 v81, 16, v64
    v_and_b32 v82, 0xffff0000, v64
    v_mul_f32 v81, v81, v23
    v_mul_f32 v82, v82, v23
    v_cvt_pk_bf16_f32 v81, v81, v82
    v_lshlrev_b32 v82, 16, v80
    v_and_b32 v80, 0xffff0000, v80
    v_lshlrev_b32 v83, 16, v81
    v_and_b32 v81, 0xffff0000, v81
    v_add_f32 v82, v82, v83
    v_add_f32 v80, v80, v81
    v_cvt_pk_bf16_f32 v72, v82, v80
    v_cvt_pk_bf16_f32 v80, v34, v35
    v_lshlrev_b32 v81, 16, v65
    v_and_b32 v82, 0xffff0000, v65
    v_mul_f32 v81, v81, v23
    v_mul_f32 v82, v82, v23
    v_cvt_pk_bf16_f32 v81, v81, v82
    v_lshlrev_b32 v82, 16, v80
    v_and_b32 v80, 0xffff0000, v80
    v_lshlrev_b32 v83, 16, v81
    v_and_b32 v81, 0xffff0000, v81
    v_add_f32 v82, v82, v83
    v_add_f32 v80, v80, v81
    v_cvt_pk_bf16_f32 v73, v82, v80
    ds_write_b64 v7, v[72:73] offset:32448
    s_waitcnt lgkmcnt(3)
    s_waitcnt lgkmcnt(0)
    v_cvt_pk_bf16_f32 v80, v36, v37
    v_lshlrev_b32 v81, 16, v66
    v_and_b32 v82, 0xffff0000, v66
    v_mul_f32 v81, v81, v23
    v_mul_f32 v82, v82, v23
    v_cvt_pk_bf16_f32 v81, v81, v82
    v_lshlrev_b32 v82, 16, v80
    v_and_b32 v80, 0xffff0000, v80
    v_lshlrev_b32 v83, 16, v81
    v_and_b32 v81, 0xffff0000, v81
    v_add_f32 v82, v82, v83
    v_add_f32 v80, v80, v81
    v_cvt_pk_bf16_f32 v74, v82, v80
    v_cvt_pk_bf16_f32 v80, v38, v39
    v_lshlrev_b32 v81, 16, v67
    v_and_b32 v82, 0xffff0000, v67
    v_mul_f32 v81, v81, v23
    v_mul_f32 v82, v82, v23
    v_cvt_pk_bf16_f32 v81, v81, v82
    v_lshlrev_b32 v82, 16, v80
    v_and_b32 v80, 0xffff0000, v80
    v_lshlrev_b32 v83, 16, v81
    v_and_b32 v81, 0xffff0000, v81
    v_add_f32 v82, v82, v83
    v_add_f32 v80, v80, v81
    v_cvt_pk_bf16_f32 v75, v82, v80
    ds_write_b64 v7, v[74:75] offset:32960
    s_waitcnt lgkmcnt(3)
    s_waitcnt lgkmcnt(0)
    v_cvt_pk_bf16_f32 v80, v40, v41
    v_lshlrev_b32 v81, 16, v68
    v_and_b32 v82, 0xffff0000, v68
    v_mul_f32 v81, v81, v23
    v_mul_f32 v82, v82, v23
    v_cvt_pk_bf16_f32 v81, v81, v82
    v_lshlrev_b32 v82, 16, v80
    v_and_b32 v80, 0xffff0000, v80
    v_lshlrev_b32 v83, 16, v81
    v_and_b32 v81, 0xffff0000, v81
    v_add_f32 v82, v82, v83
    v_add_f32 v80, v80, v81
    v_cvt_pk_bf16_f32 v76, v82, v80
    v_cvt_pk_bf16_f32 v80, v42, v43
    v_lshlrev_b32 v81, 16, v69
    v_and_b32 v82, 0xffff0000, v69
    v_mul_f32 v81, v81, v23
    v_mul_f32 v82, v82, v23
    v_cvt_pk_bf16_f32 v81, v81, v82
    v_lshlrev_b32 v82, 16, v80
    v_and_b32 v80, 0xffff0000, v80
    v_lshlrev_b32 v83, 16, v81
    v_and_b32 v81, 0xffff0000, v81
    v_add_f32 v82, v82, v83
    v_add_f32 v80, v80, v81
    v_cvt_pk_bf16_f32 v77, v82, v80
    ds_write_b64 v7, v[76:77] offset:34496
    s_waitcnt lgkmcnt(3)
    s_waitcnt lgkmcnt(0)
    v_cvt_pk_bf16_f32 v80, v44, v45
    v_lshlrev_b32 v81, 16, v70
    v_and_b32 v82, 0xffff0000, v70
    v_mul_f32 v81, v81, v23
    v_mul_f32 v82, v82, v23
    v_cvt_pk_bf16_f32 v81, v81, v82
    v_lshlrev_b32 v82, 16, v80
    v_and_b32 v80, 0xffff0000, v80
    v_lshlrev_b32 v83, 16, v81
    v_and_b32 v81, 0xffff0000, v81
    v_add_f32 v82, v82, v83
    v_add_f32 v80, v80, v81
    v_cvt_pk_bf16_f32 v78, v82, v80
    v_cvt_pk_bf16_f32 v80, v46, v47
    v_lshlrev_b32 v81, 16, v71
    v_and_b32 v82, 0xffff0000, v71
    v_mul_f32 v81, v81, v23
    v_mul_f32 v82, v82, v23
    v_cvt_pk_bf16_f32 v81, v81, v82
    v_lshlrev_b32 v82, 16, v80
    v_and_b32 v80, 0xffff0000, v80
    v_lshlrev_b32 v83, 16, v81
    v_and_b32 v81, 0xffff0000, v81
    v_add_f32 v82, v82, v83
    v_add_f32 v80, v80, v81
    v_cvt_pk_bf16_f32 v79, v82, v80
    ds_write_b64 v7, v[78:79] offset:35008
main_kernel_s_cvend:
    s_waitcnt lgkmcnt(0)
    s_barrier
    v_and_b32 v7, 127, v0
    v_lshlrev_b32 v7, 4, v7
    v_add_u32 v9, s20, v7
    ds_read_b128 v[32:35], v9 offset:31936
    ds_read_b128 v[36:39], v9 offset:33984
    s_lshl_b32 s16, s14, 12
    s_add_u32 s16, s16, 0x5000000
    s_waitcnt lgkmcnt(1)
    buffer_store_dwordx4 v[32:35], v7, s[4:7], s16 offen sc1
    s_waitcnt lgkmcnt(0)
    buffer_store_dwordx4 v[36:39], v7, s[4:7], s16 offen offset:2048 sc1
    s_branch main_kernel_sig
main_kernel_t_mono:
    s_sub_u32 s49, s49, 1344
    s_lshr_b32 s16, s49, 2
    s_lshr_b32 s18, s16, 3
    s_add_u32 s18, s18, 2
    s_cmp_lt_u32 s16, 4
    s_cselect_b32 s18, 1, s18
    s_cmp_lt_u32 s16, 2
    s_cselect_b32 s18, 0, s18
    s_cmp_lg_u32 s48, 0
    s_cbranch_scc1 main_kernel_md0_ok
    s_cmp_eq_u32 s97, 1
    s_cbranch_scc1 main_kernel_md0_ok
    v_mbcnt_lo_u32_b32 v250, -1, 0
    v_mbcnt_hi_u32_b32 v250, -1, v250
    v_lshlrev_b32 v250, 2, v250
    s_mov_b32 s21, 0x40000
main_kernel_md0:
    buffer_load_dword v251, v250, s[44:47], 0 offen sc1
    s_waitcnt vmcnt(0)
    v_mov_b32 v249, 0
    v_lshrrev_b32 v248, 2, v250
    v_cmp_le_u32 vcc, 18, v248
    v_cmp_ge_u32 s[22:23], 18, v248
    s_nop 0
    s_and_b64 vcc, vcc, s[22:23]
    v_mov_b32 v247, 128
    v_cndmask_b32 v249, v249, v247, vcc
    v_cmp_le_u32 vcc, 19, v248
    v_cmp_ge_u32 s[22:23], 19, v248
    s_nop 0
    s_and_b64 vcc, vcc, s[22:23]
    v_mov_b32 v247, 256
    v_cndmask_b32 v249, v249, v247, vcc
    v_cmp_le_u32 vcc, 20, v248
    v_cmp_ge_u32 s[22:23], 20, v248
    s_nop 0
    s_and_b64 vcc, vcc, s[22:23]
    v_mov_b32 v247, 32
    v_cndmask_b32 v249, v249, v247, vcc
    v_cmp_le_u32 vcc, 24, v248
    v_cmp_ge_u32 s[22:23], 33, v248
    s_nop 0
    s_and_b64 vcc, vcc, s[22:23]
    v_mov_b32 v247, 64
    v_cndmask_b32 v249, v249, v247, vcc
    v_cmp_le_u32 vcc, 34, v248
    v_cmp_ge_u32 s[22:23], 43, v248
    s_nop 0
    s_and_b64 vcc, vcc, s[22:23]
    v_mov_b32 v247, 32
    v_cndmask_b32 v249, v249, v247, vcc
    v_cmp_lt_u32 vcc, v251, v249
    s_nop 0
    s_cmp_eq_u64 vcc, 0
    s_cselect_b32 s97, 1, 0
    s_cbranch_scc1 main_kernel_md0_ok
    s_mov_b32 s27, 1
    s_add_u32 s24, s18, 24
    s_add_u32 s25, s18, 34
    v_readlane_b32 s22, v251, 20
    s_nop 0
    s_cmp_ge_u32 s22, 32
    s_cselect_b32 s27, s27, 0
    v_readlane_b32 s22, v251, 18
    s_nop 0
    s_cmp_ge_u32 s22, 128
    s_cselect_b32 s27, s27, 0
    v_readlane_b32 s22, v251, 19
    s_nop 0
    s_cmp_ge_u32 s22, 256
    s_cselect_b32 s27, s27, 0
    v_readlane_b32 s22, v251, s24
    s_nop 0
    s_cmp_ge_u32 s22, 64
    s_cselect_b32 s27, s27, 0
    v_readlane_b32 s22, v251, s25
    s_nop 0
    s_cmp_ge_u32 s22, 32
    s_cselect_b32 s27, s27, 0
    s_cmp_eq_u32 s27, 1
    s_cbranch_scc1 main_kernel_md0_ok
    s_sleep 40
    s_sub_u32 s21, s21, 1
    s_cbranch_scc0 main_kernel_md0
main_kernel_md0_ok:
    s_barrier
    s_cmp_lg_u32 s48, 0
    s_cbranch_scc1 main_kernel_md1_ok
    s_mov_b64 exec, 1
    s_and_b32 s22, s2, 31
    s_lshl_b32 s22, s22, 7
    s_add_u32 s22, s22, 0x4300000
    v_mov_b32 v250, s22
    s_lshl_b32 s22, s16, 7
    s_add_u32 s22, s22, 0x4301000
    v_mov_b32 v249, s22
    v_mov_b32 v248, 84
    s_mov_b32 s21, 0x40000
    s_add_u32 s23, s16, 1
    s_min_u32 s24, s23, 63
main_kernel_md1_p:
    s_cmp_ge_u32 s96, s24
    s_cbranch_scc1 main_kernel_md1_p2
    buffer_load_dword v251, v250, s[4:7], 0 offen sc1
    s_waitcnt vmcnt(0)
    v_readfirstlane_b32 s96, v251
    s_nop 0
    s_cmp_ge_u32 s96, s24
    s_cbranch_scc1 main_kernel_md1_p2
    s_sub_u32 s22, s24, s96
main_kernel_md1_bk:
    s_cmp_lt_u32 s22, 2
    s_cbranch_scc1 main_kernel_md1_bke
    s_sleep 56
    s_sub_u32 s22, s22, 1
    s_branch main_kernel_md1_bk
main_kernel_md1_bke:
    s_sleep 10
    s_sub_u32 s21, s21, 1
    s_cbranch_scc0 main_kernel_md1_p
main_kernel_md1_p2:
    s_cmp_lt_u32 s16, 63
    s_cbranch_scc1 main_kernel_md1_done
    buffer_load_dword v251, v248, s[44:47], 0 offen sc1
    s_waitcnt vmcnt(0)
    v_readfirstlane_b32 s22, v251
    s_nop 0
    s_cmp_ge_u32 s22, 32
    s_cbranch_scc1 main_kernel_md1_done
    s_sleep 10
    s_sub_u32 s21, s21, 1
    s_cbranch_scc0 main_kernel_md1_p2
main_kernel_md1_done:
    s_mov_b64 exec, -1
main_kernel_md1_ok:
    s_barrier
    s_mov_b32 s92, 51
    s_lshr_b32 s12, s49, 2
    s_and_b32 s13, s49, 3
    v_lshrrev_b32 v1, 6, v0
    s_nop 0
    v_readfirstlane_b32 s15, v1
    v_and_b32 v2, 63, v0
    v_lshlrev_b32 v152, 4, v2
    s_load_dwordx2 s[28:29], s[0:1], 128
    s_load_dwordx2 s[30:31], s[0:1], 136
    s_mov_b32 s8, s52
    s_and_b32 s9, s53, 0xffff
    s_mov_b32 s10, 0x200000
    s_mov_b32 s11, 0x00020000
    s_mov_b32 s27, 0x3e0293ee
    s_waitcnt lgkmcnt(0)
    s_mov_b32 s20, s28
    s_and_b32 s21, s29, 0xffff
    s_mov_b32 s22, 0x400
    s_mov_b32 s23, 0x00020000
    s_mov_b32 s32, s30
    s_and_b32 s33, s31, 0xffff
    s_mov_b32 s34, 0x200000
    s_mov_b32 s35, 0x00020000
    s_lshl_b32 s16, s12, 5
    s_add_u32 s16, s16, s15
    s_lshl_b32 s36, s16, 13
    s_add_u32 s37, s36, 0x1000000
    s_add_u32 s38, s36, 0x2000000
    s_lshl_b32 s39, s16, 12
    s_add_u32 s40, s39, 0x3800000
    s_add_u32 s39, s39, 0x3000000
    s_lshl_b32 s41, s15, 17
    s_lshl_b32 s16, s13, 13
    s_add_u32 s41, s41, s16
    s_add_u32 s41, s41, 0x4800000
    s_mov_b32 s14, 0x8000
    s_mov_b32 s19, 0x4000
    s_mov_b32 s25, 0x80000
    buffer_load_dwordx4 a[128:131], v152, s[4:7], s38 offen offset:0
    buffer_load_dwordx4 a[132:135], v152, s[4:7], s38 offen offset:1024
    buffer_load_dwordx4 a[136:139], v152, s[4:7], s38 offen offset:2048
    buffer_load_dwordx4 a[140:143], v152, s[4:7], s38 offen offset:3072
    s_add_u32 s16, s38, 4096
    buffer_load_dwordx4 a[144:147], v152, s[4:7], s16 offen offset:0
    s_add_u32 s16, s38, 4096
    buffer_load_dwordx4 a[148:151], v152, s[4:7], s16 offen offset:1024
    s_add_u32 s16, s38, 4096
    buffer_load_dwordx4 a[152:155], v152, s[4:7], s16 offen offset:2048
    s_add_u32 s16, s38, 4096
    buffer_load_dwordx4 a[156:159], v152, s[4:7], s16 offen offset:3072
    buffer_load_dwordx4 a[160:163], v152, s[4:7], s36 offen offset:0
    buffer_load_dwordx4 a[164:167], v152, s[4:7], s36 offen offset:1024
    buffer_load_dwordx4 a[168:171], v152, s[4:7], s36 offen offset:2048
    buffer_load_dwordx4 a[172:175], v152, s[4:7], s36 offen offset:3072
    s_add_u32 s16, s36, 4096
    buffer_load_dwordx4 a[176:179], v152, s[4:7], s16 offen offset:0
    s_add_u32 s16, s36, 4096
    buffer_load_dwordx4 a[180:183], v152, s[4:7], s16 offen offset:1024
    s_add_u32 s16, s36, 4096
    buffer_load_dwordx4 a[184:187], v152, s[4:7], s16 offen offset:2048
    s_add_u32 s16, s36, 4096
    buffer_load_dwordx4 a[188:191], v152, s[4:7], s16 offen offset:3072
    buffer_load_dwordx4 a[192:195], v152, s[4:7], s39 offen offset:0
    buffer_load_dwordx4 a[196:199], v152, s[4:7], s39 offen offset:1024
    buffer_load_dwordx4 a[200:203], v152, s[4:7], s39 offen offset:2048
    buffer_load_dwordx4 a[204:207], v152, s[4:7], s39 offen offset:3072
    s_add_u32 s38, s38, s14
    s_add_u32 s36, s36, s14
    s_add_u32 s39, s39, s19
    buffer_load_dwordx4 a[208:211], v152, s[4:7], s37 offen offset:0
    buffer_load_dwordx4 a[212:215], v152, s[4:7], s37 offen offset:1024
    buffer_load_dwordx4 a[216:219], v152, s[4:7], s37 offen offset:2048
    buffer_load_dwordx4 a[220:223], v152, s[4:7], s37 offen offset:3072
    s_add_u32 s16, s37, 4096
    buffer_load_dwordx4 a[224:227], v152, s[4:7], s16 offen offset:0
    s_add_u32 s16, s37, 4096
    buffer_load_dwordx4 a[228:231], v152, s[4:7], s16 offen offset:1024
    s_add_u32 s16, s37, 4096
    buffer_load_dwordx4 a[232:235], v152, s[4:7], s16 offen offset:2048
    s_add_u32 s16, s37, 4096
    buffer_load_dwordx4 a[236:239], v152, s[4:7], s16 offen offset:3072
    buffer_load_dwordx4 a[240:243], v152, s[4:7], s40 offen offset:0
    buffer_load_dwordx4 a[244:247], v152, s[4:7], s40 offen offset:1024
    buffer_load_dwordx4 a[248:251], v152, s[4:7], s40 offen offset:2048
    buffer_load_dwordx4 a[252:255], v152, s[4:7], s40 offen offset:3072
    s_add_u32 s37, s37, s14
    s_add_u32 s40, s40, s19
    buffer_load_dwordx4 a[0:3], v152, s[4:7], s41 offen offset:0
    buffer_load_dwordx4 a[4:7], v152, s[4:7], s41 offen offset:1024
    buffer_load_dwordx4 a[8:11], v152, s[4:7], s41 offen offset:2048
    buffer_load_dwordx4 a[12:15], v152, s[4:7], s41 offen offset:3072
    s_add_u32 s16, s41, 4096
    buffer_load_dwordx4 a[16:19], v152, s[4:7], s16 offen offset:0
    s_add_u32 s16, s41, 4096
    buffer_load_dwordx4 a[20:23], v152, s[4:7], s16 offen offset:1024
    s_add_u32 s16, s41, 4096
    buffer_load_dwordx4 a[24:27], v152, s[4:7], s16 offen offset:2048
    s_add_u32 s16, s41, 4096
    buffer_load_dwordx4 a[28:31], v152, s[4:7], s16 offen offset:3072
    s_add_u32 s16, s41, 32768
    buffer_load_dwordx4 a[32:35], v152, s[4:7], s16 offen offset:0
    s_add_u32 s16, s41, 32768
    buffer_load_dwordx4 a[36:39], v152, s[4:7], s16 offen offset:1024
    s_add_u32 s16, s41, 32768
    buffer_load_dwordx4 a[40:43], v152, s[4:7], s16 offen offset:2048
    s_add_u32 s16, s41, 32768
    buffer_load_dwordx4 a[44:47], v152, s[4:7], s16 offen offset:3072
    s_add_u32 s16, s41, 36864
    buffer_load_dwordx4 a[48:51], v152, s[4:7], s16 offen offset:0
    s_add_u32 s16, s41, 36864
    buffer_load_dwordx4 a[52:55], v152, s[4:7], s16 offen offset:1024
    s_add_u32 s16, s41, 36864
    buffer_load_dwordx4 a[56:59], v152, s[4:7], s16 offen offset:2048
    s_add_u32 s16, s41, 36864
    buffer_load_dwordx4 a[60:63], v152, s[4:7], s16 offen offset:3072
    s_add_u32 s16, s41, 65536
    buffer_load_dwordx4 a[64:67], v152, s[4:7], s16 offen offset:0
    s_add_u32 s16, s41, 65536
    buffer_load_dwordx4 a[68:71], v152, s[4:7], s16 offen offset:1024
    s_add_u32 s16, s41, 65536
    buffer_load_dwordx4 a[72:75], v152, s[4:7], s16 offen offset:2048
    s_add_u32 s16, s41, 65536
    buffer_load_dwordx4 a[76:79], v152, s[4:7], s16 offen offset:3072
    s_add_u32 s16, s41, 69632
    buffer_load_dwordx4 a[80:83], v152, s[4:7], s16 offen offset:0
    s_add_u32 s16, s41, 69632
    buffer_load_dwordx4 a[84:87], v152, s[4:7], s16 offen offset:1024
    s_add_u32 s16, s41, 69632
    buffer_load_dwordx4 a[88:91], v152, s[4:7], s16 offen offset:2048
    s_add_u32 s16, s41, 69632
    buffer_load_dwordx4 a[92:95], v152, s[4:7], s16 offen offset:3072
    s_add_u32 s16, s41, 98304
    buffer_load_dwordx4 a[96:99], v152, s[4:7], s16 offen offset:0
    s_add_u32 s16, s41, 98304
    buffer_load_dwordx4 a[100:103], v152, s[4:7], s16 offen offset:1024
    s_add_u32 s16, s41, 98304
    buffer_load_dwordx4 a[104:107], v152, s[4:7], s16 offen offset:2048
    s_add_u32 s16, s41, 98304
    buffer_load_dwordx4 a[108:111], v152, s[4:7], s16 offen offset:3072
    s_add_u32 s16, s41, 102400
    buffer_load_dwordx4 a[112:115], v152, s[4:7], s16 offen offset:0
    s_add_u32 s16, s41, 102400
    buffer_load_dwordx4 a[116:119], v152, s[4:7], s16 offen offset:1024
    s_add_u32 s16, s41, 102400
    buffer_load_dwordx4 a[120:123], v152, s[4:7], s16 offen offset:2048
    s_add_u32 s16, s41, 102400
    buffer_load_dwordx4 a[124:127], v152, s[4:7], s16 offen offset:3072
    s_add_u32 s41, s41, s25
    s_barrier
    buffer_load_dwordx4 v[8:11], v152, s[20:23], 0 offen
    s_lshl_b32 s16, s12, 5
    s_lshl_b32 s17, s15, 3
    s_add_u32 s16, s16, s17
    s_lshl_b32 s17, s16, 10
    s_add_u32 s18, s17, 4096
    buffer_load_dwordx4 v[24:27], v152, s[8:11], s17 offen offset:0
    buffer_load_dwordx4 v[28:31], v152, s[8:11], s17 offen offset:1024
    buffer_load_dwordx4 v[32:35], v152, s[8:11], s17 offen offset:2048
    buffer_load_dwordx4 v[36:39], v152, s[8:11], s17 offen offset:3072
    buffer_load_dwordx4 v[40:43], v152, s[8:11], s18 offen offset:0
    buffer_load_dwordx4 v[44:47], v152, s[8:11], s18 offen offset:1024
    buffer_load_dwordx4 v[48:51], v152, s[8:11], s18 offen offset:2048
    buffer_load_dwordx4 v[52:55], v152, s[8:11], s18 offen offset:3072
    s_waitcnt vmcnt(8)
    v_lshlrev_b32 v12, 16, v8
    v_and_b32 v13, 0xffff0000, v8
    v_lshlrev_b32 v14, 16, v9
    v_and_b32 v15, 0xffff0000, v9
    v_lshlrev_b32 v16, 16, v10
    v_and_b32 v17, 0xffff0000, v10
    v_lshlrev_b32 v18, 16, v11
    v_and_b32 v19, 0xffff0000, v11
    s_mov_b32 s26, 0x3f803f80
    s_waitcnt vmcnt(7)
    v_lshlrev_b32 v20, 16, v24
    v_and_b32 v21, 0xffff0000, v24
    v_mul_f32 v20, v20, v12
    v_mul_f32 v21, v21, v13
    v_cvt_pk_bf16_f32 v20, v20, v21
    v_dot2_f32_bf16 v56, v20, s26, 0
    v_lshlrev_b32 v20, 16, v25
    v_and_b32 v21, 0xffff0000, v25
    v_mul_f32 v20, v20, v14
    v_mul_f32 v21, v21, v15
    v_cvt_pk_bf16_f32 v20, v20, v21
    v_dot2_f32_bf16 v56, v20, s26, v56
    v_lshlrev_b32 v20, 16, v26
    v_and_b32 v21, 0xffff0000, v26
    v_mul_f32 v20, v20, v16
    v_mul_f32 v21, v21, v17
    v_cvt_pk_bf16_f32 v20, v20, v21
    v_dot2_f32_bf16 v56, v20, s26, v56
    v_lshlrev_b32 v20, 16, v27
    v_and_b32 v21, 0xffff0000, v27
    v_mul_f32 v20, v20, v18
    v_mul_f32 v21, v21, v19
    v_cvt_pk_bf16_f32 v20, v20, v21
    v_dot2_f32_bf16 v56, v20, s26, v56
    s_waitcnt vmcnt(6)
    v_lshlrev_b32 v20, 16, v28
    v_and_b32 v21, 0xffff0000, v28
    v_mul_f32 v20, v20, v12
    v_mul_f32 v21, v21, v13
    v_cvt_pk_bf16_f32 v20, v20, v21
    v_dot2_f32_bf16 v57, v20, s26, 0
    v_lshlrev_b32 v20, 16, v29
    v_and_b32 v21, 0xffff0000, v29
    v_mul_f32 v20, v20, v14
    v_mul_f32 v21, v21, v15
    v_cvt_pk_bf16_f32 v20, v20, v21
    v_dot2_f32_bf16 v57, v20, s26, v57
    v_lshlrev_b32 v20, 16, v30
    v_and_b32 v21, 0xffff0000, v30
    v_mul_f32 v20, v20, v16
    v_mul_f32 v21, v21, v17
    v_cvt_pk_bf16_f32 v20, v20, v21
    v_dot2_f32_bf16 v57, v20, s26, v57
    v_lshlrev_b32 v20, 16, v31
    v_and_b32 v21, 0xffff0000, v31
    v_mul_f32 v20, v20, v18
    v_mul_f32 v21, v21, v19
    v_cvt_pk_bf16_f32 v20, v20, v21
    v_dot2_f32_bf16 v57, v20, s26, v57
    s_waitcnt vmcnt(5)
    v_lshlrev_b32 v20, 16, v32
    v_and_b32 v21, 0xffff0000, v32
    v_mul_f32 v20, v20, v12
    v_mul_f32 v21, v21, v13
    v_cvt_pk_bf16_f32 v20, v20, v21
    v_dot2_f32_bf16 v58, v20, s26, 0
    v_lshlrev_b32 v20, 16, v33
    v_and_b32 v21, 0xffff0000, v33
    v_mul_f32 v20, v20, v14
    v_mul_f32 v21, v21, v15
    v_cvt_pk_bf16_f32 v20, v20, v21
    v_dot2_f32_bf16 v58, v20, s26, v58
    v_lshlrev_b32 v20, 16, v34
    v_and_b32 v21, 0xffff0000, v34
    v_mul_f32 v20, v20, v16
    v_mul_f32 v21, v21, v17
    v_cvt_pk_bf16_f32 v20, v20, v21
    v_dot2_f32_bf16 v58, v20, s26, v58
    v_lshlrev_b32 v20, 16, v35
    v_and_b32 v21, 0xffff0000, v35
    v_mul_f32 v20, v20, v18
    v_mul_f32 v21, v21, v19
    v_cvt_pk_bf16_f32 v20, v20, v21
    v_dot2_f32_bf16 v58, v20, s26, v58
    s_waitcnt vmcnt(4)
    v_lshlrev_b32 v20, 16, v36
    v_and_b32 v21, 0xffff0000, v36
    v_mul_f32 v20, v20, v12
    v_mul_f32 v21, v21, v13
    v_cvt_pk_bf16_f32 v20, v20, v21
    v_dot2_f32_bf16 v59, v20, s26, 0
    v_lshlrev_b32 v20, 16, v37
    v_and_b32 v21, 0xffff0000, v37
    v_mul_f32 v20, v20, v14
    v_mul_f32 v21, v21, v15
    v_cvt_pk_bf16_f32 v20, v20, v21
    v_dot2_f32_bf16 v59, v20, s26, v59
    v_lshlrev_b32 v20, 16, v38
    v_and_b32 v21, 0xffff0000, v38
    v_mul_f32 v20, v20, v16
    v_mul_f32 v21, v21, v17
    v_cvt_pk_bf16_f32 v20, v20, v21
    v_dot2_f32_bf16 v59, v20, s26, v59
    v_lshlrev_b32 v20, 16, v39
    v_and_b32 v21, 0xffff0000, v39
    v_mul_f32 v20, v20, v18
    v_mul_f32 v21, v21, v19
    v_cvt_pk_bf16_f32 v20, v20, v21
    v_dot2_f32_bf16 v59, v20, s26, v59
    s_waitcnt vmcnt(3)
    v_lshlrev_b32 v20, 16, v40
    v_and_b32 v21, 0xffff0000, v40
    v_mul_f32 v20, v20, v12
    v_mul_f32 v21, v21, v13
    v_cvt_pk_bf16_f32 v20, v20, v21
    v_dot2_f32_bf16 v60, v20, s26, 0
    v_lshlrev_b32 v20, 16, v41
    v_and_b32 v21, 0xffff0000, v41
    v_mul_f32 v20, v20, v14
    v_mul_f32 v21, v21, v15
    v_cvt_pk_bf16_f32 v20, v20, v21
    v_dot2_f32_bf16 v60, v20, s26, v60
    v_lshlrev_b32 v20, 16, v42
    v_and_b32 v21, 0xffff0000, v42
    v_mul_f32 v20, v20, v16
    v_mul_f32 v21, v21, v17
    v_cvt_pk_bf16_f32 v20, v20, v21
    v_dot2_f32_bf16 v60, v20, s26, v60
    v_lshlrev_b32 v20, 16, v43
    v_and_b32 v21, 0xffff0000, v43
    v_mul_f32 v20, v20, v18
    v_mul_f32 v21, v21, v19
    v_cvt_pk_bf16_f32 v20, v20, v21
    v_dot2_f32_bf16 v60, v20, s26, v60
    s_waitcnt vmcnt(2)
    v_lshlrev_b32 v20, 16, v44
    v_and_b32 v21, 0xffff0000, v44
    v_mul_f32 v20, v20, v12
    v_mul_f32 v21, v21, v13
    v_cvt_pk_bf16_f32 v20, v20, v21
    v_dot2_f32_bf16 v61, v20, s26, 0
    v_lshlrev_b32 v20, 16, v45
    v_and_b32 v21, 0xffff0000, v45
    v_mul_f32 v20, v20, v14
    v_mul_f32 v21, v21, v15
    v_cvt_pk_bf16_f32 v20, v20, v21
    v_dot2_f32_bf16 v61, v20, s26, v61
    v_lshlrev_b32 v20, 16, v46
    v_and_b32 v21, 0xffff0000, v46
    v_mul_f32 v20, v20, v16
    v_mul_f32 v21, v21, v17
    v_cvt_pk_bf16_f32 v20, v20, v21
    v_dot2_f32_bf16 v61, v20, s26, v61
    v_lshlrev_b32 v20, 16, v47
    v_and_b32 v21, 0xffff0000, v47
    v_mul_f32 v20, v20, v18
    v_mul_f32 v21, v21, v19
    v_cvt_pk_bf16_f32 v20, v20, v21
    v_dot2_f32_bf16 v61, v20, s26, v61
    s_waitcnt vmcnt(1)
    v_lshlrev_b32 v20, 16, v48
    v_and_b32 v21, 0xffff0000, v48
    v_mul_f32 v20, v20, v12
    v_mul_f32 v21, v21, v13
    v_cvt_pk_bf16_f32 v20, v20, v21
    v_dot2_f32_bf16 v62, v20, s26, 0
    v_lshlrev_b32 v20, 16, v49
    v_and_b32 v21, 0xffff0000, v49
    v_mul_f32 v20, v20, v14
    v_mul_f32 v21, v21, v15
    v_cvt_pk_bf16_f32 v20, v20, v21
    v_dot2_f32_bf16 v62, v20, s26, v62
    v_lshlrev_b32 v20, 16, v50
    v_and_b32 v21, 0xffff0000, v50
    v_mul_f32 v20, v20, v16
    v_mul_f32 v21, v21, v17
    v_cvt_pk_bf16_f32 v20, v20, v21
    v_dot2_f32_bf16 v62, v20, s26, v62
    v_lshlrev_b32 v20, 16, v51
    v_and_b32 v21, 0xffff0000, v51
    v_mul_f32 v20, v20, v18
    v_mul_f32 v21, v21, v19
    v_cvt_pk_bf16_f32 v20, v20, v21
    v_dot2_f32_bf16 v62, v20, s26, v62
    s_waitcnt vmcnt(0)
    v_lshlrev_b32 v20, 16, v52
    v_and_b32 v21, 0xffff0000, v52
    v_mul_f32 v20, v20, v12
    v_mul_f32 v21, v21, v13
    v_cvt_pk_bf16_f32 v20, v20, v21
    v_dot2_f32_bf16 v63, v20, s26, 0
    v_lshlrev_b32 v20, 16, v53
    v_and_b32 v21, 0xffff0000, v53
    v_mul_f32 v20, v20, v14
    v_mul_f32 v21, v21, v15
    v_cvt_pk_bf16_f32 v20, v20, v21
    v_dot2_f32_bf16 v63, v20, s26, v63
    v_lshlrev_b32 v20, 16, v54
    v_and_b32 v21, 0xffff0000, v54
    v_mul_f32 v20, v20, v16
    v_mul_f32 v21, v21, v17
    v_cvt_pk_bf16_f32 v20, v20, v21
    v_dot2_f32_bf16 v63, v20, s26, v63
    v_lshlrev_b32 v20, 16, v55
    v_and_b32 v21, 0xffff0000, v55
    v_mul_f32 v20, v20, v18
    v_mul_f32 v21, v21, v19
    v_cvt_pk_bf16_f32 v20, v20, v21
    v_dot2_f32_bf16 v63, v20, s26, v63
    s_nop 0
    v_mov_b32_dpp v20, v56 row_ror:1 row_mask:0xf bank_mask:0xf
    v_add_f32 v56, v56, v20
    s_nop 1
    v_mov_b32_dpp v20, v56 row_ror:2 row_mask:0xf bank_mask:0xf
    v_add_f32 v56, v56, v20
    s_nop 1
    v_mov_b32_dpp v20, v56 row_ror:4 row_mask:0xf bank_mask:0xf
    v_add_f32 v56, v56, v20
    s_nop 1
    v_mov_b32_dpp v20, v56 row_ror:8 row_mask:0xf bank_mask:0xf
    v_add_f32 v56, v56, v20
    v_mov_b32 v20, v56
    s_nop 1
    v_permlane32_swap_b32 v56, v20
    v_add_f32 v56, v56, v20
    v_mov_b32 v20, v56
    s_nop 1
    v_permlane16_swap_b32 v56, v20
    v_add_f32 v56, v56, v20
    s_nop 0
    v_mov_b32_dpp v20, v57 row_ror:1 row_mask:0xf bank_mask:0xf
    v_add_f32 v57, v57, v20
    s_nop 1
    v_mov_b32_dpp v20, v57 row_ror:2 row_mask:0xf bank_mask:0xf
    v_add_f32 v57, v57, v20
    s_nop 1
    v_mov_b32_dpp v20, v57 row_ror:4 row_mask:0xf bank_mask:0xf
    v_add_f32 v57, v57, v20
    s_nop 1
    v_mov_b32_dpp v20, v57 row_ror:8 row_mask:0xf bank_mask:0xf
    v_add_f32 v57, v57, v20
    v_mov_b32 v20, v57
    s_nop 1
    v_permlane32_swap_b32 v57, v20
    v_add_f32 v57, v57, v20
    v_mov_b32 v20, v57
    s_nop 1
    v_permlane16_swap_b32 v57, v20
    v_add_f32 v57, v57, v20
    s_nop 0
    v_mov_b32_dpp v20, v58 row_ror:1 row_mask:0xf bank_mask:0xf
    v_add_f32 v58, v58, v20
    s_nop 1
    v_mov_b32_dpp v20, v58 row_ror:2 row_mask:0xf bank_mask:0xf
    v_add_f32 v58, v58, v20
    s_nop 1
    v_mov_b32_dpp v20, v58 row_ror:4 row_mask:0xf bank_mask:0xf
    v_add_f32 v58, v58, v20
    s_nop 1
    v_mov_b32_dpp v20, v58 row_ror:8 row_mask:0xf bank_mask:0xf
    v_add_f32 v58, v58, v20
    v_mov_b32 v20, v58
    s_nop 1
    v_permlane32_swap_b32 v58, v20
    v_add_f32 v58, v58, v20
    v_mov_b32 v20, v58
    s_nop 1
    v_permlane16_swap_b32 v58, v20
    v_add_f32 v58, v58, v20
    s_nop 0
    v_mov_b32_dpp v20, v59 row_ror:1 row_mask:0xf bank_mask:0xf
    v_add_f32 v59, v59, v20
    s_nop 1
    v_mov_b32_dpp v20, v59 row_ror:2 row_mask:0xf bank_mask:0xf
    v_add_f32 v59, v59, v20
    s_nop 1
    v_mov_b32_dpp v20, v59 row_ror:4 row_mask:0xf bank_mask:0xf
    v_add_f32 v59, v59, v20
    s_nop 1
    v_mov_b32_dpp v20, v59 row_ror:8 row_mask:0xf bank_mask:0xf
    v_add_f32 v59, v59, v20
    v_mov_b32 v20, v59
    s_nop 1
    v_permlane32_swap_b32 v59, v20
    v_add_f32 v59, v59, v20
    v_mov_b32 v20, v59
    s_nop 1
    v_permlane16_swap_b32 v59, v20
    v_add_f32 v59, v59, v20
    s_nop 0
    v_mov_b32_dpp v20, v60 row_ror:1 row_mask:0xf bank_mask:0xf
    v_add_f32 v60, v60, v20
    s_nop 1
    v_mov_b32_dpp v20, v60 row_ror:2 row_mask:0xf bank_mask:0xf
    v_add_f32 v60, v60, v20
    s_nop 1
    v_mov_b32_dpp v20, v60 row_ror:4 row_mask:0xf bank_mask:0xf
    v_add_f32 v60, v60, v20
    s_nop 1
    v_mov_b32_dpp v20, v60 row_ror:8 row_mask:0xf bank_mask:0xf
    v_add_f32 v60, v60, v20
    v_mov_b32 v20, v60
    s_nop 1
    v_permlane32_swap_b32 v60, v20
    v_add_f32 v60, v60, v20
    v_mov_b32 v20, v60
    s_nop 1
    v_permlane16_swap_b32 v60, v20
    v_add_f32 v60, v60, v20
    s_nop 0
    v_mov_b32_dpp v20, v61 row_ror:1 row_mask:0xf bank_mask:0xf
    v_add_f32 v61, v61, v20
    s_nop 1
    v_mov_b32_dpp v20, v61 row_ror:2 row_mask:0xf bank_mask:0xf
    v_add_f32 v61, v61, v20
    s_nop 1
    v_mov_b32_dpp v20, v61 row_ror:4 row_mask:0xf bank_mask:0xf
    v_add_f32 v61, v61, v20
    s_nop 1
    v_mov_b32_dpp v20, v61 row_ror:8 row_mask:0xf bank_mask:0xf
    v_add_f32 v61, v61, v20
    v_mov_b32 v20, v61
    s_nop 1
    v_permlane32_swap_b32 v61, v20
    v_add_f32 v61, v61, v20
    v_mov_b32 v20, v61
    s_nop 1
    v_permlane16_swap_b32 v61, v20
    v_add_f32 v61, v61, v20
    s_nop 0
    v_mov_b32_dpp v20, v62 row_ror:1 row_mask:0xf bank_mask:0xf
    v_add_f32 v62, v62, v20
    s_nop 1
    v_mov_b32_dpp v20, v62 row_ror:2 row_mask:0xf bank_mask:0xf
    v_add_f32 v62, v62, v20
    s_nop 1
    v_mov_b32_dpp v20, v62 row_ror:4 row_mask:0xf bank_mask:0xf
    v_add_f32 v62, v62, v20
    s_nop 1
    v_mov_b32_dpp v20, v62 row_ror:8 row_mask:0xf bank_mask:0xf
    v_add_f32 v62, v62, v20
    v_mov_b32 v20, v62
    s_nop 1
    v_permlane32_swap_b32 v62, v20
    v_add_f32 v62, v62, v20
    v_mov_b32 v20, v62
    s_nop 1
    v_permlane16_swap_b32 v62, v20
    v_add_f32 v62, v62, v20
    s_nop 0
    v_mov_b32_dpp v20, v63 row_ror:1 row_mask:0xf bank_mask:0xf
    v_add_f32 v63, v63, v20
    s_nop 1
    v_mov_b32_dpp v20, v63 row_ror:2 row_mask:0xf bank_mask:0xf
    v_add_f32 v63, v63, v20
    s_nop 1
    v_mov_b32_dpp v20, v63 row_ror:4 row_mask:0xf bank_mask:0xf
    v_add_f32 v63, v63, v20
    s_nop 1
    v_mov_b32_dpp v20, v63 row_ror:8 row_mask:0xf bank_mask:0xf
    v_add_f32 v63, v63, v20
    v_mov_b32 v20, v63
    s_nop 1
    v_permlane32_swap_b32 v63, v20
    v_add_f32 v63, v63, v20
    v_mov_b32 v20, v63
    s_nop 1
    v_permlane16_swap_b32 v63, v20
    v_add_f32 v63, v63, v20
    v_mov_b32 v22, v56
    v_cmp_eq_u32 vcc, 1, v2
    s_nop 1
    v_cndmask_b32 v22, v22, v57, vcc
    v_cmp_eq_u32 vcc, 2, v2
    s_nop 1
    v_cndmask_b32 v22, v22, v58, vcc
    v_cmp_eq_u32 vcc, 3, v2
    s_nop 1
    v_cndmask_b32 v22, v22, v59, vcc
    v_cmp_eq_u32 vcc, 4, v2
    s_nop 1
    v_cndmask_b32 v22, v22, v60, vcc
    v_cmp_eq_u32 vcc, 5, v2
    s_nop 1
    v_cndmask_b32 v22, v22, v61, vcc
    v_cmp_eq_u32 vcc, 6, v2
    s_nop 1
    v_cndmask_b32 v22, v22, v62, vcc
    v_cmp_eq_u32 vcc, 7, v2
    s_nop 1
    v_cndmask_b32 v22, v22, v63, vcc
    v_cvt_pk_bf16_f32 v22, v22, v22
    v_and_b32 v22, 0xffff0000, v22
    v_mul_f32 v22, 0xbfb8aa3b, v22
    v_exp_f32 v22, v22
    s_nop 0
    v_add_f32 v22, 1.0, v22
    v_rcp_f32 v22, v22
    s_nop 0
    v_cvt_pk_bf16_f32 v22, v22, v22
    v_and_b32 v22, 0xffff0000, v22
    s_lshl_b32 s16, s15, 5
    s_add_u32 s16, s16, 65536
    v_lshlrev_b32 v23, 2, v2
    v_add_u32 v23, s16, v23
    s_mov_b64 exec, 0xff
    ds_write_b32 v23, v22
    s_mov_b64 exec, -1
    v_and_b32 v3, 15, v2
    v_lshrrev_b32 v4, 4, v2
    v_lshlrev_b32 v4, 2, v4
    v_mov_b32 v5, 0xff800000
    v_mov_b32 v6, 0
    v_add_u32 v7, 0, v4
    v_cmp_le_u32 vcc, v7, v3
    s_nop 1
    v_cndmask_b32 v148, v5, v6, vcc
    v_add_u32 v7, 1, v4
    v_cmp_le_u32 vcc, v7, v3
    s_nop 1
    v_cndmask_b32 v149, v5, v6, vcc
    v_add_u32 v7, 2, v4
    v_cmp_le_u32 vcc, v7, v3
    s_nop 1
    v_cndmask_b32 v150, v5, v6, vcc
    v_add_u32 v7, 3, v4
    v_cmp_le_u32 vcc, v7, v3
    s_nop 1
    v_cndmask_b32 v151, v5, v6, vcc
    v_mov_b32 v156, v2
    v_mov_b64 v[0:1], 0
    v_mov_b64 v[2:3], 0
    v_mov_b64 v[4:5], 0
    v_mov_b64 v[6:7], 0
    v_mov_b64 v[8:9], 0
    v_mov_b64 v[10:11], 0
    v_mov_b64 v[12:13], 0
    v_mov_b64 v[14:15], 0
    v_mov_b64 v[16:17], 0
    v_mov_b64 v[18:19], 0
    v_mov_b64 v[20:21], 0
    v_mov_b64 v[22:23], 0
    v_mov_b64 v[24:25], 0
    v_mov_b64 v[26:27], 0
    v_mov_b64 v[28:29], 0
    v_mov_b64 v[30:31], 0
    v_mov_b64 v[32:33], 0
    v_mov_b64 v[34:35], 0
    v_mov_b64 v[36:37], 0
    v_mov_b64 v[38:39], 0
    v_mov_b64 v[40:41], 0
    v_mov_b64 v[42:43], 0
    v_mov_b64 v[44:45], 0
    v_mov_b64 v[46:47], 0
    v_mov_b64 v[48:49], 0
    v_mov_b64 v[50:51], 0
    v_mov_b64 v[52:53], 0
    v_mov_b64 v[54:55], 0
    v_mov_b64 v[56:57], 0
    v_mov_b64 v[58:59], 0
    v_mov_b64 v[60:61], 0
    v_mov_b64 v[62:63], 0
    s_mov_b32 s26, 0
main_kernel_m_hl:
    s_cmp_lt_u32 s26, 6
    s_cselect_b32 s14, 0x8000, 0
    s_lshr_b32 s19, s14, 1
    s_lshl_b32 s25, s14, 4
    s_waitcnt vmcnt(44)
    v_mfma_f32_16x16x32_bf16 v[64:67], a[192:195], a[128:131], 0
    v_mfma_f32_16x16x32_bf16 v[68:71], a[160:163], a[128:131], 0
    v_mfma_f32_16x16x32_bf16 v[64:67], a[196:199], a[132:135], v[64:67]
    v_mfma_f32_16x16x32_bf16 v[68:71], a[164:167], a[132:135], v[68:71]
    v_mfma_f32_16x16x32_bf16 v[64:67], a[200:203], a[136:139], v[64:67]
    v_mfma_f32_16x16x32_bf16 v[68:71], a[168:171], a[136:139], v[68:71]
    v_mfma_f32_16x16x32_bf16 v[64:67], a[204:207], a[140:143], v[64:67]
    v_mfma_f32_16x16x32_bf16 v[68:71], a[172:175], a[140:143], v[68:71]
    s_nop 7
    v_add_f32 v68, v68, v148
    v_add_f32 v69, v69, v149
    v_add_f32 v70, v70, v150
    v_add_f32 v71, v71, v151
    v_max3_f32 v153, v68, v69, v70
    v_max3_f32 v154, v71, v64, v65
    v_max_f32 v153, v153, v154
    v_mov_b32 v154, v153
    s_nop 1
    v_permlane32_swap_b32 v153, v154
    v_max_f32 v153, v153, v154
    v_mov_b32 v154, v153
    s_nop 1
    v_permlane16_swap_b32 v153, v154
    v_max_f32 v153, v153, v154
    v_mul_f32 v153, s27, v153
    v_fma_f32 v64, v64, s27, -v153
    v_fma_f32 v65, v65, s27, -v153
    v_fma_f32 v68, v68, s27, -v153
    v_fma_f32 v69, v69, s27, -v153
    v_fma_f32 v70, v70, s27, -v153
    v_fma_f32 v71, v71, s27, -v153
    v_exp_f32 v64, v64
    v_exp_f32 v65, v65
    v_exp_f32 v68, v68
    v_exp_f32 v69, v69
    v_exp_f32 v70, v70
    v_exp_f32 v71, v71
    v_add_f32 v155, v64, v65
    v_add_f32 v155, v155, v68
    v_add_f32 v155, v155, v69
    v_add_f32 v155, v155, v70
    v_add_f32 v155, v155, v71
    v_cvt_pk_bf16_f32 v80, v64, v65
    v_cvt_pk_bf16_f32 v81, v64, v65
    v_cvt_pk_bf16_f32 v76, v68, v69
    v_cvt_pk_bf16_f32 v77, v70, v71
    v_mov_b64 v[78:79], 0
    v_mov_b32 v154, v155
    s_waitcnt vmcnt(32)
    v_mfma_f32_16x16x16_bf16 v[84:87], a[240:241], v[80:81], 0
    v_permlane32_swap_b32 v155, v154
    v_add_f32 v155, v155, v154
    v_mov_b32 v154, v155
    v_mfma_f32_16x16x16_bf16 v[88:91], a[242:243], v[80:81], 0
    v_mfma_f32_16x16x16_bf16 v[92:95], a[244:245], v[80:81], 0
    v_permlane16_swap_b32 v155, v154
    v_add_f32 v155, v155, v154
    v_rcp_f32 v155, v155
    v_mfma_f32_16x16x16_bf16 v[96:99], a[246:247], v[80:81], 0
    v_mfma_f32_16x16x16_bf16 v[100:103], a[248:249], v[80:81], 0
    v_mfma_f32_16x16x16_bf16 v[104:107], a[250:251], v[80:81], 0
    v_mfma_f32_16x16x16_bf16 v[108:111], a[252:253], v[80:81], 0
    v_mfma_f32_16x16x16_bf16 v[112:115], a[254:255], v[80:81], 0
    v_mfma_f32_16x16x32_bf16 v[84:87], a[208:211], v[76:79], v[84:87]
    v_mfma_f32_16x16x32_bf16 v[88:91], a[212:215], v[76:79], v[88:91]
    v_mfma_f32_16x16x32_bf16 v[92:95], a[216:219], v[76:79], v[92:95]
    v_mfma_f32_16x16x32_bf16 v[96:99], a[220:223], v[76:79], v[96:99]
    v_mfma_f32_16x16x32_bf16 v[100:103], a[224:227], v[76:79], v[100:103]
    v_mfma_f32_16x16x32_bf16 v[104:107], a[228:231], v[76:79], v[104:107]
    v_mfma_f32_16x16x32_bf16 v[108:111], a[232:235], v[76:79], v[108:111]
    v_mfma_f32_16x16x32_bf16 v[112:115], a[236:239], v[76:79], v[112:115]
    s_nop 0
    v_mul_f32 v84, v84, v155
    v_mul_f32 v85, v85, v155
    v_mul_f32 v86, v86, v155
    v_mul_f32 v87, v87, v155
    v_cvt_pk_bf16_f32 v116, v84, v85
    v_cvt_pk_bf16_f32 v117, v86, v87
    v_mul_f32 v88, v88, v155
    v_mul_f32 v89, v89, v155
    v_mul_f32 v90, v90, v155
    v_mul_f32 v91, v91, v155
    v_cvt_pk_bf16_f32 v118, v88, v89
    v_cvt_pk_bf16_f32 v119, v90, v91
    v_mul_f32 v92, v92, v155
    v_mul_f32 v93, v93, v155
    v_mul_f32 v94, v94, v155
    v_mul_f32 v95, v95, v155
    v_cvt_pk_bf16_f32 v120, v92, v93
    v_cvt_pk_bf16_f32 v121, v94, v95
    v_mul_f32 v96, v96, v155
    v_mul_f32 v97, v97, v155
    v_mul_f32 v98, v98, v155
    v_mul_f32 v99, v99, v155
    v_cvt_pk_bf16_f32 v122, v96, v97
    v_cvt_pk_bf16_f32 v123, v98, v99
    v_mul_f32 v100, v100, v155
    v_mul_f32 v101, v101, v155
    v_mul_f32 v102, v102, v155
    v_mul_f32 v103, v103, v155
    v_cvt_pk_bf16_f32 v124, v100, v101
    v_cvt_pk_bf16_f32 v125, v102, v103
    v_mul_f32 v104, v104, v155
    v_mul_f32 v105, v105, v155
    v_mul_f32 v106, v106, v155
    v_mul_f32 v107, v107, v155
    v_cvt_pk_bf16_f32 v126, v104, v105
    v_cvt_pk_bf16_f32 v127, v106, v107
    v_mul_f32 v108, v108, v155
    v_mul_f32 v109, v109, v155
    v_mul_f32 v110, v110, v155
    v_mul_f32 v111, v111, v155
    v_cvt_pk_bf16_f32 v128, v108, v109
    v_cvt_pk_bf16_f32 v129, v110, v111
    v_mul_f32 v112, v112, v155
    v_mul_f32 v113, v113, v155
    v_mul_f32 v114, v114, v155
    v_mul_f32 v115, v115, v155
    v_cvt_pk_bf16_f32 v130, v112, v113
    v_cvt_pk_bf16_f32 v131, v114, v115
    v_mfma_f32_16x16x32_bf16 v[64:67], a[192:195], a[144:147], 0
    v_mfma_f32_16x16x32_bf16 v[68:71], a[160:163], a[144:147], 0
    v_mfma_f32_16x16x32_bf16 v[72:75], a[176:179], a[144:147], 0
    v_mfma_f32_16x16x32_bf16 v[64:67], a[196:199], a[148:151], v[64:67]
    v_mfma_f32_16x16x32_bf16 v[68:71], a[164:167], a[148:151], v[68:71]
    v_mfma_f32_16x16x32_bf16 v[72:75], a[180:183], a[148:151], v[72:75]
    v_mfma_f32_16x16x32_bf16 v[64:67], a[200:203], a[152:155], v[64:67]
    v_mfma_f32_16x16x32_bf16 v[68:71], a[168:171], a[152:155], v[68:71]
    v_mfma_f32_16x16x32_bf16 v[72:75], a[184:187], a[152:155], v[72:75]
    v_mfma_f32_16x16x32_bf16 v[64:67], a[204:207], a[156:159], v[64:67]
    v_mfma_f32_16x16x32_bf16 v[68:71], a[172:175], a[156:159], v[68:71]
    v_mfma_f32_16x16x32_bf16 v[72:75], a[188:191], a[156:159], v[72:75]
    buffer_load_dwordx4 a[128:131], v152, s[4:7], s38 offen offset:0
    buffer_load_dwordx4 a[132:135], v152, s[4:7], s38 offen offset:1024
    buffer_load_dwordx4 a[136:139], v152, s[4:7], s38 offen offset:2048
    buffer_load_dwordx4 a[140:143], v152, s[4:7], s38 offen offset:3072
    s_add_u32 s16, s38, 4096
    buffer_load_dwordx4 a[144:147], v152, s[4:7], s16 offen offset:0
    s_add_u32 s16, s38, 4096
    buffer_load_dwordx4 a[148:151], v152, s[4:7], s16 offen offset:1024
    s_add_u32 s16, s38, 4096
    buffer_load_dwordx4 a[152:155], v152, s[4:7], s16 offen offset:2048
    s_add_u32 s16, s38, 4096
    buffer_load_dwordx4 a[156:159], v152, s[4:7], s16 offen offset:3072
    buffer_load_dwordx4 a[160:163], v152, s[4:7], s36 offen offset:0
    buffer_load_dwordx4 a[164:167], v152, s[4:7], s36 offen offset:1024
    buffer_load_dwordx4 a[168:171], v152, s[4:7], s36 offen offset:2048
    buffer_load_dwordx4 a[172:175], v152, s[4:7], s36 offen offset:3072
    s_add_u32 s16, s36, 4096
    buffer_load_dwordx4 a[176:179], v152, s[4:7], s16 offen offset:0
    s_add_u32 s16, s36, 4096
    buffer_load_dwordx4 a[180:183], v152, s[4:7], s16 offen offset:1024
    s_add_u32 s16, s36, 4096
    buffer_load_dwordx4 a[184:187], v152, s[4:7], s16 offen offset:2048
    s_add_u32 s16, s36, 4096
    buffer_load_dwordx4 a[188:191], v152, s[4:7], s16 offen offset:3072
    buffer_load_dwordx4 a[192:195], v152, s[4:7], s39 offen offset:0
    buffer_load_dwordx4 a[196:199], v152, s[4:7], s39 offen offset:1024
    buffer_load_dwordx4 a[200:203], v152, s[4:7], s39 offen offset:2048
    buffer_load_dwordx4 a[204:207], v152, s[4:7], s39 offen offset:3072
    s_add_u32 s38, s38, s14
    s_add_u32 s36, s36, s14
    s_add_u32 s39, s39, s19
    v_add_f32 v72, v72, v148
    v_add_f32 v73, v73, v149
    v_add_f32 v74, v74, v150
    v_add_f32 v75, v75, v151
    v_max3_f32 v153, v68, v69, v70
    v_max3_f32 v154, v71, v64, v65
    v_max3_f32 v154, v72, v73, v154
    v_max3_f32 v153, v74, v75, v153
    v_max_f32 v153, v153, v154
    v_mov_b32 v154, v153
    s_nop 1
    v_permlane32_swap_b32 v153, v154
    v_max_f32 v153, v153, v154
    v_mov_b32 v154, v153
    s_nop 1
    v_permlane16_swap_b32 v153, v154
    v_max_f32 v153, v153, v154
    v_mul_f32 v153, s27, v153
    v_fma_f32 v64, v64, s27, -v153
    v_fma_f32 v65, v65, s27, -v153
    v_fma_f32 v68, v68, s27, -v153
    v_fma_f32 v69, v69, s27, -v153
    v_fma_f32 v70, v70, s27, -v153
    v_fma_f32 v71, v71, s27, -v153
    v_fma_f32 v72, v72, s27, -v153
    v_fma_f32 v73, v73, s27, -v153
    v_fma_f32 v74, v74, s27, -v153
    v_fma_f32 v75, v75, s27, -v153
    v_exp_f32 v64, v64
    v_exp_f32 v65, v65
    v_exp_f32 v68, v68
    v_exp_f32 v69, v69
    v_exp_f32 v70, v70
    v_exp_f32 v71, v71
    v_exp_f32 v72, v72
    v_exp_f32 v73, v73
    v_exp_f32 v74, v74
    v_exp_f32 v75, v75
    v_add_f32 v155, v64, v65
    v_add_f32 v155, v155, v68
    v_add_f32 v155, v155, v69
    v_add_f32 v155, v155, v70
    v_add_f32 v155, v155, v71
    v_add_f32 v155, v155, v72
    v_add_f32 v155, v155, v73
    v_add_f32 v155, v155, v74
    v_add_f32 v155, v155, v75
    v_cvt_pk_bf16_f32 v80, v64, v65
    v_cvt_pk_bf16_f32 v81, v64, v65
    v_cvt_pk_bf16_f32 v76, v68, v69
    v_cvt_pk_bf16_f32 v77, v70, v71
    v_cvt_pk_bf16_f32 v78, v72, v73
    v_cvt_pk_bf16_f32 v79, v74, v75
    v_mov_b32 v154, v155
    v_mfma_f32_16x16x16_bf16 v[84:87], a[240:241], v[80:81], 0
    s_nop 0
    v_permlane32_swap_b32 v155, v154
    v_add_f32 v155, v155, v154
    v_mov_b32 v154, v155
    v_mfma_f32_16x16x16_bf16 v[88:91], a[242:243], v[80:81], 0
    v_mfma_f32_16x16x16_bf16 v[92:95], a[244:245], v[80:81], 0
    v_permlane16_swap_b32 v155, v154
    v_add_f32 v155, v155, v154
    v_rcp_f32 v155, v155
    v_mfma_f32_16x16x16_bf16 v[96:99], a[246:247], v[80:81], 0
    v_mfma_f32_16x16x16_bf16 v[100:103], a[248:249], v[80:81], 0
    v_mfma_f32_16x16x16_bf16 v[104:107], a[250:251], v[80:81], 0
    v_mfma_f32_16x16x16_bf16 v[108:111], a[252:253], v[80:81], 0
    v_mfma_f32_16x16x16_bf16 v[112:115], a[254:255], v[80:81], 0
    v_mfma_f32_16x16x32_bf16 v[84:87], a[208:211], v[76:79], v[84:87]
    v_mfma_f32_16x16x32_bf16 v[88:91], a[212:215], v[76:79], v[88:91]
    v_mfma_f32_16x16x32_bf16 v[92:95], a[216:219], v[76:79], v[92:95]
    v_mfma_f32_16x16x32_bf16 v[96:99], a[220:223], v[76:79], v[96:99]
    v_mfma_f32_16x16x32_bf16 v[100:103], a[224:227], v[76:79], v[100:103]
    v_mfma_f32_16x16x32_bf16 v[104:107], a[228:231], v[76:79], v[104:107]
    v_mfma_f32_16x16x32_bf16 v[108:111], a[232:235], v[76:79], v[108:111]
    v_mfma_f32_16x16x32_bf16 v[112:115], a[236:239], v[76:79], v[112:115]
    buffer_load_dwordx4 a[208:211], v152, s[4:7], s37 offen offset:0
    buffer_load_dwordx4 a[212:215], v152, s[4:7], s37 offen offset:1024
    buffer_load_dwordx4 a[216:219], v152, s[4:7], s37 offen offset:2048
    buffer_load_dwordx4 a[220:223], v152, s[4:7], s37 offen offset:3072
    s_add_u32 s16, s37, 4096
    buffer_load_dwordx4 a[224:227], v152, s[4:7], s16 offen offset:0
    s_add_u32 s16, s37, 4096
    buffer_load_dwordx4 a[228:231], v152, s[4:7], s16 offen offset:1024
    s_add_u32 s16, s37, 4096
    buffer_load_dwordx4 a[232:235], v152, s[4:7], s16 offen offset:2048
    s_add_u32 s16, s37, 4096
    buffer_load_dwordx4 a[236:239], v152, s[4:7], s16 offen offset:3072
    buffer_load_dwordx4 a[240:243], v152, s[4:7], s40 offen offset:0
    buffer_load_dwordx4 a[244:247], v152, s[4:7], s40 offen offset:1024
    buffer_load_dwordx4 a[248:251], v152, s[4:7], s40 offen offset:2048
    buffer_load_dwordx4 a[252:255], v152, s[4:7], s40 offen offset:3072
    s_add_u32 s37, s37, s14
    s_add_u32 s40, s40, s19
    v_mul_f32 v84, v84, v155
    v_mul_f32 v85, v85, v155
    v_mul_f32 v86, v86, v155
    v_mul_f32 v87, v87, v155
    v_cvt_pk_bf16_f32 v132, v84, v85
    v_cvt_pk_bf16_f32 v133, v86, v87
    v_mul_f32 v88, v88, v155
    v_mul_f32 v89, v89, v155
    v_mul_f32 v90, v90, v155
    v_mul_f32 v91, v91, v155
    v_cvt_pk_bf16_f32 v134, v88, v89
    v_cvt_pk_bf16_f32 v135, v90, v91
    v_mul_f32 v92, v92, v155
    v_mul_f32 v93, v93, v155
    v_mul_f32 v94, v94, v155
    v_mul_f32 v95, v95, v155
    v_cvt_pk_bf16_f32 v136, v92, v93
    v_cvt_pk_bf16_f32 v137, v94, v95
    v_mul_f32 v96, v96, v155
    v_mul_f32 v97, v97, v155
    v_mul_f32 v98, v98, v155
    v_mul_f32 v99, v99, v155
    v_cvt_pk_bf16_f32 v138, v96, v97
    v_cvt_pk_bf16_f32 v139, v98, v99
    v_mul_f32 v100, v100, v155
    v_mul_f32 v101, v101, v155
    v_mul_f32 v102, v102, v155
    v_mul_f32 v103, v103, v155
    v_cvt_pk_bf16_f32 v140, v100, v101
    v_cvt_pk_bf16_f32 v141, v102, v103
    v_mul_f32 v104, v104, v155
    v_mul_f32 v105, v105, v155
    v_mul_f32 v106, v106, v155
    v_mul_f32 v107, v107, v155
    v_cvt_pk_bf16_f32 v142, v104, v105
    v_cvt_pk_bf16_f32 v143, v106, v107
    v_mul_f32 v108, v108, v155
    v_mul_f32 v109, v109, v155
    v_mul_f32 v110, v110, v155
    v_mul_f32 v111, v111, v155
    v_cvt_pk_bf16_f32 v144, v108, v109
    v_cvt_pk_bf16_f32 v145, v110, v111
    v_mul_f32 v112, v112, v155
    v_mul_f32 v113, v113, v155
    v_mul_f32 v114, v114, v155
    v_mul_f32 v115, v115, v155
    v_cvt_pk_bf16_f32 v146, v112, v113
    v_cvt_pk_bf16_f32 v147, v114, v115
    s_waitcnt vmcnt(56)
    v_mfma_f32_16x16x32_bf16 v[0:3], a[0:3], v[116:119], v[0:3]
    v_mfma_f32_16x16x32_bf16 v[4:7], a[0:3], v[132:135], v[4:7]
    v_mfma_f32_16x16x32_bf16 v[8:11], a[4:7], v[116:119], v[8:11]
    v_mfma_f32_16x16x32_bf16 v[12:15], a[4:7], v[132:135], v[12:15]
    v_mfma_f32_16x16x32_bf16 v[16:19], a[8:11], v[116:119], v[16:19]
    v_mfma_f32_16x16x32_bf16 v[20:23], a[8:11], v[132:135], v[20:23]
    v_mfma_f32_16x16x32_bf16 v[24:27], a[12:15], v[116:119], v[24:27]
    v_mfma_f32_16x16x32_bf16 v[28:31], a[12:15], v[132:135], v[28:31]
    v_mfma_f32_16x16x32_bf16 v[32:35], a[16:19], v[116:119], v[32:35]
    v_mfma_f32_16x16x32_bf16 v[36:39], a[16:19], v[132:135], v[36:39]
    v_mfma_f32_16x16x32_bf16 v[40:43], a[20:23], v[116:119], v[40:43]
    v_mfma_f32_16x16x32_bf16 v[44:47], a[20:23], v[132:135], v[44:47]
    v_mfma_f32_16x16x32_bf16 v[48:51], a[24:27], v[116:119], v[48:51]
    v_mfma_f32_16x16x32_bf16 v[52:55], a[24:27], v[132:135], v[52:55]
    v_mfma_f32_16x16x32_bf16 v[56:59], a[28:31], v[116:119], v[56:59]
    v_mfma_f32_16x16x32_bf16 v[60:63], a[28:31], v[132:135], v[60:63]
    buffer_load_dwordx4 a[0:3], v152, s[4:7], s41 offen offset:0
    buffer_load_dwordx4 a[4:7], v152, s[4:7], s41 offen offset:1024
    buffer_load_dwordx4 a[8:11], v152, s[4:7], s41 offen offset:2048
    buffer_load_dwordx4 a[12:15], v152, s[4:7], s41 offen offset:3072
    s_add_u32 s16, s41, 4096
    buffer_load_dwordx4 a[16:19], v152, s[4:7], s16 offen offset:0
    s_add_u32 s16, s41, 4096
    buffer_load_dwordx4 a[20:23], v152, s[4:7], s16 offen offset:1024
    s_add_u32 s16, s41, 4096
    buffer_load_dwordx4 a[24:27], v152, s[4:7], s16 offen offset:2048
    s_add_u32 s16, s41, 4096
    buffer_load_dwordx4 a[28:31], v152, s[4:7], s16 offen offset:3072
    s_waitcnt vmcnt(56)
    v_mfma_f32_16x16x32_bf16 v[0:3], a[32:35], v[120:123], v[0:3]
    v_mfma_f32_16x16x32_bf16 v[4:7], a[32:35], v[136:139], v[4:7]
    v_mfma_f32_16x16x32_bf16 v[8:11], a[36:39], v[120:123], v[8:11]
    v_mfma_f32_16x16x32_bf16 v[12:15], a[36:39], v[136:139], v[12:15]
    v_mfma_f32_16x16x32_bf16 v[16:19], a[40:43], v[120:123], v[16:19]
    v_mfma_f32_16x16x32_bf16 v[20:23], a[40:43], v[136:139], v[20:23]
    v_mfma_f32_16x16x32_bf16 v[24:27], a[44:47], v[120:123], v[24:27]
    v_mfma_f32_16x16x32_bf16 v[28:31], a[44:47], v[136:139], v[28:31]
    v_mfma_f32_16x16x32_bf16 v[32:35], a[48:51], v[120:123], v[32:35]
    v_mfma_f32_16x16x32_bf16 v[36:39], a[48:51], v[136:139], v[36:39]
    v_mfma_f32_16x16x32_bf16 v[40:43], a[52:55], v[120:123], v[40:43]
    v_mfma_f32_16x16x32_bf16 v[44:47], a[52:55], v[136:139], v[44:47]
    v_mfma_f32_16x16x32_bf16 v[48:51], a[56:59], v[120:123], v[48:51]
    v_mfma_f32_16x16x32_bf16 v[52:55], a[56:59], v[136:139], v[52:55]
    v_mfma_f32_16x16x32_bf16 v[56:59], a[60:63], v[120:123], v[56:59]
    v_mfma_f32_16x16x32_bf16 v[60:63], a[60:63], v[136:139], v[60:63]
    s_add_u32 s16, s41, 32768
    buffer_load_dwordx4 a[32:35], v152, s[4:7], s16 offen offset:0
    s_add_u32 s16, s41, 32768
    buffer_load_dwordx4 a[36:39], v152, s[4:7], s16 offen offset:1024
    s_add_u32 s16, s41, 32768
    buffer_load_dwordx4 a[40:43], v152, s[4:7], s16 offen offset:2048
    s_add_u32 s16, s41, 32768
    buffer_load_dwordx4 a[44:47], v152, s[4:7], s16 offen offset:3072
    s_add_u32 s16, s41, 36864
    buffer_load_dwordx4 a[48:51], v152, s[4:7], s16 offen offset:0
    s_add_u32 s16, s41, 36864
    buffer_load_dwordx4 a[52:55], v152, s[4:7], s16 offen offset:1024
    s_add_u32 s16, s41, 36864
    buffer_load_dwordx4 a[56:59], v152, s[4:7], s16 offen offset:2048
    s_add_u32 s16, s41, 36864
    buffer_load_dwordx4 a[60:63], v152, s[4:7], s16 offen offset:3072
    s_waitcnt vmcnt(56)
    v_mfma_f32_16x16x32_bf16 v[0:3], a[64:67], v[124:127], v[0:3]
    v_mfma_f32_16x16x32_bf16 v[4:7], a[64:67], v[140:143], v[4:7]
    v_mfma_f32_16x16x32_bf16 v[8:11], a[68:71], v[124:127], v[8:11]
    v_mfma_f32_16x16x32_bf16 v[12:15], a[68:71], v[140:143], v[12:15]
    v_mfma_f32_16x16x32_bf16 v[16:19], a[72:75], v[124:127], v[16:19]
    v_mfma_f32_16x16x32_bf16 v[20:23], a[72:75], v[140:143], v[20:23]
    v_mfma_f32_16x16x32_bf16 v[24:27], a[76:79], v[124:127], v[24:27]
    v_mfma_f32_16x16x32_bf16 v[28:31], a[76:79], v[140:143], v[28:31]
    v_mfma_f32_16x16x32_bf16 v[32:35], a[80:83], v[124:127], v[32:35]
    v_mfma_f32_16x16x32_bf16 v[36:39], a[80:83], v[140:143], v[36:39]
    v_mfma_f32_16x16x32_bf16 v[40:43], a[84:87], v[124:127], v[40:43]
    v_mfma_f32_16x16x32_bf16 v[44:47], a[84:87], v[140:143], v[44:47]
    v_mfma_f32_16x16x32_bf16 v[48:51], a[88:91], v[124:127], v[48:51]
    v_mfma_f32_16x16x32_bf16 v[52:55], a[88:91], v[140:143], v[52:55]
    v_mfma_f32_16x16x32_bf16 v[56:59], a[92:95], v[124:127], v[56:59]
    v_mfma_f32_16x16x32_bf16 v[60:63], a[92:95], v[140:143], v[60:63]
    s_add_u32 s16, s41, 65536
    buffer_load_dwordx4 a[64:67], v152, s[4:7], s16 offen offset:0
    s_add_u32 s16, s41, 65536
    buffer_load_dwordx4 a[68:71], v152, s[4:7], s16 offen offset:1024
    s_add_u32 s16, s41, 65536
    buffer_load_dwordx4 a[72:75], v152, s[4:7], s16 offen offset:2048
    s_add_u32 s16, s41, 65536
    buffer_load_dwordx4 a[76:79], v152, s[4:7], s16 offen offset:3072
    s_add_u32 s16, s41, 69632
    buffer_load_dwordx4 a[80:83], v152, s[4:7], s16 offen offset:0
    s_add_u32 s16, s41, 69632
    buffer_load_dwordx4 a[84:87], v152, s[4:7], s16 offen offset:1024
    s_add_u32 s16, s41, 69632
    buffer_load_dwordx4 a[88:91], v152, s[4:7], s16 offen offset:2048
    s_add_u32 s16, s41, 69632
    buffer_load_dwordx4 a[92:95], v152, s[4:7], s16 offen offset:3072
    s_waitcnt vmcnt(56)
    v_mfma_f32_16x16x32_bf16 v[0:3], a[96:99], v[128:131], v[0:3]
    v_mfma_f32_16x16x32_bf16 v[4:7], a[96:99], v[144:147], v[4:7]
    v_mfma_f32_16x16x32_bf16 v[8:11], a[100:103], v[128:131], v[8:11]
    v_mfma_f32_16x16x32_bf16 v[12:15], a[100:103], v[144:147], v[12:15]
    v_mfma_f32_16x16x32_bf16 v[16:19], a[104:107], v[128:131], v[16:19]
    v_mfma_f32_16x16x32_bf16 v[20:23], a[104:107], v[144:147], v[20:23]
    v_mfma_f32_16x16x32_bf16 v[24:27], a[108:111], v[128:131], v[24:27]
    v_mfma_f32_16x16x32_bf16 v[28:31], a[108:111], v[144:147], v[28:31]
    v_mfma_f32_16x16x32_bf16 v[32:35], a[112:115], v[128:131], v[32:35]
    v_mfma_f32_16x16x32_bf16 v[36:39], a[112:115], v[144:147], v[36:39]
    v_mfma_f32_16x16x32_bf16 v[40:43], a[116:119], v[128:131], v[40:43]
    v_mfma_f32_16x16x32_bf16 v[44:47], a[116:119], v[144:147], v[44:47]
    v_mfma_f32_16x16x32_bf16 v[48:51], a[120:123], v[128:131], v[48:51]
    v_mfma_f32_16x16x32_bf16 v[52:55], a[120:123], v[144:147], v[52:55]
    v_mfma_f32_16x16x32_bf16 v[56:59], a[124:127], v[128:131], v[56:59]
    v_mfma_f32_16x16x32_bf16 v[60:63], a[124:127], v[144:147], v[60:63]
    s_add_u32 s16, s41, 98304
    buffer_load_dwordx4 a[96:99], v152, s[4:7], s16 offen offset:0
    s_add_u32 s16, s41, 98304
    buffer_load_dwordx4 a[100:103], v152, s[4:7], s16 offen offset:1024
    s_add_u32 s16, s41, 98304
    buffer_load_dwordx4 a[104:107], v152, s[4:7], s16 offen offset:2048
    s_add_u32 s16, s41, 98304
    buffer_load_dwordx4 a[108:111], v152, s[4:7], s16 offen offset:3072
    s_add_u32 s16, s41, 102400
    buffer_load_dwordx4 a[112:115], v152, s[4:7], s16 offen offset:0
    s_add_u32 s16, s41, 102400
    buffer_load_dwordx4 a[116:119], v152, s[4:7], s16 offen offset:1024
    s_add_u32 s16, s41, 102400
    buffer_load_dwordx4 a[120:123], v152, s[4:7], s16 offen offset:2048
    s_add_u32 s16, s41, 102400
    buffer_load_dwordx4 a[124:127], v152, s[4:7], s16 offen offset:3072
    s_add_u32 s41, s41, s25
    s_add_u32 s26, s26, 1
    s_cmp_lt_u32 s26, 8
    s_cbranch_scc1 main_kernel_m_hl
    s_lshl_b32 s16, s15, 14
    v_add_u32 v153, s16, v152
    ds_write_b128 v153, v[0:3] offset:0
    ds_write_b128 v153, v[4:7] offset:1024
    ds_write_b128 v153, v[8:11] offset:2048
    ds_write_b128 v153, v[12:15] offset:3072
    ds_write_b128 v153, v[16:19] offset:4096
    ds_write_b128 v153, v[20:23] offset:5120
    ds_write_b128 v153, v[24:27] offset:6144
    ds_write_b128 v153, v[28:31] offset:7168
    ds_write_b128 v153, v[32:35] offset:8192
    ds_write_b128 v153, v[36:39] offset:9216
    ds_write_b128 v153, v[40:43] offset:10240
    ds_write_b128 v153, v[44:47] offset:11264
    ds_write_b128 v153, v[48:51] offset:12288
    ds_write_b128 v153, v[52:55] offset:13312
    ds_write_b128 v153, v[56:59] offset:14336
    ds_write_b128 v153, v[60:63] offset:15360
    v_and_b32 v64, 15, v156
    v_lshrrev_b32 v65, 4, v156
    v_lshlrev_b32 v66, 10, v64
    v_lshl_add_u32 v66, v65, 3, v66
    s_lshl_b32 s16, s12, 15
    s_lshl_b32 s17, s13, 8
    s_add_u32 s16, s16, s17
    s_lshl_b32 s17, s15, 6
    s_add_u32 s24, s16, s17
    s_add_u32 s25, s24, 16384
    v_lshlrev_b32 v90, 14, v65
    v_lshl_add_u32 v90, v64, 1, v90
    s_lshl_b32 s42, s13, 19
    s_lshl_b32 s17, s15, 17
    s_add_u32 s42, s42, s17
    s_lshl_b32 s17, s12, 6
    s_add_u32 s42, s42, s17
    s_add_u32 s42, s42, 0x5000000
    s_add_u32 s43, s42, 0
    buffer_load_ushort v96, v90, s[4:7], s43 offen offset:0
    s_add_u32 s43, s42, 4096
    buffer_load_ushort v97, v90, s[4:7], s43 offen offset:0
    s_add_u32 s43, s42, 8192
    buffer_load_ushort v98, v90, s[4:7], s43 offen offset:0
    s_add_u32 s43, s42, 12288
    buffer_load_ushort v99, v90, s[4:7], s43 offen offset:0
    s_add_u32 s43, s42, 0
    buffer_load_ushort v100, v90, s[4:7], s43 offen offset:32
    s_add_u32 s43, s42, 4096
    buffer_load_ushort v101, v90, s[4:7], s43 offen offset:32
    s_add_u32 s43, s42, 8192
    buffer_load_ushort v102, v90, s[4:7], s43 offen offset:32
    s_add_u32 s43, s42, 12288
    buffer_load_ushort v103, v90, s[4:7], s43 offen offset:32
    s_add_u32 s43, s42, 65536
    buffer_load_ushort v104, v90, s[4:7], s43 offen offset:0
    s_add_u32 s43, s42, 69632
    buffer_load_ushort v105, v90, s[4:7], s43 offen offset:0
    s_add_u32 s43, s42, 73728
    buffer_load_ushort v106, v90, s[4:7], s43 offen offset:0
    s_add_u32 s43, s42, 77824
    buffer_load_ushort v107, v90, s[4:7], s43 offen offset:0
    s_add_u32 s43, s42, 65536
    buffer_load_ushort v108, v90, s[4:7], s43 offen offset:32
    s_add_u32 s43, s42, 69632
    buffer_load_ushort v109, v90, s[4:7], s43 offen offset:32
    s_add_u32 s43, s42, 73728
    buffer_load_ushort v110, v90, s[4:7], s43 offen offset:32
    s_add_u32 s43, s42, 77824
    buffer_load_ushort v111, v90, s[4:7], s43 offen offset:32
    s_lshl_b32 s16, s15, 12
    v_add_u32 v153, s16, v152
    v_lshlrev_b32 v67, 2, v64
    s_waitcnt lgkmcnt(0)
    s_barrier
    ds_read_b128 v[0:3], v153 offset:0
    ds_read_b128 v[4:7], v153 offset:1024
    ds_read_b128 v[8:11], v153 offset:2048
    ds_read_b128 v[12:15], v153 offset:3072
    ds_read_b128 v[16:19], v153 offset:16384
    ds_read_b128 v[20:23], v153 offset:17408
    ds_read_b128 v[24:27], v153 offset:18432
    ds_read_b128 v[28:31], v153 offset:19456
    ds_read_b128 v[32:35], v153 offset:32768
    ds_read_b128 v[36:39], v153 offset:33792
    ds_read_b128 v[40:43], v153 offset:34816
    ds_read_b128 v[44:47], v153 offset:35840
    ds_read_b128 v[48:51], v153 offset:49152
    ds_read_b128 v[52:55], v153 offset:50176
    ds_read_b128 v[56:59], v153 offset:51200
    ds_read_b128 v[60:63], v153 offset:52224
    v_add_u32 v67, 65536, v67
    ds_read_b32 v76, v67
    ds_read_b32 v77, v67 offset:64
    s_waitcnt lgkmcnt(0)
    v_sub_f32 v78, 1.0, v76
    v_cvt_pk_bf16_f32 v78, v78, v78
    v_and_b32 v78, 0xffff0000, v78
    v_sub_f32 v79, 1.0, v77
    v_cvt_pk_bf16_f32 v79, v79, v79
    v_and_b32 v79, 0xffff0000, v79
    v_add_f32 v0, v0, v16
    v_add_f32 v32, v32, v48
    v_add_f32 v1, v1, v17
    v_add_f32 v33, v33, v49
    v_add_f32 v2, v2, v18
    v_add_f32 v34, v34, v50
    v_add_f32 v3, v3, v19
    v_add_f32 v35, v35, v51
    v_add_f32 v0, v0, v32
    v_add_f32 v1, v1, v33
    v_add_f32 v2, v2, v34
    v_add_f32 v3, v3, v35
    v_cvt_pk_bf16_f32 v80, v0, v1
    v_cvt_pk_bf16_f32 v81, v2, v3
    s_waitcnt vmcnt(12)
    v_lshl_or_b32 v68, v97, 16, v96
    v_lshl_or_b32 v69, v99, 16, v98
    v_lshlrev_b32 v82, 16, v80
    v_and_b32 v83, 0xffff0000, v80
    v_mul_f32 v82, v82, v76
    v_mul_f32 v83, v83, v76
    v_cvt_pk_bf16_f32 v82, v82, v83
    v_lshlrev_b32 v84, 16, v68
    v_and_b32 v85, 0xffff0000, v68
    v_mul_f32 v84, v84, v78
    v_mul_f32 v85, v85, v78
    v_cvt_pk_bf16_f32 v84, v84, v85
    v_lshlrev_b32 v83, 16, v82
    v_and_b32 v82, 0xffff0000, v82
    v_lshlrev_b32 v85, 16, v84
    v_and_b32 v84, 0xffff0000, v84
    v_add_f32 v83, v83, v85
    v_add_f32 v82, v82, v84
    v_cvt_pk_bf16_f32 v86, v83, v82
    v_lshlrev_b32 v82, 16, v81
    v_and_b32 v83, 0xffff0000, v81
    v_mul_f32 v82, v82, v76
    v_mul_f32 v83, v83, v76
    v_cvt_pk_bf16_f32 v82, v82, v83
    v_lshlrev_b32 v84, 16, v69
    v_and_b32 v85, 0xffff0000, v69
    v_mul_f32 v84, v84, v78
    v_mul_f32 v85, v85, v78
    v_cvt_pk_bf16_f32 v84, v84, v85
    v_lshlrev_b32 v83, 16, v82
    v_and_b32 v82, 0xffff0000, v82
    v_lshlrev_b32 v85, 16, v84
    v_and_b32 v84, 0xffff0000, v84
    v_add_f32 v83, v83, v85
    v_add_f32 v82, v82, v84
    v_cvt_pk_bf16_f32 v87, v83, v82
    buffer_store_dwordx2 v[86:87], v66, s[32:35], s24 offen offset:0
    v_add_f32 v4, v4, v20
    v_add_f32 v36, v36, v52
    v_add_f32 v5, v5, v21
    v_add_f32 v37, v37, v53
    v_add_f32 v6, v6, v22
    v_add_f32 v38, v38, v54
    v_add_f32 v7, v7, v23
    v_add_f32 v39, v39, v55
    v_add_f32 v4, v4, v36
    v_add_f32 v5, v5, v37
    v_add_f32 v6, v6, v38
    v_add_f32 v7, v7, v39
    v_cvt_pk_bf16_f32 v80, v4, v5
    v_cvt_pk_bf16_f32 v81, v6, v7
    s_waitcnt vmcnt(9)
    v_lshl_or_b32 v70, v101, 16, v100
    v_lshl_or_b32 v71, v103, 16, v102
    v_lshlrev_b32 v82, 16, v80
    v_and_b32 v83, 0xffff0000, v80
    v_mul_f32 v82, v82, v77
    v_mul_f32 v83, v83, v77
    v_cvt_pk_bf16_f32 v82, v82, v83
    v_lshlrev_b32 v84, 16, v70
    v_and_b32 v85, 0xffff0000, v70
    v_mul_f32 v84, v84, v79
    v_mul_f32 v85, v85, v79
    v_cvt_pk_bf16_f32 v84, v84, v85
    v_lshlrev_b32 v83, 16, v82
    v_and_b32 v82, 0xffff0000, v82
    v_lshlrev_b32 v85, 16, v84
    v_and_b32 v84, 0xffff0000, v84
    v_add_f32 v83, v83, v85
    v_add_f32 v82, v82, v84
    v_cvt_pk_bf16_f32 v88, v83, v82
    v_lshlrev_b32 v82, 16, v81
    v_and_b32 v83, 0xffff0000, v81
    v_mul_f32 v82, v82, v77
    v_mul_f32 v83, v83, v77
    v_cvt_pk_bf16_f32 v82, v82, v83
    v_lshlrev_b32 v84, 16, v71
    v_and_b32 v85, 0xffff0000, v71
    v_mul_f32 v84, v84, v79
    v_mul_f32 v85, v85, v79
    v_cvt_pk_bf16_f32 v84, v84, v85
    v_lshlrev_b32 v83, 16, v82
    v_and_b32 v82, 0xffff0000, v82
    v_lshlrev_b32 v85, 16, v84
    v_and_b32 v84, 0xffff0000, v84
    v_add_f32 v83, v83, v85
    v_add_f32 v82, v82, v84
    v_cvt_pk_bf16_f32 v89, v83, v82
    buffer_store_dwordx2 v[88:89], v66, s[32:35], s25 offen offset:0
    v_add_f32 v8, v8, v24
    v_add_f32 v40, v40, v56
    v_add_f32 v9, v9, v25
    v_add_f32 v41, v41, v57
    v_add_f32 v10, v10, v26
    v_add_f32 v42, v42, v58
    v_add_f32 v11, v11, v27
    v_add_f32 v43, v43, v59
    v_add_f32 v8, v8, v40
    v_add_f32 v9, v9, v41
    v_add_f32 v10, v10, v42
    v_add_f32 v11, v11, v43
    v_cvt_pk_bf16_f32 v80, v8, v9
    v_cvt_pk_bf16_f32 v81, v10, v11
    s_waitcnt vmcnt(6)
    v_lshl_or_b32 v72, v105, 16, v104
    v_lshl_or_b32 v73, v107, 16, v106
    v_lshlrev_b32 v82, 16, v80
    v_and_b32 v83, 0xffff0000, v80
    v_mul_f32 v82, v82, v76
    v_mul_f32 v83, v83, v76
    v_cvt_pk_bf16_f32 v82, v82, v83
    v_lshlrev_b32 v84, 16, v72
    v_and_b32 v85, 0xffff0000, v72
    v_mul_f32 v84, v84, v78
    v_mul_f32 v85, v85, v78
    v_cvt_pk_bf16_f32 v84, v84, v85
    v_lshlrev_b32 v83, 16, v82
    v_and_b32 v82, 0xffff0000, v82
    v_lshlrev_b32 v85, 16, v84
    v_and_b32 v84, 0xffff0000, v84
    v_add_f32 v83, v83, v85
    v_add_f32 v82, v82, v84
    v_cvt_pk_bf16_f32 v90, v83, v82
    v_lshlrev_b32 v82, 16, v81
    v_and_b32 v83, 0xffff0000, v81
    v_mul_f32 v82, v82, v76
    v_mul_f32 v83, v83, v76
    v_cvt_pk_bf16_f32 v82, v82, v83
    v_lshlrev_b32 v84, 16, v73
    v_and_b32 v85, 0xffff0000, v73
    v_mul_f32 v84, v84, v78
    v_mul_f32 v85, v85, v78
    v_cvt_pk_bf16_f32 v84, v84, v85
    v_lshlrev_b32 v83, 16, v82
    v_and_b32 v82, 0xffff0000, v82
    v_lshlrev_b32 v85, 16, v84
    v_and_b32 v84, 0xffff0000, v84
    v_add_f32 v83, v83, v85
    v_add_f32 v82, v82, v84
    v_cvt_pk_bf16_f32 v91, v83, v82
    buffer_store_dwordx2 v[90:91], v66, s[32:35], s24 offen offset:32
    v_add_f32 v12, v12, v28
    v_add_f32 v44, v44, v60
    v_add_f32 v13, v13, v29
    v_add_f32 v45, v45, v61
    v_add_f32 v14, v14, v30
    v_add_f32 v46, v46, v62
    v_add_f32 v15, v15, v31
    v_add_f32 v47, v47, v63
    v_add_f32 v12, v12, v44
    v_add_f32 v13, v13, v45
    v_add_f32 v14, v14, v46
    v_add_f32 v15, v15, v47
    v_cvt_pk_bf16_f32 v80, v12, v13
    v_cvt_pk_bf16_f32 v81, v14, v15
    s_waitcnt vmcnt(3)
    v_lshl_or_b32 v74, v109, 16, v108
    v_lshl_or_b32 v75, v111, 16, v110
    v_lshlrev_b32 v82, 16, v80
    v_and_b32 v83, 0xffff0000, v80
    v_mul_f32 v82, v82, v77
    v_mul_f32 v83, v83, v77
    v_cvt_pk_bf16_f32 v82, v82, v83
    v_lshlrev_b32 v84, 16, v74
    v_and_b32 v85, 0xffff0000, v74
    v_mul_f32 v84, v84, v79
    v_mul_f32 v85, v85, v79
    v_cvt_pk_bf16_f32 v84, v84, v85
    v_lshlrev_b32 v83, 16, v82
    v_and_b32 v82, 0xffff0000, v82
    v_lshlrev_b32 v85, 16, v84
    v_and_b32 v84, 0xffff0000, v84
    v_add_f32 v83, v83, v85
    v_add_f32 v82, v82, v84
    v_cvt_pk_bf16_f32 v92, v83, v82
    v_lshlrev_b32 v82, 16, v81
    v_and_b32 v83, 0xffff0000, v81
    v_mul_f32 v82, v82, v77
    v_mul_f32 v83, v83, v77
    v_cvt_pk_bf16_f32 v82, v82, v83
    v_lshlrev_b32 v84, 16, v75
    v_and_b32 v85, 0xffff0000, v75
    v_mul_f32 v84, v84, v79
    v_mul_f32 v85, v85, v79
    v_cvt_pk_bf16_f32 v84, v84, v85
    v_lshlrev_b32 v83, 16, v82
    v_and_b32 v82, 0xffff0000, v82
    v_lshlrev_b32 v85, 16, v84
    v_and_b32 v84, 0xffff0000, v84
    v_add_f32 v83, v83, v85
    v_add_f32 v82, v82, v84
    v_cvt_pk_bf16_f32 v93, v83, v82
    buffer_store_dwordx2 v[92:93], v66, s[32:35], s25 offen offset:32
    s_branch main_kernel_sig
main_kernel_t_attn:
    s_sub_u32 s49, s49, 1544
    s_mul_hi_u32 s12, s49, 0xaaaaaab
    s_mul_i32 s16, s12, 24
    s_sub_u32 s13, s49, s16
    s_add_u32 s12, s12, 50
    s_cmp_ge_u32 s13, 8
    s_cbranch_scc1 main_kernel_t_b
    s_lshl_b32 s92, s12, 7
    s_add_u32 s92, s92, 0x4301000
    v_and_b32 v2, 63, v0
    v_lshlrev_b32 v152, 4, v2
    s_lshr_b32 s18, s12, 3
    s_add_u32 s18, s18, 2
    s_cmp_lt_u32 s12, 4
    s_cselect_b32 s18, 1, s18
    s_cmp_lt_u32 s12, 2
    s_cselect_b32 s18, 0, s18
    s_cmp_lg_u32 s48, 0
    s_cbranch_scc1 main_kernel_a_d0_ok
    s_cmp_eq_u32 s97, 1
    s_cbranch_scc1 main_kernel_a_d0_ok
    v_mbcnt_lo_u32_b32 v250, -1, 0
    v_mbcnt_hi_u32_b32 v250, -1, v250
    v_lshlrev_b32 v250, 2, v250
    s_mov_b32 s21, 0x40000
main_kernel_a_d0:
    buffer_load_dword v251, v250, s[44:47], 0 offen sc1
    s_waitcnt vmcnt(0)
    v_mov_b32 v249, 0
    v_lshrrev_b32 v248, 2, v250
    v_cmp_le_u32 vcc, 18, v248
    v_cmp_ge_u32 s[22:23], 18, v248
    s_nop 0
    s_and_b64 vcc, vcc, s[22:23]
    v_mov_b32 v247, 128
    v_cndmask_b32 v249, v249, v247, vcc
    v_cmp_le_u32 vcc, 19, v248
    v_cmp_ge_u32 s[22:23], 19, v248
    s_nop 0
    s_and_b64 vcc, vcc, s[22:23]
    v_mov_b32 v247, 256
    v_cndmask_b32 v249, v249, v247, vcc
    v_cmp_le_u32 vcc, 20, v248
    v_cmp_ge_u32 s[22:23], 20, v248
    s_nop 0
    s_and_b64 vcc, vcc, s[22:23]
    v_mov_b32 v247, 32
    v_cndmask_b32 v249, v249, v247, vcc
    v_cmp_le_u32 vcc, 24, v248
    v_cmp_ge_u32 s[22:23], 33, v248
    s_nop 0
    s_and_b64 vcc, vcc, s[22:23]
    v_mov_b32 v247, 64
    v_cndmask_b32 v249, v249, v247, vcc
    v_cmp_le_u32 vcc, 34, v248
    v_cmp_ge_u32 s[22:23], 43, v248
    s_nop 0
    s_and_b64 vcc, vcc, s[22:23]
    v_mov_b32 v247, 32
    v_cndmask_b32 v249, v249, v247, vcc
    v_cmp_lt_u32 vcc, v251, v249
    s_nop 0
    s_cmp_eq_u64 vcc, 0
    s_cselect_b32 s97, 1, 0
    s_cbranch_scc1 main_kernel_a_d0_ok
    s_mov_b32 s27, 1
    s_add_u32 s24, s18, 24
    s_add_u32 s25, s18, 34
    v_readlane_b32 s22, v251, 20
    s_nop 0
    s_cmp_ge_u32 s22, 32
    s_cselect_b32 s27, s27, 0
    v_readlane_b32 s22, v251, s24
    s_nop 0
    s_cmp_ge_u32 s22, 64
    s_cselect_b32 s27, s27, 0
    v_readlane_b32 s22, v251, s25
    s_nop 0
    s_cmp_ge_u32 s22, 32
    s_cselect_b32 s27, s27, 0
    s_cmp_eq_u32 s27, 1
    s_cbranch_scc1 main_kernel_a_d0_ok
    s_sleep 40
    s_sub_u32 s21, s21, 1
    s_cbranch_scc0 main_kernel_a_d0
main_kernel_a_d0_ok:
    s_barrier
    s_lshl_b32 s16, s12, 5
    s_lshl_b32 s17, s13, 2
    s_add_u32 s16, s16, s17
    s_add_u32 s16, s16, s48
    s_lshl_b32 s36, s16, 13
    s_add_u32 s37, s36, 0x1000000
    s_add_u32 s38, s36, 0x2000000
    s_add_u32 s41, s36, 0x6000000
    s_lshl_b32 s39, s16, 12
    s_add_u32 s40, s39, 0x3800000
    s_add_u32 s39, s39, 0x3000000
    buffer_load_dwordx4 a[128:131], v152, s[4:7], s38 offen offset:0
    buffer_load_dwordx4 a[132:135], v152, s[4:7], s38 offen offset:1024
    buffer_load_dwordx4 a[136:139], v152, s[4:7], s38 offen offset:2048
    buffer_load_dwordx4 a[140:143], v152, s[4:7], s38 offen offset:3072
    s_add_u32 s17, s38, 4096
    buffer_load_dwordx4 a[144:147], v152, s[4:7], s17 offen offset:0
    s_add_u32 s17, s38, 4096
    buffer_load_dwordx4 a[148:151], v152, s[4:7], s17 offen offset:1024
    s_add_u32 s17, s38, 4096
    buffer_load_dwordx4 a[152:155], v152, s[4:7], s17 offen offset:2048
    s_add_u32 s17, s38, 4096
    buffer_load_dwordx4 a[156:159], v152, s[4:7], s17 offen offset:3072
    buffer_load_dwordx4 a[160:163], v152, s[4:7], s36 offen offset:0
    buffer_load_dwordx4 a[164:167], v152, s[4:7], s36 offen offset:1024
    buffer_load_dwordx4 a[168:171], v152, s[4:7], s36 offen offset:2048
    buffer_load_dwordx4 a[172:175], v152, s[4:7], s36 offen offset:3072
    s_add_u32 s17, s36, 4096
    buffer_load_dwordx4 a[176:179], v152, s[4:7], s17 offen offset:0
    s_add_u32 s17, s36, 4096
    buffer_load_dwordx4 a[180:183], v152, s[4:7], s17 offen offset:1024
    s_add_u32 s17, s36, 4096
    buffer_load_dwordx4 a[184:187], v152, s[4:7], s17 offen offset:2048
    s_add_u32 s17, s36, 4096
    buffer_load_dwordx4 a[188:191], v152, s[4:7], s17 offen offset:3072
    buffer_load_dwordx4 a[208:211], v152, s[4:7], s37 offen offset:0
    buffer_load_dwordx4 a[212:215], v152, s[4:7], s37 offen offset:1024
    buffer_load_dwordx4 a[216:219], v152, s[4:7], s37 offen offset:2048
    buffer_load_dwordx4 a[220:223], v152, s[4:7], s37 offen offset:3072
    s_add_u32 s17, s37, 4096
    buffer_load_dwordx4 a[224:227], v152, s[4:7], s17 offen offset:0
    s_add_u32 s17, s37, 4096
    buffer_load_dwordx4 a[228:231], v152, s[4:7], s17 offen offset:1024
    s_add_u32 s17, s37, 4096
    buffer_load_dwordx4 a[232:235], v152, s[4:7], s17 offen offset:2048
    s_add_u32 s17, s37, 4096
    buffer_load_dwordx4 a[236:239], v152, s[4:7], s17 offen offset:3072
    v_and_b32 v3, 15, v2
    v_lshrrev_b32 v4, 4, v2
    v_lshlrev_b32 v4, 2, v4
    v_mov_b32 v5, 0xff800000
    v_mov_b32 v6, 0
    v_add_u32 v7, 0, v4
    v_cmp_le_u32 vcc, v7, v3
    s_nop 1
    v_cndmask_b32 v148, v5, v6, vcc
    v_add_u32 v7, 1, v4
    v_cmp_le_u32 vcc, v7, v3
    s_nop 1
    v_cndmask_b32 v149, v5, v6, vcc
    v_add_u32 v7, 2, v4
    v_cmp_le_u32 vcc, v7, v3
    s_nop 1
    v_cndmask_b32 v150, v5, v6, vcc
    v_add_u32 v7, 3, v4
    v_cmp_le_u32 vcc, v7, v3
    s_nop 1
    v_cndmask_b32 v151, v5, v6, vcc
    s_cmp_lg_u32 s48, 0
    s_cbranch_scc1 main_kernel_a_d1_ok
    s_mov_b64 exec, 1
    s_and_b32 s22, s2, 31
    s_lshl_b32 s22, s22, 7
    s_add_u32 s22, s22, 0x4300000
    v_mov_b32 v250, s22
    s_lshl_b32 s22, s12, 7
    s_add_u32 s22, s22, 0x4301000
    v_mov_b32 v249, s22
    v_mov_b32 v248, 84
    s_mov_b32 s21, 0x40000
    s_add_u32 s23, s12, 1
    s_min_u32 s24, s23, 63
main_kernel_a_d1_p:
    s_cmp_ge_u32 s96, s24
    s_cbranch_scc1 main_kernel_a_d1_p2
    buffer_load_dword v251, v250, s[4:7], 0 offen sc1
    s_waitcnt vmcnt(0)
    v_readfirstlane_b32 s96, v251
    s_nop 0
    s_cmp_ge_u32 s96, s24
    s_cbranch_scc1 main_kernel_a_d1_p2
    s_sub_u32 s22, s24, s96
main_kernel_a_d1_bk:
    s_cmp_lt_u32 s22, 2
    s_cbranch_scc1 main_kernel_a_d1_bke
    s_sleep 56
    s_sub_u32 s22, s22, 1
    s_branch main_kernel_a_d1_bk
main_kernel_a_d1_bke:
    s_sleep 10
    s_sub_u32 s21, s21, 1
    s_cbranch_scc0 main_kernel_a_d1_p
main_kernel_a_d1_p2:
    s_cmp_lt_u32 s12, 63
    s_cbranch_scc1 main_kernel_a_d1_done
    buffer_load_dword v251, v248, s[44:47], 0 offen sc1
    s_waitcnt vmcnt(0)
    v_readfirstlane_b32 s22, v251
    s_nop 0
    s_cmp_ge_u32 s22, 32
    s_cbranch_scc1 main_kernel_a_d1_done
    s_sleep 10
    s_sub_u32 s21, s21, 1
    s_cbranch_scc0 main_kernel_a_d1_p2
main_kernel_a_d1_done:
    s_mov_b64 exec, -1
main_kernel_a_d1_ok:
    s_barrier
    buffer_load_dwordx4 a[192:195], v152, s[4:7], s39 offen offset:0
    buffer_load_dwordx4 a[196:199], v152, s[4:7], s39 offen offset:1024
    buffer_load_dwordx4 a[200:203], v152, s[4:7], s39 offen offset:2048
    buffer_load_dwordx4 a[204:207], v152, s[4:7], s39 offen offset:3072
    buffer_load_dwordx4 a[240:243], v152, s[4:7], s40 offen offset:0
    buffer_load_dwordx4 a[244:247], v152, s[4:7], s40 offen offset:1024
    buffer_load_dwordx4 a[248:251], v152, s[4:7], s40 offen offset:2048
    buffer_load_dwordx4 a[252:255], v152, s[4:7], s40 offen offset:3072
    s_mov_b32 s27, 0x3e0293ee
    s_waitcnt vmcnt(8)
    v_mfma_f32_16x16x32_bf16 v[68:71], a[160:163], a[128:131], 0
    v_mfma_f32_16x16x32_bf16 v[68:71], a[164:167], a[132:135], v[68:71]
    v_mfma_f32_16x16x32_bf16 v[68:71], a[168:171], a[136:139], v[68:71]
    v_mfma_f32_16x16x32_bf16 v[68:71], a[172:175], a[140:143], v[68:71]
    s_waitcnt vmcnt(4)
    v_mfma_f32_16x16x32_bf16 v[64:67], a[192:195], a[128:131], 0
    v_mfma_f32_16x16x32_bf16 v[64:67], a[196:199], a[132:135], v[64:67]
    v_mfma_f32_16x16x32_bf16 v[64:67], a[200:203], a[136:139], v[64:67]
    v_mfma_f32_16x16x32_bf16 v[64:67], a[204:207], a[140:143], v[64:67]
    s_nop 2
    v_add_f32 v68, v68, v148
    v_add_f32 v69, v69, v149
    v_add_f32 v70, v70, v150
    v_add_f32 v71, v71, v151
    v_max3_f32 v153, v68, v69, v70
    v_max3_f32 v154, v71, v64, v65
    v_max_f32 v153, v153, v154
    v_mov_b32 v154, v153
    s_nop 1
    v_permlane32_swap_b32 v153, v154
    v_max_f32 v153, v153, v154
    v_mov_b32 v154, v153
    s_nop 1
    v_permlane16_swap_b32 v153, v154
    v_max_f32 v153, v153, v154
    v_mul_f32 v153, s27, v153
    v_fma_f32 v64, v64, s27, -v153
    v_fma_f32 v65, v65, s27, -v153
    v_fma_f32 v68, v68, s27, -v153
    v_fma_f32 v69, v69, s27, -v153
    v_fma_f32 v70, v70, s27, -v153
    v_fma_f32 v71, v71, s27, -v153
    v_exp_f32 v64, v64
    v_exp_f32 v65, v65
    v_exp_f32 v68, v68
    v_exp_f32 v69, v69
    v_exp_f32 v70, v70
    v_exp_f32 v71, v71
    v_add_f32 v155, v64, v65
    v_add_f32 v155, v155, v68
    v_add_f32 v155, v155, v69
    v_add_f32 v155, v155, v70
    v_add_f32 v155, v155, v71
    v_cvt_pk_bf16_f32 v80, v64, v65
    v_cvt_pk_bf16_f32 v81, v64, v65
    v_cvt_pk_bf16_f32 v76, v68, v69
    v_cvt_pk_bf16_f32 v77, v70, v71
    v_mov_b64 v[78:79], 0
    v_mov_b32 v154, v155
    s_waitcnt vmcnt(0)
    v_mfma_f32_16x16x16_bf16 v[84:87], a[240:241], v[80:81], 0
    v_permlane32_swap_b32 v155, v154
    v_add_f32 v155, v155, v154
    v_mov_b32 v154, v155
    v_mfma_f32_16x16x16_bf16 v[88:91], a[242:243], v[80:81], 0
    v_mfma_f32_16x16x16_bf16 v[92:95], a[244:245], v[80:81], 0
    v_permlane16_swap_b32 v155, v154
    v_add_f32 v155, v155, v154
    v_rcp_f32 v155, v155
    v_mfma_f32_16x16x16_bf16 v[96:99], a[246:247], v[80:81], 0
    v_mfma_f32_16x16x16_bf16 v[100:103], a[248:249], v[80:81], 0
    v_mfma_f32_16x16x16_bf16 v[104:107], a[250:251], v[80:81], 0
    v_mfma_f32_16x16x16_bf16 v[108:111], a[252:253], v[80:81], 0
    v_mfma_f32_16x16x16_bf16 v[112:115], a[254:255], v[80:81], 0
    v_mfma_f32_16x16x32_bf16 v[84:87], a[208:211], v[76:79], v[84:87]
    v_mfma_f32_16x16x32_bf16 v[88:91], a[212:215], v[76:79], v[88:91]
    v_mfma_f32_16x16x32_bf16 v[92:95], a[216:219], v[76:79], v[92:95]
    v_mfma_f32_16x16x32_bf16 v[96:99], a[220:223], v[76:79], v[96:99]
    v_mfma_f32_16x16x32_bf16 v[100:103], a[224:227], v[76:79], v[100:103]
    v_mfma_f32_16x16x32_bf16 v[104:107], a[228:231], v[76:79], v[104:107]
    v_mfma_f32_16x16x32_bf16 v[108:111], a[232:235], v[76:79], v[108:111]
    v_mfma_f32_16x16x32_bf16 v[112:115], a[236:239], v[76:79], v[112:115]
    s_nop 0
    v_mul_f32 v84, v84, v155
    v_mul_f32 v85, v85, v155
    v_mul_f32 v86, v86, v155
    v_mul_f32 v87, v87, v155
    v_cvt_pk_bf16_f32 v116, v84, v85
    v_cvt_pk_bf16_f32 v117, v86, v87
    v_mul_f32 v88, v88, v155
    v_mul_f32 v89, v89, v155
    v_mul_f32 v90, v90, v155
    v_mul_f32 v91, v91, v155
    v_cvt_pk_bf16_f32 v118, v88, v89
    v_cvt_pk_bf16_f32 v119, v90, v91
    buffer_store_dwordx4 v[116:119], v152, s[4:7], s41 offen offset:0 sc1
    v_mul_f32 v92, v92, v155
    v_mul_f32 v93, v93, v155
    v_mul_f32 v94, v94, v155
    v_mul_f32 v95, v95, v155
    v_cvt_pk_bf16_f32 v120, v92, v93
    v_cvt_pk_bf16_f32 v121, v94, v95
    v_mul_f32 v96, v96, v155
    v_mul_f32 v97, v97, v155
    v_mul_f32 v98, v98, v155
    v_mul_f32 v99, v99, v155
    v_cvt_pk_bf16_f32 v122, v96, v97
    v_cvt_pk_bf16_f32 v123, v98, v99
    buffer_store_dwordx4 v[120:123], v152, s[4:7], s41 offen offset:1024 sc1
    v_mul_f32 v100, v100, v155
    v_mul_f32 v101, v101, v155
    v_mul_f32 v102, v102, v155
    v_mul_f32 v103, v103, v155
    v_cvt_pk_bf16_f32 v124, v100, v101
    v_cvt_pk_bf16_f32 v125, v102, v103
    v_mul_f32 v104, v104, v155
    v_mul_f32 v105, v105, v155
    v_mul_f32 v106, v106, v155
    v_mul_f32 v107, v107, v155
    v_cvt_pk_bf16_f32 v126, v104, v105
    v_cvt_pk_bf16_f32 v127, v106, v107
    buffer_store_dwordx4 v[124:127], v152, s[4:7], s41 offen offset:2048 sc1
    v_mul_f32 v108, v108, v155
    v_mul_f32 v109, v109, v155
    v_mul_f32 v110, v110, v155
    v_mul_f32 v111, v111, v155
    v_cvt_pk_bf16_f32 v128, v108, v109
    v_cvt_pk_bf16_f32 v129, v110, v111
    v_mul_f32 v112, v112, v155
    v_mul_f32 v113, v113, v155
    v_mul_f32 v114, v114, v155
    v_mul_f32 v115, v115, v155
    v_cvt_pk_bf16_f32 v130, v112, v113
    v_cvt_pk_bf16_f32 v131, v114, v115
    buffer_store_dwordx4 v[128:131], v152, s[4:7], s41 offen offset:3072 sc1
    s_add_u32 s41, s41, 4096
    v_mfma_f32_16x16x32_bf16 v[68:71], a[160:163], a[144:147], 0
    v_mfma_f32_16x16x32_bf16 v[72:75], a[176:179], a[144:147], 0
    v_mfma_f32_16x16x32_bf16 v[68:71], a[164:167], a[148:151], v[68:71]
    v_mfma_f32_16x16x32_bf16 v[72:75], a[180:183], a[148:151], v[72:75]
    v_mfma_f32_16x16x32_bf16 v[68:71], a[168:171], a[152:155], v[68:71]
    v_mfma_f32_16x16x32_bf16 v[72:75], a[184:187], a[152:155], v[72:75]
    v_mfma_f32_16x16x32_bf16 v[68:71], a[172:175], a[156:159], v[68:71]
    v_mfma_f32_16x16x32_bf16 v[72:75], a[188:191], a[156:159], v[72:75]
    v_mfma_f32_16x16x32_bf16 v[64:67], a[192:195], a[144:147], 0
    v_mfma_f32_16x16x32_bf16 v[64:67], a[196:199], a[148:151], v[64:67]
    v_mfma_f32_16x16x32_bf16 v[64:67], a[200:203], a[152:155], v[64:67]
    v_mfma_f32_16x16x32_bf16 v[64:67], a[204:207], a[156:159], v[64:67]
    s_nop 3
    v_add_f32 v72, v72, v148
    v_add_f32 v73, v73, v149
    v_add_f32 v74, v74, v150
    v_add_f32 v75, v75, v151
    v_max3_f32 v153, v68, v69, v70
    v_max3_f32 v153, v72, v73, v153
    v_max3_f32 v153, v74, v75, v153
    v_max3_f32 v154, v71, v64, v65
    v_max_f32 v153, v153, v154
    v_mov_b32 v154, v153
    s_nop 1
    v_permlane32_swap_b32 v153, v154
    v_max_f32 v153, v153, v154
    v_mov_b32 v154, v153
    s_nop 1
    v_permlane16_swap_b32 v153, v154
    v_max_f32 v153, v153, v154
    v_mul_f32 v153, s27, v153
    v_fma_f32 v64, v64, s27, -v153
    v_fma_f32 v65, v65, s27, -v153
    v_fma_f32 v68, v68, s27, -v153
    v_fma_f32 v69, v69, s27, -v153
    v_fma_f32 v70, v70, s27, -v153
    v_fma_f32 v71, v71, s27, -v153
    v_fma_f32 v72, v72, s27, -v153
    v_fma_f32 v73, v73, s27, -v153
    v_fma_f32 v74, v74, s27, -v153
    v_fma_f32 v75, v75, s27, -v153
    v_exp_f32 v64, v64
    v_exp_f32 v65, v65
    v_exp_f32 v68, v68
    v_exp_f32 v69, v69
    v_exp_f32 v70, v70
    v_exp_f32 v71, v71
    v_exp_f32 v72, v72
    v_exp_f32 v73, v73
    v_exp_f32 v74, v74
    v_exp_f32 v75, v75
    v_add_f32 v155, v64, v65
    v_add_f32 v155, v155, v68
    v_add_f32 v155, v155, v69
    v_add_f32 v155, v155, v70
    v_add_f32 v155, v155, v71
    v_add_f32 v155, v155, v72
    v_add_f32 v155, v155, v73
    v_add_f32 v155, v155, v74
    v_add_f32 v155, v155, v75
    v_cvt_pk_bf16_f32 v80, v64, v65
    v_cvt_pk_bf16_f32 v81, v64, v65
    v_cvt_pk_bf16_f32 v76, v68, v69
    v_cvt_pk_bf16_f32 v77, v70, v71
    v_cvt_pk_bf16_f32 v78, v72, v73
    v_cvt_pk_bf16_f32 v79, v74, v75
    v_mov_b32 v154, v155
    v_mfma_f32_16x16x16_bf16 v[84:87], a[240:241], v[80:81], 0
    s_nop 0
    v_permlane32_swap_b32 v155, v154
    v_add_f32 v155, v155, v154
    v_mov_b32 v154, v155
    v_mfma_f32_16x16x16_bf16 v[88:91], a[242:243], v[80:81], 0
    v_mfma_f32_16x16x16_bf16 v[92:95], a[244:245], v[80:81], 0
    v_permlane16_swap_b32 v155, v154
    v_add_f32 v155, v155, v154
    v_rcp_f32 v155, v155
    v_mfma_f32_16x16x16_bf16 v[96:99], a[246:247], v[80:81], 0
    v_mfma_f32_16x16x16_bf16 v[100:103], a[248:249], v[80:81], 0
    v_mfma_f32_16x16x16_bf16 v[104:107], a[250:251], v[80:81], 0
    v_mfma_f32_16x16x16_bf16 v[108:111], a[252:253], v[80:81], 0
    v_mfma_f32_16x16x16_bf16 v[112:115], a[254:255], v[80:81], 0
    v_mfma_f32_16x16x32_bf16 v[84:87], a[208:211], v[76:79], v[84:87]
    v_mfma_f32_16x16x32_bf16 v[88:91], a[212:215], v[76:79], v[88:91]
    v_mfma_f32_16x16x32_bf16 v[92:95], a[216:219], v[76:79], v[92:95]
    v_mfma_f32_16x16x32_bf16 v[96:99], a[220:223], v[76:79], v[96:99]
    v_mfma_f32_16x16x32_bf16 v[100:103], a[224:227], v[76:79], v[100:103]
    v_mfma_f32_16x16x32_bf16 v[104:107], a[228:231], v[76:79], v[104:107]
    v_mfma_f32_16x16x32_bf16 v[108:111], a[232:235], v[76:79], v[108:111]
    v_mfma_f32_16x16x32_bf16 v[112:115], a[236:239], v[76:79], v[112:115]
    s_nop 0
    v_mul_f32 v84, v84, v155
    v_mul_f32 v85, v85, v155
    v_mul_f32 v86, v86, v155
    v_mul_f32 v87, v87, v155
    v_cvt_pk_bf16_f32 v132, v84, v85
    v_cvt_pk_bf16_f32 v133, v86, v87
    v_mul_f32 v88, v88, v155
    v_mul_f32 v89, v89, v155
    v_mul_f32 v90, v90, v155
    v_mul_f32 v91, v91, v155
    v_cvt_pk_bf16_f32 v134, v88, v89
    v_cvt_pk_bf16_f32 v135, v90, v91
    buffer_store_dwordx4 v[132:135], v152, s[4:7], s41 offen offset:0 sc1
    v_mul_f32 v92, v92, v155
    v_mul_f32 v93, v93, v155
    v_mul_f32 v94, v94, v155
    v_mul_f32 v95, v95, v155
    v_cvt_pk_bf16_f32 v136, v92, v93
    v_cvt_pk_bf16_f32 v137, v94, v95
    v_mul_f32 v96, v96, v155
    v_mul_f32 v97, v97, v155
    v_mul_f32 v98, v98, v155
    v_mul_f32 v99, v99, v155
    v_cvt_pk_bf16_f32 v138, v96, v97
    v_cvt_pk_bf16_f32 v139, v98, v99
    buffer_store_dwordx4 v[136:139], v152, s[4:7], s41 offen offset:1024 sc1
    v_mul_f32 v100, v100, v155
    v_mul_f32 v101, v101, v155
    v_mul_f32 v102, v102, v155
    v_mul_f32 v103, v103, v155
    v_cvt_pk_bf16_f32 v140, v100, v101
    v_cvt_pk_bf16_f32 v141, v102, v103
    v_mul_f32 v104, v104, v155
    v_mul_f32 v105, v105, v155
    v_mul_f32 v106, v106, v155
    v_mul_f32 v107, v107, v155
    v_cvt_pk_bf16_f32 v142, v104, v105
    v_cvt_pk_bf16_f32 v143, v106, v107
    buffer_store_dwordx4 v[140:143], v152, s[4:7], s41 offen offset:2048 sc1
    v_mul_f32 v108, v108, v155
    v_mul_f32 v109, v109, v155
    v_mul_f32 v110, v110, v155
    v_mul_f32 v111, v111, v155
    v_cvt_pk_bf16_f32 v144, v108, v109
    v_cvt_pk_bf16_f32 v145, v110, v111
    v_mul_f32 v112, v112, v155
    v_mul_f32 v113, v113, v155
    v_mul_f32 v114, v114, v155
    v_mul_f32 v115, v115, v155
    v_cvt_pk_bf16_f32 v146, v112, v113
    v_cvt_pk_bf16_f32 v147, v114, v115
    buffer_store_dwordx4 v[144:147], v152, s[4:7], s41 offen offset:3072 sc1
    s_add_u32 s41, s41, 4096
    s_branch main_kernel_sig
main_kernel_t_b:
    s_sub_u32 s13, s13, 8
    s_mov_b32 s92, 50
    v_and_b32 v2, 63, v0
    v_lshlrev_b32 v4, 4, v2
    s_load_dwordx2 s[28:29], s[0:1], 128
    s_load_dwordx2 s[30:31], s[0:1], 136
    s_mov_b32 s8, s52
    s_and_b32 s9, s53, 0xffff
    s_mov_b32 s10, 0x200000
    s_mov_b32 s11, 0x00020000
    s_waitcnt lgkmcnt(0)
    s_mov_b32 s36, s28
    s_and_b32 s37, s29, 0xffff
    s_mov_b32 s38, 0x400
    s_mov_b32 s39, 0x00020000
    s_mov_b32 s32, s30
    s_and_b32 s33, s31, 0xffff
    s_mov_b32 s34, 0x200000
    s_mov_b32 s35, 0x00020000
    s_cmp_lg_u32 s48, 0
    s_cbranch_scc1 main_kernel_b_d0_ok
    s_cmp_eq_u32 s97, 1
    s_cbranch_scc1 main_kernel_b_d0_ok
    v_mbcnt_lo_u32_b32 v250, -1, 0
    v_mbcnt_hi_u32_b32 v250, -1, v250
    v_lshlrev_b32 v250, 2, v250
    s_mov_b32 s21, 0x40000
main_kernel_b_d0:
    buffer_load_dword v251, v250, s[44:47], 0 offen sc1
    s_waitcnt vmcnt(0)
    v_mov_b32 v249, 0
    v_lshrrev_b32 v248, 2, v250
    v_cmp_le_u32 vcc, 18, v248
    v_cmp_ge_u32 s[22:23], 18, v248
    s_nop 0
    s_and_b64 vcc, vcc, s[22:23]
    v_mov_b32 v247, 128
    v_cndmask_b32 v249, v249, v247, vcc
    v_cmp_le_u32 vcc, 19, v248
    v_cmp_ge_u32 s[22:23], 19, v248
    s_nop 0
    s_and_b64 vcc, vcc, s[22:23]
    v_mov_b32 v247, 256
    v_cndmask_b32 v249, v249, v247, vcc
    v_cmp_le_u32 vcc, 20, v248
    v_cmp_ge_u32 s[22:23], 20, v248
    s_nop 0
    s_and_b64 vcc, vcc, s[22:23]
    v_mov_b32 v247, 32
    v_cndmask_b32 v249, v249, v247, vcc
    v_cmp_le_u32 vcc, 24, v248
    v_cmp_ge_u32 s[22:23], 33, v248
    s_nop 0
    s_and_b64 vcc, vcc, s[22:23]
    v_mov_b32 v247, 64
    v_cndmask_b32 v249, v249, v247, vcc
    v_cmp_le_u32 vcc, 34, v248
    v_cmp_ge_u32 s[22:23], 43, v248
    s_nop 0
    s_and_b64 vcc, vcc, s[22:23]
    v_mov_b32 v247, 32
    v_cndmask_b32 v249, v249, v247, vcc
    v_cmp_lt_u32 vcc, v251, v249
    s_nop 0
    s_cmp_eq_u64 vcc, 0
    s_cselect_b32 s97, 1, 0
    s_cbranch_scc1 main_kernel_b_d0_ok
    s_mov_b32 s27, 1
    v_readlane_b32 s22, v251, 20
    s_nop 0
    s_cmp_ge_u32 s22, 32
    s_cselect_b32 s27, s27, 0
    v_readlane_b32 s22, v251, 18
    s_nop 0
    s_cmp_ge_u32 s22, 128
    s_cselect_b32 s27, s27, 0
    v_readlane_b32 s22, v251, 19
    s_nop 0
    s_cmp_ge_u32 s22, 256
    s_cselect_b32 s27, s27, 0
    s_cmp_eq_u32 s27, 1
    s_cbranch_scc1 main_kernel_b_d0_ok
    s_sleep 40
    s_sub_u32 s21, s21, 1
    s_cbranch_scc0 main_kernel_b_d0
main_kernel_b_d0_ok:
    s_barrier
    s_lshl_b32 s41, s48, 20
    s_lshl_b32 s16, s13, 11
    s_add_u32 s41, s41, s16
    s_add_u32 s41, s41, 0x4800000
    buffer_load_dwordx4 a[0:3], v4, s[4:7], s41 offen offset:0
    buffer_load_dwordx4 a[4:7], v4, s[4:7], s41 offen offset:1024
    s_add_u32 s41, s41, 0x8000
    buffer_load_dwordx4 a[8:11], v4, s[4:7], s41 offen offset:0
    buffer_load_dwordx4 a[12:15], v4, s[4:7], s41 offen offset:1024
    s_add_u32 s41, s41, 0x8000
    buffer_load_dwordx4 a[16:19], v4, s[4:7], s41 offen offset:0
    buffer_load_dwordx4 a[20:23], v4, s[4:7], s41 offen offset:1024
    s_add_u32 s41, s41, 0x8000
    buffer_load_dwordx4 a[24:27], v4, s[4:7], s41 offen offset:0
    buffer_load_dwordx4 a[28:31], v4, s[4:7], s41 offen offset:1024
    s_add_u32 s41, s41, 0x8000
    buffer_load_dwordx4 a[32:35], v4, s[4:7], s41 offen offset:0
    buffer_load_dwordx4 a[36:39], v4, s[4:7], s41 offen offset:1024
    s_add_u32 s41, s41, 0x8000
    buffer_load_dwordx4 a[40:43], v4, s[4:7], s41 offen offset:0
    buffer_load_dwordx4 a[44:47], v4, s[4:7], s41 offen offset:1024
    s_add_u32 s41, s41, 0x8000
    buffer_load_dwordx4 a[48:51], v4, s[4:7], s41 offen offset:0
    buffer_load_dwordx4 a[52:55], v4, s[4:7], s41 offen offset:1024
    s_add_u32 s41, s41, 0x8000
    buffer_load_dwordx4 a[56:59], v4, s[4:7], s41 offen offset:0
    buffer_load_dwordx4 a[60:63], v4, s[4:7], s41 offen offset:1024
    s_add_u32 s41, s41, 0x8000
    buffer_load_dwordx4 a[64:67], v4, s[4:7], s41 offen offset:0
    buffer_load_dwordx4 a[68:71], v4, s[4:7], s41 offen offset:1024
    s_add_u32 s41, s41, 0x8000
    buffer_load_dwordx4 a[72:75], v4, s[4:7], s41 offen offset:0
    buffer_load_dwordx4 a[76:79], v4, s[4:7], s41 offen offset:1024
    s_add_u32 s41, s41, 0x8000
    buffer_load_dwordx4 a[80:83], v4, s[4:7], s41 offen offset:0
    buffer_load_dwordx4 a[84:87], v4, s[4:7], s41 offen offset:1024
    s_add_u32 s41, s41, 0x8000
    buffer_load_dwordx4 a[88:91], v4, s[4:7], s41 offen offset:0
    buffer_load_dwordx4 a[92:95], v4, s[4:7], s41 offen offset:1024
    s_add_u32 s41, s41, 0x8000
    buffer_load_dwordx4 a[96:99], v4, s[4:7], s41 offen offset:0
    buffer_load_dwordx4 a[100:103], v4, s[4:7], s41 offen offset:1024
    s_add_u32 s41, s41, 0x8000
    buffer_load_dwordx4 a[104:107], v4, s[4:7], s41 offen offset:0
    buffer_load_dwordx4 a[108:111], v4, s[4:7], s41 offen offset:1024
    s_add_u32 s41, s41, 0x8000
    buffer_load_dwordx4 a[112:115], v4, s[4:7], s41 offen offset:0
    buffer_load_dwordx4 a[116:119], v4, s[4:7], s41 offen offset:1024
    s_add_u32 s41, s41, 0x8000
    buffer_load_dwordx4 a[120:123], v4, s[4:7], s41 offen offset:0
    buffer_load_dwordx4 a[124:127], v4, s[4:7], s41 offen offset:1024
    s_add_u32 s41, s41, 0x8000
    buffer_load_dwordx4 a[128:131], v4, s[4:7], s41 offen offset:0
    buffer_load_dwordx4 a[132:135], v4, s[4:7], s41 offen offset:1024
    s_add_u32 s41, s41, 0x8000
    buffer_load_dwordx4 a[136:139], v4, s[4:7], s41 offen offset:0
    buffer_load_dwordx4 a[140:143], v4, s[4:7], s41 offen offset:1024
    s_add_u32 s41, s41, 0x8000
    buffer_load_dwordx4 a[144:147], v4, s[4:7], s41 offen offset:0
    buffer_load_dwordx4 a[148:151], v4, s[4:7], s41 offen offset:1024
    s_add_u32 s41, s41, 0x8000
    buffer_load_dwordx4 a[152:155], v4, s[4:7], s41 offen offset:0
    buffer_load_dwordx4 a[156:159], v4, s[4:7], s41 offen offset:1024
    s_add_u32 s41, s41, 0x8000
    buffer_load_dwordx4 a[160:163], v4, s[4:7], s41 offen offset:0
    buffer_load_dwordx4 a[164:167], v4, s[4:7], s41 offen offset:1024
    s_add_u32 s41, s41, 0x8000
    buffer_load_dwordx4 a[168:171], v4, s[4:7], s41 offen offset:0
    buffer_load_dwordx4 a[172:175], v4, s[4:7], s41 offen offset:1024
    s_add_u32 s41, s41, 0x8000
    buffer_load_dwordx4 a[176:179], v4, s[4:7], s41 offen offset:0
    buffer_load_dwordx4 a[180:183], v4, s[4:7], s41 offen offset:1024
    s_add_u32 s41, s41, 0x8000
    buffer_load_dwordx4 a[184:187], v4, s[4:7], s41 offen offset:0
    buffer_load_dwordx4 a[188:191], v4, s[4:7], s41 offen offset:1024
    s_add_u32 s41, s41, 0x8000
    buffer_load_dwordx4 a[192:195], v4, s[4:7], s41 offen offset:0
    buffer_load_dwordx4 a[196:199], v4, s[4:7], s41 offen offset:1024
    s_add_u32 s41, s41, 0x8000
    buffer_load_dwordx4 a[200:203], v4, s[4:7], s41 offen offset:0
    buffer_load_dwordx4 a[204:207], v4, s[4:7], s41 offen offset:1024
    s_add_u32 s41, s41, 0x8000
    buffer_load_dwordx4 a[208:211], v4, s[4:7], s41 offen offset:0
    buffer_load_dwordx4 a[212:215], v4, s[4:7], s41 offen offset:1024
    s_add_u32 s41, s41, 0x8000
    buffer_load_dwordx4 a[216:219], v4, s[4:7], s41 offen offset:0
    buffer_load_dwordx4 a[220:223], v4, s[4:7], s41 offen offset:1024
    s_add_u32 s41, s41, 0x8000
    buffer_load_dwordx4 a[224:227], v4, s[4:7], s41 offen offset:0
    buffer_load_dwordx4 a[228:231], v4, s[4:7], s41 offen offset:1024
    s_add_u32 s41, s41, 0x8000
    buffer_load_dwordx4 a[232:235], v4, s[4:7], s41 offen offset:0
    buffer_load_dwordx4 a[236:239], v4, s[4:7], s41 offen offset:1024
    s_add_u32 s41, s41, 0x8000
    buffer_load_dwordx4 a[240:243], v4, s[4:7], s41 offen offset:0
    buffer_load_dwordx4 a[244:247], v4, s[4:7], s41 offen offset:1024
    s_add_u32 s41, s41, 0x8000
    buffer_load_dwordx4 a[248:251], v4, s[4:7], s41 offen offset:0
    buffer_load_dwordx4 a[252:255], v4, s[4:7], s41 offen offset:1024
    s_add_u32 s41, s41, 0x8000
    s_barrier
    buffer_load_dwordx4 v[8:11], v4, s[36:39], 0 offen
    s_lshl_b32 s16, s12, 5
    s_lshl_b32 s17, s48, 3
    s_add_u32 s16, s16, s17
    s_lshl_b32 s17, s16, 10
    s_add_u32 s18, s17, 4096
    buffer_load_dwordx4 v[24:27], v4, s[8:11], s17 offen offset:0
    buffer_load_dwordx4 v[28:31], v4, s[8:11], s17 offen offset:1024
    buffer_load_dwordx4 v[32:35], v4, s[8:11], s17 offen offset:2048
    buffer_load_dwordx4 v[36:39], v4, s[8:11], s17 offen offset:3072
    buffer_load_dwordx4 v[40:43], v4, s[8:11], s18 offen offset:0
    buffer_load_dwordx4 v[44:47], v4, s[8:11], s18 offen offset:1024
    buffer_load_dwordx4 v[48:51], v4, s[8:11], s18 offen offset:2048
    buffer_load_dwordx4 v[52:55], v4, s[8:11], s18 offen offset:3072
    v_and_b32 v64, 15, v2
    v_lshrrev_b32 v65, 4, v2
    v_lshlrev_b32 v66, 14, v65
    v_lshl_add_u32 v66, v64, 1, v66
    s_lshl_b32 s42, s13, 17
    s_lshr_b32 s16, s48, 1
    s_lshl_b32 s16, s16, 16
    s_add_u32 s42, s42, s16
    s_lshl_b32 s16, s12, 6
    s_add_u32 s42, s42, s16
    s_and_b32 s16, s48, 1
    s_lshl_b32 s16, s16, 5
    s_add_u32 s42, s42, s16
    s_add_u32 s42, s42, 0x5000000
    buffer_load_ushort v68, v66, s[4:7], s42 offen
    s_add_u32 s42, s42, 4096
    buffer_load_ushort v69, v66, s[4:7], s42 offen
    s_add_u32 s42, s42, 4096
    buffer_load_ushort v70, v66, s[4:7], s42 offen
    s_add_u32 s42, s42, 4096
    buffer_load_ushort v71, v66, s[4:7], s42 offen
    s_add_u32 s42, s42, 4096
    s_waitcnt vmcnt(12)
    v_lshlrev_b32 v12, 16, v8
    v_and_b32 v13, 0xffff0000, v8
    v_lshlrev_b32 v14, 16, v9
    v_and_b32 v15, 0xffff0000, v9
    v_lshlrev_b32 v16, 16, v10
    v_and_b32 v17, 0xffff0000, v10
    v_lshlrev_b32 v18, 16, v11
    v_and_b32 v19, 0xffff0000, v11
    s_mov_b32 s26, 0x3f803f80
    s_waitcnt vmcnt(11)
    v_lshlrev_b32 v20, 16, v24
    v_and_b32 v21, 0xffff0000, v24
    v_mul_f32 v20, v20, v12
    v_mul_f32 v21, v21, v13
    v_cvt_pk_bf16_f32 v20, v20, v21
    v_dot2_f32_bf16 v56, v20, s26, 0
    v_lshlrev_b32 v20, 16, v25
    v_and_b32 v21, 0xffff0000, v25
    v_mul_f32 v20, v20, v14
    v_mul_f32 v21, v21, v15
    v_cvt_pk_bf16_f32 v20, v20, v21
    v_dot2_f32_bf16 v56, v20, s26, v56
    v_lshlrev_b32 v20, 16, v26
    v_and_b32 v21, 0xffff0000, v26
    v_mul_f32 v20, v20, v16
    v_mul_f32 v21, v21, v17
    v_cvt_pk_bf16_f32 v20, v20, v21
    v_dot2_f32_bf16 v56, v20, s26, v56
    v_lshlrev_b32 v20, 16, v27
    v_and_b32 v21, 0xffff0000, v27
    v_mul_f32 v20, v20, v18
    v_mul_f32 v21, v21, v19
    v_cvt_pk_bf16_f32 v20, v20, v21
    v_dot2_f32_bf16 v56, v20, s26, v56
    s_waitcnt vmcnt(10)
    v_lshlrev_b32 v20, 16, v28
    v_and_b32 v21, 0xffff0000, v28
    v_mul_f32 v20, v20, v12
    v_mul_f32 v21, v21, v13
    v_cvt_pk_bf16_f32 v20, v20, v21
    v_dot2_f32_bf16 v57, v20, s26, 0
    v_lshlrev_b32 v20, 16, v29
    v_and_b32 v21, 0xffff0000, v29
    v_mul_f32 v20, v20, v14
    v_mul_f32 v21, v21, v15
    v_cvt_pk_bf16_f32 v20, v20, v21
    v_dot2_f32_bf16 v57, v20, s26, v57
    v_lshlrev_b32 v20, 16, v30
    v_and_b32 v21, 0xffff0000, v30
    v_mul_f32 v20, v20, v16
    v_mul_f32 v21, v21, v17
    v_cvt_pk_bf16_f32 v20, v20, v21
    v_dot2_f32_bf16 v57, v20, s26, v57
    v_lshlrev_b32 v20, 16, v31
    v_and_b32 v21, 0xffff0000, v31
    v_mul_f32 v20, v20, v18
    v_mul_f32 v21, v21, v19
    v_cvt_pk_bf16_f32 v20, v20, v21
    v_dot2_f32_bf16 v57, v20, s26, v57
    s_waitcnt vmcnt(9)
    v_lshlrev_b32 v20, 16, v32
    v_and_b32 v21, 0xffff0000, v32
    v_mul_f32 v20, v20, v12
    v_mul_f32 v21, v21, v13
    v_cvt_pk_bf16_f32 v20, v20, v21
    v_dot2_f32_bf16 v58, v20, s26, 0
    v_lshlrev_b32 v20, 16, v33
    v_and_b32 v21, 0xffff0000, v33
    v_mul_f32 v20, v20, v14
    v_mul_f32 v21, v21, v15
    v_cvt_pk_bf16_f32 v20, v20, v21
    v_dot2_f32_bf16 v58, v20, s26, v58
    v_lshlrev_b32 v20, 16, v34
    v_and_b32 v21, 0xffff0000, v34
    v_mul_f32 v20, v20, v16
    v_mul_f32 v21, v21, v17
    v_cvt_pk_bf16_f32 v20, v20, v21
    v_dot2_f32_bf16 v58, v20, s26, v58
    v_lshlrev_b32 v20, 16, v35
    v_and_b32 v21, 0xffff0000, v35
    v_mul_f32 v20, v20, v18
    v_mul_f32 v21, v21, v19
    v_cvt_pk_bf16_f32 v20, v20, v21
    v_dot2_f32_bf16 v58, v20, s26, v58
    s_waitcnt vmcnt(8)
    v_lshlrev_b32 v20, 16, v36
    v_and_b32 v21, 0xffff0000, v36
    v_mul_f32 v20, v20, v12
    v_mul_f32 v21, v21, v13
    v_cvt_pk_bf16_f32 v20, v20, v21
    v_dot2_f32_bf16 v59, v20, s26, 0
    v_lshlrev_b32 v20, 16, v37
    v_and_b32 v21, 0xffff0000, v37
    v_mul_f32 v20, v20, v14
    v_mul_f32 v21, v21, v15
    v_cvt_pk_bf16_f32 v20, v20, v21
    v_dot2_f32_bf16 v59, v20, s26, v59
    v_lshlrev_b32 v20, 16, v38
    v_and_b32 v21, 0xffff0000, v38
    v_mul_f32 v20, v20, v16
    v_mul_f32 v21, v21, v17
    v_cvt_pk_bf16_f32 v20, v20, v21
    v_dot2_f32_bf16 v59, v20, s26, v59
    v_lshlrev_b32 v20, 16, v39
    v_and_b32 v21, 0xffff0000, v39
    v_mul_f32 v20, v20, v18
    v_mul_f32 v21, v21, v19
    v_cvt_pk_bf16_f32 v20, v20, v21
    v_dot2_f32_bf16 v59, v20, s26, v59
    s_waitcnt vmcnt(7)
    v_lshlrev_b32 v20, 16, v40
    v_and_b32 v21, 0xffff0000, v40
    v_mul_f32 v20, v20, v12
    v_mul_f32 v21, v21, v13
    v_cvt_pk_bf16_f32 v20, v20, v21
    v_dot2_f32_bf16 v60, v20, s26, 0
    v_lshlrev_b32 v20, 16, v41
    v_and_b32 v21, 0xffff0000, v41
    v_mul_f32 v20, v20, v14
    v_mul_f32 v21, v21, v15
    v_cvt_pk_bf16_f32 v20, v20, v21
    v_dot2_f32_bf16 v60, v20, s26, v60
    v_lshlrev_b32 v20, 16, v42
    v_and_b32 v21, 0xffff0000, v42
    v_mul_f32 v20, v20, v16
    v_mul_f32 v21, v21, v17
    v_cvt_pk_bf16_f32 v20, v20, v21
    v_dot2_f32_bf16 v60, v20, s26, v60
    v_lshlrev_b32 v20, 16, v43
    v_and_b32 v21, 0xffff0000, v43
    v_mul_f32 v20, v20, v18
    v_mul_f32 v21, v21, v19
    v_cvt_pk_bf16_f32 v20, v20, v21
    v_dot2_f32_bf16 v60, v20, s26, v60
    s_waitcnt vmcnt(6)
    v_lshlrev_b32 v20, 16, v44
    v_and_b32 v21, 0xffff0000, v44
    v_mul_f32 v20, v20, v12
    v_mul_f32 v21, v21, v13
    v_cvt_pk_bf16_f32 v20, v20, v21
    v_dot2_f32_bf16 v61, v20, s26, 0
    v_lshlrev_b32 v20, 16, v45
    v_and_b32 v21, 0xffff0000, v45
    v_mul_f32 v20, v20, v14
    v_mul_f32 v21, v21, v15
    v_cvt_pk_bf16_f32 v20, v20, v21
    v_dot2_f32_bf16 v61, v20, s26, v61
    v_lshlrev_b32 v20, 16, v46
    v_and_b32 v21, 0xffff0000, v46
    v_mul_f32 v20, v20, v16
    v_mul_f32 v21, v21, v17
    v_cvt_pk_bf16_f32 v20, v20, v21
    v_dot2_f32_bf16 v61, v20, s26, v61
    v_lshlrev_b32 v20, 16, v47
    v_and_b32 v21, 0xffff0000, v47
    v_mul_f32 v20, v20, v18
    v_mul_f32 v21, v21, v19
    v_cvt_pk_bf16_f32 v20, v20, v21
    v_dot2_f32_bf16 v61, v20, s26, v61
    s_waitcnt vmcnt(5)
    v_lshlrev_b32 v20, 16, v48
    v_and_b32 v21, 0xffff0000, v48
    v_mul_f32 v20, v20, v12
    v_mul_f32 v21, v21, v13
    v_cvt_pk_bf16_f32 v20, v20, v21
    v_dot2_f32_bf16 v62, v20, s26, 0
    v_lshlrev_b32 v20, 16, v49
    v_and_b32 v21, 0xffff0000, v49
    v_mul_f32 v20, v20, v14
    v_mul_f32 v21, v21, v15
    v_cvt_pk_bf16_f32 v20, v20, v21
    v_dot2_f32_bf16 v62, v20, s26, v62
    v_lshlrev_b32 v20, 16, v50
    v_and_b32 v21, 0xffff0000, v50
    v_mul_f32 v20, v20, v16
    v_mul_f32 v21, v21, v17
    v_cvt_pk_bf16_f32 v20, v20, v21
    v_dot2_f32_bf16 v62, v20, s26, v62
    v_lshlrev_b32 v20, 16, v51
    v_and_b32 v21, 0xffff0000, v51
    v_mul_f32 v20, v20, v18
    v_mul_f32 v21, v21, v19
    v_cvt_pk_bf16_f32 v20, v20, v21
    v_dot2_f32_bf16 v62, v20, s26, v62
    s_waitcnt vmcnt(4)
    v_lshlrev_b32 v20, 16, v52
    v_and_b32 v21, 0xffff0000, v52
    v_mul_f32 v20, v20, v12
    v_mul_f32 v21, v21, v13
    v_cvt_pk_bf16_f32 v20, v20, v21
    v_dot2_f32_bf16 v63, v20, s26, 0
    v_lshlrev_b32 v20, 16, v53
    v_and_b32 v21, 0xffff0000, v53
    v_mul_f32 v20, v20, v14
    v_mul_f32 v21, v21, v15
    v_cvt_pk_bf16_f32 v20, v20, v21
    v_dot2_f32_bf16 v63, v20, s26, v63
    v_lshlrev_b32 v20, 16, v54
    v_and_b32 v21, 0xffff0000, v54
    v_mul_f32 v20, v20, v16
    v_mul_f32 v21, v21, v17
    v_cvt_pk_bf16_f32 v20, v20, v21
    v_dot2_f32_bf16 v63, v20, s26, v63
    v_lshlrev_b32 v20, 16, v55
    v_and_b32 v21, 0xffff0000, v55
    v_mul_f32 v20, v20, v18
    v_mul_f32 v21, v21, v19
    v_cvt_pk_bf16_f32 v20, v20, v21
    v_dot2_f32_bf16 v63, v20, s26, v63
    s_nop 0
    v_mov_b32_dpp v20, v56 row_ror:1 row_mask:0xf bank_mask:0xf
    v_add_f32 v56, v56, v20
    s_nop 1
    v_mov_b32_dpp v20, v56 row_ror:2 row_mask:0xf bank_mask:0xf
    v_add_f32 v56, v56, v20
    s_nop 1
    v_mov_b32_dpp v20, v56 row_ror:4 row_mask:0xf bank_mask:0xf
    v_add_f32 v56, v56, v20
    s_nop 1
    v_mov_b32_dpp v20, v56 row_ror:8 row_mask:0xf bank_mask:0xf
    v_add_f32 v56, v56, v20
    v_mov_b32 v20, v56
    s_nop 1
    v_permlane32_swap_b32 v56, v20
    v_add_f32 v56, v56, v20
    v_mov_b32 v20, v56
    s_nop 1
    v_permlane16_swap_b32 v56, v20
    v_add_f32 v56, v56, v20
    s_nop 0
    v_mov_b32_dpp v20, v57 row_ror:1 row_mask:0xf bank_mask:0xf
    v_add_f32 v57, v57, v20
    s_nop 1
    v_mov_b32_dpp v20, v57 row_ror:2 row_mask:0xf bank_mask:0xf
    v_add_f32 v57, v57, v20
    s_nop 1
    v_mov_b32_dpp v20, v57 row_ror:4 row_mask:0xf bank_mask:0xf
    v_add_f32 v57, v57, v20
    s_nop 1
    v_mov_b32_dpp v20, v57 row_ror:8 row_mask:0xf bank_mask:0xf
    v_add_f32 v57, v57, v20
    v_mov_b32 v20, v57
    s_nop 1
    v_permlane32_swap_b32 v57, v20
    v_add_f32 v57, v57, v20
    v_mov_b32 v20, v57
    s_nop 1
    v_permlane16_swap_b32 v57, v20
    v_add_f32 v57, v57, v20
    s_nop 0
    v_mov_b32_dpp v20, v58 row_ror:1 row_mask:0xf bank_mask:0xf
    v_add_f32 v58, v58, v20
    s_nop 1
    v_mov_b32_dpp v20, v58 row_ror:2 row_mask:0xf bank_mask:0xf
    v_add_f32 v58, v58, v20
    s_nop 1
    v_mov_b32_dpp v20, v58 row_ror:4 row_mask:0xf bank_mask:0xf
    v_add_f32 v58, v58, v20
    s_nop 1
    v_mov_b32_dpp v20, v58 row_ror:8 row_mask:0xf bank_mask:0xf
    v_add_f32 v58, v58, v20
    v_mov_b32 v20, v58
    s_nop 1
    v_permlane32_swap_b32 v58, v20
    v_add_f32 v58, v58, v20
    v_mov_b32 v20, v58
    s_nop 1
    v_permlane16_swap_b32 v58, v20
    v_add_f32 v58, v58, v20
    s_nop 0
    v_mov_b32_dpp v20, v59 row_ror:1 row_mask:0xf bank_mask:0xf
    v_add_f32 v59, v59, v20
    s_nop 1
    v_mov_b32_dpp v20, v59 row_ror:2 row_mask:0xf bank_mask:0xf
    v_add_f32 v59, v59, v20
    s_nop 1
    v_mov_b32_dpp v20, v59 row_ror:4 row_mask:0xf bank_mask:0xf
    v_add_f32 v59, v59, v20
    s_nop 1
    v_mov_b32_dpp v20, v59 row_ror:8 row_mask:0xf bank_mask:0xf
    v_add_f32 v59, v59, v20
    v_mov_b32 v20, v59
    s_nop 1
    v_permlane32_swap_b32 v59, v20
    v_add_f32 v59, v59, v20
    v_mov_b32 v20, v59
    s_nop 1
    v_permlane16_swap_b32 v59, v20
    v_add_f32 v59, v59, v20
    s_nop 0
    v_mov_b32_dpp v20, v60 row_ror:1 row_mask:0xf bank_mask:0xf
    v_add_f32 v60, v60, v20
    s_nop 1
    v_mov_b32_dpp v20, v60 row_ror:2 row_mask:0xf bank_mask:0xf
    v_add_f32 v60, v60, v20
    s_nop 1
    v_mov_b32_dpp v20, v60 row_ror:4 row_mask:0xf bank_mask:0xf
    v_add_f32 v60, v60, v20
    s_nop 1
    v_mov_b32_dpp v20, v60 row_ror:8 row_mask:0xf bank_mask:0xf
    v_add_f32 v60, v60, v20
    v_mov_b32 v20, v60
    s_nop 1
    v_permlane32_swap_b32 v60, v20
    v_add_f32 v60, v60, v20
    v_mov_b32 v20, v60
    s_nop 1
    v_permlane16_swap_b32 v60, v20
    v_add_f32 v60, v60, v20
    s_nop 0
    v_mov_b32_dpp v20, v61 row_ror:1 row_mask:0xf bank_mask:0xf
    v_add_f32 v61, v61, v20
    s_nop 1
    v_mov_b32_dpp v20, v61 row_ror:2 row_mask:0xf bank_mask:0xf
    v_add_f32 v61, v61, v20
    s_nop 1
    v_mov_b32_dpp v20, v61 row_ror:4 row_mask:0xf bank_mask:0xf
    v_add_f32 v61, v61, v20
    s_nop 1
    v_mov_b32_dpp v20, v61 row_ror:8 row_mask:0xf bank_mask:0xf
    v_add_f32 v61, v61, v20
    v_mov_b32 v20, v61
    s_nop 1
    v_permlane32_swap_b32 v61, v20
    v_add_f32 v61, v61, v20
    v_mov_b32 v20, v61
    s_nop 1
    v_permlane16_swap_b32 v61, v20
    v_add_f32 v61, v61, v20
    s_nop 0
    v_mov_b32_dpp v20, v62 row_ror:1 row_mask:0xf bank_mask:0xf
    v_add_f32 v62, v62, v20
    s_nop 1
    v_mov_b32_dpp v20, v62 row_ror:2 row_mask:0xf bank_mask:0xf
    v_add_f32 v62, v62, v20
    s_nop 1
    v_mov_b32_dpp v20, v62 row_ror:4 row_mask:0xf bank_mask:0xf
    v_add_f32 v62, v62, v20
    s_nop 1
    v_mov_b32_dpp v20, v62 row_ror:8 row_mask:0xf bank_mask:0xf
    v_add_f32 v62, v62, v20
    v_mov_b32 v20, v62
    s_nop 1
    v_permlane32_swap_b32 v62, v20
    v_add_f32 v62, v62, v20
    v_mov_b32 v20, v62
    s_nop 1
    v_permlane16_swap_b32 v62, v20
    v_add_f32 v62, v62, v20
    s_nop 0
    v_mov_b32_dpp v20, v63 row_ror:1 row_mask:0xf bank_mask:0xf
    v_add_f32 v63, v63, v20
    s_nop 1
    v_mov_b32_dpp v20, v63 row_ror:2 row_mask:0xf bank_mask:0xf
    v_add_f32 v63, v63, v20
    s_nop 1
    v_mov_b32_dpp v20, v63 row_ror:4 row_mask:0xf bank_mask:0xf
    v_add_f32 v63, v63, v20
    s_nop 1
    v_mov_b32_dpp v20, v63 row_ror:8 row_mask:0xf bank_mask:0xf
    v_add_f32 v63, v63, v20
    v_mov_b32 v20, v63
    s_nop 1
    v_permlane32_swap_b32 v63, v20
    v_add_f32 v63, v63, v20
    v_mov_b32 v20, v63
    s_nop 1
    v_permlane16_swap_b32 v63, v20
    v_add_f32 v63, v63, v20
    v_mov_b32 v22, v56
    v_cmp_eq_u32 vcc, 1, v2
    s_nop 1
    v_cndmask_b32 v22, v22, v57, vcc
    v_cmp_eq_u32 vcc, 2, v2
    s_nop 1
    v_cndmask_b32 v22, v22, v58, vcc
    v_cmp_eq_u32 vcc, 3, v2
    s_nop 1
    v_cndmask_b32 v22, v22, v59, vcc
    v_cmp_eq_u32 vcc, 4, v2
    s_nop 1
    v_cndmask_b32 v22, v22, v60, vcc
    v_cmp_eq_u32 vcc, 5, v2
    s_nop 1
    v_cndmask_b32 v22, v22, v61, vcc
    v_cmp_eq_u32 vcc, 6, v2
    s_nop 1
    v_cndmask_b32 v22, v22, v62, vcc
    v_cmp_eq_u32 vcc, 7, v2
    s_nop 1
    v_cndmask_b32 v22, v22, v63, vcc
    v_cvt_pk_bf16_f32 v22, v22, v22
    v_and_b32 v22, 0xffff0000, v22
    v_mul_f32 v22, 0xbfb8aa3b, v22
    v_exp_f32 v22, v22
    s_nop 0
    v_add_f32 v22, 1.0, v22
    v_rcp_f32 v22, v22
    s_nop 0
    v_cvt_pk_bf16_f32 v22, v22, v22
    v_and_b32 v22, 0xffff0000, v22
    s_lshl_b32 s16, s48, 5
    s_add_u32 s16, s16, 16384
    v_lshlrev_b32 v23, 2, v2
    v_add_u32 v23, s16, v23
    s_mov_b64 exec, 0xff
    ds_write_b32 v23, v22
    s_mov_b64 exec, -1
    v_lshlrev_b32 v67, 10, v64
    v_lshl_add_u32 v67, v65, 3, v67
    s_lshl_b32 s24, s12, 15
    s_and_b32 s16, s48, 1
    s_lshl_b32 s16, s16, 14
    s_add_u32 s24, s24, s16
    s_lshl_b32 s16, s13, 6
    s_add_u32 s24, s24, s16
    s_lshr_b32 s16, s48, 1
    s_lshl_b32 s16, s16, 5
    s_add_u32 s43, s24, s16
    s_cmp_lg_u32 s48, 0
    s_cbranch_scc1 main_kernel_b_d1_ok
    s_mov_b64 exec, 1
    s_and_b32 s22, s2, 31
    s_lshl_b32 s22, s22, 7
    s_add_u32 s22, s22, 0x4300000
    v_mov_b32 v250, s22
    s_lshl_b32 s22, s12, 7
    s_add_u32 s22, s22, 0x4301000
    v_mov_b32 v249, s22
    v_mov_b32 v248, 84
    s_mov_b32 s21, 0x40000
    s_add_u32 s23, s12, 1
    s_min_u32 s24, s23, 63
main_kernel_b_d1_p:
    s_cmp_ge_u32 s96, s24
    s_cbranch_scc1 main_kernel_b_d1_p2
    buffer_load_dword v251, v250, s[4:7], 0 offen sc1
    s_waitcnt vmcnt(0)
    v_readfirstlane_b32 s96, v251
    s_nop 0
    s_cmp_ge_u32 s96, s24
    s_cbranch_scc1 main_kernel_b_d1_p2
    s_sub_u32 s22, s24, s96
main_kernel_b_d1_bk:
    s_cmp_lt_u32 s22, 2
    s_cbranch_scc1 main_kernel_b_d1_bke
    s_sleep 56
    s_sub_u32 s22, s22, 1
    s_branch main_kernel_b_d1_bk
main_kernel_b_d1_bke:
    s_sleep 10
    s_sub_u32 s21, s21, 1
    s_cbranch_scc0 main_kernel_b_d1_p
main_kernel_b_d1_p2:
    buffer_load_dword v251, v249, s[4:7], 0 offen sc1
    s_waitcnt vmcnt(0)
    v_readfirstlane_b32 s22, v251
    s_nop 0
    s_cmp_ge_u32 s22, 8
    s_cbranch_scc1 main_kernel_b_d1_done
    s_sleep 10
    s_sub_u32 s21, s21, 1
    s_cbranch_scc0 main_kernel_b_d1_p2
main_kernel_b_d1_done:
    s_mov_b64 exec, -1
main_kernel_b_d1_ok:
    s_barrier
    s_lshl_b32 s40, s12, 5
    s_lshl_b32 s16, s48, 3
    s_add_u32 s40, s40, s16
    s_lshl_b32 s40, s40, 13
    s_add_u32 s40, s40, 0x6000000
    buffer_load_dwordx4 v[96:99], v4, s[4:7], s40 offen offset:0
    buffer_load_dwordx4 v[100:103], v4, s[4:7], s40 offen offset:1024
    buffer_load_dwordx4 v[104:107], v4, s[4:7], s40 offen offset:2048
    buffer_load_dwordx4 v[108:111], v4, s[4:7], s40 offen offset:3072
    s_add_u32 s40, s40, 4096
    buffer_load_dwordx4 v[112:115], v4, s[4:7], s40 offen offset:0
    buffer_load_dwordx4 v[116:119], v4, s[4:7], s40 offen offset:1024
    buffer_load_dwordx4 v[120:123], v4, s[4:7], s40 offen offset:2048
    buffer_load_dwordx4 v[124:127], v4, s[4:7], s40 offen offset:3072
    s_add_u32 s40, s40, 4096
    buffer_load_dwordx4 v[128:131], v4, s[4:7], s40 offen offset:0
    buffer_load_dwordx4 v[132:135], v4, s[4:7], s40 offen offset:1024
    buffer_load_dwordx4 v[136:139], v4, s[4:7], s40 offen offset:2048
    buffer_load_dwordx4 v[140:143], v4, s[4:7], s40 offen offset:3072
    s_add_u32 s40, s40, 4096
    buffer_load_dwordx4 v[144:147], v4, s[4:7], s40 offen offset:0
    buffer_load_dwordx4 v[148:151], v4, s[4:7], s40 offen offset:1024
    buffer_load_dwordx4 v[152:155], v4, s[4:7], s40 offen offset:2048
    buffer_load_dwordx4 v[156:159], v4, s[4:7], s40 offen offset:3072
    s_add_u32 s40, s40, 4096
    buffer_load_dwordx4 v[160:163], v4, s[4:7], s40 offen offset:0
    buffer_load_dwordx4 v[164:167], v4, s[4:7], s40 offen offset:1024
    buffer_load_dwordx4 v[168:171], v4, s[4:7], s40 offen offset:2048
    buffer_load_dwordx4 v[172:175], v4, s[4:7], s40 offen offset:3072
    s_add_u32 s40, s40, 4096
    buffer_load_dwordx4 v[176:179], v4, s[4:7], s40 offen offset:0
    buffer_load_dwordx4 v[180:183], v4, s[4:7], s40 offen offset:1024
    buffer_load_dwordx4 v[184:187], v4, s[4:7], s40 offen offset:2048
    buffer_load_dwordx4 v[188:191], v4, s[4:7], s40 offen offset:3072
    s_add_u32 s40, s40, 4096
    buffer_load_dwordx4 v[192:195], v4, s[4:7], s40 offen offset:0
    buffer_load_dwordx4 v[196:199], v4, s[4:7], s40 offen offset:1024
    buffer_load_dwordx4 v[200:203], v4, s[4:7], s40 offen offset:2048
    buffer_load_dwordx4 v[204:207], v4, s[4:7], s40 offen offset:3072
    s_add_u32 s40, s40, 4096
    buffer_load_dwordx4 v[208:211], v4, s[4:7], s40 offen offset:0
    buffer_load_dwordx4 v[212:215], v4, s[4:7], s40 offen offset:1024
    buffer_load_dwordx4 v[216:219], v4, s[4:7], s40 offen offset:2048
    buffer_load_dwordx4 v[220:223], v4, s[4:7], s40 offen offset:3072
    s_add_u32 s40, s40, 4096
    s_waitcnt vmcnt(24)
    v_mfma_f32_16x16x32_bf16 v[72:75], a[0:3], v[96:99], 0
    v_mfma_f32_16x16x32_bf16 v[76:79], a[0:3], v[112:115], 0
    v_mfma_f32_16x16x32_bf16 v[80:83], a[4:7], v[96:99], 0
    v_mfma_f32_16x16x32_bf16 v[84:87], a[4:7], v[112:115], 0
    v_mfma_f32_16x16x32_bf16 v[72:75], a[8:11], v[100:103], v[72:75]
    v_mfma_f32_16x16x32_bf16 v[76:79], a[8:11], v[116:119], v[76:79]
    v_mfma_f32_16x16x32_bf16 v[80:83], a[12:15], v[100:103], v[80:83]
    v_mfma_f32_16x16x32_bf16 v[84:87], a[12:15], v[116:119], v[84:87]
    v_mfma_f32_16x16x32_bf16 v[72:75], a[16:19], v[104:107], v[72:75]
    v_mfma_f32_16x16x32_bf16 v[76:79], a[16:19], v[120:123], v[76:79]
    v_mfma_f32_16x16x32_bf16 v[80:83], a[20:23], v[104:107], v[80:83]
    v_mfma_f32_16x16x32_bf16 v[84:87], a[20:23], v[120:123], v[84:87]
    v_mfma_f32_16x16x32_bf16 v[72:75], a[24:27], v[108:111], v[72:75]
    v_mfma_f32_16x16x32_bf16 v[76:79], a[24:27], v[124:127], v[76:79]
    v_mfma_f32_16x16x32_bf16 v[80:83], a[28:31], v[108:111], v[80:83]
    v_mfma_f32_16x16x32_bf16 v[84:87], a[28:31], v[124:127], v[84:87]
    buffer_load_dwordx4 v[96:99], v4, s[4:7], s40 offen offset:0
    buffer_load_dwordx4 v[100:103], v4, s[4:7], s40 offen offset:1024
    buffer_load_dwordx4 v[104:107], v4, s[4:7], s40 offen offset:2048
    buffer_load_dwordx4 v[108:111], v4, s[4:7], s40 offen offset:3072
    s_add_u32 s40, s40, 4096
    buffer_load_dwordx4 v[112:115], v4, s[4:7], s40 offen offset:0
    buffer_load_dwordx4 v[116:119], v4, s[4:7], s40 offen offset:1024
    buffer_load_dwordx4 v[120:123], v4, s[4:7], s40 offen offset:2048
    buffer_load_dwordx4 v[124:127], v4, s[4:7], s40 offen offset:3072
    s_add_u32 s40, s40, 4096
    s_waitcnt vmcnt(24)
    v_mfma_f32_16x16x32_bf16 v[72:75], a[32:35], v[128:131], v[72:75]
    v_mfma_f32_16x16x32_bf16 v[76:79], a[32:35], v[144:147], v[76:79]
    v_mfma_f32_16x16x32_bf16 v[80:83], a[36:39], v[128:131], v[80:83]
    v_mfma_f32_16x16x32_bf16 v[84:87], a[36:39], v[144:147], v[84:87]
    v_mfma_f32_16x16x32_bf16 v[72:75], a[40:43], v[132:135], v[72:75]
    v_mfma_f32_16x16x32_bf16 v[76:79], a[40:43], v[148:151], v[76:79]
    v_mfma_f32_16x16x32_bf16 v[80:83], a[44:47], v[132:135], v[80:83]
    v_mfma_f32_16x16x32_bf16 v[84:87], a[44:47], v[148:151], v[84:87]
    v_mfma_f32_16x16x32_bf16 v[72:75], a[48:51], v[136:139], v[72:75]
    v_mfma_f32_16x16x32_bf16 v[76:79], a[48:51], v[152:155], v[76:79]
    v_mfma_f32_16x16x32_bf16 v[80:83], a[52:55], v[136:139], v[80:83]
    v_mfma_f32_16x16x32_bf16 v[84:87], a[52:55], v[152:155], v[84:87]
    v_mfma_f32_16x16x32_bf16 v[72:75], a[56:59], v[140:143], v[72:75]
    v_mfma_f32_16x16x32_bf16 v[76:79], a[56:59], v[156:159], v[76:79]
    v_mfma_f32_16x16x32_bf16 v[80:83], a[60:63], v[140:143], v[80:83]
    v_mfma_f32_16x16x32_bf16 v[84:87], a[60:63], v[156:159], v[84:87]
    buffer_load_dwordx4 v[128:131], v4, s[4:7], s40 offen offset:0
    buffer_load_dwordx4 v[132:135], v4, s[4:7], s40 offen offset:1024
    buffer_load_dwordx4 v[136:139], v4, s[4:7], s40 offen offset:2048
    buffer_load_dwordx4 v[140:143], v4, s[4:7], s40 offen offset:3072
    s_add_u32 s40, s40, 4096
    buffer_load_dwordx4 v[144:147], v4, s[4:7], s40 offen offset:0
    buffer_load_dwordx4 v[148:151], v4, s[4:7], s40 offen offset:1024
    buffer_load_dwordx4 v[152:155], v4, s[4:7], s40 offen offset:2048
    buffer_load_dwordx4 v[156:159], v4, s[4:7], s40 offen offset:3072
    s_add_u32 s40, s40, 4096
    s_waitcnt vmcnt(24)
    v_mfma_f32_16x16x32_bf16 v[72:75], a[64:67], v[160:163], v[72:75]
    v_mfma_f32_16x16x32_bf16 v[76:79], a[64:67], v[176:179], v[76:79]
    v_mfma_f32_16x16x32_bf16 v[80:83], a[68:71], v[160:163], v[80:83]
    v_mfma_f32_16x16x32_bf16 v[84:87], a[68:71], v[176:179], v[84:87]
    v_mfma_f32_16x16x32_bf16 v[72:75], a[72:75], v[164:167], v[72:75]
    v_mfma_f32_16x16x32_bf16 v[76:79], a[72:75], v[180:183], v[76:79]
    v_mfma_f32_16x16x32_bf16 v[80:83], a[76:79], v[164:167], v[80:83]
    v_mfma_f32_16x16x32_bf16 v[84:87], a[76:79], v[180:183], v[84:87]
    v_mfma_f32_16x16x32_bf16 v[72:75], a[80:83], v[168:171], v[72:75]
    v_mfma_f32_16x16x32_bf16 v[76:79], a[80:83], v[184:187], v[76:79]
    v_mfma_f32_16x16x32_bf16 v[80:83], a[84:87], v[168:171], v[80:83]
    v_mfma_f32_16x16x32_bf16 v[84:87], a[84:87], v[184:187], v[84:87]
    v_mfma_f32_16x16x32_bf16 v[72:75], a[88:91], v[172:175], v[72:75]
    v_mfma_f32_16x16x32_bf16 v[76:79], a[88:91], v[188:191], v[76:79]
    v_mfma_f32_16x16x32_bf16 v[80:83], a[92:95], v[172:175], v[80:83]
    v_mfma_f32_16x16x32_bf16 v[84:87], a[92:95], v[188:191], v[84:87]
    buffer_load_dwordx4 v[160:163], v4, s[4:7], s40 offen offset:0
    buffer_load_dwordx4 v[164:167], v4, s[4:7], s40 offen offset:1024
    buffer_load_dwordx4 v[168:171], v4, s[4:7], s40 offen offset:2048
    buffer_load_dwordx4 v[172:175], v4, s[4:7], s40 offen offset:3072
    s_add_u32 s40, s40, 4096
    buffer_load_dwordx4 v[176:179], v4, s[4:7], s40 offen offset:0
    buffer_load_dwordx4 v[180:183], v4, s[4:7], s40 offen offset:1024
    buffer_load_dwordx4 v[184:187], v4, s[4:7], s40 offen offset:2048
    buffer_load_dwordx4 v[188:191], v4, s[4:7], s40 offen offset:3072
    s_add_u32 s40, s40, 4096
    s_waitcnt vmcnt(24)
    v_mfma_f32_16x16x32_bf16 v[72:75], a[96:99], v[192:195], v[72:75]
    v_mfma_f32_16x16x32_bf16 v[76:79], a[96:99], v[208:211], v[76:79]
    v_mfma_f32_16x16x32_bf16 v[80:83], a[100:103], v[192:195], v[80:83]
    v_mfma_f32_16x16x32_bf16 v[84:87], a[100:103], v[208:211], v[84:87]
    v_mfma_f32_16x16x32_bf16 v[72:75], a[104:107], v[196:199], v[72:75]
    v_mfma_f32_16x16x32_bf16 v[76:79], a[104:107], v[212:215], v[76:79]
    v_mfma_f32_16x16x32_bf16 v[80:83], a[108:111], v[196:199], v[80:83]
    v_mfma_f32_16x16x32_bf16 v[84:87], a[108:111], v[212:215], v[84:87]
    v_mfma_f32_16x16x32_bf16 v[72:75], a[112:115], v[200:203], v[72:75]
    v_mfma_f32_16x16x32_bf16 v[76:79], a[112:115], v[216:219], v[76:79]
    v_mfma_f32_16x16x32_bf16 v[80:83], a[116:119], v[200:203], v[80:83]
    v_mfma_f32_16x16x32_bf16 v[84:87], a[116:119], v[216:219], v[84:87]
    v_mfma_f32_16x16x32_bf16 v[72:75], a[120:123], v[204:207], v[72:75]
    v_mfma_f32_16x16x32_bf16 v[76:79], a[120:123], v[220:223], v[76:79]
    v_mfma_f32_16x16x32_bf16 v[80:83], a[124:127], v[204:207], v[80:83]
    v_mfma_f32_16x16x32_bf16 v[84:87], a[124:127], v[220:223], v[84:87]
    buffer_load_dwordx4 v[192:195], v4, s[4:7], s40 offen offset:0
    buffer_load_dwordx4 v[196:199], v4, s[4:7], s40 offen offset:1024
    buffer_load_dwordx4 v[200:203], v4, s[4:7], s40 offen offset:2048
    buffer_load_dwordx4 v[204:207], v4, s[4:7], s40 offen offset:3072
    s_add_u32 s40, s40, 4096
    buffer_load_dwordx4 v[208:211], v4, s[4:7], s40 offen offset:0
    buffer_load_dwordx4 v[212:215], v4, s[4:7], s40 offen offset:1024
    buffer_load_dwordx4 v[216:219], v4, s[4:7], s40 offen offset:2048
    buffer_load_dwordx4 v[220:223], v4, s[4:7], s40 offen offset:3072
    s_add_u32 s40, s40, 4096
    s_waitcnt vmcnt(24)
    v_mfma_f32_16x16x32_bf16 v[72:75], a[128:131], v[96:99], v[72:75]
    v_mfma_f32_16x16x32_bf16 v[76:79], a[128:131], v[112:115], v[76:79]
    v_mfma_f32_16x16x32_bf16 v[80:83], a[132:135], v[96:99], v[80:83]
    v_mfma_f32_16x16x32_bf16 v[84:87], a[132:135], v[112:115], v[84:87]
    v_mfma_f32_16x16x32_bf16 v[72:75], a[136:139], v[100:103], v[72:75]
    v_mfma_f32_16x16x32_bf16 v[76:79], a[136:139], v[116:119], v[76:79]
    v_mfma_f32_16x16x32_bf16 v[80:83], a[140:143], v[100:103], v[80:83]
    v_mfma_f32_16x16x32_bf16 v[84:87], a[140:143], v[116:119], v[84:87]
    v_mfma_f32_16x16x32_bf16 v[72:75], a[144:147], v[104:107], v[72:75]
    v_mfma_f32_16x16x32_bf16 v[76:79], a[144:147], v[120:123], v[76:79]
    v_mfma_f32_16x16x32_bf16 v[80:83], a[148:151], v[104:107], v[80:83]
    v_mfma_f32_16x16x32_bf16 v[84:87], a[148:151], v[120:123], v[84:87]
    v_mfma_f32_16x16x32_bf16 v[72:75], a[152:155], v[108:111], v[72:75]
    v_mfma_f32_16x16x32_bf16 v[76:79], a[152:155], v[124:127], v[76:79]
    v_mfma_f32_16x16x32_bf16 v[80:83], a[156:159], v[108:111], v[80:83]
    v_mfma_f32_16x16x32_bf16 v[84:87], a[156:159], v[124:127], v[84:87]
    s_waitcnt vmcnt(16)
    v_mfma_f32_16x16x32_bf16 v[72:75], a[160:163], v[128:131], v[72:75]
    v_mfma_f32_16x16x32_bf16 v[76:79], a[160:163], v[144:147], v[76:79]
    v_mfma_f32_16x16x32_bf16 v[80:83], a[164:167], v[128:131], v[80:83]
    v_mfma_f32_16x16x32_bf16 v[84:87], a[164:167], v[144:147], v[84:87]
    v_mfma_f32_16x16x32_bf16 v[72:75], a[168:171], v[132:135], v[72:75]
    v_mfma_f32_16x16x32_bf16 v[76:79], a[168:171], v[148:151], v[76:79]
    v_mfma_f32_16x16x32_bf16 v[80:83], a[172:175], v[132:135], v[80:83]
    v_mfma_f32_16x16x32_bf16 v[84:87], a[172:175], v[148:151], v[84:87]
    v_mfma_f32_16x16x32_bf16 v[72:75], a[176:179], v[136:139], v[72:75]
    v_mfma_f32_16x16x32_bf16 v[76:79], a[176:179], v[152:155], v[76:79]
    v_mfma_f32_16x16x32_bf16 v[80:83], a[180:183], v[136:139], v[80:83]
    v_mfma_f32_16x16x32_bf16 v[84:87], a[180:183], v[152:155], v[84:87]
    v_mfma_f32_16x16x32_bf16 v[72:75], a[184:187], v[140:143], v[72:75]
    v_mfma_f32_16x16x32_bf16 v[76:79], a[184:187], v[156:159], v[76:79]
    v_mfma_f32_16x16x32_bf16 v[80:83], a[188:191], v[140:143], v[80:83]
    v_mfma_f32_16x16x32_bf16 v[84:87], a[188:191], v[156:159], v[84:87]
    s_waitcnt vmcnt(8)
    v_mfma_f32_16x16x32_bf16 v[72:75], a[192:195], v[160:163], v[72:75]
    v_mfma_f32_16x16x32_bf16 v[76:79], a[192:195], v[176:179], v[76:79]
    v_mfma_f32_16x16x32_bf16 v[80:83], a[196:199], v[160:163], v[80:83]
    v_mfma_f32_16x16x32_bf16 v[84:87], a[196:199], v[176:179], v[84:87]
    v_mfma_f32_16x16x32_bf16 v[72:75], a[200:203], v[164:167], v[72:75]
    v_mfma_f32_16x16x32_bf16 v[76:79], a[200:203], v[180:183], v[76:79]
    v_mfma_f32_16x16x32_bf16 v[80:83], a[204:207], v[164:167], v[80:83]
    v_mfma_f32_16x16x32_bf16 v[84:87], a[204:207], v[180:183], v[84:87]
    v_mfma_f32_16x16x32_bf16 v[72:75], a[208:211], v[168:171], v[72:75]
    v_mfma_f32_16x16x32_bf16 v[76:79], a[208:211], v[184:187], v[76:79]
    v_mfma_f32_16x16x32_bf16 v[80:83], a[212:215], v[168:171], v[80:83]
    v_mfma_f32_16x16x32_bf16 v[84:87], a[212:215], v[184:187], v[84:87]
    v_mfma_f32_16x16x32_bf16 v[72:75], a[216:219], v[172:175], v[72:75]
    v_mfma_f32_16x16x32_bf16 v[76:79], a[216:219], v[188:191], v[76:79]
    v_mfma_f32_16x16x32_bf16 v[80:83], a[220:223], v[172:175], v[80:83]
    v_mfma_f32_16x16x32_bf16 v[84:87], a[220:223], v[188:191], v[84:87]
    s_waitcnt vmcnt(0)
    v_mfma_f32_16x16x32_bf16 v[72:75], a[224:227], v[192:195], v[72:75]
    v_mfma_f32_16x16x32_bf16 v[76:79], a[224:227], v[208:211], v[76:79]
    v_mfma_f32_16x16x32_bf16 v[80:83], a[228:231], v[192:195], v[80:83]
    v_mfma_f32_16x16x32_bf16 v[84:87], a[228:231], v[208:211], v[84:87]
    v_mfma_f32_16x16x32_bf16 v[72:75], a[232:235], v[196:199], v[72:75]
    v_mfma_f32_16x16x32_bf16 v[76:79], a[232:235], v[212:215], v[76:79]
    v_mfma_f32_16x16x32_bf16 v[80:83], a[236:239], v[196:199], v[80:83]
    v_mfma_f32_16x16x32_bf16 v[84:87], a[236:239], v[212:215], v[84:87]
    v_mfma_f32_16x16x32_bf16 v[72:75], a[240:243], v[200:203], v[72:75]
    v_mfma_f32_16x16x32_bf16 v[76:79], a[240:243], v[216:219], v[76:79]
    v_mfma_f32_16x16x32_bf16 v[80:83], a[244:247], v[200:203], v[80:83]
    v_mfma_f32_16x16x32_bf16 v[84:87], a[244:247], v[216:219], v[84:87]
    v_mfma_f32_16x16x32_bf16 v[72:75], a[248:251], v[204:207], v[72:75]
    v_mfma_f32_16x16x32_bf16 v[76:79], a[248:251], v[220:223], v[76:79]
    v_mfma_f32_16x16x32_bf16 v[80:83], a[252:255], v[204:207], v[80:83]
    v_mfma_f32_16x16x32_bf16 v[84:87], a[252:255], v[220:223], v[84:87]
    s_lshl_b32 s16, s48, 12
    v_add_u32 v5, s16, v4
    s_nop 2
    ds_write_b128 v5, v[72:75] offset:0
    ds_write_b128 v5, v[76:79] offset:1024
    ds_write_b128 v5, v[80:83] offset:2048
    ds_write_b128 v5, v[84:87] offset:3072
    s_lshl_b32 s16, s48, 10
    v_add_u32 v5, s16, v4
    s_and_b32 s16, s48, 1
    s_lshl_b32 s16, s16, 6
    s_add_u32 s16, s16, 16384
    v_lshlrev_b32 v90, 2, v64
    v_add_u32 v90, s16, v90
    s_waitcnt lgkmcnt(0)
    s_barrier
    ds_read_b128 v[8:11], v5 offset:0
    ds_read_b128 v[12:15], v5 offset:4096
    ds_read_b128 v[16:19], v5 offset:8192
    ds_read_b128 v[20:23], v5 offset:12288
    ds_read_b32 v76, v90
    v_lshl_or_b32 v68, v69, 16, v68
    v_lshl_or_b32 v69, v71, 16, v70
    s_waitcnt lgkmcnt(0)
    v_sub_f32 v78, 1.0, v76
    v_cvt_pk_bf16_f32 v78, v78, v78
    v_and_b32 v78, 0xffff0000, v78
    v_add_f32 v8, v8, v12
    v_add_f32 v16, v16, v20
    v_add_f32 v9, v9, v13
    v_add_f32 v17, v17, v21
    v_add_f32 v10, v10, v14
    v_add_f32 v18, v18, v22
    v_add_f32 v11, v11, v15
    v_add_f32 v19, v19, v23
    v_add_f32 v8, v8, v16
    v_add_f32 v9, v9, v17
    v_add_f32 v10, v10, v18
    v_add_f32 v11, v11, v19
    v_cvt_pk_bf16_f32 v80, v8, v9
    v_cvt_pk_bf16_f32 v81, v10, v11
    v_lshlrev_b32 v82, 16, v80
    v_and_b32 v83, 0xffff0000, v80
    v_mul_f32 v82, v82, v76
    v_mul_f32 v83, v83, v76
    v_cvt_pk_bf16_f32 v82, v82, v83
    v_lshlrev_b32 v84, 16, v68
    v_and_b32 v85, 0xffff0000, v68
    v_mul_f32 v84, v84, v78
    v_mul_f32 v85, v85, v78
    v_cvt_pk_bf16_f32 v84, v84, v85
    v_lshlrev_b32 v83, 16, v82
    v_and_b32 v82, 0xffff0000, v82
    v_lshlrev_b32 v85, 16, v84
    v_and_b32 v84, 0xffff0000, v84
    v_add_f32 v83, v83, v85
    v_add_f32 v82, v82, v84
    v_cvt_pk_bf16_f32 v86, v83, v82
    v_lshlrev_b32 v82, 16, v81
    v_and_b32 v83, 0xffff0000, v81
    v_mul_f32 v82, v82, v76
    v_mul_f32 v83, v83, v76
    v_cvt_pk_bf16_f32 v82, v82, v83
    v_lshlrev_b32 v84, 16, v69
    v_and_b32 v85, 0xffff0000, v69
    v_mul_f32 v84, v84, v78
    v_mul_f32 v85, v85, v78
    v_cvt_pk_bf16_f32 v84, v84, v85
    v_lshlrev_b32 v83, 16, v82
    v_and_b32 v82, 0xffff0000, v82
    v_lshlrev_b32 v85, 16, v84
    v_and_b32 v84, 0xffff0000, v84
    v_add_f32 v83, v83, v85
    v_add_f32 v82, v82, v84
    v_cvt_pk_bf16_f32 v87, v83, v82
    buffer_store_dwordx2 v[86:87], v67, s[32:35], s43 offen
main_kernel_sig:
    s_waitcnt vmcnt(0)
    s_barrier
    s_cmp_lg_u32 s48, 0
    s_cbranch_scc1 main_kernel_next
    s_mov_b64 exec, 1
    v_mov_b32 v3, 1
    s_cmp_ge_u32 s92, 64
    s_cbranch_scc1 main_kernel_sigws
    s_lshl_b32 s92, s92, 2
    v_mov_b32 v2, s92
    buffer_atomic_add v3, v2, s[44:47], 0 offen
    s_branch main_kernel_sige
main_kernel_sigws:
    v_mov_b32 v2, s92
    buffer_atomic_add v3, v2, s[4:7], 0 offen
main_kernel_sige:
    s_mov_b64 exec, -1
    s_cmp_lt_u32 s86, 32
    s_cbranch_scc1 main_kernel_tochain
    s_cmp_eq_u32 s99, 1
    s_cbranch_scc1 main_kernel_loop
    s_mov_b64 exec, 1
    v_mov_b32 v253, 68
    v_mov_b32 v254, 1
    buffer_atomic_add v254, v253, s[44:47], 0 offen sc0
    s_mov_b64 exec, -1
    s_branch main_kernel_loop
main_kernel_next:
    s_cmp_ge_u32 s86, 32
    s_cbranch_scc1 main_kernel_loop
main_kernel_tochain:
    s_mov_b32 s100, s49
    v_mbcnt_lo_u32_b32 v0, -1, 0
    v_mbcnt_hi_u32_b32 v0, -1, v0
    v_mov_b32 v7, v0
    s_lshl_b32 s16, s48, 6
    v_add_u32 v0, s16, v0
    s_mov_b32 s13, s48
    s_mov_b32 s12, s86
    s_mov_b32 s92, 1
    s_branch main_kernel_chain
main_kernel_exit:
    s_endpgm
.section .rodata,"a"
.p2align 6
.amdhsa_kernel main_kernel
  .amdhsa_next_free_vgpr 512
  .amdhsa_next_free_sgpr 102
  .amdhsa_accum_offset 256
  .amdhsa_group_segment_fixed_size 0
  .amdhsa_kernarg_size 160
  .amdhsa_user_sgpr_count 2
  .amdhsa_user_sgpr_kernarg_segment_ptr 1
  .amdhsa_system_sgpr_workgroup_id_x 1
  .amdhsa_float_denorm_mode_32 3
.end_amdhsa_kernel
```
